```python
import torch

def _softmax(x, axis=-1):
    return torch.softmax(x, dim=axis)
def _gelu(x):
    return torch.nn.functional.gelu(x, approximate="tanh")
def _silu(x):
    return torch.nn.functional.silu(x)
def _sigmoid(x):
    return torch.sigmoid(x)
def _layernorm(x, axis=-1, eps=1e-5):
    m = x.mean(dim=axis, keepdim=True)
    v = x.var(dim=axis, keepdim=True, unbiased=False)
    return (x - m) / torch.sqrt(v + eps)
def _scatter_add(tgt, idx, src, axis=0):
    return tgt.clone().index_add_(axis, idx, src)
def _segment_sum(src, seg, n):
    out = torch.zeros((n,) + src.shape[1:], dtype=src.dtype)
    return out.index_add_(0, seg, src)
def _pad(x, pw):
    flat = tuple(v for pair in reversed(pw) for v in pair)
    return torch.nn.functional.pad(x, flat)

kernel_name = 'concat_heads__gqa_block_cached__gqa_block_cached__near_ridge'

def setup_inputs():

    _w = (lambda a: (lambda t: t.to(torch.bfloat16) if t.is_floating_point() else t)(torch.as_tensor(a)))
    def _A_setup():
        B, Sq, D = 16, 128, 448
        Hq, Hkv, Sk, Dh = 16, 8, 512, 256
        assert Hq % Hkv == 0, (Hq, Hkv)
        return {
            "x": _w((lambda *s: torch.randn(*s, dtype=torch.bfloat16) * 0.8)(B, Sq, D)),
            "k_cache": _w((lambda *s: torch.randn(*s, dtype=torch.bfloat16) * 0.8)(B, Hkv, Sk, Dh)),
            "v_cache": _w((lambda *s: torch.randn(*s, dtype=torch.bfloat16) * 0.05)(B, Hkv, Sk, Dh)),
            "wq": _w((lambda *s: torch.randn(*s, dtype=torch.bfloat16) * 0.8)(D, Hq * Dh) * (D ** -0.5)),
            "wo": _w((lambda *s: torch.randn(*s, dtype=torch.bfloat16) * 0.05)(Hq * Dh, D) * ((Hq * Dh) ** -0.5)),
        }
    _A_in = _A_setup()

    def _B_setup():
        B, Sq, D = 16, 128, 448
        Hq, Hkv, Sk, Dh = 16, 8, 512, 256
        assert Hq % Hkv == 0, (Hq, Hkv)
        return {
            "x": _w((lambda *s: torch.randn(*s, dtype=torch.bfloat16) * 0.8)(B, Sq, D)),
            "k_cache": _w((lambda *s: torch.randn(*s, dtype=torch.bfloat16) * 0.8)(B, Hkv, Sk, Dh)),
            "v_cache": _w((lambda *s: torch.randn(*s, dtype=torch.bfloat16) * 0.05)(B, Hkv, Sk, Dh)),
            "wq": _w((lambda *s: torch.randn(*s, dtype=torch.bfloat16) * 0.8)(D, Hq * Dh) * (D ** -0.5)),
            "wo": _w((lambda *s: torch.randn(*s, dtype=torch.bfloat16) * 0.05)(Hq * Dh, D) * ((Hq * Dh) ** -0.5)),
        }
    _B_in = _B_setup()

    return {
        "A_x": _A_in["x"],
        "A_k_cache": _A_in["k_cache"],
        "A_v_cache": _A_in["v_cache"],
        "A_wq": _A_in["wq"],
        "A_wo": _A_in["wo"],
        "B_x": _B_in["x"],
        "B_k_cache": _B_in["k_cache"],
        "B_v_cache": _B_in["v_cache"],
        "B_wq": _B_in["wq"],
        "B_wo": _B_in["wo"],
    }

def reference(A_x, A_k_cache, A_v_cache, A_wq, A_wo, B_x, B_k_cache, B_v_cache, B_wq, B_wo):
    def _A_ref(x, k_cache, v_cache, wq, wo):
        B, Sq, D = x.shape
        Hq, Dh = 16, 256
        Hkv = k_cache.shape[1]
        rep = Hq // Hkv
        q = (lambda x, *d: x.permute(*d))((x @ wq).reshape(B, Sq, Hq, Dh), 0, 2, 1, 3)
        k = (lambda x, n, axis: torch.repeat_interleave(x, n, dim=axis))(k_cache, rep, axis=1)
        v = (lambda x, n, axis: torch.repeat_interleave(x, n, dim=axis))(v_cache, rep, axis=1)
        scores = torch.einsum("bhqd,bhkd->bhqk", q, k) * (Dh ** -0.5)
        p = _softmax(scores, axis=-1)
        o = torch.einsum("bhqk,bhkd->bhqd", p, v)
        return (lambda x, *d: x.permute(*d))(o, 0, 2, 1, 3).reshape(B, Sq, Hq * Dh) @ wo

    def _B_ref(x, k_cache, v_cache, wq, wo):
        B, Sq, D = x.shape
        Hq, Dh = 16, 256
        Hkv = k_cache.shape[1]
        rep = Hq // Hkv
        q = (lambda x, *d: x.permute(*d))((x @ wq).reshape(B, Sq, Hq, Dh), 0, 2, 1, 3)
        k = (lambda x, n, axis: torch.repeat_interleave(x, n, dim=axis))(k_cache, rep, axis=1)
        v = (lambda x, n, axis: torch.repeat_interleave(x, n, dim=axis))(v_cache, rep, axis=1)
        scores = torch.einsum("bhqd,bhkd->bhqk", q, k) * (Dh ** -0.5)
        p = _softmax(scores, axis=-1)
        o = torch.einsum("bhqk,bhkd->bhqd", p, v)
        return (lambda x, *d: x.permute(*d))(o, 0, 2, 1, 3).reshape(B, Sq, Hq * Dh) @ wo

    a = _A_ref(A_x, A_k_cache, A_v_cache, A_wq, A_wo)
    b = _B_ref(B_x, B_k_cache, B_v_cache, B_wq, B_wo)
    return torch.concatenate([a, b], axis=-1)
```

```asm
; @launch kernel=concat_heads__gqa_block_cached__gqa_block_cached__near_ridge_kernel grid=(256,1,1) block=(256,1,1) lds=163840
; @launch kernel=reduce_out_kernel grid=(224,1,1) block=(256,1,1) lds=0
.amdgcn_target "amdgcn-amd-amdhsa--gfx950"
.text
.globl concat_heads__gqa_block_cached__gqa_block_cached__near_ridge_kernel
.p2align 8
.type concat_heads__gqa_block_cached__gqa_block_cached__near_ridge_kernel,@function
concat_heads__gqa_block_cached__gqa_block_cached__near_ridge_kernel:
  s_cmp_ge_u32 s2, 256
  s_cbranch_scc1 L_end
  s_bfe_u32 s43, s2, 0x10002
  s_and_b32 s41, s2, 3
  s_lshl_b32 s41, s41, 1
  s_bfe_u32 s3, s2, 0x10003
  s_or_b32 s41, s41, s3
  s_lshr_b32 s42, s2, 4
  s_load_dwordx2 s[14:15], s[0:1], 96
  s_mul_i32 s3, s43, 40
  s_add_u32 s0, s0, s3
  s_addc_u32 s1, s1, 0
  s_load_dwordx8 s[4:11], s[0:1], 0
  s_load_dwordx2 s[12:13], s[0:1], 32
  v_and_b32 v240, 63, v0
  v_lshrrev_b32 v241, 6, v0
  s_nop 0
  v_readfirstlane_b32 s40, v241
  v_lshlrev_b32 v227, 4, v240
  s_getpc_b64 s[96:97]
L_pc:
  v_lshlrev_b32 v121, 6, v0
  s_mov_b32 s98, L_text_end-L_pc-4
  s_bfe_u32 s99, s2, 0x30003
  s_mul_i32 s99, s99, 11264
  v_add_u32 v121, s99, v121
  v_min_u32 v121, s98, v121
  global_load_dword v118, v121, s[96:97]
  v_lshrrev_b32 v241, 3, v240
  v_mul_u32_u24 v241, 896, v241
  v_and_b32 v242, 7, v240
  v_lshrrev_b32 v243, 4, v240
  v_xor_b32 v242, v242, v243
  v_lshl_add_u32 v112, v242, 4, v241
  v_xor_b32 v113, 64, v112
  s_mul_i32 s45, s40, 4352
  s_lshl_b32 s46, s40, 15
  s_lshl_b32 s48, s40, 12
  s_add_u32 s48, s48, 33280
  s_mul_i32 s57, s40, 28672
  s_waitcnt lgkmcnt(0)
  s_lshl_b32 s3, s41, 10
  s_add_u32 s28, s10, s3
  s_addc_u32 s29, s11, 0
  s_mov_b32 s30, 3662848
  s_mov_b32 s31, 0x00020000
  s_mul_i32 s3, s42, 114688
  s_add_u32 s16, s4, s3
  s_addc_u32 s17, s5, 0
  s_mov_b32 s18, 114688
  s_mov_b32 s19, 0x00020000
  s_add_u32 m0, s45, 83968
  s_add_u32 s50, s46, 0
  buffer_load_dwordx4 v227, s[28:31], s50 offen lds
  s_add_u32 m0, s45, 85056
  s_add_u32 s50, s46, 8192
  buffer_load_dwordx4 v227, s[28:31], s50 offen lds
  s_add_u32 m0, s45, 86144
  s_add_u32 s50, s46, 16384
  buffer_load_dwordx4 v227, s[28:31], s50 offen lds
  s_add_u32 m0, s45, 87232
  s_add_u32 s50, s46, 24576
  buffer_load_dwordx4 v227, s[28:31], s50 offen lds
  s_add_u32 m0, s48, 0
  s_add_u32 s51, s57, 0
  buffer_load_dwordx4 v112, s[16:19], s51 offen lds
  s_add_u32 m0, s48, 1024
  s_add_u32 s51, s57, 7168
  buffer_load_dwordx4 v113, s[16:19], s51 offen lds
  s_add_u32 m0, s48, 2048
  s_add_u32 s51, s57, 14336
  buffer_load_dwordx4 v112, s[16:19], s51 offen lds
  s_add_u32 m0, s48, 3072
  s_add_u32 s51, s57, 21504
  buffer_load_dwordx4 v113, s[16:19], s51 offen lds
  s_add_u32 m0, s45, 101376
  s_add_u32 s50, s46, 131072
  buffer_load_dwordx4 v227, s[28:31], s50 offen lds
  s_add_u32 m0, s45, 102464
  s_add_u32 s50, s46, 139264
  buffer_load_dwordx4 v227, s[28:31], s50 offen lds
  s_add_u32 m0, s45, 103552
  s_add_u32 s50, s46, 147456
  buffer_load_dwordx4 v227, s[28:31], s50 offen lds
  s_add_u32 m0, s45, 104640
  s_add_u32 s50, s46, 155648
  buffer_load_dwordx4 v227, s[28:31], s50 offen lds
  s_add_u32 m0, s48, 16384
  s_add_u32 s51, s57, 128
  buffer_load_dwordx4 v112, s[16:19], s51 offen lds
  s_add_u32 m0, s48, 17408
  s_add_u32 s51, s57, 7296
  buffer_load_dwordx4 v113, s[16:19], s51 offen lds
  s_add_u32 m0, s48, 18432
  s_add_u32 s51, s57, 14464
  buffer_load_dwordx4 v112, s[16:19], s51 offen lds
  s_add_u32 m0, s48, 19456
  s_add_u32 s51, s57, 21632
  buffer_load_dwordx4 v113, s[16:19], s51 offen lds
  s_add_u32 m0, s45, 118784
  s_add_u32 s50, s46, 262144
  buffer_load_dwordx4 v227, s[28:31], s50 offen lds
  s_add_u32 m0, s45, 119872
  s_add_u32 s50, s46, 270336
  buffer_load_dwordx4 v227, s[28:31], s50 offen lds
  s_add_u32 m0, s45, 120960
  s_add_u32 s50, s46, 278528
  buffer_load_dwordx4 v227, s[28:31], s50 offen lds
  s_add_u32 m0, s45, 122048
  s_add_u32 s50, s46, 286720
  buffer_load_dwordx4 v227, s[28:31], s50 offen lds
  s_lshl_b32 s3, s42, 3
  s_add_u32 s3, s3, s41
  s_lshl_b32 s3, s3, 18
  s_add_u32 s20, s6, s3
  s_addc_u32 s21, s7, 0
  s_mov_b32 s22, 262144
  s_mov_b32 s23, 0x00020000
  s_add_u32 s24, s8, s3
  s_addc_u32 s25, s9, 0
  s_mov_b32 s26, 262144
  s_mov_b32 s27, 0x00020000
  s_mul_i32 s3, s41, 458752
  s_add_u32 s32, s12, s3
  s_addc_u32 s33, s13, 0
  s_mov_b32 s34, 458752
  s_mov_b32 s35, 0x00020000
  s_lshl_b32 s3, s43, 4
  s_add_u32 s3, s3, s42
  s_lshl_b32 s3, s3, 3
  s_add_u32 s3, s3, s41
  s_mul_i32 s3, s3, 114688
  s_add_u32 s36, s14, s3
  s_addc_u32 s37, s15, 0
  s_mov_b32 s38, 114688
  s_mov_b32 s39, 0x00020000
  s_mov_b32 s44, 0x3db8aa3b
  s_mov_b32 s62, 0x42b17218
  s_mov_b32 s56, 0
  s_mul_i32 s47, s40, 4160
  s_lshl_b32 s49, s40, 11
  s_lshl_b32 s60, s40, 13
  s_mul_i32 s63, s40, 57344
  s_mul_i32 s61, s40, 28672
  v_lshrrev_b32 v241, 5, v240
  v_and_b32 v242, 31, v240
  v_lshlrev_b32 v243, 13, v241
  v_lshl_add_u32 v226, v242, 4, v243
  v_bfe_u32 v243, v242, 1, 3
  v_xor_b32 v243, v243, v241
  v_lshlrev_b32 v243, 4, v243
  v_lshl_add_u32 v243, v242, 7, v243
  v_add_u32 v114, s48, v243
  v_xor_b32 v115, 32, v114
  v_xor_b32 v116, 64, v114
  v_xor_b32 v117, 96, v114
  v_and_b32 v243, 3, v242
  v_and_b32 v244, 4, v242
  v_lshl_add_u32 v243, v244, 1, v243
  v_and_b32 v244, 8, v242
  v_lshrrev_b32 v244, 1, v244
  v_add_u32 v243, v243, v244
  v_mul_u32_u24 v224, 1040, v243
  v_lshrrev_b32 v244, 4, v242
  v_lshl_add_u32 v224, v244, 9, v224
  v_lshl_add_u32 v224, v241, 4, v224
  v_bfe_u32 v245, v240, 2, 2
  v_lshl_add_u32 v243, v241, 3, v245
  v_and_b32 v244, 1, v240
  v_lshlrev_b32 v244, 4, v244
  v_and_b32 v242, 2, v240
  v_lshl_add_u32 v244, v242, 2, v244
  v_bfe_u32 v242, v240, 4, 1
  v_lshl_add_u32 v244, v242, 5, v244
  v_mul_u32_u24 v225, 1088, v243
  v_add_u32 v225, v225, v244
  v_add_u32 v250, 83968, v225
  v_add_u32 v225, 66560, v225
  v_lshl_add_u32 v243, v243, 7, v244
  v_lshrrev_b32 v245, 1, v245
  v_lshlrev_b32 v245, 6, v245
  v_add_u32 v252, v243, v245
  v_xor_b32 v245, 64, v245
  v_add_u32 v253, v243, v245
  v_add_u32 v254, 65536, v252
  v_add_u32 v255, 65536, v253
  v_lshrrev_b32 v243, 3, v240
  v_mul_u32_u24 v243, 896, v243
  v_and_b32 v244, 7, v240
  v_lshlrev_b32 v242, 2, v242
  v_xor_b32 v244, v244, v242
  v_lshl_add_u32 v251, v244, 4, v243
  v_lshrrev_b32 v241, 3, v240
  v_and_b32 v242, 7, v240
  v_lshlrev_b32 v241, 13, v241
  v_lshl_add_u32 v119, v242, 7, v241
  s_mul_i32 s3, s42, 229376
  s_lshl_b32 s100, s40, 16
  s_add_u32 s100, s100, s3
  s_waitcnt vmcnt(12)
  ds_read_b128 v[0:3], v114 offset:0
  ds_read_b128 v[4:7], v115 offset:0
  ds_read_b128 v[8:11], v116 offset:0
  ds_read_b128 v[12:15], v117 offset:0
  s_barrier
  ds_read_b64_tr_b16 v[192:193], v250 offset:0
  ds_read_b64_tr_b16 v[194:195], v250 offset:4352
  ds_read_b64_tr_b16 v[196:197], v250 offset:64
  ds_read_b64_tr_b16 v[198:199], v250 offset:4416
  ds_read_b64_tr_b16 v[200:201], v250 offset:128
  ds_read_b64_tr_b16 v[202:203], v250 offset:4480
  ds_read_b64_tr_b16 v[204:205], v250 offset:192
  ds_read_b64_tr_b16 v[206:207], v250 offset:4544
  ds_read_b64_tr_b16 v[208:209], v250 offset:256
  ds_read_b64_tr_b16 v[210:211], v250 offset:4608
  ds_read_b64_tr_b16 v[212:213], v250 offset:320
  ds_read_b64_tr_b16 v[214:215], v250 offset:4672
  s_waitcnt lgkmcnt(10)
  v_mfma_f32_32x32x16_bf16 a[0:15], v[192:195], v[0:3], 0
  ds_read_b64_tr_b16 v[216:217], v250 offset:384
  ds_read_b64_tr_b16 v[218:219], v250 offset:4736
  s_waitcnt lgkmcnt(10)
  v_mfma_f32_32x32x16_bf16 a[16:31], v[196:199], v[0:3], 0
  ds_read_b64_tr_b16 v[220:221], v250 offset:448
  ds_read_b64_tr_b16 v[222:223], v250 offset:4800
  s_waitcnt lgkmcnt(10)
  v_mfma_f32_32x32x16_bf16 a[32:47], v[200:203], v[0:3], 0
  ds_read_b64_tr_b16 v[192:193], v250 offset:512
  ds_read_b64_tr_b16 v[194:195], v250 offset:4864
  s_waitcnt lgkmcnt(10)
  v_mfma_f32_32x32x16_bf16 a[48:63], v[204:207], v[0:3], 0
  ds_read_b64_tr_b16 v[196:197], v250 offset:576
  ds_read_b64_tr_b16 v[198:199], v250 offset:4928
  s_waitcnt vmcnt(8)
  s_barrier
  s_waitcnt lgkmcnt(10)
  v_mfma_f32_32x32x16_bf16 a[64:79], v[208:211], v[0:3], 0
  ds_read_b64_tr_b16 v[200:201], v250 offset:640
  ds_read_b64_tr_b16 v[202:203], v250 offset:4992
  s_add_u32 m0, s45, 136192
  s_add_u32 s50, s46, 393216
  buffer_load_dwordx4 v227, s[28:31], s50 offen lds
  s_waitcnt lgkmcnt(10)
  v_mfma_f32_32x32x16_bf16 a[80:95], v[212:215], v[0:3], 0
  ds_read_b64_tr_b16 v[204:205], v250 offset:704
  ds_read_b64_tr_b16 v[206:207], v250 offset:5056
  s_add_u32 m0, s45, 137280
  s_add_u32 s50, s46, 401408
  buffer_load_dwordx4 v227, s[28:31], s50 offen lds
  s_waitcnt lgkmcnt(10)
  v_mfma_f32_32x32x16_bf16 a[96:111], v[216:219], v[0:3], 0
  ds_read_b64_tr_b16 v[208:209], v250 offset:768
  ds_read_b64_tr_b16 v[210:211], v250 offset:5120
  s_add_u32 m0, s45, 138368
  s_add_u32 s50, s46, 409600
  s_waitcnt lgkmcnt(10)
  v_mfma_f32_32x32x16_bf16 a[112:127], v[220:223], v[0:3], 0
  ds_read_b64_tr_b16 v[212:213], v250 offset:832
  ds_read_b64_tr_b16 v[214:215], v250 offset:5184
  buffer_load_dwordx4 v227, s[28:31], s50 offen lds
  s_add_u32 m0, s45, 139456
  s_add_u32 s50, s46, 417792
  s_waitcnt lgkmcnt(10)
  v_mfma_f32_32x32x16_bf16 a[128:143], v[192:195], v[0:3], 0
  ds_read_b64_tr_b16 v[216:217], v250 offset:896
  ds_read_b64_tr_b16 v[218:219], v250 offset:5248
  buffer_load_dwordx4 v227, s[28:31], s50 offen lds
  s_waitcnt lgkmcnt(0)
  v_mfma_f32_32x32x16_bf16 a[144:159], v[196:199], v[0:3], 0
  ds_read_b64_tr_b16 v[220:221], v250 offset:960
  ds_read_b64_tr_b16 v[222:223], v250 offset:5312
  s_add_u32 m0, s48, 0
  s_add_u32 s51, s57, 256
  buffer_load_dwordx4 v112, s[16:19], s51 offen lds
  v_mfma_f32_32x32x16_bf16 a[160:175], v[200:203], v[0:3], 0
  ds_read_b64_tr_b16 v[192:193], v250 offset:17408
  ds_read_b64_tr_b16 v[194:195], v250 offset:21760
  s_add_u32 m0, s48, 1024
  s_add_u32 s51, s57, 7424
  v_mfma_f32_32x32x16_bf16 a[176:191], v[204:207], v[0:3], 0
  ds_read_b64_tr_b16 v[196:197], v250 offset:17472
  ds_read_b64_tr_b16 v[198:199], v250 offset:21824
  buffer_load_dwordx4 v113, s[16:19], s51 offen lds
  s_add_u32 m0, s48, 2048
  s_add_u32 s51, s57, 14592
  v_mfma_f32_32x32x16_bf16 a[192:207], v[208:211], v[0:3], 0
  ds_read_b64_tr_b16 v[200:201], v250 offset:17536
  ds_read_b64_tr_b16 v[202:203], v250 offset:21888
  buffer_load_dwordx4 v112, s[16:19], s51 offen lds
  s_add_u32 m0, s48, 3072
  s_add_u32 s51, s57, 21760
  v_mfma_f32_32x32x16_bf16 a[208:223], v[212:215], v[0:3], 0
  ds_read_b64_tr_b16 v[204:205], v250 offset:17600
  ds_read_b64_tr_b16 v[206:207], v250 offset:21952
  buffer_load_dwordx4 v113, s[16:19], s51 offen lds
  v_mfma_f32_32x32x16_bf16 a[224:239], v[216:219], v[0:3], 0
  ds_read_b64_tr_b16 v[208:209], v250 offset:17664
  ds_read_b64_tr_b16 v[210:211], v250 offset:22016
  s_waitcnt lgkmcnt(10)
  v_mfma_f32_32x32x16_bf16 a[240:255], v[220:223], v[0:3], 0
  ds_read_b64_tr_b16 v[212:213], v250 offset:17728
  ds_read_b64_tr_b16 v[214:215], v250 offset:22080
  s_waitcnt lgkmcnt(10)
  v_mfma_f32_32x32x16_bf16 a[0:15], v[192:195], v[4:7], a[0:15]
  ds_read_b64_tr_b16 v[216:217], v250 offset:17792
  ds_read_b64_tr_b16 v[218:219], v250 offset:22144
  s_waitcnt lgkmcnt(10)
  v_mfma_f32_32x32x16_bf16 a[16:31], v[196:199], v[4:7], a[16:31]
  ds_read_b64_tr_b16 v[220:221], v250 offset:17856
  ds_read_b64_tr_b16 v[222:223], v250 offset:22208
  s_waitcnt lgkmcnt(10)
  v_mfma_f32_32x32x16_bf16 a[32:47], v[200:203], v[4:7], a[32:47]
  ds_read_b64_tr_b16 v[192:193], v250 offset:17920
  ds_read_b64_tr_b16 v[194:195], v250 offset:22272
  s_waitcnt lgkmcnt(10)
  v_mfma_f32_32x32x16_bf16 a[48:63], v[204:207], v[4:7], a[48:63]
  ds_read_b64_tr_b16 v[196:197], v250 offset:17984
  ds_read_b64_tr_b16 v[198:199], v250 offset:22336
  s_waitcnt vmcnt(8)
  s_barrier
  s_waitcnt lgkmcnt(10)
  v_mfma_f32_32x32x16_bf16 a[64:79], v[208:211], v[4:7], a[64:79]
  ds_read_b64_tr_b16 v[200:201], v250 offset:18048
  ds_read_b64_tr_b16 v[202:203], v250 offset:22400
  s_add_u32 m0, s45, 83968
  s_add_u32 s50, s46, 524288
  s_waitcnt lgkmcnt(10)
  v_mfma_f32_32x32x16_bf16 a[80:95], v[212:215], v[4:7], a[80:95]
  ds_read_b64_tr_b16 v[204:205], v250 offset:18112
  ds_read_b64_tr_b16 v[206:207], v250 offset:22464
  buffer_load_dwordx4 v227, s[28:31], s50 offen lds
  s_add_u32 m0, s45, 85056
  s_add_u32 s50, s46, 532480
  s_waitcnt lgkmcnt(10)
  v_mfma_f32_32x32x16_bf16 a[96:111], v[216:219], v[4:7], a[96:111]
  ds_read_b64_tr_b16 v[208:209], v250 offset:18176
  ds_read_b64_tr_b16 v[210:211], v250 offset:22528
  buffer_load_dwordx4 v227, s[28:31], s50 offen lds
  s_waitcnt lgkmcnt(10)
  v_mfma_f32_32x32x16_bf16 a[112:127], v[220:223], v[4:7], a[112:127]
  ds_read_b64_tr_b16 v[212:213], v250 offset:18240
  ds_read_b64_tr_b16 v[214:215], v250 offset:22592
  s_add_u32 m0, s45, 86144
  s_add_u32 s50, s46, 540672
  s_waitcnt lgkmcnt(10)
  v_mfma_f32_32x32x16_bf16 a[128:143], v[192:195], v[4:7], a[128:143]
  ds_read_b64_tr_b16 v[216:217], v250 offset:18304
  ds_read_b64_tr_b16 v[218:219], v250 offset:22656
  buffer_load_dwordx4 v227, s[28:31], s50 offen lds
  s_waitcnt lgkmcnt(10)
  v_mfma_f32_32x32x16_bf16 a[144:159], v[196:199], v[4:7], a[144:159]
  ds_read_b64_tr_b16 v[220:221], v250 offset:18368
  ds_read_b64_tr_b16 v[222:223], v250 offset:22720
  s_add_u32 m0, s45, 87232
  s_add_u32 s50, s46, 548864
  s_waitcnt lgkmcnt(10)
  v_mfma_f32_32x32x16_bf16 a[160:175], v[200:203], v[4:7], a[160:175]
  ds_read_b64_tr_b16 v[192:193], v250 offset:34816
  ds_read_b64_tr_b16 v[194:195], v250 offset:39168
  buffer_load_dwordx4 v227, s[28:31], s50 offen lds
  s_waitcnt lgkmcnt(10)
  v_mfma_f32_32x32x16_bf16 a[176:191], v[204:207], v[4:7], a[176:191]
  ds_read_b64_tr_b16 v[196:197], v250 offset:34880
  ds_read_b64_tr_b16 v[198:199], v250 offset:39232
  buffer_load_dword v118, v119, s[28:31], s100 offen
  buffer_load_dword v118, v119, s[28:31], s100 offen offset:64
  s_waitcnt lgkmcnt(10)
  v_mfma_f32_32x32x16_bf16 a[192:207], v[208:211], v[4:7], a[192:207]
  ds_read_b64_tr_b16 v[200:201], v250 offset:34944
  ds_read_b64_tr_b16 v[202:203], v250 offset:39296
  ds_read_b128 v[16:19], v114 offset:16384
  s_waitcnt lgkmcnt(11)
  v_mfma_f32_32x32x16_bf16 a[208:223], v[212:215], v[4:7], a[208:223]
  ds_read_b64_tr_b16 v[204:205], v250 offset:35008
  ds_read_b64_tr_b16 v[206:207], v250 offset:39360
  ds_read_b128 v[20:23], v115 offset:16384
  ds_read_b128 v[24:27], v116 offset:16384
  ds_read_b128 v[28:31], v117 offset:16384
  s_waitcnt lgkmcnt(14)
  v_mfma_f32_32x32x16_bf16 a[224:239], v[216:219], v[4:7], a[224:239]
  ds_read_b64_tr_b16 v[208:209], v250 offset:35072
  ds_read_b64_tr_b16 v[210:211], v250 offset:39424
  s_waitcnt lgkmcnt(14)
  v_mfma_f32_32x32x16_bf16 a[240:255], v[220:223], v[4:7], a[240:255]
  ds_read_b64_tr_b16 v[212:213], v250 offset:35136
  ds_read_b64_tr_b16 v[214:215], v250 offset:39488
  s_waitcnt lgkmcnt(14)
  v_mfma_f32_32x32x16_bf16 a[0:15], v[192:195], v[8:11], a[0:15]
  ds_read_b64_tr_b16 v[216:217], v250 offset:35200
  ds_read_b64_tr_b16 v[218:219], v250 offset:39552
  s_waitcnt lgkmcnt(14)
  v_mfma_f32_32x32x16_bf16 a[16:31], v[196:199], v[8:11], a[16:31]
  ds_read_b64_tr_b16 v[220:221], v250 offset:35264
  ds_read_b64_tr_b16 v[222:223], v250 offset:39616
  s_waitcnt lgkmcnt(14)
  v_mfma_f32_32x32x16_bf16 a[32:47], v[200:203], v[8:11], a[32:47]
  ds_read_b64_tr_b16 v[192:193], v250 offset:35328
  ds_read_b64_tr_b16 v[194:195], v250 offset:39680
  s_waitcnt lgkmcnt(13)
  v_mfma_f32_32x32x16_bf16 a[48:63], v[204:207], v[8:11], a[48:63]
  ds_read_b64_tr_b16 v[196:197], v250 offset:35392
  ds_read_b64_tr_b16 v[198:199], v250 offset:39744
  s_waitcnt vmcnt(10)
  s_barrier
  s_waitcnt lgkmcnt(10)
  v_mfma_f32_32x32x16_bf16 a[64:79], v[208:211], v[8:11], a[64:79]
  ds_read_b64_tr_b16 v[200:201], v250 offset:35456
  ds_read_b64_tr_b16 v[202:203], v250 offset:39808
  s_add_u32 m0, s45, 101376
  s_add_u32 s50, s46, 655360
  s_waitcnt lgkmcnt(10)
  v_mfma_f32_32x32x16_bf16 a[80:95], v[212:215], v[8:11], a[80:95]
  ds_read_b64_tr_b16 v[204:205], v250 offset:35520
  ds_read_b64_tr_b16 v[206:207], v250 offset:39872
  buffer_load_dwordx4 v227, s[28:31], s50 offen lds
  s_waitcnt lgkmcnt(10)
  v_mfma_f32_32x32x16_bf16 a[96:111], v[216:219], v[8:11], a[96:111]
  ds_read_b64_tr_b16 v[208:209], v250 offset:35584
  ds_read_b64_tr_b16 v[210:211], v250 offset:39936
  s_add_u32 m0, s45, 102464
  s_add_u32 s50, s46, 663552
  s_waitcnt lgkmcnt(10)
  v_mfma_f32_32x32x16_bf16 a[112:127], v[220:223], v[8:11], a[112:127]
  ds_read_b64_tr_b16 v[212:213], v250 offset:35648
  ds_read_b64_tr_b16 v[214:215], v250 offset:40000
  buffer_load_dwordx4 v227, s[28:31], s50 offen lds
  s_waitcnt lgkmcnt(10)
  v_mfma_f32_32x32x16_bf16 a[128:143], v[192:195], v[8:11], a[128:143]
  ds_read_b64_tr_b16 v[216:217], v250 offset:35712
  ds_read_b64_tr_b16 v[218:219], v250 offset:40064
  s_waitcnt lgkmcnt(10)
  v_mfma_f32_32x32x16_bf16 a[144:159], v[196:199], v[8:11], a[144:159]
  ds_read_b64_tr_b16 v[220:221], v250 offset:35776
  ds_read_b64_tr_b16 v[222:223], v250 offset:40128
  s_add_u32 m0, s45, 103552
  s_add_u32 s50, s46, 671744
  s_waitcnt lgkmcnt(10)
  v_mfma_f32_32x32x16_bf16 a[160:175], v[200:203], v[8:11], a[160:175]
  ds_read_b64_tr_b16 v[192:193], v250 offset:52224
  ds_read_b64_tr_b16 v[194:195], v250 offset:56576
  buffer_load_dwordx4 v227, s[28:31], s50 offen lds
  s_waitcnt lgkmcnt(10)
  v_mfma_f32_32x32x16_bf16 a[176:191], v[204:207], v[8:11], a[176:191]
  ds_read_b64_tr_b16 v[196:197], v250 offset:52288
  ds_read_b64_tr_b16 v[198:199], v250 offset:56640
  s_add_u32 m0, s45, 104640
  s_add_u32 s50, s46, 679936
  s_waitcnt lgkmcnt(10)
  v_mfma_f32_32x32x16_bf16 a[192:207], v[208:211], v[8:11], a[192:207]
  ds_read_b64_tr_b16 v[200:201], v250 offset:52352
  ds_read_b64_tr_b16 v[202:203], v250 offset:56704
  buffer_load_dwordx4 v227, s[28:31], s50 offen lds
  s_waitcnt lgkmcnt(10)
  v_mfma_f32_32x32x16_bf16 a[208:223], v[212:215], v[8:11], a[208:223]
  ds_read_b64_tr_b16 v[204:205], v250 offset:52416
  ds_read_b64_tr_b16 v[206:207], v250 offset:56768
  s_waitcnt lgkmcnt(10)
  v_mfma_f32_32x32x16_bf16 a[224:239], v[216:219], v[8:11], a[224:239]
  ds_read_b64_tr_b16 v[208:209], v250 offset:52480
  ds_read_b64_tr_b16 v[210:211], v250 offset:56832
  s_waitcnt lgkmcnt(10)
  v_mfma_f32_32x32x16_bf16 a[240:255], v[220:223], v[8:11], a[240:255]
  ds_read_b64_tr_b16 v[212:213], v250 offset:52544
  ds_read_b64_tr_b16 v[214:215], v250 offset:56896
  s_waitcnt lgkmcnt(10)
  v_mfma_f32_32x32x16_bf16 a[0:15], v[192:195], v[12:15], a[0:15]
  ds_read_b64_tr_b16 v[216:217], v250 offset:52608
  ds_read_b64_tr_b16 v[218:219], v250 offset:56960
  s_waitcnt lgkmcnt(10)
  v_mfma_f32_32x32x16_bf16 a[16:31], v[196:199], v[12:15], a[16:31]
  ds_read_b64_tr_b16 v[220:221], v250 offset:52672
  ds_read_b64_tr_b16 v[222:223], v250 offset:57024
  s_waitcnt lgkmcnt(10)
  v_mfma_f32_32x32x16_bf16 a[32:47], v[200:203], v[12:15], a[32:47]
  ds_read_b64_tr_b16 v[192:193], v250 offset:52736
  ds_read_b64_tr_b16 v[194:195], v250 offset:57088
  s_waitcnt lgkmcnt(10)
  v_mfma_f32_32x32x16_bf16 a[48:63], v[204:207], v[12:15], a[48:63]
  ds_read_b64_tr_b16 v[196:197], v250 offset:52800
  ds_read_b64_tr_b16 v[198:199], v250 offset:57152
  s_waitcnt vmcnt(6)
  s_barrier
  s_waitcnt lgkmcnt(10)
  v_mfma_f32_32x32x16_bf16 a[64:79], v[208:211], v[12:15], a[64:79]
  ds_read_b64_tr_b16 v[200:201], v250 offset:52864
  ds_read_b64_tr_b16 v[202:203], v250 offset:57216
  s_add_u32 m0, s45, 118784
  s_add_u32 s50, s46, 786432
  buffer_load_dwordx4 v227, s[28:31], s50 offen lds
  s_waitcnt lgkmcnt(10)
  v_mfma_f32_32x32x16_bf16 a[80:95], v[212:215], v[12:15], a[80:95]
  ds_read_b64_tr_b16 v[204:205], v250 offset:52928
  ds_read_b64_tr_b16 v[206:207], v250 offset:57280
  s_add_u32 m0, s45, 119872
  s_add_u32 s50, s46, 794624
  s_waitcnt lgkmcnt(10)
  v_mfma_f32_32x32x16_bf16 a[96:111], v[216:219], v[12:15], a[96:111]
  ds_read_b64_tr_b16 v[208:209], v250 offset:52992
  ds_read_b64_tr_b16 v[210:211], v250 offset:57344
  buffer_load_dwordx4 v227, s[28:31], s50 offen lds
  s_waitcnt lgkmcnt(10)
  v_mfma_f32_32x32x16_bf16 a[112:127], v[220:223], v[12:15], a[112:127]
  ds_read_b64_tr_b16 v[212:213], v250 offset:53056
  ds_read_b64_tr_b16 v[214:215], v250 offset:57408
  s_add_u32 m0, s45, 120960
  s_add_u32 s50, s46, 802816
  s_waitcnt lgkmcnt(10)
  v_mfma_f32_32x32x16_bf16 a[128:143], v[192:195], v[12:15], a[128:143]
  ds_read_b64_tr_b16 v[216:217], v250 offset:53120
  ds_read_b64_tr_b16 v[218:219], v250 offset:57472
  buffer_load_dwordx4 v227, s[28:31], s50 offen lds
  s_waitcnt lgkmcnt(10)
  v_mfma_f32_32x32x16_bf16 a[144:159], v[196:199], v[12:15], a[144:159]
  ds_read_b64_tr_b16 v[220:221], v250 offset:53184
  ds_read_b64_tr_b16 v[222:223], v250 offset:57536
  s_add_u32 m0, s45, 122048
  s_add_u32 s50, s46, 811008
  buffer_load_dwordx4 v227, s[28:31], s50 offen lds
  s_waitcnt lgkmcnt(10)
  v_mfma_f32_32x32x16_bf16 a[160:175], v[200:203], v[12:15], a[160:175]
  ds_read_b64_tr_b16 v[192:193], v250 offset:0
  ds_read_b64_tr_b16 v[194:195], v250 offset:4352
  s_add_u32 s51, s49, 0
  s_add_u32 m0, s47, 0
  s_waitcnt lgkmcnt(10)
  v_mfma_f32_32x32x16_bf16 a[176:191], v[204:207], v[12:15], a[176:191]
  ds_read_b64_tr_b16 v[196:197], v250 offset:64
  ds_read_b64_tr_b16 v[198:199], v250 offset:4416
  buffer_load_dwordx4 v226, s[20:23], s51 offen nt lds
  s_waitcnt lgkmcnt(10)
  v_mfma_f32_32x32x16_bf16 a[192:207], v[208:211], v[12:15], a[192:207]
  ds_read_b64_tr_b16 v[200:201], v250 offset:128
  ds_read_b64_tr_b16 v[202:203], v250 offset:4480
  s_add_u32 s51, s49, 0
  s_add_u32 m0, s47, 528
  s_waitcnt lgkmcnt(10)
  v_mfma_f32_32x32x16_bf16 a[208:223], v[212:215], v[12:15], a[208:223]
  ds_read_b64_tr_b16 v[204:205], v250 offset:192
  ds_read_b64_tr_b16 v[206:207], v250 offset:4544
  buffer_load_dwordx4 v226, s[20:23], s51 offen offset:512 nt lds
  s_waitcnt lgkmcnt(10)
  v_mfma_f32_32x32x16_bf16 a[224:239], v[216:219], v[12:15], a[224:239]
  ds_read_b64_tr_b16 v[208:209], v250 offset:256
  ds_read_b64_tr_b16 v[210:211], v250 offset:4608
  s_waitcnt lgkmcnt(10)
  v_mfma_f32_32x32x16_bf16 a[240:255], v[220:223], v[12:15], a[240:255]
  ds_read_b64_tr_b16 v[212:213], v250 offset:320
  ds_read_b64_tr_b16 v[214:215], v250 offset:4672
  s_waitcnt lgkmcnt(10)
  v_mfma_f32_32x32x16_bf16 a[0:15], v[192:195], v[16:19], a[0:15]
  ds_read_b64_tr_b16 v[216:217], v250 offset:384
  ds_read_b64_tr_b16 v[218:219], v250 offset:4736
  s_waitcnt lgkmcnt(10)
  v_mfma_f32_32x32x16_bf16 a[16:31], v[196:199], v[16:19], a[16:31]
  ds_read_b64_tr_b16 v[220:221], v250 offset:448
  ds_read_b64_tr_b16 v[222:223], v250 offset:4800
  s_waitcnt lgkmcnt(10)
  v_mfma_f32_32x32x16_bf16 a[32:47], v[200:203], v[16:19], a[32:47]
  ds_read_b64_tr_b16 v[192:193], v250 offset:512
  ds_read_b64_tr_b16 v[194:195], v250 offset:4864
  s_waitcnt lgkmcnt(10)
  v_mfma_f32_32x32x16_bf16 a[48:63], v[204:207], v[16:19], a[48:63]
  ds_read_b64_tr_b16 v[196:197], v250 offset:576
  ds_read_b64_tr_b16 v[198:199], v250 offset:4928
  s_waitcnt vmcnt(6)
  s_barrier
  s_waitcnt lgkmcnt(10)
  v_mfma_f32_32x32x16_bf16 a[64:79], v[208:211], v[16:19], a[64:79]
  ds_read_b64_tr_b16 v[200:201], v250 offset:640
  ds_read_b64_tr_b16 v[202:203], v250 offset:4992
  s_add_u32 m0, s45, 136192
  s_add_u32 s50, s46, 917504
  buffer_load_dwordx4 v227, s[28:31], s50 offen lds
  s_waitcnt lgkmcnt(10)
  v_mfma_f32_32x32x16_bf16 a[80:95], v[212:215], v[16:19], a[80:95]
  ds_read_b64_tr_b16 v[204:205], v250 offset:704
  ds_read_b64_tr_b16 v[206:207], v250 offset:5056
  s_add_u32 m0, s45, 137280
  s_add_u32 s50, s46, 925696
  buffer_load_dwordx4 v227, s[28:31], s50 offen lds
  s_waitcnt lgkmcnt(10)
  v_mfma_f32_32x32x16_bf16 a[96:111], v[216:219], v[16:19], a[96:111]
  ds_read_b64_tr_b16 v[208:209], v250 offset:768
  ds_read_b64_tr_b16 v[210:211], v250 offset:5120
  s_add_u32 m0, s45, 138368
  s_add_u32 s50, s46, 933888
  buffer_load_dwordx4 v227, s[28:31], s50 offen lds
  s_waitcnt lgkmcnt(10)
  v_mfma_f32_32x32x16_bf16 a[112:127], v[220:223], v[16:19], a[112:127]
  ds_read_b64_tr_b16 v[212:213], v250 offset:832
  ds_read_b64_tr_b16 v[214:215], v250 offset:5184
  s_add_u32 m0, s45, 139456
  s_add_u32 s50, s46, 942080
  buffer_load_dwordx4 v227, s[28:31], s50 offen lds
  s_waitcnt lgkmcnt(10)
  v_mfma_f32_32x32x16_bf16 a[128:143], v[192:195], v[16:19], a[128:143]
  ds_read_b64_tr_b16 v[216:217], v250 offset:896
  ds_read_b64_tr_b16 v[218:219], v250 offset:5248
  s_add_u32 s51, s49, 0
  s_add_u32 m0, s47, 1056
  s_waitcnt lgkmcnt(10)
  v_mfma_f32_32x32x16_bf16 a[144:159], v[196:199], v[16:19], a[144:159]
  ds_read_b64_tr_b16 v[220:221], v250 offset:960
  ds_read_b64_tr_b16 v[222:223], v250 offset:5312
  buffer_load_dwordx4 v226, s[20:23], s51 offen offset:1024 nt lds
  s_add_u32 m0, s48, 16384
  s_add_u32 s51, s57, 384
  s_waitcnt lgkmcnt(10)
  v_mfma_f32_32x32x16_bf16 a[160:175], v[200:203], v[16:19], a[160:175]
  ds_read_b64_tr_b16 v[192:193], v250 offset:17408
  ds_read_b64_tr_b16 v[194:195], v250 offset:21760
  buffer_load_dwordx4 v112, s[16:19], s51 offen lds
  s_add_u32 m0, s48, 17408
  s_add_u32 s51, s57, 7552
  s_waitcnt lgkmcnt(10)
  v_mfma_f32_32x32x16_bf16 a[176:191], v[204:207], v[16:19], a[176:191]
  ds_read_b64_tr_b16 v[196:197], v250 offset:17472
  ds_read_b64_tr_b16 v[198:199], v250 offset:21824
  buffer_load_dwordx4 v113, s[16:19], s51 offen lds
  s_add_u32 m0, s48, 18432
  s_add_u32 s51, s57, 14720
  s_waitcnt lgkmcnt(10)
  v_mfma_f32_32x32x16_bf16 a[192:207], v[208:211], v[16:19], a[192:207]
  ds_read_b64_tr_b16 v[200:201], v250 offset:17536
  ds_read_b64_tr_b16 v[202:203], v250 offset:21888
  buffer_load_dwordx4 v112, s[16:19], s51 offen lds
  s_add_u32 m0, s48, 19456
  s_waitcnt lgkmcnt(10)
  v_mfma_f32_32x32x16_bf16 a[208:223], v[212:215], v[16:19], a[208:223]
  ds_read_b64_tr_b16 v[204:205], v250 offset:17600
  ds_read_b64_tr_b16 v[206:207], v250 offset:21952
  s_add_u32 s51, s57, 21888
  buffer_load_dwordx4 v113, s[16:19], s51 offen lds
  s_waitcnt lgkmcnt(10)
  v_mfma_f32_32x32x16_bf16 a[224:239], v[216:219], v[16:19], a[224:239]
  ds_read_b64_tr_b16 v[208:209], v250 offset:17664
  ds_read_b64_tr_b16 v[210:211], v250 offset:22016
  s_waitcnt lgkmcnt(10)
  v_mfma_f32_32x32x16_bf16 a[240:255], v[220:223], v[16:19], a[240:255]
  ds_read_b64_tr_b16 v[212:213], v250 offset:17728
  ds_read_b64_tr_b16 v[214:215], v250 offset:22080
  s_waitcnt lgkmcnt(10)
  v_mfma_f32_32x32x16_bf16 a[0:15], v[192:195], v[20:23], a[0:15]
  ds_read_b64_tr_b16 v[216:217], v250 offset:17792
  ds_read_b64_tr_b16 v[218:219], v250 offset:22144
  s_waitcnt lgkmcnt(10)
  v_mfma_f32_32x32x16_bf16 a[16:31], v[196:199], v[20:23], a[16:31]
  ds_read_b64_tr_b16 v[220:221], v250 offset:17856
  ds_read_b64_tr_b16 v[222:223], v250 offset:22208
  s_waitcnt lgkmcnt(10)
  v_mfma_f32_32x32x16_bf16 a[32:47], v[200:203], v[20:23], a[32:47]
  ds_read_b64_tr_b16 v[192:193], v250 offset:17920
  ds_read_b64_tr_b16 v[194:195], v250 offset:22272
  s_waitcnt lgkmcnt(10)
  v_mfma_f32_32x32x16_bf16 a[48:63], v[204:207], v[20:23], a[48:63]
  ds_read_b64_tr_b16 v[196:197], v250 offset:17984
  ds_read_b64_tr_b16 v[198:199], v250 offset:22336
  s_waitcnt vmcnt(11)
  s_barrier
  s_waitcnt lgkmcnt(10)
  v_mfma_f32_32x32x16_bf16 a[64:79], v[208:211], v[20:23], a[64:79]
  ds_read_b64_tr_b16 v[200:201], v250 offset:18048
  ds_read_b64_tr_b16 v[202:203], v250 offset:22400
  s_add_u32 m0, s45, 83968
  s_add_u32 s50, s46, 1048576
  buffer_load_dwordx4 v227, s[28:31], s50 offen lds
  s_waitcnt lgkmcnt(10)
  v_mfma_f32_32x32x16_bf16 a[80:95], v[212:215], v[20:23], a[80:95]
  ds_read_b64_tr_b16 v[204:205], v250 offset:18112
  ds_read_b64_tr_b16 v[206:207], v250 offset:22464
  s_add_u32 m0, s45, 85056
  s_add_u32 s50, s46, 1056768
  s_waitcnt lgkmcnt(10)
  v_mfma_f32_32x32x16_bf16 a[96:111], v[216:219], v[20:23], a[96:111]
  ds_read_b64_tr_b16 v[208:209], v250 offset:18176
  ds_read_b64_tr_b16 v[210:211], v250 offset:22528
  buffer_load_dwordx4 v227, s[28:31], s50 offen lds
  s_add_u32 m0, s45, 86144
  s_waitcnt lgkmcnt(10)
  v_mfma_f32_32x32x16_bf16 a[112:127], v[220:223], v[20:23], a[112:127]
  ds_read_b64_tr_b16 v[212:213], v250 offset:18240
  ds_read_b64_tr_b16 v[214:215], v250 offset:22592
  s_add_u32 s50, s46, 1064960
  buffer_load_dwordx4 v227, s[28:31], s50 offen lds
  s_waitcnt lgkmcnt(10)
  v_mfma_f32_32x32x16_bf16 a[128:143], v[192:195], v[20:23], a[128:143]
  ds_read_b64_tr_b16 v[216:217], v250 offset:18304
  ds_read_b64_tr_b16 v[218:219], v250 offset:22656
  s_add_u32 m0, s45, 87232
  s_add_u32 s50, s46, 1073152
  s_waitcnt lgkmcnt(10)
  v_mfma_f32_32x32x16_bf16 a[144:159], v[196:199], v[20:23], a[144:159]
  ds_read_b64_tr_b16 v[220:221], v250 offset:18368
  ds_read_b64_tr_b16 v[222:223], v250 offset:22720
  buffer_load_dwordx4 v227, s[28:31], s50 offen lds
  s_add_u32 s51, s49, 0
  s_add_u32 m0, s47, 1584
  s_waitcnt lgkmcnt(10)
  v_mfma_f32_32x32x16_bf16 a[160:175], v[200:203], v[20:23], a[160:175]
  ds_read_b64_tr_b16 v[192:193], v250 offset:34816
  ds_read_b64_tr_b16 v[194:195], v250 offset:39168
  buffer_load_dwordx4 v226, s[20:23], s51 offen offset:1536 nt lds
  s_waitcnt lgkmcnt(10)
  v_mfma_f32_32x32x16_bf16 a[176:191], v[204:207], v[20:23], a[176:191]
  ds_read_b64_tr_b16 v[196:197], v250 offset:34880
  ds_read_b64_tr_b16 v[198:199], v250 offset:39232
  s_add_u32 s51, s49, 16384
  s_add_u32 m0, s47, 16640
  s_nop 0
  buffer_load_dwordx4 v226, s[20:23], s51 offen nt lds
  s_waitcnt lgkmcnt(10)
  v_mfma_f32_32x32x16_bf16 a[192:207], v[208:211], v[20:23], a[192:207]
  ds_read_b64_tr_b16 v[200:201], v250 offset:34944
  ds_read_b64_tr_b16 v[202:203], v250 offset:39296
  ds_read_b128 v[32:35], v114 offset:0
  s_waitcnt lgkmcnt(11)
  v_mfma_f32_32x32x16_bf16 a[208:223], v[212:215], v[20:23], a[208:223]
  ds_read_b64_tr_b16 v[204:205], v250 offset:35008
  ds_read_b64_tr_b16 v[206:207], v250 offset:39360
  ds_read_b128 v[36:39], v115 offset:0
  ds_read_b128 v[40:43], v116 offset:0
  ds_read_b128 v[44:47], v117 offset:0
  s_waitcnt lgkmcnt(14)
  v_mfma_f32_32x32x16_bf16 a[224:239], v[216:219], v[20:23], a[224:239]
  ds_read_b64_tr_b16 v[208:209], v250 offset:35072
  ds_read_b64_tr_b16 v[210:211], v250 offset:39424
  s_waitcnt lgkmcnt(14)
  v_mfma_f32_32x32x16_bf16 a[240:255], v[220:223], v[20:23], a[240:255]
  ds_read_b64_tr_b16 v[212:213], v250 offset:35136
  ds_read_b64_tr_b16 v[214:215], v250 offset:39488
  s_waitcnt lgkmcnt(14)
  v_mfma_f32_32x32x16_bf16 a[0:15], v[192:195], v[24:27], a[0:15]
  ds_read_b64_tr_b16 v[216:217], v250 offset:35200
  ds_read_b64_tr_b16 v[218:219], v250 offset:39552
  s_waitcnt lgkmcnt(14)
  v_mfma_f32_32x32x16_bf16 a[16:31], v[196:199], v[24:27], a[16:31]
  ds_read_b64_tr_b16 v[220:221], v250 offset:35264
  ds_read_b64_tr_b16 v[222:223], v250 offset:39616
  s_waitcnt lgkmcnt(14)
  v_mfma_f32_32x32x16_bf16 a[32:47], v[200:203], v[24:27], a[32:47]
  ds_read_b64_tr_b16 v[192:193], v250 offset:35328
  ds_read_b64_tr_b16 v[194:195], v250 offset:39680
  s_waitcnt lgkmcnt(13)
  v_mfma_f32_32x32x16_bf16 a[48:63], v[204:207], v[24:27], a[48:63]
  ds_read_b64_tr_b16 v[196:197], v250 offset:35392
  ds_read_b64_tr_b16 v[198:199], v250 offset:39744
  s_waitcnt vmcnt(11)
  s_barrier
  s_waitcnt lgkmcnt(10)
  v_mfma_f32_32x32x16_bf16 a[64:79], v[208:211], v[24:27], a[64:79]
  ds_read_b64_tr_b16 v[200:201], v250 offset:35456
  ds_read_b64_tr_b16 v[202:203], v250 offset:39808
  s_add_u32 m0, s45, 101376
  s_add_u32 s50, s46, 1179648
  s_waitcnt lgkmcnt(10)
  v_mfma_f32_32x32x16_bf16 a[80:95], v[212:215], v[24:27], a[80:95]
  ds_read_b64_tr_b16 v[204:205], v250 offset:35520
  ds_read_b64_tr_b16 v[206:207], v250 offset:39872
  buffer_load_dwordx4 v227, s[28:31], s50 offen lds
  s_waitcnt lgkmcnt(10)
  v_mfma_f32_32x32x16_bf16 a[96:111], v[216:219], v[24:27], a[96:111]
  ds_read_b64_tr_b16 v[208:209], v250 offset:35584
  ds_read_b64_tr_b16 v[210:211], v250 offset:39936
  s_add_u32 m0, s45, 102464
  s_add_u32 s50, s46, 1187840
  s_waitcnt lgkmcnt(10)
  v_mfma_f32_32x32x16_bf16 a[112:127], v[220:223], v[24:27], a[112:127]
  ds_read_b64_tr_b16 v[212:213], v250 offset:35648
  ds_read_b64_tr_b16 v[214:215], v250 offset:40000
  buffer_load_dwordx4 v227, s[28:31], s50 offen lds
  s_waitcnt lgkmcnt(10)
  v_mfma_f32_32x32x16_bf16 a[128:143], v[192:195], v[24:27], a[128:143]
  ds_read_b64_tr_b16 v[216:217], v250 offset:35712
  ds_read_b64_tr_b16 v[218:219], v250 offset:40064
  s_add_u32 m0, s45, 103552
  s_add_u32 s50, s46, 1196032
  s_waitcnt lgkmcnt(10)
  v_mfma_f32_32x32x16_bf16 a[144:159], v[196:199], v[24:27], a[144:159]
  ds_read_b64_tr_b16 v[220:221], v250 offset:35776
  ds_read_b64_tr_b16 v[222:223], v250 offset:40128
  buffer_load_dwordx4 v227, s[28:31], s50 offen lds
  s_waitcnt lgkmcnt(10)
  v_mfma_f32_32x32x16_bf16 a[160:175], v[200:203], v[24:27], a[160:175]
  ds_read_b64_tr_b16 v[192:193], v250 offset:52224
  ds_read_b64_tr_b16 v[194:195], v250 offset:56576
  s_add_u32 m0, s45, 104640
  s_add_u32 s50, s46, 1204224
  s_waitcnt lgkmcnt(10)
  v_mfma_f32_32x32x16_bf16 a[176:191], v[204:207], v[24:27], a[176:191]
  ds_read_b64_tr_b16 v[196:197], v250 offset:52288
  ds_read_b64_tr_b16 v[198:199], v250 offset:56640
  buffer_load_dwordx4 v227, s[28:31], s50 offen lds
  s_waitcnt lgkmcnt(10)
  v_mfma_f32_32x32x16_bf16 a[192:207], v[208:211], v[24:27], a[192:207]
  ds_read_b64_tr_b16 v[200:201], v250 offset:52352
  ds_read_b64_tr_b16 v[202:203], v250 offset:56704
  s_add_u32 s51, s49, 16384
  s_add_u32 m0, s47, 17168
  s_waitcnt lgkmcnt(10)
  v_mfma_f32_32x32x16_bf16 a[208:223], v[212:215], v[24:27], a[208:223]
  ds_read_b64_tr_b16 v[204:205], v250 offset:52416
  ds_read_b64_tr_b16 v[206:207], v250 offset:56768
  buffer_load_dwordx4 v226, s[20:23], s51 offen offset:512 nt lds
  s_waitcnt lgkmcnt(10)
  v_mfma_f32_32x32x16_bf16 a[224:239], v[216:219], v[24:27], a[224:239]
  ds_read_b64_tr_b16 v[208:209], v250 offset:52480
  ds_read_b64_tr_b16 v[210:211], v250 offset:56832
  s_waitcnt lgkmcnt(10)
  v_mfma_f32_32x32x16_bf16 a[240:255], v[220:223], v[24:27], a[240:255]
  ds_read_b64_tr_b16 v[212:213], v250 offset:52544
  ds_read_b64_tr_b16 v[214:215], v250 offset:56896
  s_waitcnt lgkmcnt(10)
  v_mfma_f32_32x32x16_bf16 a[0:15], v[192:195], v[28:31], a[0:15]
  ds_read_b64_tr_b16 v[216:217], v250 offset:52608
  ds_read_b64_tr_b16 v[218:219], v250 offset:56960
  s_waitcnt lgkmcnt(10)
  v_mfma_f32_32x32x16_bf16 a[16:31], v[196:199], v[28:31], a[16:31]
  ds_read_b64_tr_b16 v[220:221], v250 offset:52672
  ds_read_b64_tr_b16 v[222:223], v250 offset:57024
  s_waitcnt lgkmcnt(10)
  v_mfma_f32_32x32x16_bf16 a[32:47], v[200:203], v[28:31], a[32:47]
  ds_read_b64_tr_b16 v[192:193], v250 offset:52736
  ds_read_b64_tr_b16 v[194:195], v250 offset:57088
  s_waitcnt lgkmcnt(10)
  v_mfma_f32_32x32x16_bf16 a[48:63], v[204:207], v[28:31], a[48:63]
  ds_read_b64_tr_b16 v[196:197], v250 offset:52800
  ds_read_b64_tr_b16 v[198:199], v250 offset:57152
  s_waitcnt vmcnt(7)
  s_barrier
  s_waitcnt lgkmcnt(10)
  v_mfma_f32_32x32x16_bf16 a[64:79], v[208:211], v[28:31], a[64:79]
  ds_read_b64_tr_b16 v[200:201], v250 offset:52864
  ds_read_b64_tr_b16 v[202:203], v250 offset:57216
  s_add_u32 m0, s45, 118784
  s_add_u32 s50, s46, 1310720
  s_waitcnt lgkmcnt(10)
  v_mfma_f32_32x32x16_bf16 a[80:95], v[212:215], v[28:31], a[80:95]
  ds_read_b64_tr_b16 v[204:205], v250 offset:52928
  ds_read_b64_tr_b16 v[206:207], v250 offset:57280
  buffer_load_dwordx4 v227, s[28:31], s50 offen lds
  s_waitcnt lgkmcnt(10)
  v_mfma_f32_32x32x16_bf16 a[96:111], v[216:219], v[28:31], a[96:111]
  ds_read_b64_tr_b16 v[208:209], v250 offset:52992
  ds_read_b64_tr_b16 v[210:211], v250 offset:57344
  s_add_u32 m0, s45, 119872
  s_add_u32 s50, s46, 1318912
  s_waitcnt lgkmcnt(10)
  v_mfma_f32_32x32x16_bf16 a[112:127], v[220:223], v[28:31], a[112:127]
  ds_read_b64_tr_b16 v[212:213], v250 offset:53056
  ds_read_b64_tr_b16 v[214:215], v250 offset:57408
  buffer_load_dwordx4 v227, s[28:31], s50 offen lds
  s_waitcnt lgkmcnt(10)
  v_mfma_f32_32x32x16_bf16 a[128:143], v[192:195], v[28:31], a[128:143]
  ds_read_b64_tr_b16 v[216:217], v250 offset:53120
  ds_read_b64_tr_b16 v[218:219], v250 offset:57472
  s_add_u32 m0, s45, 120960
  s_add_u32 s50, s46, 1327104
  s_waitcnt lgkmcnt(10)
  v_mfma_f32_32x32x16_bf16 a[144:159], v[196:199], v[28:31], a[144:159]
  ds_read_b64_tr_b16 v[220:221], v250 offset:53184
  ds_read_b64_tr_b16 v[222:223], v250 offset:57536
  buffer_load_dwordx4 v227, s[28:31], s50 offen lds
  s_waitcnt lgkmcnt(10)
  v_mfma_f32_32x32x16_bf16 a[160:175], v[200:203], v[28:31], a[160:175]
  ds_read_b64_tr_b16 v[192:193], v250 offset:0
  ds_read_b64_tr_b16 v[194:195], v250 offset:4352
  s_add_u32 m0, s45, 122048
  s_add_u32 s50, s46, 1335296
  s_waitcnt lgkmcnt(10)
  v_mfma_f32_32x32x16_bf16 a[176:191], v[204:207], v[28:31], a[176:191]
  ds_read_b64_tr_b16 v[196:197], v250 offset:64
  ds_read_b64_tr_b16 v[198:199], v250 offset:4416
  buffer_load_dwordx4 v227, s[28:31], s50 offen lds
  s_waitcnt lgkmcnt(10)
  v_mfma_f32_32x32x16_bf16 a[192:207], v[208:211], v[28:31], a[192:207]
  ds_read_b64_tr_b16 v[200:201], v250 offset:128
  ds_read_b64_tr_b16 v[202:203], v250 offset:4480
  s_add_u32 s51, s49, 16384
  s_add_u32 m0, s47, 17696
  s_waitcnt lgkmcnt(10)
  v_mfma_f32_32x32x16_bf16 a[208:223], v[212:215], v[28:31], a[208:223]
  ds_read_b64_tr_b16 v[204:205], v250 offset:192
  ds_read_b64_tr_b16 v[206:207], v250 offset:4544
  buffer_load_dwordx4 v226, s[20:23], s51 offen offset:1024 nt lds
  s_waitcnt lgkmcnt(10)
  v_mfma_f32_32x32x16_bf16 a[224:239], v[216:219], v[28:31], a[224:239]
  ds_read_b64_tr_b16 v[208:209], v250 offset:256
  ds_read_b64_tr_b16 v[210:211], v250 offset:4608
  s_waitcnt lgkmcnt(10)
  v_mfma_f32_32x32x16_bf16 a[240:255], v[220:223], v[28:31], a[240:255]
  ds_read_b64_tr_b16 v[212:213], v250 offset:320
  ds_read_b64_tr_b16 v[214:215], v250 offset:4672
  s_waitcnt lgkmcnt(10)
  v_mfma_f32_32x32x16_bf16 a[0:15], v[192:195], v[32:35], a[0:15]
  ds_read_b64_tr_b16 v[216:217], v250 offset:384
  ds_read_b64_tr_b16 v[218:219], v250 offset:4736
  s_waitcnt lgkmcnt(10)
  v_mfma_f32_32x32x16_bf16 a[16:31], v[196:199], v[32:35], a[16:31]
  ds_read_b64_tr_b16 v[220:221], v250 offset:448
  ds_read_b64_tr_b16 v[222:223], v250 offset:4800
  s_waitcnt lgkmcnt(10)
  v_mfma_f32_32x32x16_bf16 a[32:47], v[200:203], v[32:35], a[32:47]
  ds_read_b64_tr_b16 v[192:193], v250 offset:512
  ds_read_b64_tr_b16 v[194:195], v250 offset:4864
  s_waitcnt lgkmcnt(10)
  v_mfma_f32_32x32x16_bf16 a[48:63], v[204:207], v[32:35], a[48:63]
  ds_read_b64_tr_b16 v[196:197], v250 offset:576
  ds_read_b64_tr_b16 v[198:199], v250 offset:4928
  s_waitcnt vmcnt(6)
  s_barrier
  s_waitcnt lgkmcnt(10)
  v_mfma_f32_32x32x16_bf16 a[64:79], v[208:211], v[32:35], a[64:79]
  ds_read_b64_tr_b16 v[200:201], v250 offset:640
  ds_read_b64_tr_b16 v[202:203], v250 offset:4992
  s_add_u32 m0, s45, 136192
  s_add_u32 s50, s46, 1441792
  buffer_load_dwordx4 v227, s[28:31], s50 offen lds
  s_waitcnt lgkmcnt(10)
  v_mfma_f32_32x32x16_bf16 a[80:95], v[212:215], v[32:35], a[80:95]
  ds_read_b64_tr_b16 v[204:205], v250 offset:704
  ds_read_b64_tr_b16 v[206:207], v250 offset:5056
  s_add_u32 m0, s45, 137280
  s_add_u32 s50, s46, 1449984
  buffer_load_dwordx4 v227, s[28:31], s50 offen lds
  s_waitcnt lgkmcnt(10)
  v_mfma_f32_32x32x16_bf16 a[96:111], v[216:219], v[32:35], a[96:111]
  ds_read_b64_tr_b16 v[208:209], v250 offset:768
  ds_read_b64_tr_b16 v[210:211], v250 offset:5120
  s_add_u32 m0, s45, 138368
  s_add_u32 s50, s46, 1458176
  buffer_load_dwordx4 v227, s[28:31], s50 offen lds
  s_waitcnt lgkmcnt(10)
  v_mfma_f32_32x32x16_bf16 a[112:127], v[220:223], v[32:35], a[112:127]
  ds_read_b64_tr_b16 v[212:213], v250 offset:832
  ds_read_b64_tr_b16 v[214:215], v250 offset:5184
  s_add_u32 m0, s45, 139456
  s_add_u32 s50, s46, 1466368
  buffer_load_dwordx4 v227, s[28:31], s50 offen lds
  s_waitcnt lgkmcnt(10)
  v_mfma_f32_32x32x16_bf16 a[128:143], v[192:195], v[32:35], a[128:143]
  ds_read_b64_tr_b16 v[216:217], v250 offset:896
  ds_read_b64_tr_b16 v[218:219], v250 offset:5248
  s_add_u32 s51, s49, 16384
  s_add_u32 m0, s47, 18224
  s_nop 0
  buffer_load_dwordx4 v226, s[20:23], s51 offen offset:1536 nt lds
  s_waitcnt lgkmcnt(10)
  v_mfma_f32_32x32x16_bf16 a[144:159], v[196:199], v[32:35], a[144:159]
  ds_read_b64_tr_b16 v[220:221], v250 offset:960
  ds_read_b64_tr_b16 v[222:223], v250 offset:5312
  s_add_u32 s51, s49, 0
  s_add_u32 m0, s45, 66560
  s_nop 0
  buffer_load_dwordx4 v226, s[24:27], s51 offen nt lds
  s_waitcnt lgkmcnt(10)
  v_mfma_f32_32x32x16_bf16 a[160:175], v[200:203], v[32:35], a[160:175]
  ds_read_b64_tr_b16 v[192:193], v250 offset:17408
  ds_read_b64_tr_b16 v[194:195], v250 offset:21760
  s_add_u32 m0, s48, 0
  s_add_u32 s51, s57, 512
  buffer_load_dwordx4 v112, s[16:19], s51 offen lds
  s_waitcnt lgkmcnt(10)
  v_mfma_f32_32x32x16_bf16 a[176:191], v[204:207], v[32:35], a[176:191]
  ds_read_b64_tr_b16 v[196:197], v250 offset:17472
  ds_read_b64_tr_b16 v[198:199], v250 offset:21824
  s_add_u32 m0, s48, 1024
  s_add_u32 s51, s57, 7680
  buffer_load_dwordx4 v113, s[16:19], s51 offen lds
  s_waitcnt lgkmcnt(10)
  v_mfma_f32_32x32x16_bf16 a[192:207], v[208:211], v[32:35], a[192:207]
  ds_read_b64_tr_b16 v[200:201], v250 offset:17536
  ds_read_b64_tr_b16 v[202:203], v250 offset:21888
  s_add_u32 m0, s48, 2048
  s_add_u32 s51, s57, 14848
  buffer_load_dwordx4 v112, s[16:19], s51 offen lds
  s_waitcnt lgkmcnt(10)
  v_mfma_f32_32x32x16_bf16 a[208:223], v[212:215], v[32:35], a[208:223]
  ds_read_b64_tr_b16 v[204:205], v250 offset:17600
  ds_read_b64_tr_b16 v[206:207], v250 offset:21952
  s_add_u32 m0, s48, 3072
  s_add_u32 s51, s57, 22016
  buffer_load_dwordx4 v113, s[16:19], s51 offen lds
  s_waitcnt lgkmcnt(10)
  v_mfma_f32_32x32x16_bf16 a[224:239], v[216:219], v[32:35], a[224:239]
  ds_read_b64_tr_b16 v[208:209], v250 offset:17664
  ds_read_b64_tr_b16 v[210:211], v250 offset:22016
  s_waitcnt lgkmcnt(10)
  v_mfma_f32_32x32x16_bf16 a[240:255], v[220:223], v[32:35], a[240:255]
  ds_read_b64_tr_b16 v[212:213], v250 offset:17728
  ds_read_b64_tr_b16 v[214:215], v250 offset:22080
  s_waitcnt lgkmcnt(10)
  v_mfma_f32_32x32x16_bf16 a[0:15], v[192:195], v[36:39], a[0:15]
  ds_read_b64_tr_b16 v[216:217], v250 offset:17792
  ds_read_b64_tr_b16 v[218:219], v250 offset:22144
  s_waitcnt lgkmcnt(10)
  v_mfma_f32_32x32x16_bf16 a[16:31], v[196:199], v[36:39], a[16:31]
  ds_read_b64_tr_b16 v[220:221], v250 offset:17856
  ds_read_b64_tr_b16 v[222:223], v250 offset:22208
  s_waitcnt lgkmcnt(10)
  v_mfma_f32_32x32x16_bf16 a[32:47], v[200:203], v[36:39], a[32:47]
  ds_read_b64_tr_b16 v[192:193], v250 offset:17920
  ds_read_b64_tr_b16 v[194:195], v250 offset:22272
  s_waitcnt lgkmcnt(10)
  v_mfma_f32_32x32x16_bf16 a[48:63], v[204:207], v[36:39], a[48:63]
  ds_read_b64_tr_b16 v[196:197], v250 offset:17984
  ds_read_b64_tr_b16 v[198:199], v250 offset:22336
  s_waitcnt vmcnt(11)
  s_barrier
  s_waitcnt lgkmcnt(10)
  v_mfma_f32_32x32x16_bf16 a[64:79], v[208:211], v[36:39], a[64:79]
  ds_read_b64_tr_b16 v[200:201], v250 offset:18048
  ds_read_b64_tr_b16 v[202:203], v250 offset:22400
  s_add_u32 m0, s45, 83968
  s_add_u32 s50, s46, 1572864
  buffer_load_dwordx4 v227, s[28:31], s50 offen lds
  s_waitcnt lgkmcnt(10)
  v_mfma_f32_32x32x16_bf16 a[80:95], v[212:215], v[36:39], a[80:95]
  ds_read_b64_tr_b16 v[204:205], v250 offset:18112
  ds_read_b64_tr_b16 v[206:207], v250 offset:22464
  s_add_u32 m0, s45, 85056
  s_add_u32 s50, s46, 1581056
  s_waitcnt lgkmcnt(10)
  v_mfma_f32_32x32x16_bf16 a[96:111], v[216:219], v[36:39], a[96:111]
  ds_read_b64_tr_b16 v[208:209], v250 offset:18176
  ds_read_b64_tr_b16 v[210:211], v250 offset:22528
  buffer_load_dwordx4 v227, s[28:31], s50 offen lds
  s_waitcnt lgkmcnt(10)
  v_mfma_f32_32x32x16_bf16 a[112:127], v[220:223], v[36:39], a[112:127]
  ds_read_b64_tr_b16 v[212:213], v250 offset:18240
  ds_read_b64_tr_b16 v[214:215], v250 offset:22592
  s_add_u32 m0, s45, 86144
  s_add_u32 s50, s46, 1589248
  s_waitcnt lgkmcnt(10)
  v_mfma_f32_32x32x16_bf16 a[128:143], v[192:195], v[36:39], a[128:143]
  ds_read_b64_tr_b16 v[216:217], v250 offset:18304
  ds_read_b64_tr_b16 v[218:219], v250 offset:22656
  buffer_load_dwordx4 v227, s[28:31], s50 offen lds
  s_waitcnt lgkmcnt(10)
  v_mfma_f32_32x32x16_bf16 a[144:159], v[196:199], v[36:39], a[144:159]
  ds_read_b64_tr_b16 v[220:221], v250 offset:18368
  ds_read_b64_tr_b16 v[222:223], v250 offset:22720
  s_add_u32 m0, s45, 87232
  s_add_u32 s50, s46, 1597440
  buffer_load_dwordx4 v227, s[28:31], s50 offen lds
  s_waitcnt lgkmcnt(10)
  v_mfma_f32_32x32x16_bf16 a[160:175], v[200:203], v[36:39], a[160:175]
  ds_read_b64_tr_b16 v[192:193], v250 offset:34816
  ds_read_b64_tr_b16 v[194:195], v250 offset:39168
  s_add_u32 s51, s49, 0
  s_add_u32 m0, s45, 67136
  s_waitcnt lgkmcnt(10)
  v_mfma_f32_32x32x16_bf16 a[176:191], v[204:207], v[36:39], a[176:191]
  ds_read_b64_tr_b16 v[196:197], v250 offset:34880
  ds_read_b64_tr_b16 v[198:199], v250 offset:39232
  buffer_load_dwordx4 v226, s[24:27], s51 offen offset:512 nt lds
  s_waitcnt lgkmcnt(10)
  v_mfma_f32_32x32x16_bf16 a[192:207], v[208:211], v[36:39], a[192:207]
  ds_read_b64_tr_b16 v[200:201], v250 offset:34944
  ds_read_b64_tr_b16 v[202:203], v250 offset:39296
  ds_read_b128 v[48:51], v114 offset:16384
  s_waitcnt lgkmcnt(11)
  v_mfma_f32_32x32x16_bf16 a[208:223], v[212:215], v[36:39], a[208:223]
  ds_read_b64_tr_b16 v[204:205], v250 offset:35008
  ds_read_b64_tr_b16 v[206:207], v250 offset:39360
  ds_read_b128 v[52:55], v115 offset:16384
  ds_read_b128 v[56:59], v116 offset:16384
  ds_read_b128 v[60:63], v117 offset:16384
  s_waitcnt lgkmcnt(14)
  v_mfma_f32_32x32x16_bf16 a[224:239], v[216:219], v[36:39], a[224:239]
  ds_read_b64_tr_b16 v[208:209], v250 offset:35072
  ds_read_b64_tr_b16 v[210:211], v250 offset:39424
  s_waitcnt lgkmcnt(14)
  v_mfma_f32_32x32x16_bf16 a[240:255], v[220:223], v[36:39], a[240:255]
  ds_read_b64_tr_b16 v[212:213], v250 offset:35136
  ds_read_b64_tr_b16 v[214:215], v250 offset:39488
  s_waitcnt lgkmcnt(14)
  v_mfma_f32_32x32x16_bf16 a[0:15], v[192:195], v[40:43], a[0:15]
  ds_read_b64_tr_b16 v[216:217], v250 offset:35200
  ds_read_b64_tr_b16 v[218:219], v250 offset:39552
  s_waitcnt lgkmcnt(14)
  v_mfma_f32_32x32x16_bf16 a[16:31], v[196:199], v[40:43], a[16:31]
  ds_read_b64_tr_b16 v[220:221], v250 offset:35264
  ds_read_b64_tr_b16 v[222:223], v250 offset:39616
  s_waitcnt lgkmcnt(14)
  v_mfma_f32_32x32x16_bf16 a[32:47], v[200:203], v[40:43], a[32:47]
  ds_read_b64_tr_b16 v[192:193], v250 offset:35328
  ds_read_b64_tr_b16 v[194:195], v250 offset:39680
  s_waitcnt lgkmcnt(13)
  v_mfma_f32_32x32x16_bf16 a[48:63], v[204:207], v[40:43], a[48:63]
  ds_read_b64_tr_b16 v[196:197], v250 offset:35392
  ds_read_b64_tr_b16 v[198:199], v250 offset:39744
  s_waitcnt vmcnt(11)
  s_barrier
  s_waitcnt lgkmcnt(10)
  v_mfma_f32_32x32x16_bf16 a[64:79], v[208:211], v[40:43], a[64:79]
  ds_read_b64_tr_b16 v[200:201], v250 offset:35456
  ds_read_b64_tr_b16 v[202:203], v250 offset:39808
  s_add_u32 m0, s45, 101376
  s_add_u32 s50, s46, 1703936
  buffer_load_dwordx4 v227, s[28:31], s50 offen lds
  s_waitcnt lgkmcnt(10)
  v_mfma_f32_32x32x16_bf16 a[80:95], v[212:215], v[40:43], a[80:95]
  ds_read_b64_tr_b16 v[204:205], v250 offset:35520
  ds_read_b64_tr_b16 v[206:207], v250 offset:39872
  s_add_u32 m0, s45, 102464
  s_add_u32 s50, s46, 1712128
  s_waitcnt lgkmcnt(10)
  v_mfma_f32_32x32x16_bf16 a[96:111], v[216:219], v[40:43], a[96:111]
  ds_read_b64_tr_b16 v[208:209], v250 offset:35584
  ds_read_b64_tr_b16 v[210:211], v250 offset:39936
  buffer_load_dwordx4 v227, s[28:31], s50 offen lds
  s_waitcnt lgkmcnt(10)
  v_mfma_f32_32x32x16_bf16 a[112:127], v[220:223], v[40:43], a[112:127]
  ds_read_b64_tr_b16 v[212:213], v250 offset:35648
  ds_read_b64_tr_b16 v[214:215], v250 offset:40000
  s_add_u32 m0, s45, 103552
  s_add_u32 s50, s46, 1720320
  s_waitcnt lgkmcnt(10)
  v_mfma_f32_32x32x16_bf16 a[128:143], v[192:195], v[40:43], a[128:143]
  ds_read_b64_tr_b16 v[216:217], v250 offset:35712
  ds_read_b64_tr_b16 v[218:219], v250 offset:40064
  buffer_load_dwordx4 v227, s[28:31], s50 offen lds
  s_waitcnt lgkmcnt(10)
  v_mfma_f32_32x32x16_bf16 a[144:159], v[196:199], v[40:43], a[144:159]
  ds_read_b64_tr_b16 v[220:221], v250 offset:35776
  ds_read_b64_tr_b16 v[222:223], v250 offset:40128
  s_add_u32 m0, s45, 104640
  s_add_u32 s50, s46, 1728512
  buffer_load_dwordx4 v227, s[28:31], s50 offen lds
  s_waitcnt lgkmcnt(10)
  v_mfma_f32_32x32x16_bf16 a[160:175], v[200:203], v[40:43], a[160:175]
  ds_read_b64_tr_b16 v[192:193], v250 offset:52224
  ds_read_b64_tr_b16 v[194:195], v250 offset:56576
  s_add_u32 s51, s49, 0
  s_add_u32 m0, s45, 67712
  s_waitcnt lgkmcnt(10)
  v_mfma_f32_32x32x16_bf16 a[176:191], v[204:207], v[40:43], a[176:191]
  ds_read_b64_tr_b16 v[196:197], v250 offset:52288
  ds_read_b64_tr_b16 v[198:199], v250 offset:56640
  buffer_load_dwordx4 v226, s[24:27], s51 offen offset:1024 nt lds
  s_waitcnt lgkmcnt(10)
  v_mfma_f32_32x32x16_bf16 a[192:207], v[208:211], v[40:43], a[192:207]
  ds_read_b64_tr_b16 v[200:201], v250 offset:52352
  ds_read_b64_tr_b16 v[202:203], v250 offset:56704
  s_add_u32 s51, s49, 0
  s_add_u32 m0, s45, 68288
  s_waitcnt lgkmcnt(10)
  v_mfma_f32_32x32x16_bf16 a[208:223], v[212:215], v[40:43], a[208:223]
  ds_read_b64_tr_b16 v[204:205], v250 offset:52416
  ds_read_b64_tr_b16 v[206:207], v250 offset:56768
  buffer_load_dwordx4 v226, s[24:27], s51 offen offset:1536 nt lds
  s_waitcnt lgkmcnt(10)
  v_mfma_f32_32x32x16_bf16 a[224:239], v[216:219], v[40:43], a[224:239]
  ds_read_b64_tr_b16 v[208:209], v250 offset:52480
  ds_read_b64_tr_b16 v[210:211], v250 offset:56832
  s_waitcnt lgkmcnt(10)
  v_mfma_f32_32x32x16_bf16 a[240:255], v[220:223], v[40:43], a[240:255]
  ds_read_b64_tr_b16 v[212:213], v250 offset:52544
  ds_read_b64_tr_b16 v[214:215], v250 offset:56896
  s_waitcnt lgkmcnt(10)
  v_mfma_f32_32x32x16_bf16 a[0:15], v[192:195], v[44:47], a[0:15]
  ds_read_b64_tr_b16 v[216:217], v250 offset:52608
  ds_read_b64_tr_b16 v[218:219], v250 offset:56960
  s_waitcnt lgkmcnt(10)
  v_mfma_f32_32x32x16_bf16 a[16:31], v[196:199], v[44:47], a[16:31]
  ds_read_b64_tr_b16 v[220:221], v250 offset:52672
  ds_read_b64_tr_b16 v[222:223], v250 offset:57024
  s_waitcnt lgkmcnt(10)
  v_mfma_f32_32x32x16_bf16 a[32:47], v[200:203], v[44:47], a[32:47]
  ds_read_b64_tr_b16 v[192:193], v250 offset:52736
  ds_read_b64_tr_b16 v[194:195], v250 offset:57088
  s_waitcnt lgkmcnt(10)
  v_mfma_f32_32x32x16_bf16 a[48:63], v[204:207], v[44:47], a[48:63]
  ds_read_b64_tr_b16 v[196:197], v250 offset:52800
  ds_read_b64_tr_b16 v[198:199], v250 offset:57152
  s_waitcnt vmcnt(7)
  s_barrier
  s_waitcnt lgkmcnt(10)
  v_mfma_f32_32x32x16_bf16 a[64:79], v[208:211], v[44:47], a[64:79]
  ds_read_b64_tr_b16 v[200:201], v250 offset:52864
  ds_read_b64_tr_b16 v[202:203], v250 offset:57216
  s_add_u32 m0, s45, 118784
  s_add_u32 s50, s46, 1835008
  s_waitcnt lgkmcnt(10)
  v_mfma_f32_32x32x16_bf16 a[80:95], v[212:215], v[44:47], a[80:95]
  ds_read_b64_tr_b16 v[204:205], v250 offset:52928
  ds_read_b64_tr_b16 v[206:207], v250 offset:57280
  buffer_load_dwordx4 v227, s[28:31], s50 offen lds
  s_waitcnt lgkmcnt(10)
  v_mfma_f32_32x32x16_bf16 a[96:111], v[216:219], v[44:47], a[96:111]
  ds_read_b64_tr_b16 v[208:209], v250 offset:52992
  ds_read_b64_tr_b16 v[210:211], v250 offset:57344
  s_add_u32 m0, s45, 119872
  s_add_u32 s50, s46, 1843200
  s_waitcnt lgkmcnt(10)
  v_mfma_f32_32x32x16_bf16 a[112:127], v[220:223], v[44:47], a[112:127]
  ds_read_b64_tr_b16 v[212:213], v250 offset:53056
  ds_read_b64_tr_b16 v[214:215], v250 offset:57408
  buffer_load_dwordx4 v227, s[28:31], s50 offen lds
  s_waitcnt lgkmcnt(10)
  v_mfma_f32_32x32x16_bf16 a[128:143], v[192:195], v[44:47], a[128:143]
  ds_read_b64_tr_b16 v[216:217], v250 offset:53120
  ds_read_b64_tr_b16 v[218:219], v250 offset:57472
  s_add_u32 m0, s45, 120960
  s_add_u32 s50, s46, 1851392
  s_waitcnt lgkmcnt(10)
  v_mfma_f32_32x32x16_bf16 a[144:159], v[196:199], v[44:47], a[144:159]
  ds_read_b64_tr_b16 v[220:221], v250 offset:53184
  ds_read_b64_tr_b16 v[222:223], v250 offset:57536
  buffer_load_dwordx4 v227, s[28:31], s50 offen lds
  s_waitcnt lgkmcnt(10)
  v_mfma_f32_32x32x16_bf16 a[160:175], v[200:203], v[44:47], a[160:175]
  ds_read_b64_tr_b16 v[192:193], v250 offset:0
  ds_read_b64_tr_b16 v[194:195], v250 offset:4352
  s_add_u32 m0, s45, 122048
  s_add_u32 s50, s46, 1859584
  s_waitcnt lgkmcnt(10)
  v_mfma_f32_32x32x16_bf16 a[176:191], v[204:207], v[44:47], a[176:191]
  ds_read_b64_tr_b16 v[196:197], v250 offset:64
  ds_read_b64_tr_b16 v[198:199], v250 offset:4416
  buffer_load_dwordx4 v227, s[28:31], s50 offen lds
  s_waitcnt lgkmcnt(10)
  v_mfma_f32_32x32x16_bf16 a[192:207], v[208:211], v[44:47], a[192:207]
  ds_read_b64_tr_b16 v[200:201], v250 offset:128
  ds_read_b64_tr_b16 v[202:203], v250 offset:4480
  s_add_u32 s51, s49, 16384
  s_waitcnt lgkmcnt(10)
  v_mfma_f32_32x32x16_bf16 a[208:223], v[212:215], v[44:47], a[208:223]
  ds_read_b64_tr_b16 v[204:205], v250 offset:192
  ds_read_b64_tr_b16 v[206:207], v250 offset:4544
  buffer_load_dwordx4 v[128:131], v226, s[24:27], s51 offen nt
  s_waitcnt lgkmcnt(10)
  v_mfma_f32_32x32x16_bf16 a[224:239], v[216:219], v[44:47], a[224:239]
  ds_read_b64_tr_b16 v[208:209], v250 offset:256
  ds_read_b64_tr_b16 v[210:211], v250 offset:4608
  s_waitcnt lgkmcnt(10)
  v_mfma_f32_32x32x16_bf16 a[240:255], v[220:223], v[44:47], a[240:255]
  ds_read_b64_tr_b16 v[212:213], v250 offset:320
  ds_read_b64_tr_b16 v[214:215], v250 offset:4672
  s_waitcnt lgkmcnt(10)
  v_mfma_f32_32x32x16_bf16 a[0:15], v[192:195], v[48:51], a[0:15]
  ds_read_b64_tr_b16 v[216:217], v250 offset:384
  ds_read_b64_tr_b16 v[218:219], v250 offset:4736
  s_waitcnt lgkmcnt(10)
  v_mfma_f32_32x32x16_bf16 a[16:31], v[196:199], v[48:51], a[16:31]
  ds_read_b64_tr_b16 v[220:221], v250 offset:448
  ds_read_b64_tr_b16 v[222:223], v250 offset:4800
  s_waitcnt lgkmcnt(10)
  v_mfma_f32_32x32x16_bf16 a[32:47], v[200:203], v[48:51], a[32:47]
  ds_read_b64_tr_b16 v[192:193], v250 offset:512
  ds_read_b64_tr_b16 v[194:195], v250 offset:4864
  s_waitcnt lgkmcnt(10)
  v_mfma_f32_32x32x16_bf16 a[48:63], v[204:207], v[48:51], a[48:63]
  ds_read_b64_tr_b16 v[196:197], v250 offset:576
  ds_read_b64_tr_b16 v[198:199], v250 offset:4928
  s_waitcnt vmcnt(7)
  s_barrier
  s_waitcnt lgkmcnt(10)
  v_mfma_f32_32x32x16_bf16 a[64:79], v[208:211], v[48:51], a[64:79]
  ds_read_b64_tr_b16 v[200:201], v250 offset:640
  ds_read_b64_tr_b16 v[202:203], v250 offset:4992
  s_add_u32 m0, s45, 136192
  s_add_u32 s50, s46, 1966080
  buffer_load_dwordx4 v227, s[28:31], s50 offen lds
  s_waitcnt lgkmcnt(10)
  v_mfma_f32_32x32x16_bf16 a[80:95], v[212:215], v[48:51], a[80:95]
  ds_read_b64_tr_b16 v[204:205], v250 offset:704
  ds_read_b64_tr_b16 v[206:207], v250 offset:5056
  s_add_u32 m0, s45, 137280
  s_add_u32 s50, s46, 1974272
  buffer_load_dwordx4 v227, s[28:31], s50 offen lds
  s_waitcnt lgkmcnt(10)
  v_mfma_f32_32x32x16_bf16 a[96:111], v[216:219], v[48:51], a[96:111]
  ds_read_b64_tr_b16 v[208:209], v250 offset:768
  ds_read_b64_tr_b16 v[210:211], v250 offset:5120
  s_add_u32 m0, s45, 138368
  s_add_u32 s50, s46, 1982464
  s_waitcnt lgkmcnt(10)
  v_mfma_f32_32x32x16_bf16 a[112:127], v[220:223], v[48:51], a[112:127]
  ds_read_b64_tr_b16 v[212:213], v250 offset:832
  ds_read_b64_tr_b16 v[214:215], v250 offset:5184
  buffer_load_dwordx4 v227, s[28:31], s50 offen lds
  s_add_u32 m0, s45, 139456
  s_add_u32 s50, s46, 1990656
  s_waitcnt lgkmcnt(10)
  v_mfma_f32_32x32x16_bf16 a[128:143], v[192:195], v[48:51], a[128:143]
  ds_read_b64_tr_b16 v[216:217], v250 offset:896
  ds_read_b64_tr_b16 v[218:219], v250 offset:5248
  buffer_load_dwordx4 v227, s[28:31], s50 offen lds
  s_add_u32 s51, s49, 16384
  s_waitcnt lgkmcnt(10)
  v_mfma_f32_32x32x16_bf16 a[144:159], v[196:199], v[48:51], a[144:159]
  ds_read_b64_tr_b16 v[220:221], v250 offset:960
  ds_read_b64_tr_b16 v[222:223], v250 offset:5312
  buffer_load_dwordx4 v[132:135], v226, s[24:27], s51 offen offset:512 nt
  s_add_u32 m0, s48, 16384
  s_add_u32 s51, s57, 640
  buffer_load_dwordx4 v112, s[16:19], s51 offen lds
  s_waitcnt lgkmcnt(10)
  v_mfma_f32_32x32x16_bf16 a[160:175], v[200:203], v[48:51], a[160:175]
  ds_read_b64_tr_b16 v[192:193], v250 offset:17408
  ds_read_b64_tr_b16 v[194:195], v250 offset:21760
  s_add_u32 m0, s48, 17408
  s_add_u32 s51, s57, 7808
  s_waitcnt lgkmcnt(10)
  v_mfma_f32_32x32x16_bf16 a[176:191], v[204:207], v[48:51], a[176:191]
  ds_read_b64_tr_b16 v[196:197], v250 offset:17472
  ds_read_b64_tr_b16 v[198:199], v250 offset:21824
  buffer_load_dwordx4 v113, s[16:19], s51 offen lds
  s_add_u32 m0, s48, 18432
  s_add_u32 s51, s57, 14976
  s_waitcnt lgkmcnt(10)
  v_mfma_f32_32x32x16_bf16 a[192:207], v[208:211], v[48:51], a[192:207]
  ds_read_b64_tr_b16 v[200:201], v250 offset:17536
  ds_read_b64_tr_b16 v[202:203], v250 offset:21888
  buffer_load_dwordx4 v112, s[16:19], s51 offen lds
  s_add_u32 m0, s48, 19456
  s_add_u32 s51, s57, 22144
  s_waitcnt lgkmcnt(10)
  v_mfma_f32_32x32x16_bf16 a[208:223], v[212:215], v[48:51], a[208:223]
  ds_read_b64_tr_b16 v[204:205], v250 offset:17600
  ds_read_b64_tr_b16 v[206:207], v250 offset:21952
  buffer_load_dwordx4 v113, s[16:19], s51 offen lds
  s_waitcnt lgkmcnt(10)
  v_mfma_f32_32x32x16_bf16 a[224:239], v[216:219], v[48:51], a[224:239]
  ds_read_b64_tr_b16 v[208:209], v250 offset:17664
  ds_read_b64_tr_b16 v[210:211], v250 offset:22016
  s_waitcnt lgkmcnt(10)
  v_mfma_f32_32x32x16_bf16 a[240:255], v[220:223], v[48:51], a[240:255]
  ds_read_b64_tr_b16 v[212:213], v250 offset:17728
  ds_read_b64_tr_b16 v[214:215], v250 offset:22080
  s_waitcnt lgkmcnt(10)
  v_mfma_f32_32x32x16_bf16 a[0:15], v[192:195], v[52:55], a[0:15]
  ds_read_b64_tr_b16 v[216:217], v250 offset:17792
  ds_read_b64_tr_b16 v[218:219], v250 offset:22144
  s_waitcnt lgkmcnt(10)
  v_mfma_f32_32x32x16_bf16 a[16:31], v[196:199], v[52:55], a[16:31]
  ds_read_b64_tr_b16 v[220:221], v250 offset:17856
  ds_read_b64_tr_b16 v[222:223], v250 offset:22208
  s_waitcnt lgkmcnt(10)
  v_mfma_f32_32x32x16_bf16 a[32:47], v[200:203], v[52:55], a[32:47]
  ds_read_b64_tr_b16 v[192:193], v250 offset:17920
  ds_read_b64_tr_b16 v[194:195], v250 offset:22272
  s_waitcnt lgkmcnt(10)
  v_mfma_f32_32x32x16_bf16 a[48:63], v[204:207], v[52:55], a[48:63]
  ds_read_b64_tr_b16 v[196:197], v250 offset:17984
  ds_read_b64_tr_b16 v[198:199], v250 offset:22336
  s_waitcnt vmcnt(10)
  s_barrier
  s_waitcnt lgkmcnt(10)
  v_mfma_f32_32x32x16_bf16 a[64:79], v[208:211], v[52:55], a[64:79]
  ds_read_b64_tr_b16 v[200:201], v250 offset:18048
  ds_read_b64_tr_b16 v[202:203], v250 offset:22400
  s_add_u32 m0, s45, 83968
  s_add_u32 s50, s46, 2097152
  buffer_load_dwordx4 v227, s[28:31], s50 offen lds
  s_waitcnt lgkmcnt(10)
  v_mfma_f32_32x32x16_bf16 a[80:95], v[212:215], v[52:55], a[80:95]
  ds_read_b64_tr_b16 v[204:205], v250 offset:18112
  ds_read_b64_tr_b16 v[206:207], v250 offset:22464
  s_add_u32 m0, s45, 85056
  s_add_u32 s50, s46, 2105344
  s_waitcnt lgkmcnt(10)
  v_mfma_f32_32x32x16_bf16 a[96:111], v[216:219], v[52:55], a[96:111]
  ds_read_b64_tr_b16 v[208:209], v250 offset:18176
  ds_read_b64_tr_b16 v[210:211], v250 offset:22528
  buffer_load_dwordx4 v227, s[28:31], s50 offen lds
  s_waitcnt lgkmcnt(10)
  v_mfma_f32_32x32x16_bf16 a[112:127], v[220:223], v[52:55], a[112:127]
  ds_read_b64_tr_b16 v[212:213], v250 offset:18240
  ds_read_b64_tr_b16 v[214:215], v250 offset:22592
  s_add_u32 m0, s45, 86144
  s_add_u32 s50, s46, 2113536
  s_waitcnt lgkmcnt(10)
  v_mfma_f32_32x32x16_bf16 a[128:143], v[192:195], v[52:55], a[128:143]
  ds_read_b64_tr_b16 v[216:217], v250 offset:18304
  ds_read_b64_tr_b16 v[218:219], v250 offset:22656
  buffer_load_dwordx4 v227, s[28:31], s50 offen lds
  s_waitcnt lgkmcnt(10)
  v_mfma_f32_32x32x16_bf16 a[144:159], v[196:199], v[52:55], a[144:159]
  ds_read_b64_tr_b16 v[220:221], v250 offset:18368
  ds_read_b64_tr_b16 v[222:223], v250 offset:22720
  s_add_u32 m0, s45, 87232
  s_add_u32 s50, s46, 2121728
  buffer_load_dwordx4 v227, s[28:31], s50 offen lds
  s_waitcnt lgkmcnt(10)
  v_mfma_f32_32x32x16_bf16 a[160:175], v[200:203], v[52:55], a[160:175]
  ds_read_b64_tr_b16 v[192:193], v250 offset:34816
  ds_read_b64_tr_b16 v[194:195], v250 offset:39168
  s_add_u32 s51, s49, 16384
  s_waitcnt lgkmcnt(10)
  v_mfma_f32_32x32x16_bf16 a[176:191], v[204:207], v[52:55], a[176:191]
  ds_read_b64_tr_b16 v[196:197], v250 offset:34880
  ds_read_b64_tr_b16 v[198:199], v250 offset:39232
  buffer_load_dwordx4 v[136:139], v226, s[24:27], s51 offen offset:1024 nt
  s_add_u32 s51, s49, 16384
  buffer_load_dwordx4 v[140:143], v226, s[24:27], s51 offen offset:1536 nt
  s_waitcnt lgkmcnt(10)
  v_mfma_f32_32x32x16_bf16 a[192:207], v[208:211], v[52:55], a[192:207]
  ds_read_b64_tr_b16 v[200:201], v250 offset:34944
  ds_read_b64_tr_b16 v[202:203], v250 offset:39296
  ds_read_b128 v[64:67], v114 offset:0
  s_waitcnt lgkmcnt(11)
  v_mfma_f32_32x32x16_bf16 a[208:223], v[212:215], v[52:55], a[208:223]
  ds_read_b64_tr_b16 v[204:205], v250 offset:35008
  ds_read_b64_tr_b16 v[206:207], v250 offset:39360
  ds_read_b128 v[68:71], v115 offset:0
  ds_read_b128 v[72:75], v116 offset:0
  ds_read_b128 v[76:79], v117 offset:0
  s_waitcnt lgkmcnt(14)
  v_mfma_f32_32x32x16_bf16 a[224:239], v[216:219], v[52:55], a[224:239]
  ds_read_b64_tr_b16 v[208:209], v250 offset:35072
  ds_read_b64_tr_b16 v[210:211], v250 offset:39424
  s_waitcnt lgkmcnt(14)
  v_mfma_f32_32x32x16_bf16 a[240:255], v[220:223], v[52:55], a[240:255]
  ds_read_b64_tr_b16 v[212:213], v250 offset:35136
  ds_read_b64_tr_b16 v[214:215], v250 offset:39488
  s_waitcnt lgkmcnt(14)
  v_mfma_f32_32x32x16_bf16 a[0:15], v[192:195], v[56:59], a[0:15]
  ds_read_b64_tr_b16 v[216:217], v250 offset:35200
  ds_read_b64_tr_b16 v[218:219], v250 offset:39552
  s_waitcnt lgkmcnt(14)
  v_mfma_f32_32x32x16_bf16 a[16:31], v[196:199], v[56:59], a[16:31]
  ds_read_b64_tr_b16 v[220:221], v250 offset:35264
  ds_read_b64_tr_b16 v[222:223], v250 offset:39616
  s_waitcnt lgkmcnt(14)
  v_mfma_f32_32x32x16_bf16 a[32:47], v[200:203], v[56:59], a[32:47]
  ds_read_b64_tr_b16 v[192:193], v250 offset:35328
  ds_read_b64_tr_b16 v[194:195], v250 offset:39680
  s_waitcnt lgkmcnt(13)
  v_mfma_f32_32x32x16_bf16 a[48:63], v[204:207], v[56:59], a[48:63]
  ds_read_b64_tr_b16 v[196:197], v250 offset:35392
  ds_read_b64_tr_b16 v[198:199], v250 offset:39744
  s_waitcnt vmcnt(11)
  s_barrier
  s_waitcnt lgkmcnt(10)
  v_mfma_f32_32x32x16_bf16 a[64:79], v[208:211], v[56:59], a[64:79]
  ds_read_b64_tr_b16 v[200:201], v250 offset:35456
  ds_read_b64_tr_b16 v[202:203], v250 offset:39808
  s_add_u32 m0, s45, 101376
  s_add_u32 s50, s46, 2228224
  s_waitcnt lgkmcnt(10)
  v_mfma_f32_32x32x16_bf16 a[80:95], v[212:215], v[56:59], a[80:95]
  ds_read_b64_tr_b16 v[204:205], v250 offset:35520
  ds_read_b64_tr_b16 v[206:207], v250 offset:39872
  buffer_load_dwordx4 v227, s[28:31], s50 offen lds
  s_waitcnt lgkmcnt(10)
  v_mfma_f32_32x32x16_bf16 a[96:111], v[216:219], v[56:59], a[96:111]
  ds_read_b64_tr_b16 v[208:209], v250 offset:35584
  ds_read_b64_tr_b16 v[210:211], v250 offset:39936
  s_add_u32 m0, s45, 102464
  s_add_u32 s50, s46, 2236416
  s_waitcnt lgkmcnt(10)
  v_mfma_f32_32x32x16_bf16 a[112:127], v[220:223], v[56:59], a[112:127]
  ds_read_b64_tr_b16 v[212:213], v250 offset:35648
  ds_read_b64_tr_b16 v[214:215], v250 offset:40000
  buffer_load_dwordx4 v227, s[28:31], s50 offen lds
  s_waitcnt lgkmcnt(10)
  v_mfma_f32_32x32x16_bf16 a[128:143], v[192:195], v[56:59], a[128:143]
  ds_read_b64_tr_b16 v[216:217], v250 offset:35712
  ds_read_b64_tr_b16 v[218:219], v250 offset:40064
  s_add_u32 m0, s45, 103552
  s_add_u32 s50, s46, 2244608
  s_waitcnt lgkmcnt(10)
  v_mfma_f32_32x32x16_bf16 a[144:159], v[196:199], v[56:59], a[144:159]
  ds_read_b64_tr_b16 v[220:221], v250 offset:35776
  ds_read_b64_tr_b16 v[222:223], v250 offset:40128
  buffer_load_dwordx4 v227, s[28:31], s50 offen lds
  s_waitcnt lgkmcnt(10)
  v_mfma_f32_32x32x16_bf16 a[160:175], v[200:203], v[56:59], a[160:175]
  ds_read_b64_tr_b16 v[192:193], v250 offset:52224
  ds_read_b64_tr_b16 v[194:195], v250 offset:56576
  s_add_u32 m0, s45, 104640
  s_add_u32 s50, s46, 2252800
  s_waitcnt lgkmcnt(10)
  v_mfma_f32_32x32x16_bf16 a[176:191], v[204:207], v[56:59], a[176:191]
  ds_read_b64_tr_b16 v[196:197], v250 offset:52288
  ds_read_b64_tr_b16 v[198:199], v250 offset:56640
  buffer_load_dwordx4 v227, s[28:31], s50 offen lds
  s_waitcnt lgkmcnt(10)
  v_mfma_f32_32x32x16_bf16 a[192:207], v[208:211], v[56:59], a[192:207]
  ds_read_b64_tr_b16 v[200:201], v250 offset:52352
  ds_read_b64_tr_b16 v[202:203], v250 offset:56704
  s_add_u32 s51, s49, 32768
  s_waitcnt lgkmcnt(10)
  v_mfma_f32_32x32x16_bf16 a[208:223], v[212:215], v[56:59], a[208:223]
  ds_read_b64_tr_b16 v[204:205], v250 offset:52416
  ds_read_b64_tr_b16 v[206:207], v250 offset:56768
  buffer_load_dwordx4 v[144:147], v226, s[24:27], s51 offen nt
  s_waitcnt lgkmcnt(10)
  v_mfma_f32_32x32x16_bf16 a[224:239], v[216:219], v[56:59], a[224:239]
  ds_read_b64_tr_b16 v[208:209], v250 offset:52480
  ds_read_b64_tr_b16 v[210:211], v250 offset:56832
  s_waitcnt lgkmcnt(10)
  v_mfma_f32_32x32x16_bf16 a[240:255], v[220:223], v[56:59], a[240:255]
  ds_read_b64_tr_b16 v[212:213], v250 offset:52544
  ds_read_b64_tr_b16 v[214:215], v250 offset:56896
  s_waitcnt lgkmcnt(10)
  v_mfma_f32_32x32x16_bf16 a[0:15], v[192:195], v[60:63], a[0:15]
  ds_read_b64_tr_b16 v[216:217], v250 offset:52608
  ds_read_b64_tr_b16 v[218:219], v250 offset:56960
  s_waitcnt lgkmcnt(10)
  v_mfma_f32_32x32x16_bf16 a[16:31], v[196:199], v[60:63], a[16:31]
  ds_read_b64_tr_b16 v[220:221], v250 offset:52672
  ds_read_b64_tr_b16 v[222:223], v250 offset:57024
  s_waitcnt lgkmcnt(10)
  v_mfma_f32_32x32x16_bf16 a[32:47], v[200:203], v[60:63], a[32:47]
  ds_read_b64_tr_b16 v[192:193], v250 offset:52736
  ds_read_b64_tr_b16 v[194:195], v250 offset:57088
  s_waitcnt lgkmcnt(10)
  v_mfma_f32_32x32x16_bf16 a[48:63], v[204:207], v[60:63], a[48:63]
  ds_read_b64_tr_b16 v[196:197], v250 offset:52800
  ds_read_b64_tr_b16 v[198:199], v250 offset:57152
  s_waitcnt vmcnt(7)
  s_barrier
  s_waitcnt lgkmcnt(10)
  v_mfma_f32_32x32x16_bf16 a[64:79], v[208:211], v[60:63], a[64:79]
  ds_read_b64_tr_b16 v[200:201], v250 offset:52864
  ds_read_b64_tr_b16 v[202:203], v250 offset:57216
  s_add_u32 m0, s45, 118784
  s_add_u32 s50, s46, 2359296
  s_waitcnt lgkmcnt(10)
  v_mfma_f32_32x32x16_bf16 a[80:95], v[212:215], v[60:63], a[80:95]
  ds_read_b64_tr_b16 v[204:205], v250 offset:52928
  ds_read_b64_tr_b16 v[206:207], v250 offset:57280
  buffer_load_dwordx4 v227, s[28:31], s50 offen lds
  s_waitcnt lgkmcnt(10)
  v_mfma_f32_32x32x16_bf16 a[96:111], v[216:219], v[60:63], a[96:111]
  ds_read_b64_tr_b16 v[208:209], v250 offset:52992
  ds_read_b64_tr_b16 v[210:211], v250 offset:57344
  s_add_u32 m0, s45, 119872
  s_add_u32 s50, s46, 2367488
  s_waitcnt lgkmcnt(10)
  v_mfma_f32_32x32x16_bf16 a[112:127], v[220:223], v[60:63], a[112:127]
  ds_read_b64_tr_b16 v[212:213], v250 offset:53056
  ds_read_b64_tr_b16 v[214:215], v250 offset:57408
  buffer_load_dwordx4 v227, s[28:31], s50 offen lds
  s_waitcnt lgkmcnt(10)
  v_mfma_f32_32x32x16_bf16 a[128:143], v[192:195], v[60:63], a[128:143]
  ds_read_b64_tr_b16 v[216:217], v250 offset:53120
  ds_read_b64_tr_b16 v[218:219], v250 offset:57472
  s_add_u32 m0, s45, 120960
  s_add_u32 s50, s46, 2375680
  s_waitcnt lgkmcnt(10)
  v_mfma_f32_32x32x16_bf16 a[144:159], v[196:199], v[60:63], a[144:159]
  ds_read_b64_tr_b16 v[220:221], v250 offset:53184
  ds_read_b64_tr_b16 v[222:223], v250 offset:57536
  buffer_load_dwordx4 v227, s[28:31], s50 offen lds
  s_waitcnt lgkmcnt(10)
  v_mfma_f32_32x32x16_bf16 a[160:175], v[200:203], v[60:63], a[160:175]
  ds_read_b64_tr_b16 v[192:193], v250 offset:0
  ds_read_b64_tr_b16 v[194:195], v250 offset:4352
  s_add_u32 m0, s45, 122048
  s_add_u32 s50, s46, 2383872
  s_waitcnt lgkmcnt(10)
  v_mfma_f32_32x32x16_bf16 a[176:191], v[204:207], v[60:63], a[176:191]
  ds_read_b64_tr_b16 v[196:197], v250 offset:64
  ds_read_b64_tr_b16 v[198:199], v250 offset:4416
  buffer_load_dwordx4 v227, s[28:31], s50 offen lds
  s_waitcnt lgkmcnt(10)
  v_mfma_f32_32x32x16_bf16 a[192:207], v[208:211], v[60:63], a[192:207]
  ds_read_b64_tr_b16 v[200:201], v250 offset:128
  ds_read_b64_tr_b16 v[202:203], v250 offset:4480
  s_add_u32 s51, s49, 32768
  buffer_load_dwordx4 v[148:151], v226, s[24:27], s51 offen offset:512 nt
  s_waitcnt lgkmcnt(10)
  v_mfma_f32_32x32x16_bf16 a[208:223], v[212:215], v[60:63], a[208:223]
  ds_read_b64_tr_b16 v[204:205], v250 offset:192
  ds_read_b64_tr_b16 v[206:207], v250 offset:4544
  s_add_u32 s51, s49, 32768
  buffer_load_dwordx4 v[152:155], v226, s[24:27], s51 offen offset:1024 nt
  s_waitcnt lgkmcnt(10)
  v_mfma_f32_32x32x16_bf16 a[224:239], v[216:219], v[60:63], a[224:239]
  ds_read_b64_tr_b16 v[208:209], v250 offset:256
  ds_read_b64_tr_b16 v[210:211], v250 offset:4608
  s_waitcnt lgkmcnt(10)
  v_mfma_f32_32x32x16_bf16 a[240:255], v[220:223], v[60:63], a[240:255]
  ds_read_b64_tr_b16 v[212:213], v250 offset:320
  ds_read_b64_tr_b16 v[214:215], v250 offset:4672
  s_waitcnt lgkmcnt(10)
  v_mfma_f32_32x32x16_bf16 a[0:15], v[192:195], v[64:67], a[0:15]
  ds_read_b64_tr_b16 v[216:217], v250 offset:384
  ds_read_b64_tr_b16 v[218:219], v250 offset:4736
  s_waitcnt lgkmcnt(10)
  v_mfma_f32_32x32x16_bf16 a[16:31], v[196:199], v[64:67], a[16:31]
  ds_read_b64_tr_b16 v[220:221], v250 offset:448
  ds_read_b64_tr_b16 v[222:223], v250 offset:4800
  s_waitcnt lgkmcnt(10)
  v_mfma_f32_32x32x16_bf16 a[32:47], v[200:203], v[64:67], a[32:47]
  ds_read_b64_tr_b16 v[192:193], v250 offset:512
  ds_read_b64_tr_b16 v[194:195], v250 offset:4864
  s_waitcnt lgkmcnt(10)
  v_mfma_f32_32x32x16_bf16 a[48:63], v[204:207], v[64:67], a[48:63]
  ds_read_b64_tr_b16 v[196:197], v250 offset:576
  ds_read_b64_tr_b16 v[198:199], v250 offset:4928
  s_waitcnt vmcnt(7)
  s_barrier
  s_waitcnt lgkmcnt(10)
  v_mfma_f32_32x32x16_bf16 a[64:79], v[208:211], v[64:67], a[64:79]
  ds_read_b64_tr_b16 v[200:201], v250 offset:640
  ds_read_b64_tr_b16 v[202:203], v250 offset:4992
  s_add_u32 m0, s45, 136192
  s_add_u32 s50, s46, 2490368
  buffer_load_dwordx4 v227, s[28:31], s50 offen lds
  s_waitcnt lgkmcnt(10)
  v_mfma_f32_32x32x16_bf16 a[80:95], v[212:215], v[64:67], a[80:95]
  ds_read_b64_tr_b16 v[204:205], v250 offset:704
  ds_read_b64_tr_b16 v[206:207], v250 offset:5056
  s_add_u32 m0, s45, 137280
  s_add_u32 s50, s46, 2498560
  buffer_load_dwordx4 v227, s[28:31], s50 offen lds
  s_waitcnt lgkmcnt(10)
  v_mfma_f32_32x32x16_bf16 a[96:111], v[216:219], v[64:67], a[96:111]
  ds_read_b64_tr_b16 v[208:209], v250 offset:768
  ds_read_b64_tr_b16 v[210:211], v250 offset:5120
  s_add_u32 m0, s45, 138368
  s_add_u32 s50, s46, 2506752
  s_waitcnt lgkmcnt(10)
  v_mfma_f32_32x32x16_bf16 a[112:127], v[220:223], v[64:67], a[112:127]
  ds_read_b64_tr_b16 v[212:213], v250 offset:832
  ds_read_b64_tr_b16 v[214:215], v250 offset:5184
  buffer_load_dwordx4 v227, s[28:31], s50 offen lds
  s_add_u32 m0, s45, 139456
  s_add_u32 s50, s46, 2514944
  s_waitcnt lgkmcnt(10)
  v_mfma_f32_32x32x16_bf16 a[128:143], v[192:195], v[64:67], a[128:143]
  ds_read_b64_tr_b16 v[216:217], v250 offset:896
  ds_read_b64_tr_b16 v[218:219], v250 offset:5248
  buffer_load_dwordx4 v227, s[28:31], s50 offen lds
  s_add_u32 s51, s49, 32768
  s_waitcnt lgkmcnt(10)
  v_mfma_f32_32x32x16_bf16 a[144:159], v[196:199], v[64:67], a[144:159]
  ds_read_b64_tr_b16 v[220:221], v250 offset:960
  ds_read_b64_tr_b16 v[222:223], v250 offset:5312
  buffer_load_dwordx4 v[156:159], v226, s[24:27], s51 offen offset:1536 nt
  s_add_u32 m0, s48, 0
  s_add_u32 s51, s57, 768
  buffer_load_dwordx4 v112, s[16:19], s51 offen lds
  s_waitcnt lgkmcnt(10)
  v_mfma_f32_32x32x16_bf16 a[160:175], v[200:203], v[64:67], a[160:175]
  ds_read_b64_tr_b16 v[192:193], v250 offset:17408
  ds_read_b64_tr_b16 v[194:195], v250 offset:21760
  s_add_u32 m0, s48, 1024
  s_add_u32 s51, s57, 7936
  s_waitcnt lgkmcnt(10)
  v_mfma_f32_32x32x16_bf16 a[176:191], v[204:207], v[64:67], a[176:191]
  ds_read_b64_tr_b16 v[196:197], v250 offset:17472
  ds_read_b64_tr_b16 v[198:199], v250 offset:21824
  buffer_load_dwordx4 v113, s[16:19], s51 offen lds
  s_add_u32 m0, s48, 2048
  s_add_u32 s51, s57, 15104
  s_waitcnt lgkmcnt(10)
  v_mfma_f32_32x32x16_bf16 a[192:207], v[208:211], v[64:67], a[192:207]
  ds_read_b64_tr_b16 v[200:201], v250 offset:17536
  ds_read_b64_tr_b16 v[202:203], v250 offset:21888
  buffer_load_dwordx4 v112, s[16:19], s51 offen lds
  s_add_u32 m0, s48, 3072
  s_add_u32 s51, s57, 22272
  s_waitcnt lgkmcnt(10)
  v_mfma_f32_32x32x16_bf16 a[208:223], v[212:215], v[64:67], a[208:223]
  ds_read_b64_tr_b16 v[204:205], v250 offset:17600
  ds_read_b64_tr_b16 v[206:207], v250 offset:21952
  buffer_load_dwordx4 v113, s[16:19], s51 offen lds
  s_waitcnt lgkmcnt(10)
  v_mfma_f32_32x32x16_bf16 a[224:239], v[216:219], v[64:67], a[224:239]
  ds_read_b64_tr_b16 v[208:209], v250 offset:17664
  ds_read_b64_tr_b16 v[210:211], v250 offset:22016
  s_waitcnt lgkmcnt(10)
  v_mfma_f32_32x32x16_bf16 a[240:255], v[220:223], v[64:67], a[240:255]
  ds_read_b64_tr_b16 v[212:213], v250 offset:17728
  ds_read_b64_tr_b16 v[214:215], v250 offset:22080
  s_waitcnt lgkmcnt(10)
  v_mfma_f32_32x32x16_bf16 a[0:15], v[192:195], v[68:71], a[0:15]
  ds_read_b64_tr_b16 v[216:217], v250 offset:17792
  ds_read_b64_tr_b16 v[218:219], v250 offset:22144
  s_waitcnt lgkmcnt(10)
  v_mfma_f32_32x32x16_bf16 a[16:31], v[196:199], v[68:71], a[16:31]
  ds_read_b64_tr_b16 v[220:221], v250 offset:17856
  ds_read_b64_tr_b16 v[222:223], v250 offset:22208
  s_waitcnt lgkmcnt(10)
  v_mfma_f32_32x32x16_bf16 a[32:47], v[200:203], v[68:71], a[32:47]
  ds_read_b64_tr_b16 v[192:193], v250 offset:17920
  ds_read_b64_tr_b16 v[194:195], v250 offset:22272
  s_waitcnt lgkmcnt(10)
  v_mfma_f32_32x32x16_bf16 a[48:63], v[204:207], v[68:71], a[48:63]
  ds_read_b64_tr_b16 v[196:197], v250 offset:17984
  ds_read_b64_tr_b16 v[198:199], v250 offset:22336
  s_waitcnt vmcnt(11)
  s_barrier
  s_waitcnt lgkmcnt(10)
  v_mfma_f32_32x32x16_bf16 a[64:79], v[208:211], v[68:71], a[64:79]
  ds_read_b64_tr_b16 v[200:201], v250 offset:18048
  ds_read_b64_tr_b16 v[202:203], v250 offset:22400
  s_add_u32 m0, s45, 83968
  s_add_u32 s50, s46, 2621440
  s_waitcnt lgkmcnt(10)
  v_mfma_f32_32x32x16_bf16 a[80:95], v[212:215], v[68:71], a[80:95]
  ds_read_b64_tr_b16 v[204:205], v250 offset:18112
  ds_read_b64_tr_b16 v[206:207], v250 offset:22464
  buffer_load_dwordx4 v227, s[28:31], s50 offen lds
  s_add_u32 m0, s45, 85056
  s_waitcnt lgkmcnt(10)
  v_mfma_f32_32x32x16_bf16 a[96:111], v[216:219], v[68:71], a[96:111]
  ds_read_b64_tr_b16 v[208:209], v250 offset:18176
  ds_read_b64_tr_b16 v[210:211], v250 offset:22528
  s_add_u32 s50, s46, 2629632
  buffer_load_dwordx4 v227, s[28:31], s50 offen lds
  s_waitcnt lgkmcnt(10)
  v_mfma_f32_32x32x16_bf16 a[112:127], v[220:223], v[68:71], a[112:127]
  ds_read_b64_tr_b16 v[212:213], v250 offset:18240
  ds_read_b64_tr_b16 v[214:215], v250 offset:22592
  s_add_u32 m0, s45, 86144
  s_add_u32 s50, s46, 2637824
  s_waitcnt lgkmcnt(10)
  v_mfma_f32_32x32x16_bf16 a[128:143], v[192:195], v[68:71], a[128:143]
  ds_read_b64_tr_b16 v[216:217], v250 offset:18304
  ds_read_b64_tr_b16 v[218:219], v250 offset:22656
  buffer_load_dwordx4 v227, s[28:31], s50 offen lds
  s_waitcnt lgkmcnt(10)
  v_mfma_f32_32x32x16_bf16 a[144:159], v[196:199], v[68:71], a[144:159]
  ds_read_b64_tr_b16 v[220:221], v250 offset:18368
  ds_read_b64_tr_b16 v[222:223], v250 offset:22720
  s_add_u32 m0, s45, 87232
  s_add_u32 s50, s46, 2646016
  s_waitcnt lgkmcnt(10)
  v_mfma_f32_32x32x16_bf16 a[160:175], v[200:203], v[68:71], a[160:175]
  ds_read_b64_tr_b16 v[192:193], v250 offset:34816
  ds_read_b64_tr_b16 v[194:195], v250 offset:39168
  buffer_load_dwordx4 v227, s[28:31], s50 offen lds
  s_waitcnt lgkmcnt(10)
  v_mfma_f32_32x32x16_bf16 a[176:191], v[204:207], v[68:71], a[176:191]
  ds_read_b64_tr_b16 v[196:197], v250 offset:34880
  ds_read_b64_tr_b16 v[198:199], v250 offset:39232
  s_add_u32 s51, s49, 49152
  buffer_load_dwordx4 v[160:163], v226, s[24:27], s51 offen nt
  s_waitcnt lgkmcnt(10)
  v_mfma_f32_32x32x16_bf16 a[192:207], v[208:211], v[68:71], a[192:207]
  ds_read_b64_tr_b16 v[200:201], v250 offset:34944
  ds_read_b64_tr_b16 v[202:203], v250 offset:39296
  ds_read_b128 v[80:83], v114 offset:16384
  s_waitcnt lgkmcnt(11)
  v_mfma_f32_32x32x16_bf16 a[208:223], v[212:215], v[68:71], a[208:223]
  ds_read_b64_tr_b16 v[204:205], v250 offset:35008
  ds_read_b64_tr_b16 v[206:207], v250 offset:39360
  ds_read_b128 v[84:87], v115 offset:16384
  ds_read_b128 v[88:91], v116 offset:16384
  ds_read_b128 v[92:95], v117 offset:16384
  s_waitcnt lgkmcnt(14)
  v_mfma_f32_32x32x16_bf16 a[224:239], v[216:219], v[68:71], a[224:239]
  ds_read_b64_tr_b16 v[208:209], v250 offset:35072
  ds_read_b64_tr_b16 v[210:211], v250 offset:39424
  s_waitcnt lgkmcnt(14)
  v_mfma_f32_32x32x16_bf16 a[240:255], v[220:223], v[68:71], a[240:255]
  ds_read_b64_tr_b16 v[212:213], v250 offset:35136
  ds_read_b64_tr_b16 v[214:215], v250 offset:39488
  s_waitcnt lgkmcnt(14)
  v_mfma_f32_32x32x16_bf16 a[0:15], v[192:195], v[72:75], a[0:15]
  ds_read_b64_tr_b16 v[216:217], v250 offset:35200
  ds_read_b64_tr_b16 v[218:219], v250 offset:39552
  s_waitcnt lgkmcnt(14)
  v_mfma_f32_32x32x16_bf16 a[16:31], v[196:199], v[72:75], a[16:31]
  ds_read_b64_tr_b16 v[220:221], v250 offset:35264
  ds_read_b64_tr_b16 v[222:223], v250 offset:39616
  s_waitcnt lgkmcnt(14)
  v_mfma_f32_32x32x16_bf16 a[32:47], v[200:203], v[72:75], a[32:47]
  ds_read_b64_tr_b16 v[192:193], v250 offset:35328
  ds_read_b64_tr_b16 v[194:195], v250 offset:39680
  s_waitcnt lgkmcnt(13)
  v_mfma_f32_32x32x16_bf16 a[48:63], v[204:207], v[72:75], a[48:63]
  ds_read_b64_tr_b16 v[196:197], v250 offset:35392
  ds_read_b64_tr_b16 v[198:199], v250 offset:39744
  s_waitcnt vmcnt(10)
  s_barrier
  s_waitcnt lgkmcnt(10)
  v_mfma_f32_32x32x16_bf16 a[64:79], v[208:211], v[72:75], a[64:79]
  ds_read_b64_tr_b16 v[200:201], v250 offset:35456
  ds_read_b64_tr_b16 v[202:203], v250 offset:39808
  s_add_u32 m0, s45, 101376
  s_add_u32 s50, s46, 2752512
  s_waitcnt lgkmcnt(10)
  v_mfma_f32_32x32x16_bf16 a[80:95], v[212:215], v[72:75], a[80:95]
  ds_read_b64_tr_b16 v[204:205], v250 offset:35520
  ds_read_b64_tr_b16 v[206:207], v250 offset:39872
  buffer_load_dwordx4 v227, s[28:31], s50 offen lds
  s_waitcnt lgkmcnt(10)
  v_mfma_f32_32x32x16_bf16 a[96:111], v[216:219], v[72:75], a[96:111]
  ds_read_b64_tr_b16 v[208:209], v250 offset:35584
  ds_read_b64_tr_b16 v[210:211], v250 offset:39936
  s_add_u32 m0, s45, 102464
  s_add_u32 s50, s46, 2760704
  s_waitcnt lgkmcnt(10)
  v_mfma_f32_32x32x16_bf16 a[112:127], v[220:223], v[72:75], a[112:127]
  ds_read_b64_tr_b16 v[212:213], v250 offset:35648
  ds_read_b64_tr_b16 v[214:215], v250 offset:40000
  buffer_load_dwordx4 v227, s[28:31], s50 offen lds
  s_waitcnt lgkmcnt(10)
  v_mfma_f32_32x32x16_bf16 a[128:143], v[192:195], v[72:75], a[128:143]
  ds_read_b64_tr_b16 v[216:217], v250 offset:35712
  ds_read_b64_tr_b16 v[218:219], v250 offset:40064
  s_add_u32 m0, s45, 103552
  s_add_u32 s50, s46, 2768896
  s_waitcnt lgkmcnt(10)
  v_mfma_f32_32x32x16_bf16 a[144:159], v[196:199], v[72:75], a[144:159]
  ds_read_b64_tr_b16 v[220:221], v250 offset:35776
  ds_read_b64_tr_b16 v[222:223], v250 offset:40128
  buffer_load_dwordx4 v227, s[28:31], s50 offen lds
  s_waitcnt lgkmcnt(10)
  v_mfma_f32_32x32x16_bf16 a[160:175], v[200:203], v[72:75], a[160:175]
  ds_read_b64_tr_b16 v[192:193], v250 offset:52224
  ds_read_b64_tr_b16 v[194:195], v250 offset:56576
  s_add_u32 m0, s45, 104640
  s_add_u32 s50, s46, 2777088
  s_waitcnt lgkmcnt(10)
  v_mfma_f32_32x32x16_bf16 a[176:191], v[204:207], v[72:75], a[176:191]
  ds_read_b64_tr_b16 v[196:197], v250 offset:52288
  ds_read_b64_tr_b16 v[198:199], v250 offset:56640
  buffer_load_dwordx4 v227, s[28:31], s50 offen lds
  s_waitcnt lgkmcnt(10)
  v_mfma_f32_32x32x16_bf16 a[192:207], v[208:211], v[72:75], a[192:207]
  ds_read_b64_tr_b16 v[200:201], v250 offset:52352
  ds_read_b64_tr_b16 v[202:203], v250 offset:56704
  s_add_u32 s51, s49, 49152
  buffer_load_dwordx4 v[164:167], v226, s[24:27], s51 offen offset:512 nt
  s_waitcnt lgkmcnt(10)
  v_mfma_f32_32x32x16_bf16 a[208:223], v[212:215], v[72:75], a[208:223]
  ds_read_b64_tr_b16 v[204:205], v250 offset:52416
  ds_read_b64_tr_b16 v[206:207], v250 offset:56768
  s_add_u32 s51, s49, 49152
  buffer_load_dwordx4 v[168:171], v226, s[24:27], s51 offen offset:1024 nt
  s_waitcnt lgkmcnt(10)
  v_mfma_f32_32x32x16_bf16 a[224:239], v[216:219], v[72:75], a[224:239]
  ds_read_b64_tr_b16 v[208:209], v250 offset:52480
  ds_read_b64_tr_b16 v[210:211], v250 offset:56832
  s_waitcnt lgkmcnt(10)
  v_mfma_f32_32x32x16_bf16 a[240:255], v[220:223], v[72:75], a[240:255]
  ds_read_b64_tr_b16 v[212:213], v250 offset:52544
  ds_read_b64_tr_b16 v[214:215], v250 offset:56896
  s_waitcnt lgkmcnt(10)
  v_mfma_f32_32x32x16_bf16 a[0:15], v[192:195], v[76:79], a[0:15]
  ds_read_b64_tr_b16 v[216:217], v250 offset:52608
  ds_read_b64_tr_b16 v[218:219], v250 offset:56960
  s_waitcnt lgkmcnt(10)
  v_mfma_f32_32x32x16_bf16 a[16:31], v[196:199], v[76:79], a[16:31]
  ds_read_b64_tr_b16 v[220:221], v250 offset:52672
  ds_read_b64_tr_b16 v[222:223], v250 offset:57024
  s_waitcnt lgkmcnt(10)
  v_mfma_f32_32x32x16_bf16 a[32:47], v[200:203], v[76:79], a[32:47]
  ds_read_b64_tr_b16 v[192:193], v250 offset:52736
  ds_read_b64_tr_b16 v[194:195], v250 offset:57088
  s_waitcnt lgkmcnt(10)
  v_mfma_f32_32x32x16_bf16 a[48:63], v[204:207], v[76:79], a[48:63]
  ds_read_b64_tr_b16 v[196:197], v250 offset:52800
  ds_read_b64_tr_b16 v[198:199], v250 offset:57152
  s_waitcnt vmcnt(7)
  s_barrier
  s_waitcnt lgkmcnt(10)
  v_mfma_f32_32x32x16_bf16 a[64:79], v[208:211], v[76:79], a[64:79]
  ds_read_b64_tr_b16 v[200:201], v250 offset:52864
  ds_read_b64_tr_b16 v[202:203], v250 offset:57216
  s_add_u32 m0, s45, 118784
  s_add_u32 s50, s46, 2883584
  s_waitcnt lgkmcnt(10)
  v_mfma_f32_32x32x16_bf16 a[80:95], v[212:215], v[76:79], a[80:95]
  ds_read_b64_tr_b16 v[204:205], v250 offset:52928
  ds_read_b64_tr_b16 v[206:207], v250 offset:57280
  buffer_load_dwordx4 v227, s[28:31], s50 offen lds
  s_waitcnt lgkmcnt(10)
  v_mfma_f32_32x32x16_bf16 a[96:111], v[216:219], v[76:79], a[96:111]
  ds_read_b64_tr_b16 v[208:209], v250 offset:52992
  ds_read_b64_tr_b16 v[210:211], v250 offset:57344
  s_add_u32 m0, s45, 119872
  s_add_u32 s50, s46, 2891776
  s_waitcnt lgkmcnt(10)
  v_mfma_f32_32x32x16_bf16 a[112:127], v[220:223], v[76:79], a[112:127]
  ds_read_b64_tr_b16 v[212:213], v250 offset:53056
  ds_read_b64_tr_b16 v[214:215], v250 offset:57408
  buffer_load_dwordx4 v227, s[28:31], s50 offen lds
  s_waitcnt lgkmcnt(10)
  v_mfma_f32_32x32x16_bf16 a[128:143], v[192:195], v[76:79], a[128:143]
  ds_read_b64_tr_b16 v[216:217], v250 offset:53120
  ds_read_b64_tr_b16 v[218:219], v250 offset:57472
  s_add_u32 m0, s45, 120960
  s_add_u32 s50, s46, 2899968
  s_waitcnt lgkmcnt(10)
  v_mfma_f32_32x32x16_bf16 a[144:159], v[196:199], v[76:79], a[144:159]
  ds_read_b64_tr_b16 v[220:221], v250 offset:53184
  ds_read_b64_tr_b16 v[222:223], v250 offset:57536
  buffer_load_dwordx4 v227, s[28:31], s50 offen lds
  s_waitcnt lgkmcnt(10)
  v_mfma_f32_32x32x16_bf16 a[160:175], v[200:203], v[76:79], a[160:175]
  ds_read_b64_tr_b16 v[192:193], v250 offset:0
  ds_read_b64_tr_b16 v[194:195], v250 offset:4352
  s_add_u32 m0, s45, 122048
  s_add_u32 s50, s46, 2908160
  s_waitcnt lgkmcnt(10)
  v_mfma_f32_32x32x16_bf16 a[176:191], v[204:207], v[76:79], a[176:191]
  ds_read_b64_tr_b16 v[196:197], v250 offset:64
  ds_read_b64_tr_b16 v[198:199], v250 offset:4416
  buffer_load_dwordx4 v227, s[28:31], s50 offen lds
  s_waitcnt lgkmcnt(10)
  v_mfma_f32_32x32x16_bf16 a[192:207], v[208:211], v[76:79], a[192:207]
  ds_read_b64_tr_b16 v[200:201], v250 offset:128
  ds_read_b64_tr_b16 v[202:203], v250 offset:4480
  s_add_u32 s51, s49, 49152
  s_waitcnt lgkmcnt(10)
  v_mfma_f32_32x32x16_bf16 a[208:223], v[212:215], v[76:79], a[208:223]
  ds_read_b64_tr_b16 v[204:205], v250 offset:192
  ds_read_b64_tr_b16 v[206:207], v250 offset:4544
  buffer_load_dwordx4 v[172:175], v226, s[24:27], s51 offen offset:1536 nt
  s_waitcnt lgkmcnt(10)
  v_mfma_f32_32x32x16_bf16 a[224:239], v[216:219], v[76:79], a[224:239]
  ds_read_b64_tr_b16 v[208:209], v250 offset:256
  ds_read_b64_tr_b16 v[210:211], v250 offset:4608
  s_waitcnt lgkmcnt(10)
  v_mfma_f32_32x32x16_bf16 a[240:255], v[220:223], v[76:79], a[240:255]
  ds_read_b64_tr_b16 v[212:213], v250 offset:320
  ds_read_b64_tr_b16 v[214:215], v250 offset:4672
  s_waitcnt lgkmcnt(10)
  v_mfma_f32_32x32x16_bf16 a[0:15], v[192:195], v[80:83], a[0:15]
  ds_read_b64_tr_b16 v[216:217], v250 offset:384
  ds_read_b64_tr_b16 v[218:219], v250 offset:4736
  s_waitcnt lgkmcnt(10)
  v_mfma_f32_32x32x16_bf16 a[16:31], v[196:199], v[80:83], a[16:31]
  ds_read_b64_tr_b16 v[220:221], v250 offset:448
  ds_read_b64_tr_b16 v[222:223], v250 offset:4800
  s_waitcnt lgkmcnt(10)
  v_mfma_f32_32x32x16_bf16 a[32:47], v[200:203], v[80:83], a[32:47]
  ds_read_b64_tr_b16 v[192:193], v250 offset:512
  ds_read_b64_tr_b16 v[194:195], v250 offset:4864
  s_waitcnt lgkmcnt(10)
  v_mfma_f32_32x32x16_bf16 a[48:63], v[204:207], v[80:83], a[48:63]
  ds_read_b64_tr_b16 v[196:197], v250 offset:576
  ds_read_b64_tr_b16 v[198:199], v250 offset:4928
  s_waitcnt vmcnt(7)
  s_barrier
  s_waitcnt lgkmcnt(10)
  v_mfma_f32_32x32x16_bf16 a[64:79], v[208:211], v[80:83], a[64:79]
  ds_read_b64_tr_b16 v[200:201], v250 offset:640
  ds_read_b64_tr_b16 v[202:203], v250 offset:4992
  s_add_u32 m0, s45, 136192
  s_add_u32 s50, s46, 3014656
  s_waitcnt lgkmcnt(10)
  v_mfma_f32_32x32x16_bf16 a[80:95], v[212:215], v[80:83], a[80:95]
  ds_read_b64_tr_b16 v[204:205], v250 offset:704
  ds_read_b64_tr_b16 v[206:207], v250 offset:5056
  buffer_load_dwordx4 v227, s[28:31], s50 offen lds
  s_waitcnt lgkmcnt(10)
  v_mfma_f32_32x32x16_bf16 a[96:111], v[216:219], v[80:83], a[96:111]
  ds_read_b64_tr_b16 v[208:209], v250 offset:768
  ds_read_b64_tr_b16 v[210:211], v250 offset:5120
  s_add_u32 m0, s45, 137280
  s_add_u32 s50, s46, 3022848
  s_waitcnt lgkmcnt(10)
  v_mfma_f32_32x32x16_bf16 a[112:127], v[220:223], v[80:83], a[112:127]
  ds_read_b64_tr_b16 v[212:213], v250 offset:832
  ds_read_b64_tr_b16 v[214:215], v250 offset:5184
  buffer_load_dwordx4 v227, s[28:31], s50 offen lds
  s_waitcnt lgkmcnt(10)
  v_mfma_f32_32x32x16_bf16 a[128:143], v[192:195], v[80:83], a[128:143]
  ds_read_b64_tr_b16 v[216:217], v250 offset:896
  ds_read_b64_tr_b16 v[218:219], v250 offset:5248
  s_add_u32 m0, s45, 138368
  s_add_u32 s50, s46, 3031040
  s_waitcnt lgkmcnt(10)
  v_mfma_f32_32x32x16_bf16 a[144:159], v[196:199], v[80:83], a[144:159]
  ds_read_b64_tr_b16 v[220:221], v250 offset:960
  ds_read_b64_tr_b16 v[222:223], v250 offset:5312
  buffer_load_dwordx4 v227, s[28:31], s50 offen lds
  s_waitcnt lgkmcnt(10)
  v_mfma_f32_32x32x16_bf16 a[160:175], v[200:203], v[80:83], a[160:175]
  ds_read_b64_tr_b16 v[192:193], v250 offset:17408
  ds_read_b64_tr_b16 v[194:195], v250 offset:21760
  s_add_u32 m0, s45, 139456
  s_add_u32 s50, s46, 3039232
  s_waitcnt lgkmcnt(10)
  v_mfma_f32_32x32x16_bf16 a[176:191], v[204:207], v[80:83], a[176:191]
  ds_read_b64_tr_b16 v[196:197], v250 offset:17472
  ds_read_b64_tr_b16 v[198:199], v250 offset:21824
  buffer_load_dwordx4 v227, s[28:31], s50 offen lds
  s_waitcnt lgkmcnt(10)
  v_mfma_f32_32x32x16_bf16 a[192:207], v[208:211], v[80:83], a[192:207]
  ds_read_b64_tr_b16 v[200:201], v250 offset:17536
  ds_read_b64_tr_b16 v[202:203], v250 offset:21888
  s_add_u32 s51, s49, 65536
  buffer_load_dwordx4 v[176:179], v226, s[24:27], s51 offen nt
  s_waitcnt lgkmcnt(10)
  v_mfma_f32_32x32x16_bf16 a[208:223], v[212:215], v[80:83], a[208:223]
  ds_read_b64_tr_b16 v[204:205], v250 offset:17600
  ds_read_b64_tr_b16 v[206:207], v250 offset:21952
  s_add_u32 s51, s49, 65536
  buffer_load_dwordx4 v[180:183], v226, s[24:27], s51 offen offset:512 nt
  s_waitcnt lgkmcnt(10)
  v_mfma_f32_32x32x16_bf16 a[224:239], v[216:219], v[80:83], a[224:239]
  ds_read_b64_tr_b16 v[208:209], v250 offset:17664
  ds_read_b64_tr_b16 v[210:211], v250 offset:22016
  s_waitcnt lgkmcnt(10)
  v_mfma_f32_32x32x16_bf16 a[240:255], v[220:223], v[80:83], a[240:255]
  ds_read_b64_tr_b16 v[212:213], v250 offset:17728
  ds_read_b64_tr_b16 v[214:215], v250 offset:22080
  s_waitcnt lgkmcnt(10)
  v_mfma_f32_32x32x16_bf16 a[0:15], v[192:195], v[84:87], a[0:15]
  ds_read_b64_tr_b16 v[216:217], v250 offset:17792
  ds_read_b64_tr_b16 v[218:219], v250 offset:22144
  s_waitcnt lgkmcnt(10)
  v_mfma_f32_32x32x16_bf16 a[16:31], v[196:199], v[84:87], a[16:31]
  ds_read_b64_tr_b16 v[220:221], v250 offset:17856
  ds_read_b64_tr_b16 v[222:223], v250 offset:22208
  s_waitcnt lgkmcnt(10)
  v_mfma_f32_32x32x16_bf16 a[32:47], v[200:203], v[84:87], a[32:47]
  ds_read_b64_tr_b16 v[192:193], v250 offset:17920
  ds_read_b64_tr_b16 v[194:195], v250 offset:22272
  s_waitcnt lgkmcnt(10)
  v_mfma_f32_32x32x16_bf16 a[48:63], v[204:207], v[84:87], a[48:63]
  ds_read_b64_tr_b16 v[196:197], v250 offset:17984
  ds_read_b64_tr_b16 v[198:199], v250 offset:22336
  s_waitcnt vmcnt(7)
  s_barrier
  s_waitcnt lgkmcnt(10)
  v_mfma_f32_32x32x16_bf16 a[64:79], v[208:211], v[84:87], a[64:79]
  ds_read_b64_tr_b16 v[200:201], v250 offset:18048
  ds_read_b64_tr_b16 v[202:203], v250 offset:22400
  s_add_u32 m0, s45, 83968
  s_add_u32 s50, s46, 3145728
  s_waitcnt lgkmcnt(10)
  v_mfma_f32_32x32x16_bf16 a[80:95], v[212:215], v[84:87], a[80:95]
  ds_read_b64_tr_b16 v[204:205], v250 offset:18112
  ds_read_b64_tr_b16 v[206:207], v250 offset:22464
  buffer_load_dwordx4 v227, s[28:31], s50 offen lds
  s_add_u32 m0, s45, 85056
  s_waitcnt lgkmcnt(10)
  v_mfma_f32_32x32x16_bf16 a[96:111], v[216:219], v[84:87], a[96:111]
  ds_read_b64_tr_b16 v[208:209], v250 offset:18176
  ds_read_b64_tr_b16 v[210:211], v250 offset:22528
  s_add_u32 s50, s46, 3153920
  buffer_load_dwordx4 v227, s[28:31], s50 offen lds
  s_waitcnt lgkmcnt(10)
  v_mfma_f32_32x32x16_bf16 a[112:127], v[220:223], v[84:87], a[112:127]
  ds_read_b64_tr_b16 v[212:213], v250 offset:18240
  ds_read_b64_tr_b16 v[214:215], v250 offset:22592
  s_add_u32 m0, s45, 86144
  s_add_u32 s50, s46, 3162112
  s_waitcnt lgkmcnt(10)
  v_mfma_f32_32x32x16_bf16 a[128:143], v[192:195], v[84:87], a[128:143]
  ds_read_b64_tr_b16 v[216:217], v250 offset:18304
  ds_read_b64_tr_b16 v[218:219], v250 offset:22656
  buffer_load_dwordx4 v227, s[28:31], s50 offen lds
  s_waitcnt lgkmcnt(10)
  v_mfma_f32_32x32x16_bf16 a[144:159], v[196:199], v[84:87], a[144:159]
  ds_read_b64_tr_b16 v[220:221], v250 offset:18368
  ds_read_b64_tr_b16 v[222:223], v250 offset:22720
  s_add_u32 m0, s45, 87232
  s_add_u32 s50, s46, 3170304
  s_waitcnt lgkmcnt(10)
  v_mfma_f32_32x32x16_bf16 a[160:175], v[200:203], v[84:87], a[160:175]
  ds_read_b64_tr_b16 v[192:193], v250 offset:34816
  ds_read_b64_tr_b16 v[194:195], v250 offset:39168
  buffer_load_dwordx4 v227, s[28:31], s50 offen lds
  s_waitcnt lgkmcnt(10)
  v_mfma_f32_32x32x16_bf16 a[176:191], v[204:207], v[84:87], a[176:191]
  ds_read_b64_tr_b16 v[196:197], v250 offset:34880
  ds_read_b64_tr_b16 v[198:199], v250 offset:39232
  s_add_u32 s51, s49, 65536
  buffer_load_dwordx4 v[184:187], v226, s[24:27], s51 offen offset:1024 nt
  s_waitcnt lgkmcnt(10)
  v_mfma_f32_32x32x16_bf16 a[192:207], v[208:211], v[84:87], a[192:207]
  ds_read_b64_tr_b16 v[200:201], v250 offset:34944
  ds_read_b64_tr_b16 v[202:203], v250 offset:39296
  ds_read_b128 v[96:99], v114 offset:0
  s_waitcnt lgkmcnt(11)
  v_mfma_f32_32x32x16_bf16 a[208:223], v[212:215], v[84:87], a[208:223]
  ds_read_b64_tr_b16 v[204:205], v250 offset:35008
  ds_read_b64_tr_b16 v[206:207], v250 offset:39360
  ds_read_b128 v[100:103], v115 offset:0
  ds_read_b128 v[104:107], v116 offset:0
  ds_read_b128 v[108:111], v117 offset:0
  s_waitcnt lgkmcnt(14)
  v_mfma_f32_32x32x16_bf16 a[224:239], v[216:219], v[84:87], a[224:239]
  ds_read_b64_tr_b16 v[208:209], v250 offset:35072
  ds_read_b64_tr_b16 v[210:211], v250 offset:39424
  s_waitcnt lgkmcnt(14)
  v_mfma_f32_32x32x16_bf16 a[240:255], v[220:223], v[84:87], a[240:255]
  ds_read_b64_tr_b16 v[212:213], v250 offset:35136
  ds_read_b64_tr_b16 v[214:215], v250 offset:39488
  s_waitcnt lgkmcnt(14)
  v_mfma_f32_32x32x16_bf16 a[0:15], v[192:195], v[88:91], a[0:15]
  ds_read_b64_tr_b16 v[216:217], v250 offset:35200
  ds_read_b64_tr_b16 v[218:219], v250 offset:39552
  s_waitcnt lgkmcnt(14)
  v_mfma_f32_32x32x16_bf16 a[16:31], v[196:199], v[88:91], a[16:31]
  ds_read_b64_tr_b16 v[220:221], v250 offset:35264
  ds_read_b64_tr_b16 v[222:223], v250 offset:39616
  s_waitcnt lgkmcnt(14)
  v_mfma_f32_32x32x16_bf16 a[32:47], v[200:203], v[88:91], a[32:47]
  ds_read_b64_tr_b16 v[192:193], v250 offset:35328
  ds_read_b64_tr_b16 v[194:195], v250 offset:39680
  s_waitcnt lgkmcnt(13)
  v_mfma_f32_32x32x16_bf16 a[48:63], v[204:207], v[88:91], a[48:63]
  ds_read_b64_tr_b16 v[196:197], v250 offset:35392
  ds_read_b64_tr_b16 v[198:199], v250 offset:39744
  s_waitcnt vmcnt(7)
  s_barrier
  s_waitcnt lgkmcnt(10)
  v_mfma_f32_32x32x16_bf16 a[64:79], v[208:211], v[88:91], a[64:79]
  ds_read_b64_tr_b16 v[200:201], v250 offset:35456
  ds_read_b64_tr_b16 v[202:203], v250 offset:39808
  s_add_u32 m0, s45, 101376
  s_add_u32 s50, s46, 3276800
  s_waitcnt lgkmcnt(10)
  v_mfma_f32_32x32x16_bf16 a[80:95], v[212:215], v[88:91], a[80:95]
  ds_read_b64_tr_b16 v[204:205], v250 offset:35520
  ds_read_b64_tr_b16 v[206:207], v250 offset:39872
  buffer_load_dwordx4 v227, s[28:31], s50 offen lds
  s_waitcnt lgkmcnt(10)
  v_mfma_f32_32x32x16_bf16 a[96:111], v[216:219], v[88:91], a[96:111]
  ds_read_b64_tr_b16 v[208:209], v250 offset:35584
  ds_read_b64_tr_b16 v[210:211], v250 offset:39936
  s_add_u32 m0, s45, 102464
  s_add_u32 s50, s46, 3284992
  s_waitcnt lgkmcnt(10)
  v_mfma_f32_32x32x16_bf16 a[112:127], v[220:223], v[88:91], a[112:127]
  ds_read_b64_tr_b16 v[212:213], v250 offset:35648
  ds_read_b64_tr_b16 v[214:215], v250 offset:40000
  buffer_load_dwordx4 v227, s[28:31], s50 offen lds
  s_waitcnt lgkmcnt(10)
  v_mfma_f32_32x32x16_bf16 a[128:143], v[192:195], v[88:91], a[128:143]
  ds_read_b64_tr_b16 v[216:217], v250 offset:35712
  ds_read_b64_tr_b16 v[218:219], v250 offset:40064
  s_add_u32 m0, s45, 103552
  s_add_u32 s50, s46, 3293184
  s_waitcnt lgkmcnt(10)
  v_mfma_f32_32x32x16_bf16 a[144:159], v[196:199], v[88:91], a[144:159]
  ds_read_b64_tr_b16 v[220:221], v250 offset:35776
  ds_read_b64_tr_b16 v[222:223], v250 offset:40128
  buffer_load_dwordx4 v227, s[28:31], s50 offen lds
  s_waitcnt lgkmcnt(10)
  v_mfma_f32_32x32x16_bf16 a[160:175], v[200:203], v[88:91], a[160:175]
  ds_read_b64_tr_b16 v[192:193], v250 offset:52224
  ds_read_b64_tr_b16 v[194:195], v250 offset:56576
  s_add_u32 m0, s45, 104640
  s_add_u32 s50, s46, 3301376
  s_waitcnt lgkmcnt(10)
  v_mfma_f32_32x32x16_bf16 a[176:191], v[204:207], v[88:91], a[176:191]
  ds_read_b64_tr_b16 v[196:197], v250 offset:52288
  ds_read_b64_tr_b16 v[198:199], v250 offset:56640
  buffer_load_dwordx4 v227, s[28:31], s50 offen lds
  s_waitcnt lgkmcnt(10)
  v_mfma_f32_32x32x16_bf16 a[192:207], v[208:211], v[88:91], a[192:207]
  ds_read_b64_tr_b16 v[200:201], v250 offset:52352
  ds_read_b64_tr_b16 v[202:203], v250 offset:56704
  s_add_u32 s51, s49, 65536
  s_waitcnt lgkmcnt(10)
  v_mfma_f32_32x32x16_bf16 a[208:223], v[212:215], v[88:91], a[208:223]
  ds_read_b64_tr_b16 v[204:205], v250 offset:52416
  ds_read_b64_tr_b16 v[206:207], v250 offset:56768
  buffer_load_dwordx4 v[188:191], v226, s[24:27], s51 offen offset:1536 nt
  s_waitcnt lgkmcnt(10)
  v_mfma_f32_32x32x16_bf16 a[224:239], v[216:219], v[88:91], a[224:239]
  ds_read_b64_tr_b16 v[208:209], v250 offset:52480
  ds_read_b64_tr_b16 v[210:211], v250 offset:56832
  s_waitcnt lgkmcnt(10)
  v_mfma_f32_32x32x16_bf16 a[240:255], v[220:223], v[88:91], a[240:255]
  ds_read_b64_tr_b16 v[212:213], v250 offset:52544
  ds_read_b64_tr_b16 v[214:215], v250 offset:56896
  s_waitcnt lgkmcnt(10)
  v_mfma_f32_32x32x16_bf16 a[0:15], v[192:195], v[92:95], a[0:15]
  ds_read_b64_tr_b16 v[216:217], v250 offset:52608
  ds_read_b64_tr_b16 v[218:219], v250 offset:56960
  s_waitcnt lgkmcnt(10)
  v_mfma_f32_32x32x16_bf16 a[16:31], v[196:199], v[92:95], a[16:31]
  ds_read_b64_tr_b16 v[220:221], v250 offset:52672
  ds_read_b64_tr_b16 v[222:223], v250 offset:57024
  s_waitcnt lgkmcnt(10)
  v_mfma_f32_32x32x16_bf16 a[32:47], v[200:203], v[92:95], a[32:47]
  ds_read_b64_tr_b16 v[192:193], v250 offset:52736
  ds_read_b64_tr_b16 v[194:195], v250 offset:57088
  s_waitcnt lgkmcnt(10)
  v_mfma_f32_32x32x16_bf16 a[48:63], v[204:207], v[92:95], a[48:63]
  ds_read_b64_tr_b16 v[196:197], v250 offset:52800
  ds_read_b64_tr_b16 v[198:199], v250 offset:57152
  s_waitcnt lgkmcnt(0)
  s_waitcnt vmcnt(6)
  s_barrier
  v_mfma_f32_32x32x16_bf16 a[64:79], v[208:211], v[92:95], a[64:79]
  ds_read_b64_tr_b16 v[200:201], v250 offset:52864
  ds_read_b64_tr_b16 v[202:203], v250 offset:57216
  s_add_u32 m0, s45, 118784
  s_add_u32 s50, s46, 3407872
  buffer_load_dwordx4 v227, s[28:31], s50 offen lds
  v_mfma_f32_32x32x16_bf16 a[80:95], v[212:215], v[92:95], a[80:95]
  ds_read_b64_tr_b16 v[204:205], v250 offset:52928
  ds_read_b64_tr_b16 v[206:207], v250 offset:57280
  s_add_u32 m0, s45, 119872
  s_add_u32 s50, s46, 3416064
  v_mfma_f32_32x32x16_bf16 a[96:111], v[216:219], v[92:95], a[96:111]
  ds_read_b64_tr_b16 v[208:209], v250 offset:52992
  ds_read_b64_tr_b16 v[210:211], v250 offset:57344
  buffer_load_dwordx4 v227, s[28:31], s50 offen lds
  v_mfma_f32_32x32x16_bf16 a[112:127], v[220:223], v[92:95], a[112:127]
  ds_read_b64_tr_b16 v[212:213], v250 offset:53056
  ds_read_b64_tr_b16 v[214:215], v250 offset:57408
  s_add_u32 m0, s45, 120960
  s_add_u32 s50, s46, 3424256
  v_mfma_f32_32x32x16_bf16 a[128:143], v[192:195], v[92:95], a[128:143]
  ds_read_b64_tr_b16 v[216:217], v250 offset:53120
  ds_read_b64_tr_b16 v[218:219], v250 offset:57472
  buffer_load_dwordx4 v227, s[28:31], s50 offen lds
  v_mfma_f32_32x32x16_bf16 a[144:159], v[196:199], v[92:95], a[144:159]
  ds_read_b64_tr_b16 v[220:221], v250 offset:53184
  ds_read_b64_tr_b16 v[222:223], v250 offset:57536
  s_add_u32 m0, s45, 122048
  s_add_u32 s50, s46, 3432448
  buffer_load_dwordx4 v227, s[28:31], s50 offen lds
  s_waitcnt lgkmcnt(10)
  v_mfma_f32_32x32x16_bf16 a[160:175], v[200:203], v[92:95], a[160:175]
  ds_read_b64_tr_b16 v[192:193], v250 offset:0
  ds_read_b64_tr_b16 v[194:195], v250 offset:4352
  s_add_u32 s51, s49, 32768
  s_add_u32 m0, s47, 33280
  s_waitcnt lgkmcnt(10)
  v_mfma_f32_32x32x16_bf16 a[176:191], v[204:207], v[92:95], a[176:191]
  ds_read_b64_tr_b16 v[196:197], v250 offset:64
  ds_read_b64_tr_b16 v[198:199], v250 offset:4416
  buffer_load_dwordx4 v226, s[20:23], s51 offen nt lds
  s_waitcnt lgkmcnt(10)
  v_mfma_f32_32x32x16_bf16 a[192:207], v[208:211], v[92:95], a[192:207]
  ds_read_b64_tr_b16 v[200:201], v250 offset:128
  ds_read_b64_tr_b16 v[202:203], v250 offset:4480
  s_add_u32 s51, s49, 32768
  s_add_u32 m0, s47, 33808
  s_waitcnt lgkmcnt(10)
  v_mfma_f32_32x32x16_bf16 a[208:223], v[212:215], v[92:95], a[208:223]
  ds_read_b64_tr_b16 v[204:205], v250 offset:192
  ds_read_b64_tr_b16 v[206:207], v250 offset:4544
  buffer_load_dwordx4 v226, s[20:23], s51 offen offset:512 nt lds
  s_waitcnt lgkmcnt(10)
  v_mfma_f32_32x32x16_bf16 a[224:239], v[216:219], v[92:95], a[224:239]
  ds_read_b64_tr_b16 v[208:209], v250 offset:256
  ds_read_b64_tr_b16 v[210:211], v250 offset:4608
  s_waitcnt lgkmcnt(10)
  v_mfma_f32_32x32x16_bf16 a[240:255], v[220:223], v[92:95], a[240:255]
  ds_read_b64_tr_b16 v[212:213], v250 offset:320
  ds_read_b64_tr_b16 v[214:215], v250 offset:4672
  s_waitcnt lgkmcnt(10)
  v_mfma_f32_32x32x16_bf16 a[0:15], v[192:195], v[96:99], a[0:15]
  ds_read_b64_tr_b16 v[216:217], v250 offset:384
  ds_read_b64_tr_b16 v[218:219], v250 offset:4736
  s_waitcnt lgkmcnt(10)
  v_mfma_f32_32x32x16_bf16 a[16:31], v[196:199], v[96:99], a[16:31]
  ds_read_b64_tr_b16 v[220:221], v250 offset:448
  ds_read_b64_tr_b16 v[222:223], v250 offset:4800
  s_waitcnt lgkmcnt(10)
  v_mfma_f32_32x32x16_bf16 a[32:47], v[200:203], v[96:99], a[32:47]
  ds_read_b64_tr_b16 v[192:193], v250 offset:512
  ds_read_b64_tr_b16 v[194:195], v250 offset:4864
  s_waitcnt lgkmcnt(10)
  v_mfma_f32_32x32x16_bf16 a[48:63], v[204:207], v[96:99], a[48:63]
  ds_read_b64_tr_b16 v[196:197], v250 offset:576
  ds_read_b64_tr_b16 v[198:199], v250 offset:4928
  s_waitcnt vmcnt(7)
  s_barrier
  s_waitcnt lgkmcnt(10)
  v_mfma_f32_32x32x16_bf16 a[64:79], v[208:211], v[96:99], a[64:79]
  ds_read_b64_tr_b16 v[200:201], v250 offset:640
  ds_read_b64_tr_b16 v[202:203], v250 offset:4992
  s_add_u32 m0, s45, 136192
  s_add_u32 s50, s46, 3538944
  buffer_load_dwordx4 v227, s[28:31], s50 offen lds
  s_waitcnt lgkmcnt(10)
  v_mfma_f32_32x32x16_bf16 a[80:95], v[212:215], v[96:99], a[80:95]
  ds_read_b64_tr_b16 v[204:205], v250 offset:704
  ds_read_b64_tr_b16 v[206:207], v250 offset:5056
  s_add_u32 m0, s45, 137280
  s_add_u32 s50, s46, 3547136
  s_waitcnt lgkmcnt(10)
  v_mfma_f32_32x32x16_bf16 a[96:111], v[216:219], v[96:99], a[96:111]
  ds_read_b64_tr_b16 v[208:209], v250 offset:768
  ds_read_b64_tr_b16 v[210:211], v250 offset:5120
  buffer_load_dwordx4 v227, s[28:31], s50 offen lds
  s_waitcnt lgkmcnt(10)
  v_mfma_f32_32x32x16_bf16 a[112:127], v[220:223], v[96:99], a[112:127]
  ds_read_b64_tr_b16 v[212:213], v250 offset:832
  ds_read_b64_tr_b16 v[214:215], v250 offset:5184
  s_add_u32 m0, s45, 138368
  s_add_u32 s50, s46, 3555328
  s_waitcnt lgkmcnt(10)
  v_mfma_f32_32x32x16_bf16 a[128:143], v[192:195], v[96:99], a[128:143]
  ds_read_b64_tr_b16 v[216:217], v250 offset:896
  ds_read_b64_tr_b16 v[218:219], v250 offset:5248
  buffer_load_dwordx4 v227, s[28:31], s50 offen lds
  s_waitcnt lgkmcnt(10)
  v_mfma_f32_32x32x16_bf16 a[144:159], v[196:199], v[96:99], a[144:159]
  ds_read_b64_tr_b16 v[220:221], v250 offset:960
  ds_read_b64_tr_b16 v[222:223], v250 offset:5312
  s_add_u32 m0, s45, 139456
  s_add_u32 s50, s46, 3563520
  buffer_load_dwordx4 v227, s[28:31], s50 offen lds
  s_waitcnt lgkmcnt(10)
  v_mfma_f32_32x32x16_bf16 a[160:175], v[200:203], v[96:99], a[160:175]
  ds_read_b64_tr_b16 v[192:193], v250 offset:17408
  ds_read_b64_tr_b16 v[194:195], v250 offset:21760
  s_add_u32 s51, s49, 32768
  s_add_u32 m0, s47, 34336
  s_waitcnt lgkmcnt(10)
  v_mfma_f32_32x32x16_bf16 a[176:191], v[204:207], v[96:99], a[176:191]
  ds_read_b64_tr_b16 v[196:197], v250 offset:17472
  ds_read_b64_tr_b16 v[198:199], v250 offset:21824
  buffer_load_dwordx4 v226, s[20:23], s51 offen offset:1024 nt lds
  s_waitcnt lgkmcnt(10)
  v_mfma_f32_32x32x16_bf16 a[192:207], v[208:211], v[96:99], a[192:207]
  ds_read_b64_tr_b16 v[200:201], v250 offset:17536
  ds_read_b64_tr_b16 v[202:203], v250 offset:21888
  s_add_u32 s51, s49, 32768
  s_add_u32 m0, s47, 34864
  s_waitcnt lgkmcnt(10)
  v_mfma_f32_32x32x16_bf16 a[208:223], v[212:215], v[96:99], a[208:223]
  ds_read_b64_tr_b16 v[204:205], v250 offset:17600
  ds_read_b64_tr_b16 v[206:207], v250 offset:21952
  buffer_load_dwordx4 v226, s[20:23], s51 offen offset:1536 nt lds
  s_waitcnt lgkmcnt(10)
  v_mfma_f32_32x32x16_bf16 a[224:239], v[216:219], v[96:99], a[224:239]
  ds_read_b64_tr_b16 v[208:209], v250 offset:17664
  ds_read_b64_tr_b16 v[210:211], v250 offset:22016
  s_waitcnt lgkmcnt(10)
  v_mfma_f32_32x32x16_bf16 a[240:255], v[220:223], v[96:99], a[240:255]
  ds_read_b64_tr_b16 v[212:213], v250 offset:17728
  ds_read_b64_tr_b16 v[214:215], v250 offset:22080
  s_waitcnt lgkmcnt(10)
  v_mfma_f32_32x32x16_bf16 a[0:15], v[192:195], v[100:103], a[0:15]
  ds_read_b64_tr_b16 v[216:217], v250 offset:17792
  ds_read_b64_tr_b16 v[218:219], v250 offset:22144
  s_waitcnt lgkmcnt(10)
  v_mfma_f32_32x32x16_bf16 a[16:31], v[196:199], v[100:103], a[16:31]
  ds_read_b64_tr_b16 v[220:221], v250 offset:17856
  ds_read_b64_tr_b16 v[222:223], v250 offset:22208
  s_waitcnt lgkmcnt(10)
  v_mfma_f32_32x32x16_bf16 a[32:47], v[200:203], v[100:103], a[32:47]
  ds_read_b64_tr_b16 v[192:193], v250 offset:17920
  ds_read_b64_tr_b16 v[194:195], v250 offset:22272
  s_waitcnt lgkmcnt(10)
  v_mfma_f32_32x32x16_bf16 a[48:63], v[204:207], v[100:103], a[48:63]
  ds_read_b64_tr_b16 v[196:197], v250 offset:17984
  ds_read_b64_tr_b16 v[198:199], v250 offset:22336
  s_waitcnt vmcnt(8)
  s_barrier
  s_waitcnt lgkmcnt(10)
  v_mfma_f32_32x32x16_bf16 a[64:79], v[208:211], v[100:103], a[64:79]
  ds_read_b64_tr_b16 v[200:201], v250 offset:18048
  ds_read_b64_tr_b16 v[202:203], v250 offset:22400
  s_add_u32 s51, s49, 49152
  s_add_u32 m0, s47, 49920
  s_waitcnt lgkmcnt(10)
  v_mfma_f32_32x32x16_bf16 a[80:95], v[212:215], v[100:103], a[80:95]
  ds_read_b64_tr_b16 v[204:205], v250 offset:18112
  ds_read_b64_tr_b16 v[206:207], v250 offset:22464
  s_waitcnt lgkmcnt(10)
  v_mfma_f32_32x32x16_bf16 a[96:111], v[216:219], v[100:103], a[96:111]
  ds_read_b64_tr_b16 v[208:209], v250 offset:18176
  ds_read_b64_tr_b16 v[210:211], v250 offset:22528
  buffer_load_dwordx4 v226, s[20:23], s51 offen nt lds
  s_waitcnt lgkmcnt(10)
  v_mfma_f32_32x32x16_bf16 a[112:127], v[220:223], v[100:103], a[112:127]
  ds_read_b64_tr_b16 v[212:213], v250 offset:18240
  ds_read_b64_tr_b16 v[214:215], v250 offset:22592
  s_waitcnt lgkmcnt(10)
  v_mfma_f32_32x32x16_bf16 a[128:143], v[192:195], v[100:103], a[128:143]
  ds_read_b64_tr_b16 v[216:217], v250 offset:18304
  ds_read_b64_tr_b16 v[218:219], v250 offset:22656
  s_waitcnt lgkmcnt(10)
  v_mfma_f32_32x32x16_bf16 a[144:159], v[196:199], v[100:103], a[144:159]
  ds_read_b64_tr_b16 v[220:221], v250 offset:18368
  ds_read_b64_tr_b16 v[222:223], v250 offset:22720
  s_add_u32 s51, s49, 49152
  s_add_u32 m0, s47, 50448
  s_waitcnt lgkmcnt(10)
  v_mfma_f32_32x32x16_bf16 a[160:175], v[200:203], v[100:103], a[160:175]
  ds_read_b64_tr_b16 v[192:193], v250 offset:34816
  ds_read_b64_tr_b16 v[194:195], v250 offset:39168
  s_waitcnt lgkmcnt(10)
  v_mfma_f32_32x32x16_bf16 a[176:191], v[204:207], v[100:103], a[176:191]
  ds_read_b64_tr_b16 v[196:197], v250 offset:34880
  ds_read_b64_tr_b16 v[198:199], v250 offset:39232
  buffer_load_dwordx4 v226, s[20:23], s51 offen offset:512 nt lds
  s_waitcnt lgkmcnt(10)
  v_mfma_f32_32x32x16_bf16 a[192:207], v[208:211], v[100:103], a[192:207]
  ds_read_b64_tr_b16 v[200:201], v250 offset:34944
  ds_read_b64_tr_b16 v[202:203], v250 offset:39296
  s_waitcnt lgkmcnt(10)
  v_mfma_f32_32x32x16_bf16 a[208:223], v[212:215], v[100:103], a[208:223]
  ds_read_b64_tr_b16 v[204:205], v250 offset:35008
  ds_read_b64_tr_b16 v[206:207], v250 offset:39360
  s_waitcnt lgkmcnt(10)
  v_mfma_f32_32x32x16_bf16 a[224:239], v[216:219], v[100:103], a[224:239]
  ds_read_b64_tr_b16 v[208:209], v250 offset:35072
  ds_read_b64_tr_b16 v[210:211], v250 offset:39424
  s_waitcnt lgkmcnt(10)
  v_mfma_f32_32x32x16_bf16 a[240:255], v[220:223], v[100:103], a[240:255]
  ds_read_b64_tr_b16 v[212:213], v250 offset:35136
  ds_read_b64_tr_b16 v[214:215], v250 offset:39488
  s_waitcnt lgkmcnt(10)
  v_mfma_f32_32x32x16_bf16 a[0:15], v[192:195], v[104:107], a[0:15]
  ds_read_b64_tr_b16 v[216:217], v250 offset:35200
  ds_read_b64_tr_b16 v[218:219], v250 offset:39552
  s_waitcnt lgkmcnt(10)
  v_mfma_f32_32x32x16_bf16 a[16:31], v[196:199], v[104:107], a[16:31]
  ds_read_b64_tr_b16 v[220:221], v250 offset:35264
  ds_read_b64_tr_b16 v[222:223], v250 offset:39616
  s_waitcnt lgkmcnt(10)
  v_mfma_f32_32x32x16_bf16 a[32:47], v[200:203], v[104:107], a[32:47]
  ds_read_b64_tr_b16 v[192:193], v250 offset:35328
  ds_read_b64_tr_b16 v[194:195], v250 offset:39680
  s_waitcnt lgkmcnt(10)
  v_mfma_f32_32x32x16_bf16 a[48:63], v[204:207], v[104:107], a[48:63]
  ds_read_b64_tr_b16 v[196:197], v250 offset:35392
  ds_read_b64_tr_b16 v[198:199], v250 offset:39744
  s_waitcnt vmcnt(4)
  s_barrier
  s_waitcnt lgkmcnt(10)
  v_mfma_f32_32x32x16_bf16 a[64:79], v[208:211], v[104:107], a[64:79]
  ds_read_b64_tr_b16 v[200:201], v250 offset:35456
  ds_read_b64_tr_b16 v[202:203], v250 offset:39808
  s_add_u32 s51, s49, 49152
  s_add_u32 m0, s47, 50976
  s_waitcnt lgkmcnt(10)
  v_mfma_f32_32x32x16_bf16 a[80:95], v[212:215], v[104:107], a[80:95]
  ds_read_b64_tr_b16 v[204:205], v250 offset:35520
  ds_read_b64_tr_b16 v[206:207], v250 offset:39872
  s_waitcnt lgkmcnt(10)
  v_mfma_f32_32x32x16_bf16 a[96:111], v[216:219], v[104:107], a[96:111]
  ds_read_b64_tr_b16 v[208:209], v250 offset:35584
  ds_read_b64_tr_b16 v[210:211], v250 offset:39936
  buffer_load_dwordx4 v226, s[20:23], s51 offen offset:1024 nt lds
  s_waitcnt lgkmcnt(10)
  v_mfma_f32_32x32x16_bf16 a[112:127], v[220:223], v[104:107], a[112:127]
  ds_read_b64_tr_b16 v[212:213], v250 offset:35648
  ds_read_b64_tr_b16 v[214:215], v250 offset:40000
  s_waitcnt lgkmcnt(10)
  v_mfma_f32_32x32x16_bf16 a[128:143], v[192:195], v[104:107], a[128:143]
  ds_read_b64_tr_b16 v[216:217], v250 offset:35712
  ds_read_b64_tr_b16 v[218:219], v250 offset:40064
  s_waitcnt lgkmcnt(10)
  v_mfma_f32_32x32x16_bf16 a[144:159], v[196:199], v[104:107], a[144:159]
  ds_read_b64_tr_b16 v[220:221], v250 offset:35776
  ds_read_b64_tr_b16 v[222:223], v250 offset:40128
  s_add_u32 s51, s49, 49152
  s_add_u32 m0, s47, 51504
  s_waitcnt lgkmcnt(10)
  v_mfma_f32_32x32x16_bf16 a[160:175], v[200:203], v[104:107], a[160:175]
  ds_read_b64_tr_b16 v[192:193], v250 offset:52224
  ds_read_b64_tr_b16 v[194:195], v250 offset:56576
  s_waitcnt lgkmcnt(10)
  v_mfma_f32_32x32x16_bf16 a[176:191], v[204:207], v[104:107], a[176:191]
  ds_read_b64_tr_b16 v[196:197], v250 offset:52288
  ds_read_b64_tr_b16 v[198:199], v250 offset:56640
  buffer_load_dwordx4 v226, s[20:23], s51 offen offset:1536 nt lds
  s_waitcnt lgkmcnt(10)
  v_mfma_f32_32x32x16_bf16 a[192:207], v[208:211], v[104:107], a[192:207]
  ds_read_b64_tr_b16 v[200:201], v250 offset:52352
  ds_read_b64_tr_b16 v[202:203], v250 offset:56704
  s_waitcnt lgkmcnt(10)
  v_mfma_f32_32x32x16_bf16 a[208:223], v[212:215], v[104:107], a[208:223]
  ds_read_b64_tr_b16 v[204:205], v250 offset:52416
  ds_read_b64_tr_b16 v[206:207], v250 offset:56768
  s_waitcnt lgkmcnt(10)
  v_mfma_f32_32x32x16_bf16 a[224:239], v[216:219], v[104:107], a[224:239]
  ds_read_b64_tr_b16 v[208:209], v250 offset:52480
  ds_read_b64_tr_b16 v[210:211], v250 offset:56832
  s_waitcnt lgkmcnt(10)
  v_mfma_f32_32x32x16_bf16 a[240:255], v[220:223], v[104:107], a[240:255]
  ds_read_b64_tr_b16 v[212:213], v250 offset:52544
  ds_read_b64_tr_b16 v[214:215], v250 offset:56896
  s_waitcnt lgkmcnt(10)
  v_mfma_f32_32x32x16_bf16 a[0:15], v[192:195], v[108:111], a[0:15]
  ds_read_b64_tr_b16 v[216:217], v250 offset:52608
  ds_read_b64_tr_b16 v[218:219], v250 offset:56960
  s_waitcnt lgkmcnt(10)
  v_mfma_f32_32x32x16_bf16 a[16:31], v[196:199], v[108:111], a[16:31]
  ds_read_b64_tr_b16 v[220:221], v250 offset:52672
  ds_read_b64_tr_b16 v[222:223], v250 offset:57024
  s_waitcnt lgkmcnt(10)
  v_mfma_f32_32x32x16_bf16 a[32:47], v[200:203], v[108:111], a[32:47]
  ds_read_b64_tr_b16 v[192:193], v250 offset:52736
  ds_read_b64_tr_b16 v[194:195], v250 offset:57088
  s_waitcnt lgkmcnt(10)
  v_mfma_f32_32x32x16_bf16 a[48:63], v[204:207], v[108:111], a[48:63]
  ds_read_b64_tr_b16 v[196:197], v250 offset:52800
  ds_read_b64_tr_b16 v[198:199], v250 offset:57152
  s_waitcnt lgkmcnt(10)
  v_mfma_f32_32x32x16_bf16 a[64:79], v[208:211], v[108:111], a[64:79]
  ds_read_b64_tr_b16 v[200:201], v250 offset:52864
  ds_read_b64_tr_b16 v[202:203], v250 offset:57216
  s_waitcnt lgkmcnt(10)
  v_mfma_f32_32x32x16_bf16 a[80:95], v[212:215], v[108:111], a[80:95]
  ds_read_b64_tr_b16 v[204:205], v250 offset:52928
  ds_read_b64_tr_b16 v[206:207], v250 offset:57280
  s_waitcnt lgkmcnt(10)
  v_mfma_f32_32x32x16_bf16 a[96:111], v[216:219], v[108:111], a[96:111]
  ds_read_b64_tr_b16 v[208:209], v250 offset:52992
  ds_read_b64_tr_b16 v[210:211], v250 offset:57344
  s_waitcnt lgkmcnt(10)
  v_mfma_f32_32x32x16_bf16 a[112:127], v[220:223], v[108:111], a[112:127]
  ds_read_b64_tr_b16 v[212:213], v250 offset:53056
  ds_read_b64_tr_b16 v[214:215], v250 offset:57408
  s_waitcnt lgkmcnt(10)
  v_mfma_f32_32x32x16_bf16 a[128:143], v[192:195], v[108:111], a[128:143]
  ds_read_b64_tr_b16 v[216:217], v250 offset:53120
  ds_read_b64_tr_b16 v[218:219], v250 offset:57472
  s_waitcnt lgkmcnt(10)
  v_mfma_f32_32x32x16_bf16 a[144:159], v[196:199], v[108:111], a[144:159]
  ds_read_b64_tr_b16 v[220:221], v250 offset:53184
  ds_read_b64_tr_b16 v[222:223], v250 offset:57536
  s_waitcnt lgkmcnt(10)
  v_mfma_f32_32x32x16_bf16 a[160:175], v[200:203], v[108:111], a[160:175]
  s_waitcnt lgkmcnt(8)
  v_mfma_f32_32x32x16_bf16 a[176:191], v[204:207], v[108:111], a[176:191]
  s_waitcnt lgkmcnt(6)
  v_mfma_f32_32x32x16_bf16 a[192:207], v[208:211], v[108:111], a[192:207]
  s_waitcnt lgkmcnt(4)
  v_mfma_f32_32x32x16_bf16 a[208:223], v[212:215], v[108:111], a[208:223]
  s_waitcnt lgkmcnt(2)
  v_mfma_f32_32x32x16_bf16 a[224:239], v[216:219], v[108:111], a[224:239]
  s_waitcnt lgkmcnt(0)
  v_mfma_f32_32x32x16_bf16 a[240:255], v[220:223], v[108:111], a[240:255]
  s_barrier
  ds_read_b128 v[192:195], v224 offset:0
  ds_read_b128 v[196:199], v224 offset:32
  ds_read_b128 v[200:203], v224 offset:64
  v_add_u32 v236, s45, v227
  v_add_u32 v236, 83968, v236
  v_add_u32 v250, 69632, v225
  v_accvgpr_read_b32 v240, a0
  v_accvgpr_read_b32 v241, a1
  v_accvgpr_read_b32 v242, a2
  v_accvgpr_read_b32 v243, a3
  v_accvgpr_read_b32 v244, a4
  v_accvgpr_read_b32 v245, a5
  v_accvgpr_read_b32 v246, a6
  v_accvgpr_read_b32 v247, a7
  v_cvt_pk_bf16_f32 v0, v240, v241
  v_cvt_pk_bf16_f32 v1, v242, v243
  v_cvt_pk_bf16_f32 v2, v244, v245
  v_cvt_pk_bf16_f32 v3, v246, v247
  ds_write_b128 v236, v[128:131] offset:0
  ds_write_b128 v236, v[132:135] offset:1088
  v_accvgpr_read_b32 v240, a128
  v_accvgpr_read_b32 v241, a129
  v_accvgpr_read_b32 v242, a130
  v_accvgpr_read_b32 v243, a131
  v_accvgpr_read_b32 v244, a132
  v_accvgpr_read_b32 v245, a133
  v_accvgpr_read_b32 v246, a134
  v_accvgpr_read_b32 v247, a135
  v_cvt_pk_bf16_f32 v64, v240, v241
  v_cvt_pk_bf16_f32 v65, v242, v243
  v_cvt_pk_bf16_f32 v66, v244, v245
  v_cvt_pk_bf16_f32 v67, v246, v247
  ds_write_b128 v236, v[136:139] offset:2176
  ds_write_b128 v236, v[140:143] offset:3264
  v_accvgpr_read_b32 v240, a8
  v_accvgpr_read_b32 v241, a9
  v_accvgpr_read_b32 v242, a10
  v_accvgpr_read_b32 v243, a11
  v_accvgpr_read_b32 v244, a12
  v_accvgpr_read_b32 v245, a13
  v_accvgpr_read_b32 v246, a14
  v_accvgpr_read_b32 v247, a15
  v_cvt_pk_bf16_f32 v4, v240, v241
  v_cvt_pk_bf16_f32 v5, v242, v243
  v_cvt_pk_bf16_f32 v6, v244, v245
  v_cvt_pk_bf16_f32 v7, v246, v247
  ds_write_b128 v236, v[144:147] offset:17408
  ds_write_b128 v236, v[148:151] offset:18496
  v_accvgpr_read_b32 v240, a136
  v_accvgpr_read_b32 v241, a137
  v_accvgpr_read_b32 v242, a138
  v_accvgpr_read_b32 v243, a139
  v_accvgpr_read_b32 v244, a140
  v_accvgpr_read_b32 v245, a141
  v_accvgpr_read_b32 v246, a142
  v_accvgpr_read_b32 v247, a143
  v_cvt_pk_bf16_f32 v68, v240, v241
  v_cvt_pk_bf16_f32 v69, v242, v243
  v_cvt_pk_bf16_f32 v70, v244, v245
  v_cvt_pk_bf16_f32 v71, v246, v247
  ds_write_b128 v236, v[152:155] offset:19584
  ds_write_b128 v236, v[156:159] offset:20672
  v_accvgpr_read_b32 v240, a16
  v_accvgpr_read_b32 v241, a17
  v_accvgpr_read_b32 v242, a18
  v_accvgpr_read_b32 v243, a19
  v_accvgpr_read_b32 v244, a20
  v_accvgpr_read_b32 v245, a21
  v_accvgpr_read_b32 v246, a22
  v_accvgpr_read_b32 v247, a23
  v_cvt_pk_bf16_f32 v8, v240, v241
  v_cvt_pk_bf16_f32 v9, v242, v243
  v_cvt_pk_bf16_f32 v10, v244, v245
  v_cvt_pk_bf16_f32 v11, v246, v247
  ds_write_b128 v236, v[160:163] offset:34816
  ds_write_b128 v236, v[164:167] offset:35904
  v_accvgpr_read_b32 v240, a144
  v_accvgpr_read_b32 v241, a145
  v_accvgpr_read_b32 v242, a146
  v_accvgpr_read_b32 v243, a147
  v_accvgpr_read_b32 v244, a148
  v_accvgpr_read_b32 v245, a149
  v_accvgpr_read_b32 v246, a150
  v_accvgpr_read_b32 v247, a151
  v_cvt_pk_bf16_f32 v72, v240, v241
  v_cvt_pk_bf16_f32 v73, v242, v243
  v_cvt_pk_bf16_f32 v74, v244, v245
  v_cvt_pk_bf16_f32 v75, v246, v247
  ds_write_b128 v236, v[168:171] offset:36992
  ds_write_b128 v236, v[172:175] offset:38080
  v_accvgpr_read_b32 v240, a24
  v_accvgpr_read_b32 v241, a25
  v_accvgpr_read_b32 v242, a26
  v_accvgpr_read_b32 v243, a27
  v_accvgpr_read_b32 v244, a28
  v_accvgpr_read_b32 v245, a29
  v_accvgpr_read_b32 v246, a30
  v_accvgpr_read_b32 v247, a31
  v_cvt_pk_bf16_f32 v12, v240, v241
  v_cvt_pk_bf16_f32 v13, v242, v243
  v_cvt_pk_bf16_f32 v14, v244, v245
  v_cvt_pk_bf16_f32 v15, v246, v247
  ds_write_b128 v236, v[176:179] offset:52224
  ds_write_b128 v236, v[180:183] offset:53312
  v_accvgpr_read_b32 v240, a152
  v_accvgpr_read_b32 v241, a153
  v_accvgpr_read_b32 v242, a154
  v_accvgpr_read_b32 v243, a155
  v_accvgpr_read_b32 v244, a156
  v_accvgpr_read_b32 v245, a157
  v_accvgpr_read_b32 v246, a158
  v_accvgpr_read_b32 v247, a159
  v_cvt_pk_bf16_f32 v76, v240, v241
  v_cvt_pk_bf16_f32 v77, v242, v243
  v_cvt_pk_bf16_f32 v78, v244, v245
  v_cvt_pk_bf16_f32 v79, v246, v247
  ds_write_b128 v236, v[184:187] offset:54400
  ds_write_b128 v236, v[188:191] offset:55488
  s_waitcnt lgkmcnt(0)
  v_mfma_f32_32x32x16_bf16 v[128:143], v[192:195], v[0:3], 0
  ds_read_b128 v[204:207], v224 offset:96
  v_accvgpr_read_b32 v240, a32
  v_accvgpr_read_b32 v241, a33
  v_accvgpr_read_b32 v242, a34
  v_accvgpr_read_b32 v243, a35
  v_accvgpr_read_b32 v244, a36
  v_accvgpr_read_b32 v245, a37
  v_accvgpr_read_b32 v246, a38
  v_accvgpr_read_b32 v247, a39
  v_cvt_pk_bf16_f32 v16, v240, v241
  v_cvt_pk_bf16_f32 v17, v242, v243
  v_cvt_pk_bf16_f32 v18, v244, v245
  v_cvt_pk_bf16_f32 v19, v246, v247
  v_mfma_f32_32x32x16_bf16 v[144:159], v[192:195], v[64:67], 0
  v_accvgpr_read_b32 v240, a160
  v_accvgpr_read_b32 v241, a161
  v_accvgpr_read_b32 v242, a162
  v_accvgpr_read_b32 v243, a163
  v_accvgpr_read_b32 v244, a164
  v_accvgpr_read_b32 v245, a165
  v_accvgpr_read_b32 v246, a166
  v_accvgpr_read_b32 v247, a167
  v_cvt_pk_bf16_f32 v80, v240, v241
  v_cvt_pk_bf16_f32 v81, v242, v243
  v_cvt_pk_bf16_f32 v82, v244, v245
  v_cvt_pk_bf16_f32 v83, v246, v247
  v_mfma_f32_32x32x16_bf16 v[128:143], v[196:199], v[4:7], v[128:143]
  ds_read_b128 v[192:195], v224 offset:128
  v_accvgpr_read_b32 v240, a40
  v_accvgpr_read_b32 v241, a41
  v_accvgpr_read_b32 v242, a42
  v_accvgpr_read_b32 v243, a43
  v_accvgpr_read_b32 v244, a44
  v_accvgpr_read_b32 v245, a45
  v_accvgpr_read_b32 v246, a46
  v_accvgpr_read_b32 v247, a47
  v_cvt_pk_bf16_f32 v20, v240, v241
  v_cvt_pk_bf16_f32 v21, v242, v243
  v_cvt_pk_bf16_f32 v22, v244, v245
  v_cvt_pk_bf16_f32 v23, v246, v247
  v_mfma_f32_32x32x16_bf16 v[144:159], v[196:199], v[68:71], v[144:159]
  v_accvgpr_read_b32 v240, a168
  v_accvgpr_read_b32 v241, a169
  v_accvgpr_read_b32 v242, a170
  v_accvgpr_read_b32 v243, a171
  v_accvgpr_read_b32 v244, a172
  v_accvgpr_read_b32 v245, a173
  v_accvgpr_read_b32 v246, a174
  v_accvgpr_read_b32 v247, a175
  v_cvt_pk_bf16_f32 v84, v240, v241
  v_cvt_pk_bf16_f32 v85, v242, v243
  v_cvt_pk_bf16_f32 v86, v244, v245
  v_cvt_pk_bf16_f32 v87, v246, v247
  v_mfma_f32_32x32x16_bf16 v[128:143], v[200:203], v[8:11], v[128:143]
  ds_read_b128 v[196:199], v224 offset:160
  v_accvgpr_read_b32 v240, a48
  v_accvgpr_read_b32 v241, a49
  v_accvgpr_read_b32 v242, a50
  v_accvgpr_read_b32 v243, a51
  v_accvgpr_read_b32 v244, a52
  v_accvgpr_read_b32 v245, a53
  v_accvgpr_read_b32 v246, a54
  v_accvgpr_read_b32 v247, a55
  v_cvt_pk_bf16_f32 v24, v240, v241
  v_cvt_pk_bf16_f32 v25, v242, v243
  v_cvt_pk_bf16_f32 v26, v244, v245
  v_cvt_pk_bf16_f32 v27, v246, v247
  v_mfma_f32_32x32x16_bf16 v[144:159], v[200:203], v[72:75], v[144:159]
  v_accvgpr_read_b32 v240, a176
  v_accvgpr_read_b32 v241, a177
  v_accvgpr_read_b32 v242, a178
  v_accvgpr_read_b32 v243, a179
  v_accvgpr_read_b32 v244, a180
  v_accvgpr_read_b32 v245, a181
  v_accvgpr_read_b32 v246, a182
  v_accvgpr_read_b32 v247, a183
  v_cvt_pk_bf16_f32 v88, v240, v241
  v_cvt_pk_bf16_f32 v89, v242, v243
  v_cvt_pk_bf16_f32 v90, v244, v245
  v_cvt_pk_bf16_f32 v91, v246, v247
  s_waitcnt lgkmcnt(2)
  v_mfma_f32_32x32x16_bf16 v[128:143], v[204:207], v[12:15], v[128:143]
  ds_read_b128 v[200:203], v224 offset:192
  v_accvgpr_read_b32 v240, a56
  v_accvgpr_read_b32 v241, a57
  v_accvgpr_read_b32 v242, a58
  v_accvgpr_read_b32 v243, a59
  v_accvgpr_read_b32 v244, a60
  v_accvgpr_read_b32 v245, a61
  v_accvgpr_read_b32 v246, a62
  v_accvgpr_read_b32 v247, a63
  v_cvt_pk_bf16_f32 v28, v240, v241
  v_cvt_pk_bf16_f32 v29, v242, v243
  v_cvt_pk_bf16_f32 v30, v244, v245
  v_cvt_pk_bf16_f32 v31, v246, v247
  v_mfma_f32_32x32x16_bf16 v[144:159], v[204:207], v[76:79], v[144:159]
  v_accvgpr_read_b32 v240, a184
  v_accvgpr_read_b32 v241, a185
  v_accvgpr_read_b32 v242, a186
  v_accvgpr_read_b32 v243, a187
  v_accvgpr_read_b32 v244, a188
  v_accvgpr_read_b32 v245, a189
  v_accvgpr_read_b32 v246, a190
  v_accvgpr_read_b32 v247, a191
  v_cvt_pk_bf16_f32 v92, v240, v241
  v_cvt_pk_bf16_f32 v93, v242, v243
  v_cvt_pk_bf16_f32 v94, v244, v245
  v_cvt_pk_bf16_f32 v95, v246, v247
  s_waitcnt lgkmcnt(2)
  v_mfma_f32_32x32x16_bf16 v[128:143], v[192:195], v[16:19], v[128:143]
  ds_read_b128 v[204:207], v224 offset:224
  v_accvgpr_read_b32 v240, a64
  v_accvgpr_read_b32 v241, a65
  v_accvgpr_read_b32 v242, a66
  v_accvgpr_read_b32 v243, a67
  v_accvgpr_read_b32 v244, a68
  v_accvgpr_read_b32 v245, a69
  v_accvgpr_read_b32 v246, a70
  v_accvgpr_read_b32 v247, a71
  v_cvt_pk_bf16_f32 v32, v240, v241
  v_cvt_pk_bf16_f32 v33, v242, v243
  v_cvt_pk_bf16_f32 v34, v244, v245
  v_cvt_pk_bf16_f32 v35, v246, v247
  v_mfma_f32_32x32x16_bf16 v[144:159], v[192:195], v[80:83], v[144:159]
  v_accvgpr_read_b32 v240, a192
  v_accvgpr_read_b32 v241, a193
  v_accvgpr_read_b32 v242, a194
  v_accvgpr_read_b32 v243, a195
  v_accvgpr_read_b32 v244, a196
  v_accvgpr_read_b32 v245, a197
  v_accvgpr_read_b32 v246, a198
  v_accvgpr_read_b32 v247, a199
  v_cvt_pk_bf16_f32 v96, v240, v241
  v_cvt_pk_bf16_f32 v97, v242, v243
  v_cvt_pk_bf16_f32 v98, v244, v245
  v_cvt_pk_bf16_f32 v99, v246, v247
  s_waitcnt lgkmcnt(2)
  v_mfma_f32_32x32x16_bf16 v[128:143], v[196:199], v[20:23], v[128:143]
  ds_read_b128 v[192:195], v224 offset:256
  v_accvgpr_read_b32 v240, a72
  v_accvgpr_read_b32 v241, a73
  v_accvgpr_read_b32 v242, a74
  v_accvgpr_read_b32 v243, a75
  v_accvgpr_read_b32 v244, a76
  v_accvgpr_read_b32 v245, a77
  v_accvgpr_read_b32 v246, a78
  v_accvgpr_read_b32 v247, a79
  v_cvt_pk_bf16_f32 v36, v240, v241
  v_cvt_pk_bf16_f32 v37, v242, v243
  v_cvt_pk_bf16_f32 v38, v244, v245
  v_cvt_pk_bf16_f32 v39, v246, v247
  v_mfma_f32_32x32x16_bf16 v[144:159], v[196:199], v[84:87], v[144:159]
  v_accvgpr_read_b32 v240, a200
  v_accvgpr_read_b32 v241, a201
  v_accvgpr_read_b32 v242, a202
  v_accvgpr_read_b32 v243, a203
  v_accvgpr_read_b32 v244, a204
  v_accvgpr_read_b32 v245, a205
  v_accvgpr_read_b32 v246, a206
  v_accvgpr_read_b32 v247, a207
  v_cvt_pk_bf16_f32 v100, v240, v241
  v_cvt_pk_bf16_f32 v101, v242, v243
  v_cvt_pk_bf16_f32 v102, v244, v245
  v_cvt_pk_bf16_f32 v103, v246, v247
  s_waitcnt lgkmcnt(2)
  v_mfma_f32_32x32x16_bf16 v[128:143], v[200:203], v[24:27], v[128:143]
  ds_read_b128 v[196:199], v224 offset:288
  v_accvgpr_read_b32 v240, a80
  v_accvgpr_read_b32 v241, a81
  v_accvgpr_read_b32 v242, a82
  v_accvgpr_read_b32 v243, a83
  v_accvgpr_read_b32 v244, a84
  v_accvgpr_read_b32 v245, a85
  v_accvgpr_read_b32 v246, a86
  v_accvgpr_read_b32 v247, a87
  v_cvt_pk_bf16_f32 v40, v240, v241
  v_cvt_pk_bf16_f32 v41, v242, v243
  v_cvt_pk_bf16_f32 v42, v244, v245
  v_cvt_pk_bf16_f32 v43, v246, v247
  v_mfma_f32_32x32x16_bf16 v[144:159], v[200:203], v[88:91], v[144:159]
  v_accvgpr_read_b32 v240, a208
  v_accvgpr_read_b32 v241, a209
  v_accvgpr_read_b32 v242, a210
  v_accvgpr_read_b32 v243, a211
  v_accvgpr_read_b32 v244, a212
  v_accvgpr_read_b32 v245, a213
  v_accvgpr_read_b32 v246, a214
  v_accvgpr_read_b32 v247, a215
  v_cvt_pk_bf16_f32 v104, v240, v241
  v_cvt_pk_bf16_f32 v105, v242, v243
  v_cvt_pk_bf16_f32 v106, v244, v245
  v_cvt_pk_bf16_f32 v107, v246, v247
  s_waitcnt lgkmcnt(2)
  v_mfma_f32_32x32x16_bf16 v[128:143], v[204:207], v[28:31], v[128:143]
  ds_read_b128 v[200:203], v224 offset:320
  v_accvgpr_read_b32 v240, a88
  v_accvgpr_read_b32 v241, a89
  v_accvgpr_read_b32 v242, a90
  v_accvgpr_read_b32 v243, a91
  v_accvgpr_read_b32 v244, a92
  v_accvgpr_read_b32 v245, a93
  v_accvgpr_read_b32 v246, a94
  v_accvgpr_read_b32 v247, a95
  v_cvt_pk_bf16_f32 v44, v240, v241
  v_cvt_pk_bf16_f32 v45, v242, v243
  v_cvt_pk_bf16_f32 v46, v244, v245
  v_cvt_pk_bf16_f32 v47, v246, v247
  v_mfma_f32_32x32x16_bf16 v[144:159], v[204:207], v[92:95], v[144:159]
  v_accvgpr_read_b32 v240, a216
  v_accvgpr_read_b32 v241, a217
  v_accvgpr_read_b32 v242, a218
  v_accvgpr_read_b32 v243, a219
  v_accvgpr_read_b32 v244, a220
  v_accvgpr_read_b32 v245, a221
  v_accvgpr_read_b32 v246, a222
  v_accvgpr_read_b32 v247, a223
  v_cvt_pk_bf16_f32 v108, v240, v241
  v_cvt_pk_bf16_f32 v109, v242, v243
  v_cvt_pk_bf16_f32 v110, v244, v245
  v_cvt_pk_bf16_f32 v111, v246, v247
  s_waitcnt lgkmcnt(2)
  v_mfma_f32_32x32x16_bf16 v[128:143], v[192:195], v[32:35], v[128:143]
  ds_read_b128 v[204:207], v224 offset:352
  v_accvgpr_read_b32 v240, a96
  v_accvgpr_read_b32 v241, a97
  v_accvgpr_read_b32 v242, a98
  v_accvgpr_read_b32 v243, a99
  v_accvgpr_read_b32 v244, a100
  v_accvgpr_read_b32 v245, a101
  v_accvgpr_read_b32 v246, a102
  v_accvgpr_read_b32 v247, a103
  v_cvt_pk_bf16_f32 v48, v240, v241
  v_cvt_pk_bf16_f32 v49, v242, v243
  v_cvt_pk_bf16_f32 v50, v244, v245
  v_cvt_pk_bf16_f32 v51, v246, v247
  v_mfma_f32_32x32x16_bf16 v[144:159], v[192:195], v[96:99], v[144:159]
  v_accvgpr_read_b32 v240, a224
  v_accvgpr_read_b32 v241, a225
  v_accvgpr_read_b32 v242, a226
  v_accvgpr_read_b32 v243, a227
  v_accvgpr_read_b32 v244, a228
  v_accvgpr_read_b32 v245, a229
  v_accvgpr_read_b32 v246, a230
  v_accvgpr_read_b32 v247, a231
  v_cvt_pk_bf16_f32 v112, v240, v241
  v_cvt_pk_bf16_f32 v113, v242, v243
  v_cvt_pk_bf16_f32 v114, v244, v245
  v_cvt_pk_bf16_f32 v115, v246, v247
  s_waitcnt lgkmcnt(2)
  v_mfma_f32_32x32x16_bf16 v[128:143], v[196:199], v[36:39], v[128:143]
  ds_read_b128 v[192:195], v224 offset:384
  v_accvgpr_read_b32 v240, a104
  v_accvgpr_read_b32 v241, a105
  v_accvgpr_read_b32 v242, a106
  v_accvgpr_read_b32 v243, a107
  v_accvgpr_read_b32 v244, a108
  v_accvgpr_read_b32 v245, a109
  v_accvgpr_read_b32 v246, a110
  v_accvgpr_read_b32 v247, a111
  v_cvt_pk_bf16_f32 v52, v240, v241
  v_cvt_pk_bf16_f32 v53, v242, v243
  v_cvt_pk_bf16_f32 v54, v244, v245
  v_cvt_pk_bf16_f32 v55, v246, v247
  v_mfma_f32_32x32x16_bf16 v[144:159], v[196:199], v[100:103], v[144:159]
  v_accvgpr_read_b32 v240, a232
  v_accvgpr_read_b32 v241, a233
  v_accvgpr_read_b32 v242, a234
  v_accvgpr_read_b32 v243, a235
  v_accvgpr_read_b32 v244, a236
  v_accvgpr_read_b32 v245, a237
  v_accvgpr_read_b32 v246, a238
  v_accvgpr_read_b32 v247, a239
  v_cvt_pk_bf16_f32 v116, v240, v241
  v_cvt_pk_bf16_f32 v117, v242, v243
  v_cvt_pk_bf16_f32 v118, v244, v245
  v_cvt_pk_bf16_f32 v119, v246, v247
  s_waitcnt lgkmcnt(2)
  v_mfma_f32_32x32x16_bf16 v[128:143], v[200:203], v[40:43], v[128:143]
  ds_read_b128 v[196:199], v224 offset:416
  v_accvgpr_read_b32 v240, a112
  v_accvgpr_read_b32 v241, a113
  v_accvgpr_read_b32 v242, a114
  v_accvgpr_read_b32 v243, a115
  v_accvgpr_read_b32 v244, a116
  v_accvgpr_read_b32 v245, a117
  v_accvgpr_read_b32 v246, a118
  v_accvgpr_read_b32 v247, a119
  v_cvt_pk_bf16_f32 v56, v240, v241
  v_cvt_pk_bf16_f32 v57, v242, v243
  v_cvt_pk_bf16_f32 v58, v244, v245
  v_cvt_pk_bf16_f32 v59, v246, v247
  v_mfma_f32_32x32x16_bf16 v[144:159], v[200:203], v[104:107], v[144:159]
  v_accvgpr_read_b32 v240, a240
  v_accvgpr_read_b32 v241, a241
  v_accvgpr_read_b32 v242, a242
  v_accvgpr_read_b32 v243, a243
  v_accvgpr_read_b32 v244, a244
  v_accvgpr_read_b32 v245, a245
  v_accvgpr_read_b32 v246, a246
  v_accvgpr_read_b32 v247, a247
  v_cvt_pk_bf16_f32 v120, v240, v241
  v_cvt_pk_bf16_f32 v121, v242, v243
  v_cvt_pk_bf16_f32 v122, v244, v245
  v_cvt_pk_bf16_f32 v123, v246, v247
  s_waitcnt lgkmcnt(2)
  v_mfma_f32_32x32x16_bf16 v[128:143], v[204:207], v[44:47], v[128:143]
  ds_read_b128 v[200:203], v224 offset:448
  v_accvgpr_read_b32 v240, a120
  v_accvgpr_read_b32 v241, a121
  v_accvgpr_read_b32 v242, a122
  v_accvgpr_read_b32 v243, a123
  v_accvgpr_read_b32 v244, a124
  v_accvgpr_read_b32 v245, a125
  v_accvgpr_read_b32 v246, a126
  v_accvgpr_read_b32 v247, a127
  v_cvt_pk_bf16_f32 v60, v240, v241
  v_cvt_pk_bf16_f32 v61, v242, v243
  v_cvt_pk_bf16_f32 v62, v244, v245
  v_cvt_pk_bf16_f32 v63, v246, v247
  v_mfma_f32_32x32x16_bf16 v[144:159], v[204:207], v[108:111], v[144:159]
  v_accvgpr_read_b32 v240, a248
  v_accvgpr_read_b32 v241, a249
  v_accvgpr_read_b32 v242, a250
  v_accvgpr_read_b32 v243, a251
  v_accvgpr_read_b32 v244, a252
  v_accvgpr_read_b32 v245, a253
  v_accvgpr_read_b32 v246, a254
  v_accvgpr_read_b32 v247, a255
  v_cvt_pk_bf16_f32 v124, v240, v241
  v_cvt_pk_bf16_f32 v125, v242, v243
  v_cvt_pk_bf16_f32 v126, v244, v245
  v_cvt_pk_bf16_f32 v127, v246, v247
  s_waitcnt lgkmcnt(2)
  v_mfma_f32_32x32x16_bf16 v[128:143], v[192:195], v[48:51], v[128:143]
  ds_read_b128 v[204:207], v224 offset:480
  v_mfma_f32_32x32x16_bf16 v[144:159], v[192:195], v[112:115], v[144:159]
  s_waitcnt lgkmcnt(2)
  v_mfma_f32_32x32x16_bf16 v[128:143], v[196:199], v[52:55], v[128:143]
  v_mfma_f32_32x32x16_bf16 v[144:159], v[196:199], v[116:119], v[144:159]
  s_waitcnt lgkmcnt(1)
  v_mfma_f32_32x32x16_bf16 v[128:143], v[200:203], v[56:59], v[128:143]
  v_mfma_f32_32x32x16_bf16 v[144:159], v[200:203], v[120:123], v[144:159]
  s_waitcnt lgkmcnt(0)
  v_mfma_f32_32x32x16_bf16 v[128:143], v[204:207], v[60:63], v[128:143]
  v_mfma_f32_32x32x16_bf16 v[144:159], v[204:207], v[124:127], v[144:159]
  s_barrier
  s_add_u32 s51, s49, 65536
  s_add_u32 m0, s47, 0
  s_nop 0
  buffer_load_dwordx4 v226, s[20:23], s51 offen nt lds
  s_add_u32 m0, s47, 528
  s_nop 0
  buffer_load_dwordx4 v226, s[20:23], s51 offen offset:512 nt lds
  s_add_u32 m0, s47, 1056
  s_nop 0
  buffer_load_dwordx4 v226, s[20:23], s51 offen offset:1024 nt lds
  s_add_u32 m0, s47, 1584
  s_nop 0
  buffer_load_dwordx4 v226, s[20:23], s51 offen offset:1536 nt lds
  ds_read_b128 v[192:195], v224 offset:16640
  ds_read_b128 v[196:199], v224 offset:16672
  ds_read_b128 v[200:203], v224 offset:16704
  s_waitcnt lgkmcnt(2)
  v_mfma_f32_32x32x16_bf16 v[160:175], v[192:195], v[0:3], 0
  ds_read_b128 v[204:207], v224 offset:16736
  v_max3_f32 v236, v128, v129, v130
  v_max3_f32 v236, v236, v131, v132
  v_max3_f32 v236, v236, v133, v134
  v_max3_f32 v236, v236, v135, v136
  v_max3_f32 v236, v236, v137, v138
  v_mfma_f32_32x32x16_bf16 v[176:191], v[192:195], v[64:67], 0
  v_max3_f32 v236, v236, v139, v140
  v_max3_f32 v236, v236, v141, v142
  v_max_f32 v236, v236, v143
  v_max3_f32 v237, v144, v145, v146
  v_max3_f32 v237, v237, v147, v148
  v_max3_f32 v237, v237, v149, v150
  v_max3_f32 v237, v237, v151, v152
  s_waitcnt lgkmcnt(2)
  v_mfma_f32_32x32x16_bf16 v[160:175], v[196:199], v[4:7], v[160:175]
  ds_read_b128 v[192:195], v224 offset:16768
  v_max3_f32 v237, v237, v153, v154
  v_max3_f32 v237, v237, v155, v156
  v_max3_f32 v237, v237, v157, v158
  v_max_f32 v237, v237, v159
  v_mov_b32 v238, v236
  v_mfma_f32_32x32x16_bf16 v[176:191], v[196:199], v[68:71], v[176:191]
  v_mov_b32 v239, v237
  v_permlane32_swap_b32 v236, v238
  s_nop 0
  v_permlane32_swap_b32 v237, v239
  v_max_f32 v236, v236, v238
  v_max_f32 v237, v237, v239
  v_mov_b32 v248, v236
  s_waitcnt lgkmcnt(2)
  v_mfma_f32_32x32x16_bf16 v[160:175], v[200:203], v[8:11], v[160:175]
  ds_read_b128 v[196:199], v224 offset:16800
  v_mul_f32 v228, s44, v236
  v_add_f32 v230, s62, v236
  v_mov_b32 v232, 0
  v_mov_b32 v249, v237
  v_mul_f32 v229, s44, v237
  v_add_f32 v231, s62, v237
  v_mfma_f32_32x32x16_bf16 v[176:191], v[200:203], v[72:75], v[176:191]
  v_mov_b32 v233, 0
  v_fma_f32 v128, v128, s44, -v228
  v_fma_f32 v129, v129, s44, -v228
  v_fma_f32 v130, v130, s44, -v228
  v_fma_f32 v131, v131, s44, -v228
  v_exp_f32 v128, v128
  s_waitcnt lgkmcnt(2)
  v_mfma_f32_32x32x16_bf16 v[160:175], v[204:207], v[12:15], v[160:175]
  ds_read_b128 v[200:203], v224 offset:16832
  v_exp_f32 v129, v129
  v_exp_f32 v130, v130
  v_mfma_f32_32x32x16_bf16 v[176:191], v[204:207], v[76:79], v[176:191]
  v_exp_f32 v131, v131
  v_add_f32 v232, v232, v128
  v_add_f32 v232, v232, v129
  v_add_f32 v232, v232, v130
  v_add_f32 v232, v232, v131
  v_cvt_pk_bf16_f32 v128, v128, v129
  s_waitcnt lgkmcnt(2)
  v_mfma_f32_32x32x16_bf16 v[160:175], v[192:195], v[16:19], v[160:175]
  ds_read_b128 v[204:207], v224 offset:16864
  v_cvt_pk_bf16_f32 v129, v130, v131
  v_fma_f32 v132, v132, s44, -v228
  v_fma_f32 v133, v133, s44, -v228
  v_fma_f32 v134, v134, s44, -v228
  v_fma_f32 v135, v135, s44, -v228
  v_mfma_f32_32x32x16_bf16 v[176:191], v[192:195], v[80:83], v[176:191]
  v_exp_f32 v132, v132
  v_exp_f32 v133, v133
  v_exp_f32 v134, v134
  s_waitcnt lgkmcnt(2)
  v_mfma_f32_32x32x16_bf16 v[160:175], v[196:199], v[20:23], v[160:175]
  ds_read_b128 v[192:195], v224 offset:16896
  v_exp_f32 v135, v135
  v_add_f32 v232, v232, v132
  v_add_f32 v232, v232, v133
  v_add_f32 v232, v232, v134
  v_add_f32 v232, v232, v135
  v_mfma_f32_32x32x16_bf16 v[176:191], v[196:199], v[84:87], v[176:191]
  v_cvt_pk_bf16_f32 v130, v132, v133
  v_cvt_pk_bf16_f32 v131, v134, v135
  v_fma_f32 v136, v136, s44, -v228
  v_fma_f32 v137, v137, s44, -v228
  v_fma_f32 v138, v138, s44, -v228
  v_fma_f32 v139, v139, s44, -v228
  s_waitcnt lgkmcnt(2)
  v_mfma_f32_32x32x16_bf16 v[160:175], v[200:203], v[24:27], v[160:175]
  ds_read_b128 v[196:199], v224 offset:16928
  v_exp_f32 v136, v136
  v_exp_f32 v137, v137
  v_exp_f32 v138, v138
  v_mfma_f32_32x32x16_bf16 v[176:191], v[200:203], v[88:91], v[176:191]
  v_exp_f32 v139, v139
  v_add_f32 v232, v232, v136
  v_add_f32 v232, v232, v137
  v_add_f32 v232, v232, v138
  v_add_f32 v232, v232, v139
  s_waitcnt lgkmcnt(2)
  v_mfma_f32_32x32x16_bf16 v[160:175], v[204:207], v[28:31], v[160:175]
  ds_read_b128 v[200:203], v224 offset:16960
  v_cvt_pk_bf16_f32 v136, v136, v137
  v_cvt_pk_bf16_f32 v137, v138, v139
  v_fma_f32 v140, v140, s44, -v228
  v_fma_f32 v141, v141, s44, -v228
  v_fma_f32 v142, v142, s44, -v228
  v_fma_f32 v143, v143, s44, -v228
  v_mfma_f32_32x32x16_bf16 v[176:191], v[204:207], v[92:95], v[176:191]
  v_exp_f32 v140, v140
  v_exp_f32 v141, v141
  v_exp_f32 v142, v142
  s_waitcnt lgkmcnt(2)
  v_mfma_f32_32x32x16_bf16 v[160:175], v[192:195], v[32:35], v[160:175]
  ds_read_b128 v[204:207], v224 offset:16992
  v_exp_f32 v143, v143
  v_add_f32 v232, v232, v140
  v_add_f32 v232, v232, v141
  v_add_f32 v232, v232, v142
  v_mfma_f32_32x32x16_bf16 v[176:191], v[192:195], v[96:99], v[176:191]
  v_add_f32 v232, v232, v143
  v_cvt_pk_bf16_f32 v138, v140, v141
  v_cvt_pk_bf16_f32 v139, v142, v143
  v_fma_f32 v144, v144, s44, -v229
  v_fma_f32 v145, v145, s44, -v229
  v_fma_f32 v146, v146, s44, -v229
  v_fma_f32 v147, v147, s44, -v229
  s_waitcnt lgkmcnt(2)
  v_mfma_f32_32x32x16_bf16 v[160:175], v[196:199], v[36:39], v[160:175]
  ds_read_b128 v[192:195], v224 offset:17024
  v_exp_f32 v144, v144
  v_exp_f32 v145, v145
  v_exp_f32 v146, v146
  v_mfma_f32_32x32x16_bf16 v[176:191], v[196:199], v[100:103], v[176:191]
  v_exp_f32 v147, v147
  v_add_f32 v233, v233, v144
  v_add_f32 v233, v233, v145
  v_add_f32 v233, v233, v146
  s_waitcnt lgkmcnt(2)
  v_mfma_f32_32x32x16_bf16 v[160:175], v[200:203], v[40:43], v[160:175]
  ds_read_b128 v[196:199], v224 offset:17056
  v_add_f32 v233, v233, v147
  v_cvt_pk_bf16_f32 v144, v144, v145
  v_cvt_pk_bf16_f32 v145, v146, v147
  v_fma_f32 v148, v148, s44, -v229
  v_fma_f32 v149, v149, s44, -v229
  v_fma_f32 v150, v150, s44, -v229
  v_mfma_f32_32x32x16_bf16 v[176:191], v[200:203], v[104:107], v[176:191]
  v_fma_f32 v151, v151, s44, -v229
  v_exp_f32 v148, v148
  v_exp_f32 v149, v149
  v_exp_f32 v150, v150
  s_waitcnt lgkmcnt(2)
  v_mfma_f32_32x32x16_bf16 v[160:175], v[204:207], v[44:47], v[160:175]
  ds_read_b128 v[200:203], v224 offset:17088
  v_exp_f32 v151, v151
  v_add_f32 v233, v233, v148
  v_add_f32 v233, v233, v149
  v_add_f32 v233, v233, v150
  v_mfma_f32_32x32x16_bf16 v[176:191], v[204:207], v[108:111], v[176:191]
  v_add_f32 v233, v233, v151
  v_cvt_pk_bf16_f32 v146, v148, v149
  v_cvt_pk_bf16_f32 v147, v150, v151
  v_fma_f32 v152, v152, s44, -v229
  v_fma_f32 v153, v153, s44, -v229
  v_fma_f32 v154, v154, s44, -v229
  s_waitcnt lgkmcnt(2)
  v_mfma_f32_32x32x16_bf16 v[160:175], v[192:195], v[48:51], v[160:175]
  ds_read_b128 v[204:207], v224 offset:17120
  v_fma_f32 v155, v155, s44, -v229
  v_exp_f32 v152, v152
  v_exp_f32 v153, v153
  v_mfma_f32_32x32x16_bf16 v[176:191], v[192:195], v[112:115], v[176:191]
  v_exp_f32 v154, v154
  v_exp_f32 v155, v155
  v_add_f32 v233, v233, v152
  v_add_f32 v233, v233, v153
  v_add_f32 v233, v233, v154
  s_waitcnt lgkmcnt(2)
  v_mfma_f32_32x32x16_bf16 v[160:175], v[196:199], v[52:55], v[160:175]
  ds_read_b64_tr_b16 v[208:209], v225 offset:0
  ds_read_b64_tr_b16 v[210:211], v225 offset:4352
  v_add_f32 v233, v233, v155
  v_cvt_pk_bf16_f32 v152, v152, v153
  v_cvt_pk_bf16_f32 v153, v154, v155
  v_fma_f32 v156, v156, s44, -v229
  v_mfma_f32_32x32x16_bf16 v[176:191], v[196:199], v[116:119], v[176:191]
  v_fma_f32 v157, v157, s44, -v229
  v_fma_f32 v158, v158, s44, -v229
  v_fma_f32 v159, v159, s44, -v229
  v_exp_f32 v156, v156
  v_exp_f32 v157, v157
  s_waitcnt lgkmcnt(3)
  v_mfma_f32_32x32x16_bf16 v[160:175], v[200:203], v[56:59], v[160:175]
  ds_read_b64_tr_b16 v[212:213], v225 offset:512
  ds_read_b64_tr_b16 v[214:215], v225 offset:4864
  v_exp_f32 v158, v158
  v_exp_f32 v159, v159
  v_mfma_f32_32x32x16_bf16 v[176:191], v[200:203], v[120:123], v[176:191]
  v_add_f32 v233, v233, v156
  v_add_f32 v233, v233, v157
  v_add_f32 v233, v233, v158
  v_add_f32 v233, v233, v159
  v_cvt_pk_bf16_f32 v154, v156, v157
  v_cvt_pk_bf16_f32 v155, v158, v159
  s_waitcnt lgkmcnt(4)
  v_mfma_f32_32x32x16_bf16 v[160:175], v[204:207], v[60:63], v[160:175]
  ds_read_b64_tr_b16 v[216:217], v225 offset:64
  ds_read_b64_tr_b16 v[218:219], v225 offset:4416
  v_mfma_f32_32x32x16_bf16 v[176:191], v[204:207], v[124:127], v[176:191]
  s_waitcnt lgkmcnt(4)
  v_mfma_f32_32x32x16_bf16 a[0:15], v[208:211], v[128:131], 0
  ds_read_b64_tr_b16 v[220:221], v225 offset:576
  ds_read_b64_tr_b16 v[222:223], v225 offset:4928
  v_mfma_f32_32x32x16_bf16 a[16:31], v[208:211], v[144:147], 0
  s_waitcnt vmcnt(8)
  s_barrier
  s_waitcnt lgkmcnt(4)
  v_mfma_f32_32x32x16_bf16 a[0:15], v[212:215], v[136:139], a[0:15]
  ds_read_b64_tr_b16 v[208:209], v225 offset:128
  ds_read_b64_tr_b16 v[210:211], v225 offset:4480
  s_add_u32 s51, s49, 81920
  s_add_u32 m0, s47, 16640
  v_mfma_f32_32x32x16_bf16 a[16:31], v[212:215], v[152:155], a[16:31]
  buffer_load_dwordx4 v226, s[20:23], s51 offen nt lds
  s_add_u32 m0, s47, 17168
  s_waitcnt lgkmcnt(4)
  v_mfma_f32_32x32x16_bf16 a[32:47], v[216:219], v[128:131], 0
  ds_read_b64_tr_b16 v[212:213], v225 offset:640
  ds_read_b64_tr_b16 v[214:215], v225 offset:4992
  buffer_load_dwordx4 v226, s[20:23], s51 offen offset:512 nt lds
  v_mfma_f32_32x32x16_bf16 a[48:63], v[216:219], v[144:147], 0
  s_add_u32 m0, s47, 17696
  s_nop 0
  buffer_load_dwordx4 v226, s[20:23], s51 offen offset:1024 nt lds
  s_waitcnt lgkmcnt(4)
  v_mfma_f32_32x32x16_bf16 a[32:47], v[220:223], v[136:139], a[32:47]
  ds_read_b64_tr_b16 v[216:217], v225 offset:192
  ds_read_b64_tr_b16 v[218:219], v225 offset:4544
  s_add_u32 m0, s47, 18224
  v_mfma_f32_32x32x16_bf16 a[48:63], v[220:223], v[152:155], a[48:63]
  buffer_load_dwordx4 v226, s[20:23], s51 offen offset:1536 nt lds
  v_max3_f32 v236, v160, v161, v162
  s_waitcnt lgkmcnt(4)
  v_mfma_f32_32x32x16_bf16 a[64:79], v[208:211], v[128:131], 0
  ds_read_b64_tr_b16 v[220:221], v225 offset:704
  ds_read_b64_tr_b16 v[222:223], v225 offset:5056
  v_max3_f32 v236, v236, v163, v164
  v_max3_f32 v236, v236, v165, v166
  v_mfma_f32_32x32x16_bf16 a[80:95], v[208:211], v[144:147], 0
  v_max3_f32 v236, v236, v167, v168
  v_max3_f32 v236, v236, v169, v170
  v_max3_f32 v236, v236, v171, v172
  v_max3_f32 v236, v236, v173, v174
  s_waitcnt lgkmcnt(4)
  v_mfma_f32_32x32x16_bf16 a[64:79], v[212:215], v[136:139], a[64:79]
  ds_read_b64_tr_b16 v[208:209], v225 offset:256
  ds_read_b64_tr_b16 v[210:211], v225 offset:4608
  v_max_f32 v236, v236, v175
  v_max3_f32 v237, v176, v177, v178
  v_max3_f32 v237, v237, v179, v180
  v_mfma_f32_32x32x16_bf16 a[80:95], v[212:215], v[152:155], a[80:95]
  v_max3_f32 v237, v237, v181, v182
  v_max3_f32 v237, v237, v183, v184
  v_max3_f32 v237, v237, v185, v186
  v_max3_f32 v237, v237, v187, v188
  s_waitcnt lgkmcnt(4)
  v_mfma_f32_32x32x16_bf16 a[96:111], v[216:219], v[128:131], 0
  ds_read_b64_tr_b16 v[212:213], v225 offset:768
  ds_read_b64_tr_b16 v[214:215], v225 offset:5120
  v_max3_f32 v237, v237, v189, v190
  v_max_f32 v237, v237, v191
  v_mfma_f32_32x32x16_bf16 a[112:127], v[216:219], v[144:147], 0
  v_mov_b32 v238, v236
  v_mov_b32 v239, v237
  s_nop 0
  v_permlane32_swap_b32 v236, v238
  v_permlane32_swap_b32 v237, v239
  s_waitcnt lgkmcnt(4)
  v_mfma_f32_32x32x16_bf16 a[96:111], v[220:223], v[136:139], a[96:111]
  ds_read_b64_tr_b16 v[216:217], v225 offset:320
  ds_read_b64_tr_b16 v[218:219], v225 offset:4672
  v_max_f32 v236, v236, v238
  v_max_f32 v237, v237, v239
  v_mfma_f32_32x32x16_bf16 a[112:127], v[220:223], v[152:155], a[112:127]
  v_cmp_gt_f32 s[52:53], v236, v230
  v_cmp_gt_f32 s[54:55], v237, v231
  s_nop 1
  s_or_b64 s[52:53], s[52:53], s[54:55]
  s_cbranch_scc0 L_noslow1
  s_call_b64 s[58:59], L_slow
L_noslow1:
  v_fma_f32 v160, v160, s44, -v228
  s_waitcnt lgkmcnt(4)
  v_mfma_f32_32x32x16_bf16 a[128:143], v[208:211], v[128:131], 0
  ds_read_b64_tr_b16 v[220:221], v225 offset:832
  ds_read_b64_tr_b16 v[222:223], v225 offset:5184
  v_fma_f32 v161, v161, s44, -v228
  v_fma_f32 v162, v162, s44, -v228
  v_mfma_f32_32x32x16_bf16 a[144:159], v[208:211], v[144:147], 0
  v_fma_f32 v163, v163, s44, -v228
  v_exp_f32 v160, v160
  v_exp_f32 v161, v161
  s_waitcnt lgkmcnt(4)
  v_mfma_f32_32x32x16_bf16 a[128:143], v[212:215], v[136:139], a[128:143]
  ds_read_b64_tr_b16 v[208:209], v225 offset:384
  ds_read_b64_tr_b16 v[210:211], v225 offset:4736
  v_exp_f32 v162, v162
  v_mfma_f32_32x32x16_bf16 a[144:159], v[212:215], v[152:155], a[144:159]
  v_exp_f32 v163, v163
  v_add_f32 v232, v232, v160
  v_add_f32 v232, v232, v161
  s_waitcnt lgkmcnt(4)
  v_mfma_f32_32x32x16_bf16 a[160:175], v[216:219], v[128:131], 0
  ds_read_b64_tr_b16 v[212:213], v225 offset:896
  ds_read_b64_tr_b16 v[214:215], v225 offset:5248
  v_add_f32 v232, v232, v162
  v_add_f32 v232, v232, v163
  v_mfma_f32_32x32x16_bf16 a[176:191], v[216:219], v[144:147], 0
  v_cvt_pk_bf16_f32 v160, v160, v161
  v_cvt_pk_bf16_f32 v161, v162, v163
  v_fma_f32 v164, v164, s44, -v228
  v_fma_f32 v165, v165, s44, -v228
  s_waitcnt lgkmcnt(4)
  v_mfma_f32_32x32x16_bf16 a[160:175], v[220:223], v[136:139], a[160:175]
  ds_read_b64_tr_b16 v[216:217], v225 offset:448
  ds_read_b64_tr_b16 v[218:219], v225 offset:4800
  v_fma_f32 v166, v166, s44, -v228
  v_fma_f32 v167, v167, s44, -v228
  v_mfma_f32_32x32x16_bf16 a[176:191], v[220:223], v[152:155], a[176:191]
  v_exp_f32 v164, v164
  v_exp_f32 v165, v165
  s_waitcnt lgkmcnt(4)
  v_mfma_f32_32x32x16_bf16 a[192:207], v[208:211], v[128:131], 0
  ds_read_b64_tr_b16 v[220:221], v225 offset:960
  ds_read_b64_tr_b16 v[222:223], v225 offset:5312
  v_exp_f32 v166, v166
  v_exp_f32 v167, v167
  v_mfma_f32_32x32x16_bf16 a[208:223], v[208:211], v[144:147], 0
  v_add_f32 v232, v232, v164
  v_add_f32 v232, v232, v165
  v_add_f32 v232, v232, v166
  s_waitcnt lgkmcnt(4)
  v_mfma_f32_32x32x16_bf16 a[192:207], v[212:215], v[136:139], a[192:207]
  ds_read_b128 v[192:195], v224 offset:33280
  v_add_f32 v232, v232, v167
  v_cvt_pk_bf16_f32 v162, v164, v165
  v_cvt_pk_bf16_f32 v163, v166, v167
  v_mfma_f32_32x32x16_bf16 a[208:223], v[212:215], v[152:155], a[208:223]
  v_fma_f32 v168, v168, s44, -v228
  v_fma_f32 v169, v169, s44, -v228
  v_fma_f32 v170, v170, s44, -v228
  v_fma_f32 v171, v171, s44, -v228
  s_waitcnt lgkmcnt(3)
  v_mfma_f32_32x32x16_bf16 a[224:239], v[216:219], v[128:131], 0
  ds_read_b128 v[196:199], v224 offset:33312
  v_exp_f32 v168, v168
  v_exp_f32 v169, v169
  v_mfma_f32_32x32x16_bf16 a[240:255], v[216:219], v[144:147], 0
  v_exp_f32 v170, v170
  s_waitcnt lgkmcnt(2)
  v_mfma_f32_32x32x16_bf16 a[224:239], v[220:223], v[136:139], a[224:239]
  ds_read_b128 v[200:203], v224 offset:33344
  v_exp_f32 v171, v171
  v_add_f32 v232, v232, v168
  v_add_f32 v232, v232, v169
  v_mfma_f32_32x32x16_bf16 a[240:255], v[220:223], v[152:155], a[240:255]
  v_add_f32 v232, v232, v170
  v_add_f32 v232, v232, v171
  v_cvt_pk_bf16_f32 v168, v168, v169
  v_cvt_pk_bf16_f32 v169, v170, v171
  s_waitcnt lgkmcnt(2)
  v_mfma_f32_32x32x16_bf16 v[128:143], v[192:195], v[0:3], 0
  ds_read_b128 v[204:207], v224 offset:33376
  v_fma_f32 v172, v172, s44, -v228
  v_fma_f32 v173, v173, s44, -v228
  v_fma_f32 v174, v174, s44, -v228
  v_mfma_f32_32x32x16_bf16 v[144:159], v[192:195], v[64:67], 0
  v_fma_f32 v175, v175, s44, -v228
  v_exp_f32 v172, v172
  s_waitcnt lgkmcnt(2)
  v_mfma_f32_32x32x16_bf16 v[128:143], v[196:199], v[4:7], v[128:143]
  ds_read_b128 v[192:195], v224 offset:33408
  v_exp_f32 v173, v173
  v_mfma_f32_32x32x16_bf16 v[144:159], v[196:199], v[68:71], v[144:159]
  v_exp_f32 v174, v174
  v_exp_f32 v175, v175
  s_waitcnt lgkmcnt(2)
  v_mfma_f32_32x32x16_bf16 v[128:143], v[200:203], v[8:11], v[128:143]
  ds_read_b128 v[196:199], v224 offset:33440
  v_add_f32 v232, v232, v172
  v_add_f32 v232, v232, v173
  v_add_f32 v232, v232, v174
  v_mfma_f32_32x32x16_bf16 v[144:159], v[200:203], v[72:75], v[144:159]
  v_add_f32 v232, v232, v175
  v_cvt_pk_bf16_f32 v170, v172, v173
  v_cvt_pk_bf16_f32 v171, v174, v175
  s_waitcnt lgkmcnt(2)
  v_mfma_f32_32x32x16_bf16 v[128:143], v[204:207], v[12:15], v[128:143]
  ds_read_b128 v[200:203], v224 offset:33472
  v_fma_f32 v176, v176, s44, -v229
  v_fma_f32 v177, v177, s44, -v229
  v_fma_f32 v178, v178, s44, -v229
  v_mfma_f32_32x32x16_bf16 v[144:159], v[204:207], v[76:79], v[144:159]
  v_fma_f32 v179, v179, s44, -v229
  v_exp_f32 v176, v176
  s_waitcnt lgkmcnt(2)
  v_mfma_f32_32x32x16_bf16 v[128:143], v[192:195], v[16:19], v[128:143]
  ds_read_b128 v[204:207], v224 offset:33504
  v_exp_f32 v177, v177
  v_exp_f32 v178, v178
  v_mfma_f32_32x32x16_bf16 v[144:159], v[192:195], v[80:83], v[144:159]
  v_exp_f32 v179, v179
  s_waitcnt lgkmcnt(2)
  v_mfma_f32_32x32x16_bf16 v[128:143], v[196:199], v[20:23], v[128:143]
  ds_read_b128 v[192:195], v224 offset:33536
  v_add_f32 v233, v233, v176
  v_add_f32 v233, v233, v177
  v_add_f32 v233, v233, v178
  v_mfma_f32_32x32x16_bf16 v[144:159], v[196:199], v[84:87], v[144:159]
  v_add_f32 v233, v233, v179
  v_cvt_pk_bf16_f32 v176, v176, v177
  v_cvt_pk_bf16_f32 v177, v178, v179
  s_waitcnt lgkmcnt(2)
  v_mfma_f32_32x32x16_bf16 v[128:143], v[200:203], v[24:27], v[128:143]
  ds_read_b128 v[196:199], v224 offset:33568
  v_fma_f32 v180, v180, s44, -v229
  v_fma_f32 v181, v181, s44, -v229
  v_fma_f32 v182, v182, s44, -v229
  v_mfma_f32_32x32x16_bf16 v[144:159], v[200:203], v[88:91], v[144:159]
  v_fma_f32 v183, v183, s44, -v229
  v_exp_f32 v180, v180
  s_waitcnt lgkmcnt(2)
  v_mfma_f32_32x32x16_bf16 v[128:143], v[204:207], v[28:31], v[128:143]
  ds_read_b128 v[200:203], v224 offset:33600
  v_exp_f32 v181, v181
  v_exp_f32 v182, v182
  v_mfma_f32_32x32x16_bf16 v[144:159], v[204:207], v[92:95], v[144:159]
  v_exp_f32 v183, v183
  v_add_f32 v233, v233, v180
  s_waitcnt lgkmcnt(2)
  v_mfma_f32_32x32x16_bf16 v[128:143], v[192:195], v[32:35], v[128:143]
  ds_read_b128 v[204:207], v224 offset:33632
  v_add_f32 v233, v233, v181
  v_add_f32 v233, v233, v182
  v_mfma_f32_32x32x16_bf16 v[144:159], v[192:195], v[96:99], v[144:159]
  v_add_f32 v233, v233, v183
  v_cvt_pk_bf16_f32 v178, v180, v181
  v_cvt_pk_bf16_f32 v179, v182, v183
  v_fma_f32 v184, v184, s44, -v229
  s_waitcnt lgkmcnt(2)
  v_mfma_f32_32x32x16_bf16 v[128:143], v[196:199], v[36:39], v[128:143]
  ds_read_b128 v[192:195], v224 offset:33664
  v_fma_f32 v185, v185, s44, -v229
  v_fma_f32 v186, v186, s44, -v229
  v_mfma_f32_32x32x16_bf16 v[144:159], v[196:199], v[100:103], v[144:159]
  v_fma_f32 v187, v187, s44, -v229
  v_exp_f32 v184, v184
  s_waitcnt lgkmcnt(2)
  v_mfma_f32_32x32x16_bf16 v[128:143], v[200:203], v[40:43], v[128:143]
  ds_read_b128 v[196:199], v224 offset:33696
  v_exp_f32 v185, v185
  v_exp_f32 v186, v186
  v_mfma_f32_32x32x16_bf16 v[144:159], v[200:203], v[104:107], v[144:159]
  v_exp_f32 v187, v187
  v_add_f32 v233, v233, v184
  s_waitcnt lgkmcnt(2)
  v_mfma_f32_32x32x16_bf16 v[128:143], v[204:207], v[44:47], v[128:143]
  ds_read_b128 v[200:203], v224 offset:33728
  v_add_f32 v233, v233, v185
  v_add_f32 v233, v233, v186
  v_add_f32 v233, v233, v187
  v_mfma_f32_32x32x16_bf16 v[144:159], v[204:207], v[108:111], v[144:159]
  v_cvt_pk_bf16_f32 v184, v184, v185
  v_cvt_pk_bf16_f32 v185, v186, v187
  v_fma_f32 v188, v188, s44, -v229
  s_waitcnt lgkmcnt(2)
  v_mfma_f32_32x32x16_bf16 v[128:143], v[192:195], v[48:51], v[128:143]
  ds_read_b128 v[204:207], v224 offset:33760
  v_fma_f32 v189, v189, s44, -v229
  v_fma_f32 v190, v190, s44, -v229
  v_fma_f32 v191, v191, s44, -v229
  v_mfma_f32_32x32x16_bf16 v[144:159], v[192:195], v[112:115], v[144:159]
  v_exp_f32 v188, v188
  s_waitcnt lgkmcnt(2)
  v_mfma_f32_32x32x16_bf16 v[128:143], v[196:199], v[52:55], v[128:143]
  ds_read_b64_tr_b16 v[208:209], v225 offset:17408
  ds_read_b64_tr_b16 v[210:211], v225 offset:21760
  v_exp_f32 v189, v189
  v_exp_f32 v190, v190
  v_mfma_f32_32x32x16_bf16 v[144:159], v[196:199], v[116:119], v[144:159]
  v_exp_f32 v191, v191
  s_waitcnt lgkmcnt(3)
  v_mfma_f32_32x32x16_bf16 v[128:143], v[200:203], v[56:59], v[128:143]
  ds_read_b64_tr_b16 v[212:213], v225 offset:17920
  ds_read_b64_tr_b16 v[214:215], v225 offset:22272
  v_add_f32 v233, v233, v188
  v_add_f32 v233, v233, v189
  v_add_f32 v233, v233, v190
  v_mfma_f32_32x32x16_bf16 v[144:159], v[200:203], v[120:123], v[144:159]
  v_add_f32 v233, v233, v191
  v_cvt_pk_bf16_f32 v186, v188, v189
  v_cvt_pk_bf16_f32 v187, v190, v191
  s_waitcnt lgkmcnt(4)
  v_mfma_f32_32x32x16_bf16 v[128:143], v[204:207], v[60:63], v[128:143]
  ds_read_b64_tr_b16 v[216:217], v225 offset:17472
  ds_read_b64_tr_b16 v[218:219], v225 offset:21824
  v_mfma_f32_32x32x16_bf16 v[144:159], v[204:207], v[124:127], v[144:159]
  s_cmp_eq_u32 s56, 0
  s_cbranch_scc1 L_nores2
  s_call_b64 s[58:59], L_resc
L_nores2:
  s_waitcnt lgkmcnt(4)
  v_mfma_f32_32x32x16_bf16 a[0:15], v[208:211], v[160:163], a[0:15]
  ds_read_b64_tr_b16 v[220:221], v225 offset:17984
  ds_read_b64_tr_b16 v[222:223], v225 offset:22336
  v_mfma_f32_32x32x16_bf16 a[16:31], v[208:211], v[176:179], a[16:31]
  s_waitcnt vmcnt(8)
  s_barrier
  s_waitcnt lgkmcnt(4)
  v_mfma_f32_32x32x16_bf16 a[0:15], v[212:215], v[168:171], a[0:15]
  ds_read_b64_tr_b16 v[208:209], v225 offset:17536
  ds_read_b64_tr_b16 v[210:211], v225 offset:21888
  s_add_u32 s51, s49, 81920
  s_add_u32 m0, s45, 66560
  s_nop 0
  buffer_load_dwordx4 v226, s[24:27], s51 offen nt lds
  v_mfma_f32_32x32x16_bf16 a[16:31], v[212:215], v[184:187], a[16:31]
  s_add_u32 m0, s45, 67136
  s_nop 0
  buffer_load_dwordx4 v226, s[24:27], s51 offen offset:512 nt lds
  s_waitcnt lgkmcnt(4)
  v_mfma_f32_32x32x16_bf16 a[32:47], v[216:219], v[160:163], a[32:47]
  ds_read_b64_tr_b16 v[212:213], v225 offset:18048
  ds_read_b64_tr_b16 v[214:215], v225 offset:22400
  s_add_u32 m0, s45, 67712
  v_mfma_f32_32x32x16_bf16 a[48:63], v[216:219], v[176:179], a[48:63]
  buffer_load_dwordx4 v226, s[24:27], s51 offen offset:1024 nt lds
  s_add_u32 m0, s45, 68288
  s_waitcnt lgkmcnt(4)
  v_mfma_f32_32x32x16_bf16 a[32:47], v[220:223], v[168:171], a[32:47]
  ds_read_b64_tr_b16 v[216:217], v225 offset:17600
  ds_read_b64_tr_b16 v[218:219], v225 offset:21952
  buffer_load_dwordx4 v226, s[24:27], s51 offen offset:1536 nt lds
  v_mfma_f32_32x32x16_bf16 a[48:63], v[220:223], v[184:187], a[48:63]
  s_add_u32 s51, s49, 98304
  s_add_u32 m0, s47, 33280
  s_nop 0
  buffer_load_dwordx4 v226, s[20:23], s51 offen nt lds
  s_waitcnt lgkmcnt(4)
  v_mfma_f32_32x32x16_bf16 a[64:79], v[208:211], v[160:163], a[64:79]
  ds_read_b64_tr_b16 v[220:221], v225 offset:18112
  ds_read_b64_tr_b16 v[222:223], v225 offset:22464
  s_add_u32 m0, s47, 33808
  v_mfma_f32_32x32x16_bf16 a[80:95], v[208:211], v[176:179], a[80:95]
  buffer_load_dwordx4 v226, s[20:23], s51 offen offset:512 nt lds
  s_add_u32 m0, s47, 34336
  s_waitcnt lgkmcnt(4)
  v_mfma_f32_32x32x16_bf16 a[64:79], v[212:215], v[168:171], a[64:79]
  ds_read_b64_tr_b16 v[208:209], v225 offset:17664
  ds_read_b64_tr_b16 v[210:211], v225 offset:22016
  buffer_load_dwordx4 v226, s[20:23], s51 offen offset:1024 nt lds
  s_add_u32 m0, s47, 34864
  v_mfma_f32_32x32x16_bf16 a[80:95], v[212:215], v[184:187], a[80:95]
  buffer_load_dwordx4 v226, s[20:23], s51 offen offset:1536 nt lds
  v_max3_f32 v236, v128, v129, v130
  s_waitcnt lgkmcnt(4)
  v_mfma_f32_32x32x16_bf16 a[96:111], v[216:219], v[160:163], a[96:111]
  ds_read_b64_tr_b16 v[212:213], v225 offset:18176
  ds_read_b64_tr_b16 v[214:215], v225 offset:22528
  v_max3_f32 v236, v236, v131, v132
  v_max3_f32 v236, v236, v133, v134
  v_max3_f32 v236, v236, v135, v136
  v_mfma_f32_32x32x16_bf16 a[112:127], v[216:219], v[176:179], a[112:127]
  v_max3_f32 v236, v236, v137, v138
  v_max3_f32 v236, v236, v139, v140
  v_max3_f32 v236, v236, v141, v142
  v_max_f32 v236, v236, v143
  v_max3_f32 v237, v144, v145, v146
  s_waitcnt lgkmcnt(4)
  v_mfma_f32_32x32x16_bf16 a[96:111], v[220:223], v[168:171], a[96:111]
  ds_read_b64_tr_b16 v[216:217], v225 offset:17728
  ds_read_b64_tr_b16 v[218:219], v225 offset:22080
  v_max3_f32 v237, v237, v147, v148
  v_max3_f32 v237, v237, v149, v150
  v_max3_f32 v237, v237, v151, v152
  v_mfma_f32_32x32x16_bf16 a[112:127], v[220:223], v[184:187], a[112:127]
  v_max3_f32 v237, v237, v153, v154
  v_max3_f32 v237, v237, v155, v156
  v_max3_f32 v237, v237, v157, v158
  v_max_f32 v237, v237, v159
  s_waitcnt lgkmcnt(4)
  v_mfma_f32_32x32x16_bf16 a[128:143], v[208:211], v[160:163], a[128:143]
  ds_read_b64_tr_b16 v[220:221], v225 offset:18240
  ds_read_b64_tr_b16 v[222:223], v225 offset:22592
  v_mov_b32 v238, v236
  v_mov_b32 v239, v237
  s_nop 0
  v_permlane32_swap_b32 v236, v238
  v_mfma_f32_32x32x16_bf16 a[144:159], v[208:211], v[176:179], a[144:159]
  v_permlane32_swap_b32 v237, v239
  v_max_f32 v236, v236, v238
  v_max_f32 v237, v237, v239
  v_cmp_gt_f32 s[52:53], v236, v230
  v_cmp_gt_f32 s[54:55], v237, v231
  s_waitcnt lgkmcnt(4)
  v_mfma_f32_32x32x16_bf16 a[128:143], v[212:215], v[168:171], a[128:143]
  ds_read_b64_tr_b16 v[208:209], v225 offset:17792
  ds_read_b64_tr_b16 v[210:211], v225 offset:22144
  s_or_b64 s[52:53], s[52:53], s[54:55]
  s_cbranch_scc0 L_noslow3
  s_call_b64 s[58:59], L_slow
L_noslow3:
  v_fma_f32 v128, v128, s44, -v228
  v_mfma_f32_32x32x16_bf16 a[144:159], v[212:215], v[184:187], a[144:159]
  v_fma_f32 v129, v129, s44, -v228
  v_fma_f32 v130, v130, s44, -v228
  v_fma_f32 v131, v131, s44, -v228
  v_exp_f32 v128, v128
  s_waitcnt lgkmcnt(4)
  v_mfma_f32_32x32x16_bf16 a[160:175], v[216:219], v[160:163], a[160:175]
  ds_read_b64_tr_b16 v[212:213], v225 offset:18304
  ds_read_b64_tr_b16 v[214:215], v225 offset:22656
  v_exp_f32 v129, v129
  v_exp_f32 v130, v130
  v_mfma_f32_32x32x16_bf16 a[176:191], v[216:219], v[176:179], a[176:191]
  v_exp_f32 v131, v131
  v_add_f32 v232, v232, v128
  v_add_f32 v232, v232, v129
  s_waitcnt lgkmcnt(4)
  v_mfma_f32_32x32x16_bf16 a[160:175], v[220:223], v[168:171], a[160:175]
  ds_read_b64_tr_b16 v[216:217], v225 offset:17856
  ds_read_b64_tr_b16 v[218:219], v225 offset:22208
  v_add_f32 v232, v232, v130
  v_add_f32 v232, v232, v131
  v_cvt_pk_bf16_f32 v128, v128, v129
  v_mfma_f32_32x32x16_bf16 a[176:191], v[220:223], v[184:187], a[176:191]
  v_cvt_pk_bf16_f32 v129, v130, v131
  v_fma_f32 v132, v132, s44, -v228
  v_fma_f32 v133, v133, s44, -v228
  v_fma_f32 v134, v134, s44, -v228
  s_waitcnt lgkmcnt(4)
  v_mfma_f32_32x32x16_bf16 a[192:207], v[208:211], v[160:163], a[192:207]
  ds_read_b64_tr_b16 v[220:221], v225 offset:18368
  ds_read_b64_tr_b16 v[222:223], v225 offset:22720
  v_fma_f32 v135, v135, s44, -v228
  v_exp_f32 v132, v132
  v_mfma_f32_32x32x16_bf16 a[208:223], v[208:211], v[176:179], a[208:223]
  v_exp_f32 v133, v133
  v_exp_f32 v134, v134
  s_waitcnt lgkmcnt(4)
  v_mfma_f32_32x32x16_bf16 a[192:207], v[212:215], v[168:171], a[192:207]
  ds_read_b128 v[192:195], v224 offset:49920
  v_exp_f32 v135, v135
  v_add_f32 v232, v232, v132
  v_add_f32 v232, v232, v133
  v_add_f32 v232, v232, v134
  v_mfma_f32_32x32x16_bf16 a[208:223], v[212:215], v[184:187], a[208:223]
  v_add_f32 v232, v232, v135
  v_cvt_pk_bf16_f32 v130, v132, v133
  v_cvt_pk_bf16_f32 v131, v134, v135
  v_fma_f32 v136, v136, s44, -v228
  s_waitcnt lgkmcnt(3)
  v_mfma_f32_32x32x16_bf16 a[224:239], v[216:219], v[160:163], a[224:239]
  ds_read_b128 v[196:199], v224 offset:49952
  v_fma_f32 v137, v137, s44, -v228
  v_fma_f32 v138, v138, s44, -v228
  v_fma_f32 v139, v139, s44, -v228
  v_exp_f32 v136, v136
  v_mfma_f32_32x32x16_bf16 a[240:255], v[216:219], v[176:179], a[240:255]
  v_exp_f32 v137, v137
  v_exp_f32 v138, v138
  s_waitcnt lgkmcnt(2)
  v_mfma_f32_32x32x16_bf16 a[224:239], v[220:223], v[168:171], a[224:239]
  ds_read_b128 v[200:203], v224 offset:49984
  v_exp_f32 v139, v139
  v_add_f32 v232, v232, v136
  v_mfma_f32_32x32x16_bf16 a[240:255], v[220:223], v[184:187], a[240:255]
  v_add_f32 v232, v232, v137
  v_add_f32 v232, v232, v138
  v_add_f32 v232, v232, v139
  v_cvt_pk_bf16_f32 v136, v136, v137
  v_cvt_pk_bf16_f32 v137, v138, v139
  s_waitcnt lgkmcnt(2)
  v_mfma_f32_32x32x16_bf16 v[160:175], v[192:195], v[0:3], 0
  ds_read_b128 v[204:207], v224 offset:50016
  v_fma_f32 v140, v140, s44, -v228
  v_fma_f32 v141, v141, s44, -v228
  v_fma_f32 v142, v142, s44, -v228
  v_mfma_f32_32x32x16_bf16 v[176:191], v[192:195], v[64:67], 0
  v_fma_f32 v143, v143, s44, -v228
  v_exp_f32 v140, v140
  s_waitcnt lgkmcnt(2)
  v_mfma_f32_32x32x16_bf16 v[160:175], v[196:199], v[4:7], v[160:175]
  ds_read_b128 v[192:195], v224 offset:50048
  v_exp_f32 v141, v141
  v_mfma_f32_32x32x16_bf16 v[176:191], v[196:199], v[68:71], v[176:191]
  v_exp_f32 v142, v142
  v_exp_f32 v143, v143
  s_waitcnt lgkmcnt(2)
  v_mfma_f32_32x32x16_bf16 v[160:175], v[200:203], v[8:11], v[160:175]
  ds_read_b128 v[196:199], v224 offset:50080
  v_add_f32 v232, v232, v140
  v_add_f32 v232, v232, v141
  v_add_f32 v232, v232, v142
  v_mfma_f32_32x32x16_bf16 v[176:191], v[200:203], v[72:75], v[176:191]
  v_add_f32 v232, v232, v143
  v_cvt_pk_bf16_f32 v138, v140, v141
  v_cvt_pk_bf16_f32 v139, v142, v143
  s_waitcnt lgkmcnt(2)
  v_mfma_f32_32x32x16_bf16 v[160:175], v[204:207], v[12:15], v[160:175]
  ds_read_b128 v[200:203], v224 offset:50112
  v_fma_f32 v144, v144, s44, -v229
  v_fma_f32 v145, v145, s44, -v229
  v_fma_f32 v146, v146, s44, -v229
  v_mfma_f32_32x32x16_bf16 v[176:191], v[204:207], v[76:79], v[176:191]
  v_fma_f32 v147, v147, s44, -v229
  v_exp_f32 v144, v144
  s_waitcnt lgkmcnt(2)
  v_mfma_f32_32x32x16_bf16 v[160:175], v[192:195], v[16:19], v[160:175]
  ds_read_b128 v[204:207], v224 offset:50144
  v_exp_f32 v145, v145
  v_exp_f32 v146, v146
  v_mfma_f32_32x32x16_bf16 v[176:191], v[192:195], v[80:83], v[176:191]
  v_exp_f32 v147, v147
  s_waitcnt lgkmcnt(2)
  v_mfma_f32_32x32x16_bf16 v[160:175], v[196:199], v[20:23], v[160:175]
  ds_read_b128 v[192:195], v224 offset:50176
  v_add_f32 v233, v233, v144
  v_add_f32 v233, v233, v145
  v_add_f32 v233, v233, v146
  v_mfma_f32_32x32x16_bf16 v[176:191], v[196:199], v[84:87], v[176:191]
  v_add_f32 v233, v233, v147
  v_cvt_pk_bf16_f32 v144, v144, v145
  v_cvt_pk_bf16_f32 v145, v146, v147
  s_waitcnt lgkmcnt(2)
  v_mfma_f32_32x32x16_bf16 v[160:175], v[200:203], v[24:27], v[160:175]
  ds_read_b128 v[196:199], v224 offset:50208
  v_fma_f32 v148, v148, s44, -v229
  v_fma_f32 v149, v149, s44, -v229
  v_fma_f32 v150, v150, s44, -v229
  v_mfma_f32_32x32x16_bf16 v[176:191], v[200:203], v[88:91], v[176:191]
  v_fma_f32 v151, v151, s44, -v229
  v_exp_f32 v148, v148
  s_waitcnt lgkmcnt(2)
  v_mfma_f32_32x32x16_bf16 v[160:175], v[204:207], v[28:31], v[160:175]
  ds_read_b128 v[200:203], v224 offset:50240
  v_exp_f32 v149, v149
  v_exp_f32 v150, v150
  v_mfma_f32_32x32x16_bf16 v[176:191], v[204:207], v[92:95], v[176:191]
  v_exp_f32 v151, v151
  v_add_f32 v233, v233, v148
  s_waitcnt lgkmcnt(2)
  v_mfma_f32_32x32x16_bf16 v[160:175], v[192:195], v[32:35], v[160:175]
  ds_read_b128 v[204:207], v224 offset:50272
  v_add_f32 v233, v233, v149
  v_add_f32 v233, v233, v150
  v_mfma_f32_32x32x16_bf16 v[176:191], v[192:195], v[96:99], v[176:191]
  v_add_f32 v233, v233, v151
  v_cvt_pk_bf16_f32 v146, v148, v149
  v_cvt_pk_bf16_f32 v147, v150, v151
  v_fma_f32 v152, v152, s44, -v229
  s_waitcnt lgkmcnt(2)
  v_mfma_f32_32x32x16_bf16 v[160:175], v[196:199], v[36:39], v[160:175]
  ds_read_b128 v[192:195], v224 offset:50304
  v_fma_f32 v153, v153, s44, -v229
  v_fma_f32 v154, v154, s44, -v229
  v_mfma_f32_32x32x16_bf16 v[176:191], v[196:199], v[100:103], v[176:191]
  v_fma_f32 v155, v155, s44, -v229
  v_exp_f32 v152, v152
  s_waitcnt lgkmcnt(2)
  v_mfma_f32_32x32x16_bf16 v[160:175], v[200:203], v[40:43], v[160:175]
  ds_read_b128 v[196:199], v224 offset:50336
  v_exp_f32 v153, v153
  v_exp_f32 v154, v154
  v_mfma_f32_32x32x16_bf16 v[176:191], v[200:203], v[104:107], v[176:191]
  v_exp_f32 v155, v155
  v_add_f32 v233, v233, v152
  s_waitcnt lgkmcnt(2)
  v_mfma_f32_32x32x16_bf16 v[160:175], v[204:207], v[44:47], v[160:175]
  ds_read_b128 v[200:203], v224 offset:50368
  v_add_f32 v233, v233, v153
  v_add_f32 v233, v233, v154
  v_add_f32 v233, v233, v155
  v_mfma_f32_32x32x16_bf16 v[176:191], v[204:207], v[108:111], v[176:191]
  v_cvt_pk_bf16_f32 v152, v152, v153
  v_cvt_pk_bf16_f32 v153, v154, v155
  v_fma_f32 v156, v156, s44, -v229
  s_waitcnt lgkmcnt(2)
  v_mfma_f32_32x32x16_bf16 v[160:175], v[192:195], v[48:51], v[160:175]
  ds_read_b128 v[204:207], v224 offset:50400
  v_fma_f32 v157, v157, s44, -v229
  v_fma_f32 v158, v158, s44, -v229
  v_fma_f32 v159, v159, s44, -v229
  v_mfma_f32_32x32x16_bf16 v[176:191], v[192:195], v[112:115], v[176:191]
  v_exp_f32 v156, v156
  s_waitcnt lgkmcnt(2)
  v_mfma_f32_32x32x16_bf16 v[160:175], v[196:199], v[52:55], v[160:175]
  ds_read_b64_tr_b16 v[208:209], v225 offset:34816
  ds_read_b64_tr_b16 v[210:211], v225 offset:39168
  v_exp_f32 v157, v157
  v_exp_f32 v158, v158
  v_mfma_f32_32x32x16_bf16 v[176:191], v[196:199], v[116:119], v[176:191]
  v_exp_f32 v159, v159
  s_waitcnt lgkmcnt(3)
  v_mfma_f32_32x32x16_bf16 v[160:175], v[200:203], v[56:59], v[160:175]
  ds_read_b64_tr_b16 v[212:213], v225 offset:35328
  ds_read_b64_tr_b16 v[214:215], v225 offset:39680
  v_add_f32 v233, v233, v156
  v_add_f32 v233, v233, v157
  v_add_f32 v233, v233, v158
  v_mfma_f32_32x32x16_bf16 v[176:191], v[200:203], v[120:123], v[176:191]
  v_add_f32 v233, v233, v159
  v_cvt_pk_bf16_f32 v154, v156, v157
  v_cvt_pk_bf16_f32 v155, v158, v159
  s_waitcnt lgkmcnt(4)
  v_mfma_f32_32x32x16_bf16 v[160:175], v[204:207], v[60:63], v[160:175]
  ds_read_b64_tr_b16 v[216:217], v225 offset:34880
  ds_read_b64_tr_b16 v[218:219], v225 offset:39232
  v_mfma_f32_32x32x16_bf16 v[176:191], v[204:207], v[124:127], v[176:191]
  s_cmp_eq_u32 s56, 0
  s_cbranch_scc1 L_nores4
  s_call_b64 s[58:59], L_resc
L_nores4:
  s_waitcnt lgkmcnt(4)
  v_mfma_f32_32x32x16_bf16 a[0:15], v[208:211], v[128:131], a[0:15]
  ds_read_b64_tr_b16 v[220:221], v225 offset:35392
  ds_read_b64_tr_b16 v[222:223], v225 offset:39744
  v_mfma_f32_32x32x16_bf16 a[16:31], v[208:211], v[144:147], a[16:31]
  s_waitcnt vmcnt(12)
  s_barrier
  s_waitcnt lgkmcnt(4)
  v_mfma_f32_32x32x16_bf16 a[0:15], v[212:215], v[136:139], a[0:15]
  ds_read_b64_tr_b16 v[208:209], v225 offset:34944
  ds_read_b64_tr_b16 v[210:211], v225 offset:39296
  s_add_u32 s51, s49, 98304
  s_add_u32 m0, s45, 83968
  s_nop 0
  buffer_load_dwordx4 v226, s[24:27], s51 offen nt lds
  v_mfma_f32_32x32x16_bf16 a[16:31], v[212:215], v[152:155], a[16:31]
  s_add_u32 m0, s45, 84544
  s_nop 0
  buffer_load_dwordx4 v226, s[24:27], s51 offen offset:512 nt lds
  s_waitcnt lgkmcnt(4)
  v_mfma_f32_32x32x16_bf16 a[32:47], v[216:219], v[128:131], a[32:47]
  ds_read_b64_tr_b16 v[212:213], v225 offset:35456
  ds_read_b64_tr_b16 v[214:215], v225 offset:39808
  s_add_u32 m0, s45, 85120
  v_mfma_f32_32x32x16_bf16 a[48:63], v[216:219], v[144:147], a[48:63]
  buffer_load_dwordx4 v226, s[24:27], s51 offen offset:1024 nt lds
  s_add_u32 m0, s45, 85696
  s_waitcnt lgkmcnt(4)
  v_mfma_f32_32x32x16_bf16 a[32:47], v[220:223], v[136:139], a[32:47]
  ds_read_b64_tr_b16 v[216:217], v225 offset:35008
  ds_read_b64_tr_b16 v[218:219], v225 offset:39360
  buffer_load_dwordx4 v226, s[24:27], s51 offen offset:1536 nt lds
  v_mfma_f32_32x32x16_bf16 a[48:63], v[220:223], v[152:155], a[48:63]
  s_add_u32 s51, s49, 114688
  s_add_u32 m0, s47, 49920
  s_nop 0
  buffer_load_dwordx4 v226, s[20:23], s51 offen nt lds
  s_waitcnt lgkmcnt(4)
  v_mfma_f32_32x32x16_bf16 a[64:79], v[208:211], v[128:131], a[64:79]
  ds_read_b64_tr_b16 v[220:221], v225 offset:35520
  ds_read_b64_tr_b16 v[222:223], v225 offset:39872
  s_add_u32 m0, s47, 50448
  v_mfma_f32_32x32x16_bf16 a[80:95], v[208:211], v[144:147], a[80:95]
  buffer_load_dwordx4 v226, s[20:23], s51 offen offset:512 nt lds
  s_add_u32 m0, s47, 50976
  s_waitcnt lgkmcnt(4)
  v_mfma_f32_32x32x16_bf16 a[64:79], v[212:215], v[136:139], a[64:79]
  ds_read_b64_tr_b16 v[208:209], v225 offset:35072
  ds_read_b64_tr_b16 v[210:211], v225 offset:39424
  buffer_load_dwordx4 v226, s[20:23], s51 offen offset:1024 nt lds
  s_add_u32 m0, s47, 51504
  v_mfma_f32_32x32x16_bf16 a[80:95], v[212:215], v[152:155], a[80:95]
  buffer_load_dwordx4 v226, s[20:23], s51 offen offset:1536 nt lds
  v_max3_f32 v236, v160, v161, v162
  s_waitcnt lgkmcnt(4)
  v_mfma_f32_32x32x16_bf16 a[96:111], v[216:219], v[128:131], a[96:111]
  ds_read_b64_tr_b16 v[212:213], v225 offset:35584
  ds_read_b64_tr_b16 v[214:215], v225 offset:39936
  v_max3_f32 v236, v236, v163, v164
  v_max3_f32 v236, v236, v165, v166
  v_max3_f32 v236, v236, v167, v168
  v_mfma_f32_32x32x16_bf16 a[112:127], v[216:219], v[144:147], a[112:127]
  v_max3_f32 v236, v236, v169, v170
  v_max3_f32 v236, v236, v171, v172
  v_max3_f32 v236, v236, v173, v174
  v_max_f32 v236, v236, v175
  v_max3_f32 v237, v176, v177, v178
  s_waitcnt lgkmcnt(4)
  v_mfma_f32_32x32x16_bf16 a[96:111], v[220:223], v[136:139], a[96:111]
  ds_read_b64_tr_b16 v[216:217], v225 offset:35136
  ds_read_b64_tr_b16 v[218:219], v225 offset:39488
  v_max3_f32 v237, v237, v179, v180
  v_max3_f32 v237, v237, v181, v182
  v_max3_f32 v237, v237, v183, v184
  v_mfma_f32_32x32x16_bf16 a[112:127], v[220:223], v[152:155], a[112:127]
  v_max3_f32 v237, v237, v185, v186
  v_max3_f32 v237, v237, v187, v188
  v_max3_f32 v237, v237, v189, v190
  v_max_f32 v237, v237, v191
  s_waitcnt lgkmcnt(4)
  v_mfma_f32_32x32x16_bf16 a[128:143], v[208:211], v[128:131], a[128:143]
  ds_read_b64_tr_b16 v[220:221], v225 offset:35648
  ds_read_b64_tr_b16 v[222:223], v225 offset:40000
  v_mov_b32 v238, v236
  v_mov_b32 v239, v237
  s_nop 0
  v_permlane32_swap_b32 v236, v238
  v_mfma_f32_32x32x16_bf16 a[144:159], v[208:211], v[144:147], a[144:159]
  v_permlane32_swap_b32 v237, v239
  v_max_f32 v236, v236, v238
  v_max_f32 v237, v237, v239
  v_cmp_gt_f32 s[52:53], v236, v230
  v_cmp_gt_f32 s[54:55], v237, v231
  s_waitcnt lgkmcnt(4)
  v_mfma_f32_32x32x16_bf16 a[128:143], v[212:215], v[136:139], a[128:143]
  ds_read_b64_tr_b16 v[208:209], v225 offset:35200
  ds_read_b64_tr_b16 v[210:211], v225 offset:39552
  s_or_b64 s[52:53], s[52:53], s[54:55]
  s_cbranch_scc0 L_noslow5
  s_call_b64 s[58:59], L_slow
L_noslow5:
  v_fma_f32 v160, v160, s44, -v228
  v_mfma_f32_32x32x16_bf16 a[144:159], v[212:215], v[152:155], a[144:159]
  v_fma_f32 v161, v161, s44, -v228
  v_fma_f32 v162, v162, s44, -v228
  v_fma_f32 v163, v163, s44, -v228
  v_exp_f32 v160, v160
  s_waitcnt lgkmcnt(4)
  v_mfma_f32_32x32x16_bf16 a[160:175], v[216:219], v[128:131], a[160:175]
  ds_read_b64_tr_b16 v[212:213], v225 offset:35712
  ds_read_b64_tr_b16 v[214:215], v225 offset:40064
  v_exp_f32 v161, v161
  v_exp_f32 v162, v162
  v_mfma_f32_32x32x16_bf16 a[176:191], v[216:219], v[144:147], a[176:191]
  v_exp_f32 v163, v163
  v_add_f32 v232, v232, v160
  v_add_f32 v232, v232, v161
  s_waitcnt lgkmcnt(4)
  v_mfma_f32_32x32x16_bf16 a[160:175], v[220:223], v[136:139], a[160:175]
  ds_read_b64_tr_b16 v[216:217], v225 offset:35264
  ds_read_b64_tr_b16 v[218:219], v225 offset:39616
  v_add_f32 v232, v232, v162
  v_add_f32 v232, v232, v163
  v_cvt_pk_bf16_f32 v160, v160, v161
  v_mfma_f32_32x32x16_bf16 a[176:191], v[220:223], v[152:155], a[176:191]
  v_cvt_pk_bf16_f32 v161, v162, v163
  v_fma_f32 v164, v164, s44, -v228
  v_fma_f32 v165, v165, s44, -v228
  v_fma_f32 v166, v166, s44, -v228
  s_waitcnt lgkmcnt(4)
  v_mfma_f32_32x32x16_bf16 a[192:207], v[208:211], v[128:131], a[192:207]
  ds_read_b64_tr_b16 v[220:221], v225 offset:35776
  ds_read_b64_tr_b16 v[222:223], v225 offset:40128
  v_fma_f32 v167, v167, s44, -v228
  v_exp_f32 v164, v164
  v_mfma_f32_32x32x16_bf16 a[208:223], v[208:211], v[144:147], a[208:223]
  v_exp_f32 v165, v165
  v_exp_f32 v166, v166
  s_waitcnt lgkmcnt(4)
  v_mfma_f32_32x32x16_bf16 a[192:207], v[212:215], v[136:139], a[192:207]
  ds_read_b128 v[192:195], v224 offset:0
  v_exp_f32 v167, v167
  v_add_f32 v232, v232, v164
  v_add_f32 v232, v232, v165
  v_add_f32 v232, v232, v166
  v_mfma_f32_32x32x16_bf16 a[208:223], v[212:215], v[152:155], a[208:223]
  v_add_f32 v232, v232, v167
  v_cvt_pk_bf16_f32 v162, v164, v165
  v_cvt_pk_bf16_f32 v163, v166, v167
  v_fma_f32 v168, v168, s44, -v228
  s_waitcnt lgkmcnt(3)
  v_mfma_f32_32x32x16_bf16 a[224:239], v[216:219], v[128:131], a[224:239]
  ds_read_b128 v[196:199], v224 offset:32
  v_fma_f32 v169, v169, s44, -v228
  v_fma_f32 v170, v170, s44, -v228
  v_fma_f32 v171, v171, s44, -v228
  v_exp_f32 v168, v168
  v_mfma_f32_32x32x16_bf16 a[240:255], v[216:219], v[144:147], a[240:255]
  v_exp_f32 v169, v169
  v_exp_f32 v170, v170
  s_waitcnt lgkmcnt(2)
  v_mfma_f32_32x32x16_bf16 a[224:239], v[220:223], v[136:139], a[224:239]
  ds_read_b128 v[200:203], v224 offset:64
  v_exp_f32 v171, v171
  v_add_f32 v232, v232, v168
  v_mfma_f32_32x32x16_bf16 a[240:255], v[220:223], v[152:155], a[240:255]
  v_add_f32 v232, v232, v169
  v_add_f32 v232, v232, v170
  v_add_f32 v232, v232, v171
  v_cvt_pk_bf16_f32 v168, v168, v169
  v_cvt_pk_bf16_f32 v169, v170, v171
  s_waitcnt lgkmcnt(2)
  v_mfma_f32_32x32x16_bf16 v[128:143], v[192:195], v[0:3], 0
  ds_read_b128 v[204:207], v224 offset:96
  v_fma_f32 v172, v172, s44, -v228
  v_fma_f32 v173, v173, s44, -v228
  v_fma_f32 v174, v174, s44, -v228
  v_mfma_f32_32x32x16_bf16 v[144:159], v[192:195], v[64:67], 0
  v_fma_f32 v175, v175, s44, -v228
  v_exp_f32 v172, v172
  s_waitcnt lgkmcnt(2)
  v_mfma_f32_32x32x16_bf16 v[128:143], v[196:199], v[4:7], v[128:143]
  ds_read_b128 v[192:195], v224 offset:128
  v_exp_f32 v173, v173
  v_mfma_f32_32x32x16_bf16 v[144:159], v[196:199], v[68:71], v[144:159]
  v_exp_f32 v174, v174
  v_exp_f32 v175, v175
  s_waitcnt lgkmcnt(2)
  v_mfma_f32_32x32x16_bf16 v[128:143], v[200:203], v[8:11], v[128:143]
  ds_read_b128 v[196:199], v224 offset:160
  v_add_f32 v232, v232, v172
  v_add_f32 v232, v232, v173
  v_add_f32 v232, v232, v174
  v_mfma_f32_32x32x16_bf16 v[144:159], v[200:203], v[72:75], v[144:159]
  v_add_f32 v232, v232, v175
  v_cvt_pk_bf16_f32 v170, v172, v173
  v_cvt_pk_bf16_f32 v171, v174, v175
  s_waitcnt lgkmcnt(2)
  v_mfma_f32_32x32x16_bf16 v[128:143], v[204:207], v[12:15], v[128:143]
  ds_read_b128 v[200:203], v224 offset:192
  v_fma_f32 v176, v176, s44, -v229
  v_fma_f32 v177, v177, s44, -v229
  v_fma_f32 v178, v178, s44, -v229
  v_mfma_f32_32x32x16_bf16 v[144:159], v[204:207], v[76:79], v[144:159]
  v_fma_f32 v179, v179, s44, -v229
  v_exp_f32 v176, v176
  s_waitcnt lgkmcnt(2)
  v_mfma_f32_32x32x16_bf16 v[128:143], v[192:195], v[16:19], v[128:143]
  ds_read_b128 v[204:207], v224 offset:224
  v_exp_f32 v177, v177
  v_exp_f32 v178, v178
  v_mfma_f32_32x32x16_bf16 v[144:159], v[192:195], v[80:83], v[144:159]
  v_exp_f32 v179, v179
  s_waitcnt lgkmcnt(2)
  v_mfma_f32_32x32x16_bf16 v[128:143], v[196:199], v[20:23], v[128:143]
  ds_read_b128 v[192:195], v224 offset:256
  v_add_f32 v233, v233, v176
  v_add_f32 v233, v233, v177
  v_add_f32 v233, v233, v178
  v_mfma_f32_32x32x16_bf16 v[144:159], v[196:199], v[84:87], v[144:159]
  v_add_f32 v233, v233, v179
  v_cvt_pk_bf16_f32 v176, v176, v177
  v_cvt_pk_bf16_f32 v177, v178, v179
  s_waitcnt lgkmcnt(2)
  v_mfma_f32_32x32x16_bf16 v[128:143], v[200:203], v[24:27], v[128:143]
  ds_read_b128 v[196:199], v224 offset:288
  v_fma_f32 v180, v180, s44, -v229
  v_fma_f32 v181, v181, s44, -v229
  v_fma_f32 v182, v182, s44, -v229
  v_mfma_f32_32x32x16_bf16 v[144:159], v[200:203], v[88:91], v[144:159]
  v_fma_f32 v183, v183, s44, -v229
  v_exp_f32 v180, v180
  s_waitcnt lgkmcnt(2)
  v_mfma_f32_32x32x16_bf16 v[128:143], v[204:207], v[28:31], v[128:143]
  ds_read_b128 v[200:203], v224 offset:320
  v_exp_f32 v181, v181
  v_exp_f32 v182, v182
  v_mfma_f32_32x32x16_bf16 v[144:159], v[204:207], v[92:95], v[144:159]
  v_exp_f32 v183, v183
  v_add_f32 v233, v233, v180
  s_waitcnt lgkmcnt(2)
  v_mfma_f32_32x32x16_bf16 v[128:143], v[192:195], v[32:35], v[128:143]
  ds_read_b128 v[204:207], v224 offset:352
  v_add_f32 v233, v233, v181
  v_add_f32 v233, v233, v182
  v_mfma_f32_32x32x16_bf16 v[144:159], v[192:195], v[96:99], v[144:159]
  v_add_f32 v233, v233, v183
  v_cvt_pk_bf16_f32 v178, v180, v181
  v_cvt_pk_bf16_f32 v179, v182, v183
  v_fma_f32 v184, v184, s44, -v229
  s_waitcnt lgkmcnt(2)
  v_mfma_f32_32x32x16_bf16 v[128:143], v[196:199], v[36:39], v[128:143]
  ds_read_b128 v[192:195], v224 offset:384
  v_fma_f32 v185, v185, s44, -v229
  v_fma_f32 v186, v186, s44, -v229
  v_mfma_f32_32x32x16_bf16 v[144:159], v[196:199], v[100:103], v[144:159]
  v_fma_f32 v187, v187, s44, -v229
  v_exp_f32 v184, v184
  s_waitcnt lgkmcnt(2)
  v_mfma_f32_32x32x16_bf16 v[128:143], v[200:203], v[40:43], v[128:143]
  ds_read_b128 v[196:199], v224 offset:416
  v_exp_f32 v185, v185
  v_exp_f32 v186, v186
  v_mfma_f32_32x32x16_bf16 v[144:159], v[200:203], v[104:107], v[144:159]
  v_exp_f32 v187, v187
  v_add_f32 v233, v233, v184
  s_waitcnt lgkmcnt(2)
  v_mfma_f32_32x32x16_bf16 v[128:143], v[204:207], v[44:47], v[128:143]
  ds_read_b128 v[200:203], v224 offset:448
  v_add_f32 v233, v233, v185
  v_add_f32 v233, v233, v186
  v_add_f32 v233, v233, v187
  v_mfma_f32_32x32x16_bf16 v[144:159], v[204:207], v[108:111], v[144:159]
  v_cvt_pk_bf16_f32 v184, v184, v185
  v_cvt_pk_bf16_f32 v185, v186, v187
  v_fma_f32 v188, v188, s44, -v229
  s_waitcnt lgkmcnt(2)
  v_mfma_f32_32x32x16_bf16 v[128:143], v[192:195], v[48:51], v[128:143]
  ds_read_b128 v[204:207], v224 offset:480
  v_fma_f32 v189, v189, s44, -v229
  v_fma_f32 v190, v190, s44, -v229
  v_fma_f32 v191, v191, s44, -v229
  v_mfma_f32_32x32x16_bf16 v[144:159], v[192:195], v[112:115], v[144:159]
  v_exp_f32 v188, v188
  s_waitcnt lgkmcnt(2)
  v_mfma_f32_32x32x16_bf16 v[128:143], v[196:199], v[52:55], v[128:143]
  ds_read_b64_tr_b16 v[208:209], v225 offset:52224
  ds_read_b64_tr_b16 v[210:211], v225 offset:56576
  v_exp_f32 v189, v189
  v_exp_f32 v190, v190
  v_mfma_f32_32x32x16_bf16 v[144:159], v[196:199], v[116:119], v[144:159]
  v_exp_f32 v191, v191
  s_waitcnt lgkmcnt(3)
  v_mfma_f32_32x32x16_bf16 v[128:143], v[200:203], v[56:59], v[128:143]
  ds_read_b64_tr_b16 v[212:213], v225 offset:52736
  ds_read_b64_tr_b16 v[214:215], v225 offset:57088
  v_add_f32 v233, v233, v188
  v_add_f32 v233, v233, v189
  v_add_f32 v233, v233, v190
  v_mfma_f32_32x32x16_bf16 v[144:159], v[200:203], v[120:123], v[144:159]
  v_add_f32 v233, v233, v191
  v_cvt_pk_bf16_f32 v186, v188, v189
  v_cvt_pk_bf16_f32 v187, v190, v191
  s_waitcnt lgkmcnt(4)
  v_mfma_f32_32x32x16_bf16 v[128:143], v[204:207], v[60:63], v[128:143]
  ds_read_b64_tr_b16 v[216:217], v225 offset:52288
  ds_read_b64_tr_b16 v[218:219], v225 offset:56640
  v_mfma_f32_32x32x16_bf16 v[144:159], v[204:207], v[124:127], v[144:159]
  s_cmp_eq_u32 s56, 0
  s_cbranch_scc1 L_nores6
  s_call_b64 s[58:59], L_resc
L_nores6:
  s_waitcnt lgkmcnt(4)
  v_mfma_f32_32x32x16_bf16 a[0:15], v[208:211], v[160:163], a[0:15]
  ds_read_b64_tr_b16 v[220:221], v225 offset:52800
  ds_read_b64_tr_b16 v[222:223], v225 offset:57152
  v_mfma_f32_32x32x16_bf16 a[16:31], v[208:211], v[176:179], a[16:31]
  s_waitcnt vmcnt(16)
  s_barrier
  s_waitcnt lgkmcnt(4)
  v_mfma_f32_32x32x16_bf16 a[0:15], v[212:215], v[168:171], a[0:15]
  ds_read_b64_tr_b16 v[208:209], v225 offset:52352
  ds_read_b64_tr_b16 v[210:211], v225 offset:56704
  s_add_u32 s51, s49, 114688
  s_add_u32 m0, s45, 101376
  s_nop 0
  buffer_load_dwordx4 v226, s[24:27], s51 offen nt lds
  v_mfma_f32_32x32x16_bf16 a[16:31], v[212:215], v[184:187], a[16:31]
  s_add_u32 m0, s45, 101952
  s_nop 0
  buffer_load_dwordx4 v226, s[24:27], s51 offen offset:512 nt lds
  s_waitcnt lgkmcnt(4)
  v_mfma_f32_32x32x16_bf16 a[32:47], v[216:219], v[160:163], a[32:47]
  ds_read_b64_tr_b16 v[212:213], v225 offset:52864
  ds_read_b64_tr_b16 v[214:215], v225 offset:57216
  s_add_u32 m0, s45, 102528
  v_mfma_f32_32x32x16_bf16 a[48:63], v[216:219], v[176:179], a[48:63]
  buffer_load_dwordx4 v226, s[24:27], s51 offen offset:1024 nt lds
  s_add_u32 m0, s45, 103104
  s_waitcnt lgkmcnt(4)
  v_mfma_f32_32x32x16_bf16 a[32:47], v[220:223], v[168:171], a[32:47]
  ds_read_b64_tr_b16 v[216:217], v225 offset:52416
  ds_read_b64_tr_b16 v[218:219], v225 offset:56768
  buffer_load_dwordx4 v226, s[24:27], s51 offen offset:1536 nt lds
  v_mfma_f32_32x32x16_bf16 a[48:63], v[220:223], v[184:187], a[48:63]
  s_add_u32 s51, s49, 131072
  s_add_u32 m0, s47, 0
  s_nop 0
  buffer_load_dwordx4 v226, s[20:23], s51 offen nt lds
  s_waitcnt lgkmcnt(4)
  v_mfma_f32_32x32x16_bf16 a[64:79], v[208:211], v[160:163], a[64:79]
  ds_read_b64_tr_b16 v[220:221], v225 offset:52928
  ds_read_b64_tr_b16 v[222:223], v225 offset:57280
  s_add_u32 m0, s47, 528
  v_mfma_f32_32x32x16_bf16 a[80:95], v[208:211], v[176:179], a[80:95]
  buffer_load_dwordx4 v226, s[20:23], s51 offen offset:512 nt lds
  s_add_u32 m0, s47, 1056
  s_waitcnt lgkmcnt(4)
  v_mfma_f32_32x32x16_bf16 a[64:79], v[212:215], v[168:171], a[64:79]
  ds_read_b64_tr_b16 v[208:209], v225 offset:52480
  ds_read_b64_tr_b16 v[210:211], v225 offset:56832
  buffer_load_dwordx4 v226, s[20:23], s51 offen offset:1024 nt lds
  s_add_u32 m0, s47, 1584
  v_mfma_f32_32x32x16_bf16 a[80:95], v[212:215], v[184:187], a[80:95]
  buffer_load_dwordx4 v226, s[20:23], s51 offen offset:1536 nt lds
  v_max3_f32 v236, v128, v129, v130
  s_waitcnt lgkmcnt(4)
  v_mfma_f32_32x32x16_bf16 a[96:111], v[216:219], v[160:163], a[96:111]
  ds_read_b64_tr_b16 v[212:213], v225 offset:52992
  ds_read_b64_tr_b16 v[214:215], v225 offset:57344
  v_max3_f32 v236, v236, v131, v132
  v_max3_f32 v236, v236, v133, v134
  v_max3_f32 v236, v236, v135, v136
  v_mfma_f32_32x32x16_bf16 a[112:127], v[216:219], v[176:179], a[112:127]
  v_max3_f32 v236, v236, v137, v138
  v_max3_f32 v236, v236, v139, v140
  v_max3_f32 v236, v236, v141, v142
  v_max_f32 v236, v236, v143
  v_max3_f32 v237, v144, v145, v146
  s_waitcnt lgkmcnt(4)
  v_mfma_f32_32x32x16_bf16 a[96:111], v[220:223], v[168:171], a[96:111]
  ds_read_b64_tr_b16 v[216:217], v225 offset:52544
  ds_read_b64_tr_b16 v[218:219], v225 offset:56896
  v_max3_f32 v237, v237, v147, v148
  v_max3_f32 v237, v237, v149, v150
  v_max3_f32 v237, v237, v151, v152
  v_mfma_f32_32x32x16_bf16 a[112:127], v[220:223], v[184:187], a[112:127]
  v_max3_f32 v237, v237, v153, v154
  v_max3_f32 v237, v237, v155, v156
  v_max3_f32 v237, v237, v157, v158
  v_max_f32 v237, v237, v159
  s_waitcnt lgkmcnt(4)
  v_mfma_f32_32x32x16_bf16 a[128:143], v[208:211], v[160:163], a[128:143]
  ds_read_b64_tr_b16 v[220:221], v225 offset:53056
  ds_read_b64_tr_b16 v[222:223], v225 offset:57408
  v_mov_b32 v238, v236
  v_mov_b32 v239, v237
  s_nop 0
  v_permlane32_swap_b32 v236, v238
  v_mfma_f32_32x32x16_bf16 a[144:159], v[208:211], v[176:179], a[144:159]
  v_permlane32_swap_b32 v237, v239
  v_max_f32 v236, v236, v238
  v_max_f32 v237, v237, v239
  v_cmp_gt_f32 s[52:53], v236, v230
  v_cmp_gt_f32 s[54:55], v237, v231
  s_waitcnt lgkmcnt(4)
  v_mfma_f32_32x32x16_bf16 a[128:143], v[212:215], v[168:171], a[128:143]
  ds_read_b64_tr_b16 v[208:209], v225 offset:52608
  ds_read_b64_tr_b16 v[210:211], v225 offset:56960
  s_or_b64 s[52:53], s[52:53], s[54:55]
  s_cbranch_scc0 L_noslow7
  s_call_b64 s[58:59], L_slow
L_noslow7:
  v_fma_f32 v128, v128, s44, -v228
  v_mfma_f32_32x32x16_bf16 a[144:159], v[212:215], v[184:187], a[144:159]
  v_fma_f32 v129, v129, s44, -v228
  v_fma_f32 v130, v130, s44, -v228
  v_fma_f32 v131, v131, s44, -v228
  v_exp_f32 v128, v128
  s_waitcnt lgkmcnt(4)
  v_mfma_f32_32x32x16_bf16 a[160:175], v[216:219], v[160:163], a[160:175]
  ds_read_b64_tr_b16 v[212:213], v225 offset:53120
  ds_read_b64_tr_b16 v[214:215], v225 offset:57472
  v_exp_f32 v129, v129
  v_exp_f32 v130, v130
  v_mfma_f32_32x32x16_bf16 a[176:191], v[216:219], v[176:179], a[176:191]
  v_exp_f32 v131, v131
  v_add_f32 v232, v232, v128
  v_add_f32 v232, v232, v129
  s_waitcnt lgkmcnt(4)
  v_mfma_f32_32x32x16_bf16 a[160:175], v[220:223], v[168:171], a[160:175]
  ds_read_b64_tr_b16 v[216:217], v225 offset:52672
  ds_read_b64_tr_b16 v[218:219], v225 offset:57024
  v_add_f32 v232, v232, v130
  v_add_f32 v232, v232, v131
  v_cvt_pk_bf16_f32 v128, v128, v129
  v_mfma_f32_32x32x16_bf16 a[176:191], v[220:223], v[184:187], a[176:191]
  v_cvt_pk_bf16_f32 v129, v130, v131
  v_fma_f32 v132, v132, s44, -v228
  v_fma_f32 v133, v133, s44, -v228
  v_fma_f32 v134, v134, s44, -v228
  s_waitcnt lgkmcnt(4)
  v_mfma_f32_32x32x16_bf16 a[192:207], v[208:211], v[160:163], a[192:207]
  ds_read_b64_tr_b16 v[220:221], v225 offset:53184
  ds_read_b64_tr_b16 v[222:223], v225 offset:57536
  v_fma_f32 v135, v135, s44, -v228
  v_exp_f32 v132, v132
  v_mfma_f32_32x32x16_bf16 a[208:223], v[208:211], v[176:179], a[208:223]
  v_exp_f32 v133, v133
  v_exp_f32 v134, v134
  s_waitcnt lgkmcnt(4)
  v_mfma_f32_32x32x16_bf16 a[192:207], v[212:215], v[168:171], a[192:207]
  ds_read_b128 v[192:195], v224 offset:16640
  v_exp_f32 v135, v135
  v_add_f32 v232, v232, v132
  v_add_f32 v232, v232, v133
  v_add_f32 v232, v232, v134
  v_mfma_f32_32x32x16_bf16 a[208:223], v[212:215], v[184:187], a[208:223]
  v_add_f32 v232, v232, v135
  v_cvt_pk_bf16_f32 v130, v132, v133
  v_cvt_pk_bf16_f32 v131, v134, v135
  v_fma_f32 v136, v136, s44, -v228
  s_waitcnt lgkmcnt(3)
  v_mfma_f32_32x32x16_bf16 a[224:239], v[216:219], v[160:163], a[224:239]
  ds_read_b128 v[196:199], v224 offset:16672
  v_fma_f32 v137, v137, s44, -v228
  v_fma_f32 v138, v138, s44, -v228
  v_fma_f32 v139, v139, s44, -v228
  v_exp_f32 v136, v136
  v_mfma_f32_32x32x16_bf16 a[240:255], v[216:219], v[176:179], a[240:255]
  v_exp_f32 v137, v137
  v_exp_f32 v138, v138
  s_waitcnt lgkmcnt(2)
  v_mfma_f32_32x32x16_bf16 a[224:239], v[220:223], v[168:171], a[224:239]
  ds_read_b128 v[200:203], v224 offset:16704
  v_exp_f32 v139, v139
  v_add_f32 v232, v232, v136
  v_mfma_f32_32x32x16_bf16 a[240:255], v[220:223], v[184:187], a[240:255]
  v_add_f32 v232, v232, v137
  v_add_f32 v232, v232, v138
  v_add_f32 v232, v232, v139
  v_cvt_pk_bf16_f32 v136, v136, v137
  v_cvt_pk_bf16_f32 v137, v138, v139
  s_waitcnt lgkmcnt(2)
  v_mfma_f32_32x32x16_bf16 v[160:175], v[192:195], v[0:3], 0
  ds_read_b128 v[204:207], v224 offset:16736
  v_fma_f32 v140, v140, s44, -v228
  v_fma_f32 v141, v141, s44, -v228
  v_fma_f32 v142, v142, s44, -v228
  v_mfma_f32_32x32x16_bf16 v[176:191], v[192:195], v[64:67], 0
  v_fma_f32 v143, v143, s44, -v228
  v_exp_f32 v140, v140
  s_waitcnt lgkmcnt(2)
  v_mfma_f32_32x32x16_bf16 v[160:175], v[196:199], v[4:7], v[160:175]
  ds_read_b128 v[192:195], v224 offset:16768
  v_exp_f32 v141, v141
  v_mfma_f32_32x32x16_bf16 v[176:191], v[196:199], v[68:71], v[176:191]
  v_exp_f32 v142, v142
  v_exp_f32 v143, v143
  s_waitcnt lgkmcnt(2)
  v_mfma_f32_32x32x16_bf16 v[160:175], v[200:203], v[8:11], v[160:175]
  ds_read_b128 v[196:199], v224 offset:16800
  v_add_f32 v232, v232, v140
  v_add_f32 v232, v232, v141
  v_add_f32 v232, v232, v142
  v_mfma_f32_32x32x16_bf16 v[176:191], v[200:203], v[72:75], v[176:191]
  v_add_f32 v232, v232, v143
  v_cvt_pk_bf16_f32 v138, v140, v141
  v_cvt_pk_bf16_f32 v139, v142, v143
  s_waitcnt lgkmcnt(2)
  v_mfma_f32_32x32x16_bf16 v[160:175], v[204:207], v[12:15], v[160:175]
  ds_read_b128 v[200:203], v224 offset:16832
  v_fma_f32 v144, v144, s44, -v229
  v_fma_f32 v145, v145, s44, -v229
  v_fma_f32 v146, v146, s44, -v229
  v_mfma_f32_32x32x16_bf16 v[176:191], v[204:207], v[76:79], v[176:191]
  v_fma_f32 v147, v147, s44, -v229
  v_exp_f32 v144, v144
  s_waitcnt lgkmcnt(2)
  v_mfma_f32_32x32x16_bf16 v[160:175], v[192:195], v[16:19], v[160:175]
  ds_read_b128 v[204:207], v224 offset:16864
  v_exp_f32 v145, v145
  v_exp_f32 v146, v146
  v_mfma_f32_32x32x16_bf16 v[176:191], v[192:195], v[80:83], v[176:191]
  v_exp_f32 v147, v147
  s_waitcnt lgkmcnt(2)
  v_mfma_f32_32x32x16_bf16 v[160:175], v[196:199], v[20:23], v[160:175]
  ds_read_b128 v[192:195], v224 offset:16896
  v_add_f32 v233, v233, v144
  v_add_f32 v233, v233, v145
  v_add_f32 v233, v233, v146
  v_mfma_f32_32x32x16_bf16 v[176:191], v[196:199], v[84:87], v[176:191]
  v_add_f32 v233, v233, v147
  v_cvt_pk_bf16_f32 v144, v144, v145
  v_cvt_pk_bf16_f32 v145, v146, v147
  s_waitcnt lgkmcnt(2)
  v_mfma_f32_32x32x16_bf16 v[160:175], v[200:203], v[24:27], v[160:175]
  ds_read_b128 v[196:199], v224 offset:16928
  v_fma_f32 v148, v148, s44, -v229
  v_fma_f32 v149, v149, s44, -v229
  v_fma_f32 v150, v150, s44, -v229
  v_mfma_f32_32x32x16_bf16 v[176:191], v[200:203], v[88:91], v[176:191]
  v_fma_f32 v151, v151, s44, -v229
  v_exp_f32 v148, v148
  s_waitcnt lgkmcnt(2)
  v_mfma_f32_32x32x16_bf16 v[160:175], v[204:207], v[28:31], v[160:175]
  ds_read_b128 v[200:203], v224 offset:16960
  v_exp_f32 v149, v149
  v_exp_f32 v150, v150
  v_mfma_f32_32x32x16_bf16 v[176:191], v[204:207], v[92:95], v[176:191]
  v_exp_f32 v151, v151
  v_add_f32 v233, v233, v148
  s_waitcnt lgkmcnt(2)
  v_mfma_f32_32x32x16_bf16 v[160:175], v[192:195], v[32:35], v[160:175]
  ds_read_b128 v[204:207], v224 offset:16992
  v_add_f32 v233, v233, v149
  v_add_f32 v233, v233, v150
  v_mfma_f32_32x32x16_bf16 v[176:191], v[192:195], v[96:99], v[176:191]
  v_add_f32 v233, v233, v151
  v_cvt_pk_bf16_f32 v146, v148, v149
  v_cvt_pk_bf16_f32 v147, v150, v151
  v_fma_f32 v152, v152, s44, -v229
  s_waitcnt lgkmcnt(2)
  v_mfma_f32_32x32x16_bf16 v[160:175], v[196:199], v[36:39], v[160:175]
  ds_read_b128 v[192:195], v224 offset:17024
  v_fma_f32 v153, v153, s44, -v229
  v_fma_f32 v154, v154, s44, -v229
  v_mfma_f32_32x32x16_bf16 v[176:191], v[196:199], v[100:103], v[176:191]
  v_fma_f32 v155, v155, s44, -v229
  v_exp_f32 v152, v152
  s_waitcnt lgkmcnt(2)
  v_mfma_f32_32x32x16_bf16 v[160:175], v[200:203], v[40:43], v[160:175]
  ds_read_b128 v[196:199], v224 offset:17056
  v_exp_f32 v153, v153
  v_exp_f32 v154, v154
  v_mfma_f32_32x32x16_bf16 v[176:191], v[200:203], v[104:107], v[176:191]
  v_exp_f32 v155, v155
  v_add_f32 v233, v233, v152
  s_waitcnt lgkmcnt(2)
  v_mfma_f32_32x32x16_bf16 v[160:175], v[204:207], v[44:47], v[160:175]
  ds_read_b128 v[200:203], v224 offset:17088
  v_add_f32 v233, v233, v153
  v_add_f32 v233, v233, v154
  v_add_f32 v233, v233, v155
  v_mfma_f32_32x32x16_bf16 v[176:191], v[204:207], v[108:111], v[176:191]
  v_cvt_pk_bf16_f32 v152, v152, v153
  v_cvt_pk_bf16_f32 v153, v154, v155
  v_fma_f32 v156, v156, s44, -v229
  s_waitcnt lgkmcnt(2)
  v_mfma_f32_32x32x16_bf16 v[160:175], v[192:195], v[48:51], v[160:175]
  ds_read_b128 v[204:207], v224 offset:17120
  v_fma_f32 v157, v157, s44, -v229
  v_fma_f32 v158, v158, s44, -v229
  v_fma_f32 v159, v159, s44, -v229
  v_mfma_f32_32x32x16_bf16 v[176:191], v[192:195], v[112:115], v[176:191]
  v_exp_f32 v156, v156
  s_waitcnt lgkmcnt(2)
  v_mfma_f32_32x32x16_bf16 v[160:175], v[196:199], v[52:55], v[160:175]
  ds_read_b64_tr_b16 v[208:209], v250 offset:0
  ds_read_b64_tr_b16 v[210:211], v250 offset:4352
  v_exp_f32 v157, v157
  v_exp_f32 v158, v158
  v_mfma_f32_32x32x16_bf16 v[176:191], v[196:199], v[116:119], v[176:191]
  v_exp_f32 v159, v159
  s_waitcnt lgkmcnt(3)
  v_mfma_f32_32x32x16_bf16 v[160:175], v[200:203], v[56:59], v[160:175]
  ds_read_b64_tr_b16 v[212:213], v250 offset:512
  ds_read_b64_tr_b16 v[214:215], v250 offset:4864
  v_add_f32 v233, v233, v156
  v_add_f32 v233, v233, v157
  v_add_f32 v233, v233, v158
  v_mfma_f32_32x32x16_bf16 v[176:191], v[200:203], v[120:123], v[176:191]
  v_add_f32 v233, v233, v159
  v_cvt_pk_bf16_f32 v154, v156, v157
  v_cvt_pk_bf16_f32 v155, v158, v159
  s_waitcnt lgkmcnt(4)
  v_mfma_f32_32x32x16_bf16 v[160:175], v[204:207], v[60:63], v[160:175]
  ds_read_b64_tr_b16 v[216:217], v250 offset:64
  ds_read_b64_tr_b16 v[218:219], v250 offset:4416
  v_mfma_f32_32x32x16_bf16 v[176:191], v[204:207], v[124:127], v[176:191]
  s_cmp_eq_u32 s56, 0
  s_cbranch_scc1 L_nores8
  s_call_b64 s[58:59], L_resc
L_nores8:
  s_waitcnt lgkmcnt(4)
  v_mfma_f32_32x32x16_bf16 a[0:15], v[208:211], v[128:131], a[0:15]
  ds_read_b64_tr_b16 v[220:221], v250 offset:576
  ds_read_b64_tr_b16 v[222:223], v250 offset:4928
  v_mfma_f32_32x32x16_bf16 a[16:31], v[208:211], v[144:147], a[16:31]
  s_waitcnt vmcnt(16)
  s_barrier
  s_waitcnt lgkmcnt(4)
  v_mfma_f32_32x32x16_bf16 a[0:15], v[212:215], v[136:139], a[0:15]
  ds_read_b64_tr_b16 v[208:209], v250 offset:128
  ds_read_b64_tr_b16 v[210:211], v250 offset:4480
  s_add_u32 s51, s49, 131072
  s_add_u32 m0, s45, 118784
  s_nop 0
  buffer_load_dwordx4 v226, s[24:27], s51 offen nt lds
  v_mfma_f32_32x32x16_bf16 a[16:31], v[212:215], v[152:155], a[16:31]
  s_add_u32 m0, s45, 119360
  s_nop 0
  buffer_load_dwordx4 v226, s[24:27], s51 offen offset:512 nt lds
  s_waitcnt lgkmcnt(4)
  v_mfma_f32_32x32x16_bf16 a[32:47], v[216:219], v[128:131], a[32:47]
  ds_read_b64_tr_b16 v[212:213], v250 offset:640
  ds_read_b64_tr_b16 v[214:215], v250 offset:4992
  s_add_u32 m0, s45, 119936
  v_mfma_f32_32x32x16_bf16 a[48:63], v[216:219], v[144:147], a[48:63]
  buffer_load_dwordx4 v226, s[24:27], s51 offen offset:1024 nt lds
  s_add_u32 m0, s45, 120512
  s_waitcnt lgkmcnt(4)
  v_mfma_f32_32x32x16_bf16 a[32:47], v[220:223], v[136:139], a[32:47]
  ds_read_b64_tr_b16 v[216:217], v250 offset:192
  ds_read_b64_tr_b16 v[218:219], v250 offset:4544
  buffer_load_dwordx4 v226, s[24:27], s51 offen offset:1536 nt lds
  v_mfma_f32_32x32x16_bf16 a[48:63], v[220:223], v[152:155], a[48:63]
  s_add_u32 s51, s49, 147456
  s_add_u32 m0, s47, 16640
  s_nop 0
  buffer_load_dwordx4 v226, s[20:23], s51 offen nt lds
  s_waitcnt lgkmcnt(4)
  v_mfma_f32_32x32x16_bf16 a[64:79], v[208:211], v[128:131], a[64:79]
  ds_read_b64_tr_b16 v[220:221], v250 offset:704
  ds_read_b64_tr_b16 v[222:223], v250 offset:5056
  s_add_u32 m0, s47, 17168
  v_mfma_f32_32x32x16_bf16 a[80:95], v[208:211], v[144:147], a[80:95]
  buffer_load_dwordx4 v226, s[20:23], s51 offen offset:512 nt lds
  s_add_u32 m0, s47, 17696
  s_waitcnt lgkmcnt(4)
  v_mfma_f32_32x32x16_bf16 a[64:79], v[212:215], v[136:139], a[64:79]
  ds_read_b64_tr_b16 v[208:209], v250 offset:256
  ds_read_b64_tr_b16 v[210:211], v250 offset:4608
  buffer_load_dwordx4 v226, s[20:23], s51 offen offset:1024 nt lds
  s_add_u32 m0, s47, 18224
  v_mfma_f32_32x32x16_bf16 a[80:95], v[212:215], v[152:155], a[80:95]
  buffer_load_dwordx4 v226, s[20:23], s51 offen offset:1536 nt lds
  v_max3_f32 v236, v160, v161, v162
  s_waitcnt lgkmcnt(4)
  v_mfma_f32_32x32x16_bf16 a[96:111], v[216:219], v[128:131], a[96:111]
  ds_read_b64_tr_b16 v[212:213], v250 offset:768
  ds_read_b64_tr_b16 v[214:215], v250 offset:5120
  v_max3_f32 v236, v236, v163, v164
  v_max3_f32 v236, v236, v165, v166
  v_max3_f32 v236, v236, v167, v168
  v_mfma_f32_32x32x16_bf16 a[112:127], v[216:219], v[144:147], a[112:127]
  v_max3_f32 v236, v236, v169, v170
  v_max3_f32 v236, v236, v171, v172
  v_max3_f32 v236, v236, v173, v174
  v_max_f32 v236, v236, v175
  v_max3_f32 v237, v176, v177, v178
  s_waitcnt lgkmcnt(4)
  v_mfma_f32_32x32x16_bf16 a[96:111], v[220:223], v[136:139], a[96:111]
  ds_read_b64_tr_b16 v[216:217], v250 offset:320
  ds_read_b64_tr_b16 v[218:219], v250 offset:4672
  v_max3_f32 v237, v237, v179, v180
  v_max3_f32 v237, v237, v181, v182
  v_max3_f32 v237, v237, v183, v184
  v_mfma_f32_32x32x16_bf16 a[112:127], v[220:223], v[152:155], a[112:127]
  v_max3_f32 v237, v237, v185, v186
  v_max3_f32 v237, v237, v187, v188
  v_max3_f32 v237, v237, v189, v190
  v_max_f32 v237, v237, v191
  s_waitcnt lgkmcnt(4)
  v_mfma_f32_32x32x16_bf16 a[128:143], v[208:211], v[128:131], a[128:143]
  ds_read_b64_tr_b16 v[220:221], v250 offset:832
  ds_read_b64_tr_b16 v[222:223], v250 offset:5184
  v_mov_b32 v238, v236
  v_mov_b32 v239, v237
  s_nop 0
  v_permlane32_swap_b32 v236, v238
  v_mfma_f32_32x32x16_bf16 a[144:159], v[208:211], v[144:147], a[144:159]
  v_permlane32_swap_b32 v237, v239
  v_max_f32 v236, v236, v238
  v_max_f32 v237, v237, v239
  v_cmp_gt_f32 s[52:53], v236, v230
  v_cmp_gt_f32 s[54:55], v237, v231
  s_waitcnt lgkmcnt(4)
  v_mfma_f32_32x32x16_bf16 a[128:143], v[212:215], v[136:139], a[128:143]
  ds_read_b64_tr_b16 v[208:209], v250 offset:384
  ds_read_b64_tr_b16 v[210:211], v250 offset:4736
  s_or_b64 s[52:53], s[52:53], s[54:55]
  s_cbranch_scc0 L_noslow9
  s_call_b64 s[58:59], L_slow
L_noslow9:
  v_fma_f32 v160, v160, s44, -v228
  v_mfma_f32_32x32x16_bf16 a[144:159], v[212:215], v[152:155], a[144:159]
  v_fma_f32 v161, v161, s44, -v228
  v_fma_f32 v162, v162, s44, -v228
  v_fma_f32 v163, v163, s44, -v228
  v_exp_f32 v160, v160
  s_waitcnt lgkmcnt(4)
  v_mfma_f32_32x32x16_bf16 a[160:175], v[216:219], v[128:131], a[160:175]
  ds_read_b64_tr_b16 v[212:213], v250 offset:896
  ds_read_b64_tr_b16 v[214:215], v250 offset:5248
  v_exp_f32 v161, v161
  v_exp_f32 v162, v162
  v_mfma_f32_32x32x16_bf16 a[176:191], v[216:219], v[144:147], a[176:191]
  v_exp_f32 v163, v163
  v_add_f32 v232, v232, v160
  v_add_f32 v232, v232, v161
  s_waitcnt lgkmcnt(4)
  v_mfma_f32_32x32x16_bf16 a[160:175], v[220:223], v[136:139], a[160:175]
  ds_read_b64_tr_b16 v[216:217], v250 offset:448
  ds_read_b64_tr_b16 v[218:219], v250 offset:4800
  v_add_f32 v232, v232, v162
  v_add_f32 v232, v232, v163
  v_cvt_pk_bf16_f32 v160, v160, v161
  v_mfma_f32_32x32x16_bf16 a[176:191], v[220:223], v[152:155], a[176:191]
  v_cvt_pk_bf16_f32 v161, v162, v163
  v_fma_f32 v164, v164, s44, -v228
  v_fma_f32 v165, v165, s44, -v228
  v_fma_f32 v166, v166, s44, -v228
  s_waitcnt lgkmcnt(4)
  v_mfma_f32_32x32x16_bf16 a[192:207], v[208:211], v[128:131], a[192:207]
  ds_read_b64_tr_b16 v[220:221], v250 offset:960
  ds_read_b64_tr_b16 v[222:223], v250 offset:5312
  v_fma_f32 v167, v167, s44, -v228
  v_exp_f32 v164, v164
  v_mfma_f32_32x32x16_bf16 a[208:223], v[208:211], v[144:147], a[208:223]
  v_exp_f32 v165, v165
  v_exp_f32 v166, v166
  s_waitcnt lgkmcnt(4)
  v_mfma_f32_32x32x16_bf16 a[192:207], v[212:215], v[136:139], a[192:207]
  ds_read_b128 v[192:195], v224 offset:33280
  v_exp_f32 v167, v167
  v_add_f32 v232, v232, v164
  v_add_f32 v232, v232, v165
  v_add_f32 v232, v232, v166
  v_mfma_f32_32x32x16_bf16 a[208:223], v[212:215], v[152:155], a[208:223]
  v_add_f32 v232, v232, v167
  v_cvt_pk_bf16_f32 v162, v164, v165
  v_cvt_pk_bf16_f32 v163, v166, v167
  v_fma_f32 v168, v168, s44, -v228
  s_waitcnt lgkmcnt(3)
  v_mfma_f32_32x32x16_bf16 a[224:239], v[216:219], v[128:131], a[224:239]
  ds_read_b128 v[196:199], v224 offset:33312
  v_fma_f32 v169, v169, s44, -v228
  v_fma_f32 v170, v170, s44, -v228
  v_fma_f32 v171, v171, s44, -v228
  v_exp_f32 v168, v168
  v_mfma_f32_32x32x16_bf16 a[240:255], v[216:219], v[144:147], a[240:255]
  v_exp_f32 v169, v169
  v_exp_f32 v170, v170
  s_waitcnt lgkmcnt(2)
  v_mfma_f32_32x32x16_bf16 a[224:239], v[220:223], v[136:139], a[224:239]
  ds_read_b128 v[200:203], v224 offset:33344
  v_exp_f32 v171, v171
  v_add_f32 v232, v232, v168
  v_mfma_f32_32x32x16_bf16 a[240:255], v[220:223], v[152:155], a[240:255]
  v_add_f32 v232, v232, v169
  v_add_f32 v232, v232, v170
  v_add_f32 v232, v232, v171
  v_cvt_pk_bf16_f32 v168, v168, v169
  v_cvt_pk_bf16_f32 v169, v170, v171
  s_waitcnt lgkmcnt(2)
  v_mfma_f32_32x32x16_bf16 v[128:143], v[192:195], v[0:3], 0
  ds_read_b128 v[204:207], v224 offset:33376
  v_fma_f32 v172, v172, s44, -v228
  v_fma_f32 v173, v173, s44, -v228
  v_fma_f32 v174, v174, s44, -v228
  v_mfma_f32_32x32x16_bf16 v[144:159], v[192:195], v[64:67], 0
  v_fma_f32 v175, v175, s44, -v228
  v_exp_f32 v172, v172
  s_waitcnt lgkmcnt(2)
  v_mfma_f32_32x32x16_bf16 v[128:143], v[196:199], v[4:7], v[128:143]
  ds_read_b128 v[192:195], v224 offset:33408
  v_exp_f32 v173, v173
  v_mfma_f32_32x32x16_bf16 v[144:159], v[196:199], v[68:71], v[144:159]
  v_exp_f32 v174, v174
  v_exp_f32 v175, v175
  s_waitcnt lgkmcnt(2)
  v_mfma_f32_32x32x16_bf16 v[128:143], v[200:203], v[8:11], v[128:143]
  ds_read_b128 v[196:199], v224 offset:33440
  v_add_f32 v232, v232, v172
  v_add_f32 v232, v232, v173
  v_add_f32 v232, v232, v174
  v_mfma_f32_32x32x16_bf16 v[144:159], v[200:203], v[72:75], v[144:159]
  v_add_f32 v232, v232, v175
  v_cvt_pk_bf16_f32 v170, v172, v173
  v_cvt_pk_bf16_f32 v171, v174, v175
  s_waitcnt lgkmcnt(2)
  v_mfma_f32_32x32x16_bf16 v[128:143], v[204:207], v[12:15], v[128:143]
  ds_read_b128 v[200:203], v224 offset:33472
  v_fma_f32 v176, v176, s44, -v229
  v_fma_f32 v177, v177, s44, -v229
  v_fma_f32 v178, v178, s44, -v229
  v_mfma_f32_32x32x16_bf16 v[144:159], v[204:207], v[76:79], v[144:159]
  v_fma_f32 v179, v179, s44, -v229
  v_exp_f32 v176, v176
  s_waitcnt lgkmcnt(2)
  v_mfma_f32_32x32x16_bf16 v[128:143], v[192:195], v[16:19], v[128:143]
  ds_read_b128 v[204:207], v224 offset:33504
  v_exp_f32 v177, v177
  v_exp_f32 v178, v178
  v_mfma_f32_32x32x16_bf16 v[144:159], v[192:195], v[80:83], v[144:159]
  v_exp_f32 v179, v179
  s_waitcnt lgkmcnt(2)
  v_mfma_f32_32x32x16_bf16 v[128:143], v[196:199], v[20:23], v[128:143]
  ds_read_b128 v[192:195], v224 offset:33536
  v_add_f32 v233, v233, v176
  v_add_f32 v233, v233, v177
  v_add_f32 v233, v233, v178
  v_mfma_f32_32x32x16_bf16 v[144:159], v[196:199], v[84:87], v[144:159]
  v_add_f32 v233, v233, v179
  v_cvt_pk_bf16_f32 v176, v176, v177
  v_cvt_pk_bf16_f32 v177, v178, v179
  s_waitcnt lgkmcnt(2)
  v_mfma_f32_32x32x16_bf16 v[128:143], v[200:203], v[24:27], v[128:143]
  ds_read_b128 v[196:199], v224 offset:33568
  v_fma_f32 v180, v180, s44, -v229
  v_fma_f32 v181, v181, s44, -v229
  v_fma_f32 v182, v182, s44, -v229
  v_mfma_f32_32x32x16_bf16 v[144:159], v[200:203], v[88:91], v[144:159]
  v_fma_f32 v183, v183, s44, -v229
  v_exp_f32 v180, v180
  s_waitcnt lgkmcnt(2)
  v_mfma_f32_32x32x16_bf16 v[128:143], v[204:207], v[28:31], v[128:143]
  ds_read_b128 v[200:203], v224 offset:33600
  v_exp_f32 v181, v181
  v_exp_f32 v182, v182
  v_mfma_f32_32x32x16_bf16 v[144:159], v[204:207], v[92:95], v[144:159]
  v_exp_f32 v183, v183
  v_add_f32 v233, v233, v180
  s_waitcnt lgkmcnt(2)
  v_mfma_f32_32x32x16_bf16 v[128:143], v[192:195], v[32:35], v[128:143]
  ds_read_b128 v[204:207], v224 offset:33632
  v_add_f32 v233, v233, v181
  v_add_f32 v233, v233, v182
  v_mfma_f32_32x32x16_bf16 v[144:159], v[192:195], v[96:99], v[144:159]
  v_add_f32 v233, v233, v183
  v_cvt_pk_bf16_f32 v178, v180, v181
  v_cvt_pk_bf16_f32 v179, v182, v183
  v_fma_f32 v184, v184, s44, -v229
  s_waitcnt lgkmcnt(2)
  v_mfma_f32_32x32x16_bf16 v[128:143], v[196:199], v[36:39], v[128:143]
  ds_read_b128 v[192:195], v224 offset:33664
  v_fma_f32 v185, v185, s44, -v229
  v_fma_f32 v186, v186, s44, -v229
  v_mfma_f32_32x32x16_bf16 v[144:159], v[196:199], v[100:103], v[144:159]
  v_fma_f32 v187, v187, s44, -v229
  v_exp_f32 v184, v184
  s_waitcnt lgkmcnt(2)
  v_mfma_f32_32x32x16_bf16 v[128:143], v[200:203], v[40:43], v[128:143]
  ds_read_b128 v[196:199], v224 offset:33696
  v_exp_f32 v185, v185
  v_exp_f32 v186, v186
  v_mfma_f32_32x32x16_bf16 v[144:159], v[200:203], v[104:107], v[144:159]
  v_exp_f32 v187, v187
  v_add_f32 v233, v233, v184
  s_waitcnt lgkmcnt(2)
  v_mfma_f32_32x32x16_bf16 v[128:143], v[204:207], v[44:47], v[128:143]
  ds_read_b128 v[200:203], v224 offset:33728
  v_add_f32 v233, v233, v185
  v_add_f32 v233, v233, v186
  v_add_f32 v233, v233, v187
  v_mfma_f32_32x32x16_bf16 v[144:159], v[204:207], v[108:111], v[144:159]
  v_cvt_pk_bf16_f32 v184, v184, v185
  v_cvt_pk_bf16_f32 v185, v186, v187
  v_fma_f32 v188, v188, s44, -v229
  s_waitcnt lgkmcnt(2)
  v_mfma_f32_32x32x16_bf16 v[128:143], v[192:195], v[48:51], v[128:143]
  ds_read_b128 v[204:207], v224 offset:33760
  v_fma_f32 v189, v189, s44, -v229
  v_fma_f32 v190, v190, s44, -v229
  v_fma_f32 v191, v191, s44, -v229
  v_mfma_f32_32x32x16_bf16 v[144:159], v[192:195], v[112:115], v[144:159]
  v_exp_f32 v188, v188
  s_waitcnt lgkmcnt(2)
  v_mfma_f32_32x32x16_bf16 v[128:143], v[196:199], v[52:55], v[128:143]
  ds_read_b64_tr_b16 v[208:209], v225 offset:0
  ds_read_b64_tr_b16 v[210:211], v225 offset:4352
  v_exp_f32 v189, v189
  v_exp_f32 v190, v190
  v_mfma_f32_32x32x16_bf16 v[144:159], v[196:199], v[116:119], v[144:159]
  v_exp_f32 v191, v191
  s_waitcnt lgkmcnt(3)
  v_mfma_f32_32x32x16_bf16 v[128:143], v[200:203], v[56:59], v[128:143]
  ds_read_b64_tr_b16 v[212:213], v225 offset:512
  ds_read_b64_tr_b16 v[214:215], v225 offset:4864
  v_add_f32 v233, v233, v188
  v_add_f32 v233, v233, v189
  v_add_f32 v233, v233, v190
  v_mfma_f32_32x32x16_bf16 v[144:159], v[200:203], v[120:123], v[144:159]
  v_add_f32 v233, v233, v191
  v_cvt_pk_bf16_f32 v186, v188, v189
  v_cvt_pk_bf16_f32 v187, v190, v191
  s_waitcnt lgkmcnt(4)
  v_mfma_f32_32x32x16_bf16 v[128:143], v[204:207], v[60:63], v[128:143]
  ds_read_b64_tr_b16 v[216:217], v225 offset:64
  ds_read_b64_tr_b16 v[218:219], v225 offset:4416
  v_mfma_f32_32x32x16_bf16 v[144:159], v[204:207], v[124:127], v[144:159]
  s_cmp_eq_u32 s56, 0
  s_cbranch_scc1 L_nores10
  s_call_b64 s[58:59], L_resc
L_nores10:
  s_waitcnt lgkmcnt(4)
  v_mfma_f32_32x32x16_bf16 a[0:15], v[208:211], v[160:163], a[0:15]
  ds_read_b64_tr_b16 v[220:221], v225 offset:576
  ds_read_b64_tr_b16 v[222:223], v225 offset:4928
  v_mfma_f32_32x32x16_bf16 a[16:31], v[208:211], v[176:179], a[16:31]
  s_waitcnt vmcnt(16)
  s_barrier
  s_waitcnt lgkmcnt(4)
  v_mfma_f32_32x32x16_bf16 a[0:15], v[212:215], v[168:171], a[0:15]
  ds_read_b64_tr_b16 v[208:209], v225 offset:128
  ds_read_b64_tr_b16 v[210:211], v225 offset:4480
  s_add_u32 s51, s49, 147456
  s_add_u32 m0, s45, 136192
  s_nop 0
  buffer_load_dwordx4 v226, s[24:27], s51 offen nt lds
  v_mfma_f32_32x32x16_bf16 a[16:31], v[212:215], v[184:187], a[16:31]
  s_add_u32 m0, s45, 136768
  s_nop 0
  buffer_load_dwordx4 v226, s[24:27], s51 offen offset:512 nt lds
  s_waitcnt lgkmcnt(4)
  v_mfma_f32_32x32x16_bf16 a[32:47], v[216:219], v[160:163], a[32:47]
  ds_read_b64_tr_b16 v[212:213], v225 offset:640
  ds_read_b64_tr_b16 v[214:215], v225 offset:4992
  s_add_u32 m0, s45, 137344
  v_mfma_f32_32x32x16_bf16 a[48:63], v[216:219], v[176:179], a[48:63]
  buffer_load_dwordx4 v226, s[24:27], s51 offen offset:1024 nt lds
  s_add_u32 m0, s45, 137920
  s_waitcnt lgkmcnt(4)
  v_mfma_f32_32x32x16_bf16 a[32:47], v[220:223], v[168:171], a[32:47]
  ds_read_b64_tr_b16 v[216:217], v225 offset:192
  ds_read_b64_tr_b16 v[218:219], v225 offset:4544
  buffer_load_dwordx4 v226, s[24:27], s51 offen offset:1536 nt lds
  v_mfma_f32_32x32x16_bf16 a[48:63], v[220:223], v[184:187], a[48:63]
  s_add_u32 s51, s49, 163840
  s_add_u32 m0, s47, 33280
  s_nop 0
  buffer_load_dwordx4 v226, s[20:23], s51 offen nt lds
  s_waitcnt lgkmcnt(4)
  v_mfma_f32_32x32x16_bf16 a[64:79], v[208:211], v[160:163], a[64:79]
  ds_read_b64_tr_b16 v[220:221], v225 offset:704
  ds_read_b64_tr_b16 v[222:223], v225 offset:5056
  s_add_u32 m0, s47, 33808
  v_mfma_f32_32x32x16_bf16 a[80:95], v[208:211], v[176:179], a[80:95]
  buffer_load_dwordx4 v226, s[20:23], s51 offen offset:512 nt lds
  s_add_u32 m0, s47, 34336
  s_waitcnt lgkmcnt(4)
  v_mfma_f32_32x32x16_bf16 a[64:79], v[212:215], v[168:171], a[64:79]
  ds_read_b64_tr_b16 v[208:209], v225 offset:256
  ds_read_b64_tr_b16 v[210:211], v225 offset:4608
  buffer_load_dwordx4 v226, s[20:23], s51 offen offset:1024 nt lds
  s_add_u32 m0, s47, 34864
  v_mfma_f32_32x32x16_bf16 a[80:95], v[212:215], v[184:187], a[80:95]
  buffer_load_dwordx4 v226, s[20:23], s51 offen offset:1536 nt lds
  v_max3_f32 v236, v128, v129, v130
  s_waitcnt lgkmcnt(4)
  v_mfma_f32_32x32x16_bf16 a[96:111], v[216:219], v[160:163], a[96:111]
  ds_read_b64_tr_b16 v[212:213], v225 offset:768
  ds_read_b64_tr_b16 v[214:215], v225 offset:5120
  v_max3_f32 v236, v236, v131, v132
  v_max3_f32 v236, v236, v133, v134
  v_max3_f32 v236, v236, v135, v136
  v_mfma_f32_32x32x16_bf16 a[112:127], v[216:219], v[176:179], a[112:127]
  v_max3_f32 v236, v236, v137, v138
  v_max3_f32 v236, v236, v139, v140
  v_max3_f32 v236, v236, v141, v142
  v_max_f32 v236, v236, v143
  v_max3_f32 v237, v144, v145, v146
  s_waitcnt lgkmcnt(4)
  v_mfma_f32_32x32x16_bf16 a[96:111], v[220:223], v[168:171], a[96:111]
  ds_read_b64_tr_b16 v[216:217], v225 offset:320
  ds_read_b64_tr_b16 v[218:219], v225 offset:4672
  v_max3_f32 v237, v237, v147, v148
  v_max3_f32 v237, v237, v149, v150
  v_max3_f32 v237, v237, v151, v152
  v_mfma_f32_32x32x16_bf16 a[112:127], v[220:223], v[184:187], a[112:127]
  v_max3_f32 v237, v237, v153, v154
  v_max3_f32 v237, v237, v155, v156
  v_max3_f32 v237, v237, v157, v158
  v_max_f32 v237, v237, v159
  s_waitcnt lgkmcnt(4)
  v_mfma_f32_32x32x16_bf16 a[128:143], v[208:211], v[160:163], a[128:143]
  ds_read_b64_tr_b16 v[220:221], v225 offset:832
  ds_read_b64_tr_b16 v[222:223], v225 offset:5184
  v_mov_b32 v238, v236
  v_mov_b32 v239, v237
  s_nop 0
  v_permlane32_swap_b32 v236, v238
  v_mfma_f32_32x32x16_bf16 a[144:159], v[208:211], v[176:179], a[144:159]
  v_permlane32_swap_b32 v237, v239
  v_max_f32 v236, v236, v238
  v_max_f32 v237, v237, v239
  v_cmp_gt_f32 s[52:53], v236, v230
  v_cmp_gt_f32 s[54:55], v237, v231
  s_waitcnt lgkmcnt(4)
  v_mfma_f32_32x32x16_bf16 a[128:143], v[212:215], v[168:171], a[128:143]
  ds_read_b64_tr_b16 v[208:209], v225 offset:384
  ds_read_b64_tr_b16 v[210:211], v225 offset:4736
  s_or_b64 s[52:53], s[52:53], s[54:55]
  s_cbranch_scc0 L_noslow11
  s_call_b64 s[58:59], L_slow
L_noslow11:
  v_fma_f32 v128, v128, s44, -v228
  v_mfma_f32_32x32x16_bf16 a[144:159], v[212:215], v[184:187], a[144:159]
  v_fma_f32 v129, v129, s44, -v228
  v_fma_f32 v130, v130, s44, -v228
  v_fma_f32 v131, v131, s44, -v228
  v_exp_f32 v128, v128
  s_waitcnt lgkmcnt(4)
  v_mfma_f32_32x32x16_bf16 a[160:175], v[216:219], v[160:163], a[160:175]
  ds_read_b64_tr_b16 v[212:213], v225 offset:896
  ds_read_b64_tr_b16 v[214:215], v225 offset:5248
  v_exp_f32 v129, v129
  v_exp_f32 v130, v130
  v_mfma_f32_32x32x16_bf16 a[176:191], v[216:219], v[176:179], a[176:191]
  v_exp_f32 v131, v131
  v_add_f32 v232, v232, v128
  v_add_f32 v232, v232, v129
  s_waitcnt lgkmcnt(4)
  v_mfma_f32_32x32x16_bf16 a[160:175], v[220:223], v[168:171], a[160:175]
  ds_read_b64_tr_b16 v[216:217], v225 offset:448
  ds_read_b64_tr_b16 v[218:219], v225 offset:4800
  v_add_f32 v232, v232, v130
  v_add_f32 v232, v232, v131
  v_cvt_pk_bf16_f32 v128, v128, v129
  v_mfma_f32_32x32x16_bf16 a[176:191], v[220:223], v[184:187], a[176:191]
  v_cvt_pk_bf16_f32 v129, v130, v131
  v_fma_f32 v132, v132, s44, -v228
  v_fma_f32 v133, v133, s44, -v228
  v_fma_f32 v134, v134, s44, -v228
  s_waitcnt lgkmcnt(4)
  v_mfma_f32_32x32x16_bf16 a[192:207], v[208:211], v[160:163], a[192:207]
  ds_read_b64_tr_b16 v[220:221], v225 offset:960
  ds_read_b64_tr_b16 v[222:223], v225 offset:5312
  v_fma_f32 v135, v135, s44, -v228
  v_exp_f32 v132, v132
  v_mfma_f32_32x32x16_bf16 a[208:223], v[208:211], v[176:179], a[208:223]
  v_exp_f32 v133, v133
  v_exp_f32 v134, v134
  s_waitcnt lgkmcnt(4)
  v_mfma_f32_32x32x16_bf16 a[192:207], v[212:215], v[168:171], a[192:207]
  ds_read_b128 v[192:195], v224 offset:49920
  v_exp_f32 v135, v135
  v_add_f32 v232, v232, v132
  v_add_f32 v232, v232, v133
  v_add_f32 v232, v232, v134
  v_mfma_f32_32x32x16_bf16 a[208:223], v[212:215], v[184:187], a[208:223]
  v_add_f32 v232, v232, v135
  v_cvt_pk_bf16_f32 v130, v132, v133
  v_cvt_pk_bf16_f32 v131, v134, v135
  v_fma_f32 v136, v136, s44, -v228
  s_waitcnt lgkmcnt(3)
  v_mfma_f32_32x32x16_bf16 a[224:239], v[216:219], v[160:163], a[224:239]
  ds_read_b128 v[196:199], v224 offset:49952
  v_fma_f32 v137, v137, s44, -v228
  v_fma_f32 v138, v138, s44, -v228
  v_fma_f32 v139, v139, s44, -v228
  v_exp_f32 v136, v136
  v_mfma_f32_32x32x16_bf16 a[240:255], v[216:219], v[176:179], a[240:255]
  v_exp_f32 v137, v137
  v_exp_f32 v138, v138
  s_waitcnt lgkmcnt(2)
  v_mfma_f32_32x32x16_bf16 a[224:239], v[220:223], v[168:171], a[224:239]
  ds_read_b128 v[200:203], v224 offset:49984
  v_exp_f32 v139, v139
  v_add_f32 v232, v232, v136
  v_mfma_f32_32x32x16_bf16 a[240:255], v[220:223], v[184:187], a[240:255]
  v_add_f32 v232, v232, v137
  v_add_f32 v232, v232, v138
  v_add_f32 v232, v232, v139
  v_cvt_pk_bf16_f32 v136, v136, v137
  v_cvt_pk_bf16_f32 v137, v138, v139
  s_waitcnt lgkmcnt(2)
  v_mfma_f32_32x32x16_bf16 v[160:175], v[192:195], v[0:3], 0
  ds_read_b128 v[204:207], v224 offset:50016
  v_fma_f32 v140, v140, s44, -v228
  v_fma_f32 v141, v141, s44, -v228
  v_fma_f32 v142, v142, s44, -v228
  v_mfma_f32_32x32x16_bf16 v[176:191], v[192:195], v[64:67], 0
  v_fma_f32 v143, v143, s44, -v228
  v_exp_f32 v140, v140
  s_waitcnt lgkmcnt(2)
  v_mfma_f32_32x32x16_bf16 v[160:175], v[196:199], v[4:7], v[160:175]
  ds_read_b128 v[192:195], v224 offset:50048
  v_exp_f32 v141, v141
  v_mfma_f32_32x32x16_bf16 v[176:191], v[196:199], v[68:71], v[176:191]
  v_exp_f32 v142, v142
  v_exp_f32 v143, v143
  s_waitcnt lgkmcnt(2)
  v_mfma_f32_32x32x16_bf16 v[160:175], v[200:203], v[8:11], v[160:175]
  ds_read_b128 v[196:199], v224 offset:50080
  v_add_f32 v232, v232, v140
  v_add_f32 v232, v232, v141
  v_add_f32 v232, v232, v142
  v_mfma_f32_32x32x16_bf16 v[176:191], v[200:203], v[72:75], v[176:191]
  v_add_f32 v232, v232, v143
  v_cvt_pk_bf16_f32 v138, v140, v141
  v_cvt_pk_bf16_f32 v139, v142, v143
  s_waitcnt lgkmcnt(2)
  v_mfma_f32_32x32x16_bf16 v[160:175], v[204:207], v[12:15], v[160:175]
  ds_read_b128 v[200:203], v224 offset:50112
  v_fma_f32 v144, v144, s44, -v229
  v_fma_f32 v145, v145, s44, -v229
  v_fma_f32 v146, v146, s44, -v229
  v_mfma_f32_32x32x16_bf16 v[176:191], v[204:207], v[76:79], v[176:191]
  v_fma_f32 v147, v147, s44, -v229
  v_exp_f32 v144, v144
  s_waitcnt lgkmcnt(2)
  v_mfma_f32_32x32x16_bf16 v[160:175], v[192:195], v[16:19], v[160:175]
  ds_read_b128 v[204:207], v224 offset:50144
  v_exp_f32 v145, v145
  v_exp_f32 v146, v146
  v_mfma_f32_32x32x16_bf16 v[176:191], v[192:195], v[80:83], v[176:191]
  v_exp_f32 v147, v147
  s_waitcnt lgkmcnt(2)
  v_mfma_f32_32x32x16_bf16 v[160:175], v[196:199], v[20:23], v[160:175]
  ds_read_b128 v[192:195], v224 offset:50176
  v_add_f32 v233, v233, v144
  v_add_f32 v233, v233, v145
  v_add_f32 v233, v233, v146
  v_mfma_f32_32x32x16_bf16 v[176:191], v[196:199], v[84:87], v[176:191]
  v_add_f32 v233, v233, v147
  v_cvt_pk_bf16_f32 v144, v144, v145
  v_cvt_pk_bf16_f32 v145, v146, v147
  s_waitcnt lgkmcnt(2)
  v_mfma_f32_32x32x16_bf16 v[160:175], v[200:203], v[24:27], v[160:175]
  ds_read_b128 v[196:199], v224 offset:50208
  v_fma_f32 v148, v148, s44, -v229
  v_fma_f32 v149, v149, s44, -v229
  v_fma_f32 v150, v150, s44, -v229
  v_mfma_f32_32x32x16_bf16 v[176:191], v[200:203], v[88:91], v[176:191]
  v_fma_f32 v151, v151, s44, -v229
  v_exp_f32 v148, v148
  s_waitcnt lgkmcnt(2)
  v_mfma_f32_32x32x16_bf16 v[160:175], v[204:207], v[28:31], v[160:175]
  ds_read_b128 v[200:203], v224 offset:50240
  v_exp_f32 v149, v149
  v_exp_f32 v150, v150
  v_mfma_f32_32x32x16_bf16 v[176:191], v[204:207], v[92:95], v[176:191]
  v_exp_f32 v151, v151
  v_add_f32 v233, v233, v148
  s_waitcnt lgkmcnt(2)
  v_mfma_f32_32x32x16_bf16 v[160:175], v[192:195], v[32:35], v[160:175]
  ds_read_b128 v[204:207], v224 offset:50272
  v_add_f32 v233, v233, v149
  v_add_f32 v233, v233, v150
  v_mfma_f32_32x32x16_bf16 v[176:191], v[192:195], v[96:99], v[176:191]
  v_add_f32 v233, v233, v151
  v_cvt_pk_bf16_f32 v146, v148, v149
  v_cvt_pk_bf16_f32 v147, v150, v151
  v_fma_f32 v152, v152, s44, -v229
  s_waitcnt lgkmcnt(2)
  v_mfma_f32_32x32x16_bf16 v[160:175], v[196:199], v[36:39], v[160:175]
  ds_read_b128 v[192:195], v224 offset:50304
  v_fma_f32 v153, v153, s44, -v229
  v_fma_f32 v154, v154, s44, -v229
  v_mfma_f32_32x32x16_bf16 v[176:191], v[196:199], v[100:103], v[176:191]
  v_fma_f32 v155, v155, s44, -v229
  v_exp_f32 v152, v152
  s_waitcnt lgkmcnt(2)
  v_mfma_f32_32x32x16_bf16 v[160:175], v[200:203], v[40:43], v[160:175]
  ds_read_b128 v[196:199], v224 offset:50336
  v_exp_f32 v153, v153
  v_exp_f32 v154, v154
  v_mfma_f32_32x32x16_bf16 v[176:191], v[200:203], v[104:107], v[176:191]
  v_exp_f32 v155, v155
  v_add_f32 v233, v233, v152
  s_waitcnt lgkmcnt(2)
  v_mfma_f32_32x32x16_bf16 v[160:175], v[204:207], v[44:47], v[160:175]
  ds_read_b128 v[200:203], v224 offset:50368
  v_add_f32 v233, v233, v153
  v_add_f32 v233, v233, v154
  v_add_f32 v233, v233, v155
  v_mfma_f32_32x32x16_bf16 v[176:191], v[204:207], v[108:111], v[176:191]
  v_cvt_pk_bf16_f32 v152, v152, v153
  v_cvt_pk_bf16_f32 v153, v154, v155
  v_fma_f32 v156, v156, s44, -v229
  s_waitcnt lgkmcnt(2)
  v_mfma_f32_32x32x16_bf16 v[160:175], v[192:195], v[48:51], v[160:175]
  ds_read_b128 v[204:207], v224 offset:50400
  v_fma_f32 v157, v157, s44, -v229
  v_fma_f32 v158, v158, s44, -v229
  v_fma_f32 v159, v159, s44, -v229
  v_mfma_f32_32x32x16_bf16 v[176:191], v[192:195], v[112:115], v[176:191]
  v_exp_f32 v156, v156
  s_waitcnt lgkmcnt(2)
  v_mfma_f32_32x32x16_bf16 v[160:175], v[196:199], v[52:55], v[160:175]
  ds_read_b64_tr_b16 v[208:209], v225 offset:17408
  ds_read_b64_tr_b16 v[210:211], v225 offset:21760
  v_exp_f32 v157, v157
  v_exp_f32 v158, v158
  v_mfma_f32_32x32x16_bf16 v[176:191], v[196:199], v[116:119], v[176:191]
  v_exp_f32 v159, v159
  s_waitcnt lgkmcnt(3)
  v_mfma_f32_32x32x16_bf16 v[160:175], v[200:203], v[56:59], v[160:175]
  ds_read_b64_tr_b16 v[212:213], v225 offset:17920
  ds_read_b64_tr_b16 v[214:215], v225 offset:22272
  v_add_f32 v233, v233, v156
  v_add_f32 v233, v233, v157
  v_add_f32 v233, v233, v158
  v_mfma_f32_32x32x16_bf16 v[176:191], v[200:203], v[120:123], v[176:191]
  v_add_f32 v233, v233, v159
  v_cvt_pk_bf16_f32 v154, v156, v157
  v_cvt_pk_bf16_f32 v155, v158, v159
  s_waitcnt lgkmcnt(4)
  v_mfma_f32_32x32x16_bf16 v[160:175], v[204:207], v[60:63], v[160:175]
  ds_read_b64_tr_b16 v[216:217], v225 offset:17472
  ds_read_b64_tr_b16 v[218:219], v225 offset:21824
  v_mfma_f32_32x32x16_bf16 v[176:191], v[204:207], v[124:127], v[176:191]
  s_cmp_eq_u32 s56, 0
  s_cbranch_scc1 L_nores12
  s_call_b64 s[58:59], L_resc
L_nores12:
  s_waitcnt lgkmcnt(4)
  v_mfma_f32_32x32x16_bf16 a[0:15], v[208:211], v[128:131], a[0:15]
  ds_read_b64_tr_b16 v[220:221], v225 offset:17984
  ds_read_b64_tr_b16 v[222:223], v225 offset:22336
  v_mfma_f32_32x32x16_bf16 a[16:31], v[208:211], v[144:147], a[16:31]
  s_waitcnt vmcnt(16)
  s_barrier
  s_waitcnt lgkmcnt(4)
  v_mfma_f32_32x32x16_bf16 a[0:15], v[212:215], v[136:139], a[0:15]
  ds_read_b64_tr_b16 v[208:209], v225 offset:17536
  ds_read_b64_tr_b16 v[210:211], v225 offset:21888
  s_add_u32 s51, s49, 163840
  s_add_u32 m0, s45, 66560
  s_nop 0
  buffer_load_dwordx4 v226, s[24:27], s51 offen nt lds
  v_mfma_f32_32x32x16_bf16 a[16:31], v[212:215], v[152:155], a[16:31]
  s_add_u32 m0, s45, 67136
  s_nop 0
  buffer_load_dwordx4 v226, s[24:27], s51 offen offset:512 nt lds
  s_waitcnt lgkmcnt(4)
  v_mfma_f32_32x32x16_bf16 a[32:47], v[216:219], v[128:131], a[32:47]
  ds_read_b64_tr_b16 v[212:213], v225 offset:18048
  ds_read_b64_tr_b16 v[214:215], v225 offset:22400
  s_add_u32 m0, s45, 67712
  v_mfma_f32_32x32x16_bf16 a[48:63], v[216:219], v[144:147], a[48:63]
  buffer_load_dwordx4 v226, s[24:27], s51 offen offset:1024 nt lds
  s_add_u32 m0, s45, 68288
  s_waitcnt lgkmcnt(4)
  v_mfma_f32_32x32x16_bf16 a[32:47], v[220:223], v[136:139], a[32:47]
  ds_read_b64_tr_b16 v[216:217], v225 offset:17600
  ds_read_b64_tr_b16 v[218:219], v225 offset:21952
  buffer_load_dwordx4 v226, s[24:27], s51 offen offset:1536 nt lds
  v_mfma_f32_32x32x16_bf16 a[48:63], v[220:223], v[152:155], a[48:63]
  s_add_u32 s51, s49, 180224
  s_add_u32 m0, s47, 49920
  s_nop 0
  buffer_load_dwordx4 v226, s[20:23], s51 offen nt lds
  s_waitcnt lgkmcnt(4)
  v_mfma_f32_32x32x16_bf16 a[64:79], v[208:211], v[128:131], a[64:79]
  ds_read_b64_tr_b16 v[220:221], v225 offset:18112
  ds_read_b64_tr_b16 v[222:223], v225 offset:22464
  s_add_u32 m0, s47, 50448
  v_mfma_f32_32x32x16_bf16 a[80:95], v[208:211], v[144:147], a[80:95]
  buffer_load_dwordx4 v226, s[20:23], s51 offen offset:512 nt lds
  s_add_u32 m0, s47, 50976
  s_waitcnt lgkmcnt(4)
  v_mfma_f32_32x32x16_bf16 a[64:79], v[212:215], v[136:139], a[64:79]
  ds_read_b64_tr_b16 v[208:209], v225 offset:17664
  ds_read_b64_tr_b16 v[210:211], v225 offset:22016
  buffer_load_dwordx4 v226, s[20:23], s51 offen offset:1024 nt lds
  s_add_u32 m0, s47, 51504
  v_mfma_f32_32x32x16_bf16 a[80:95], v[212:215], v[152:155], a[80:95]
  buffer_load_dwordx4 v226, s[20:23], s51 offen offset:1536 nt lds
  v_max3_f32 v236, v160, v161, v162
  s_waitcnt lgkmcnt(4)
  v_mfma_f32_32x32x16_bf16 a[96:111], v[216:219], v[128:131], a[96:111]
  ds_read_b64_tr_b16 v[212:213], v225 offset:18176
  ds_read_b64_tr_b16 v[214:215], v225 offset:22528
  v_max3_f32 v236, v236, v163, v164
  v_max3_f32 v236, v236, v165, v166
  v_max3_f32 v236, v236, v167, v168
  v_mfma_f32_32x32x16_bf16 a[112:127], v[216:219], v[144:147], a[112:127]
  v_max3_f32 v236, v236, v169, v170
  v_max3_f32 v236, v236, v171, v172
  v_max3_f32 v236, v236, v173, v174
  v_max_f32 v236, v236, v175
  v_max3_f32 v237, v176, v177, v178
  s_waitcnt lgkmcnt(4)
  v_mfma_f32_32x32x16_bf16 a[96:111], v[220:223], v[136:139], a[96:111]
  ds_read_b64_tr_b16 v[216:217], v225 offset:17728
  ds_read_b64_tr_b16 v[218:219], v225 offset:22080
  v_max3_f32 v237, v237, v179, v180
  v_max3_f32 v237, v237, v181, v182
  v_max3_f32 v237, v237, v183, v184
  v_mfma_f32_32x32x16_bf16 a[112:127], v[220:223], v[152:155], a[112:127]
  v_max3_f32 v237, v237, v185, v186
  v_max3_f32 v237, v237, v187, v188
  v_max3_f32 v237, v237, v189, v190
  v_max_f32 v237, v237, v191
  s_waitcnt lgkmcnt(4)
  v_mfma_f32_32x32x16_bf16 a[128:143], v[208:211], v[128:131], a[128:143]
  ds_read_b64_tr_b16 v[220:221], v225 offset:18240
  ds_read_b64_tr_b16 v[222:223], v225 offset:22592
  v_mov_b32 v238, v236
  v_mov_b32 v239, v237
  s_nop 0
  v_permlane32_swap_b32 v236, v238
  v_mfma_f32_32x32x16_bf16 a[144:159], v[208:211], v[144:147], a[144:159]
  v_permlane32_swap_b32 v237, v239
  v_max_f32 v236, v236, v238
  v_max_f32 v237, v237, v239
  v_cmp_gt_f32 s[52:53], v236, v230
  v_cmp_gt_f32 s[54:55], v237, v231
  s_waitcnt lgkmcnt(4)
  v_mfma_f32_32x32x16_bf16 a[128:143], v[212:215], v[136:139], a[128:143]
  ds_read_b64_tr_b16 v[208:209], v225 offset:17792
  ds_read_b64_tr_b16 v[210:211], v225 offset:22144
  s_or_b64 s[52:53], s[52:53], s[54:55]
  s_cbranch_scc0 L_noslow13
  s_call_b64 s[58:59], L_slow
L_noslow13:
  v_fma_f32 v160, v160, s44, -v228
  v_mfma_f32_32x32x16_bf16 a[144:159], v[212:215], v[152:155], a[144:159]
  v_fma_f32 v161, v161, s44, -v228
  v_fma_f32 v162, v162, s44, -v228
  v_fma_f32 v163, v163, s44, -v228
  v_exp_f32 v160, v160
  s_waitcnt lgkmcnt(4)
  v_mfma_f32_32x32x16_bf16 a[160:175], v[216:219], v[128:131], a[160:175]
  ds_read_b64_tr_b16 v[212:213], v225 offset:18304
  ds_read_b64_tr_b16 v[214:215], v225 offset:22656
  v_exp_f32 v161, v161
  v_exp_f32 v162, v162
  v_mfma_f32_32x32x16_bf16 a[176:191], v[216:219], v[144:147], a[176:191]
  v_exp_f32 v163, v163
  v_add_f32 v232, v232, v160
  v_add_f32 v232, v232, v161
  s_waitcnt lgkmcnt(4)
  v_mfma_f32_32x32x16_bf16 a[160:175], v[220:223], v[136:139], a[160:175]
  ds_read_b64_tr_b16 v[216:217], v225 offset:17856
  ds_read_b64_tr_b16 v[218:219], v225 offset:22208
  v_add_f32 v232, v232, v162
  v_add_f32 v232, v232, v163
  v_cvt_pk_bf16_f32 v160, v160, v161
  v_mfma_f32_32x32x16_bf16 a[176:191], v[220:223], v[152:155], a[176:191]
  v_cvt_pk_bf16_f32 v161, v162, v163
  v_fma_f32 v164, v164, s44, -v228
  v_fma_f32 v165, v165, s44, -v228
  v_fma_f32 v166, v166, s44, -v228
  s_waitcnt lgkmcnt(4)
  v_mfma_f32_32x32x16_bf16 a[192:207], v[208:211], v[128:131], a[192:207]
  ds_read_b64_tr_b16 v[220:221], v225 offset:18368
  ds_read_b64_tr_b16 v[222:223], v225 offset:22720
  v_fma_f32 v167, v167, s44, -v228
  v_exp_f32 v164, v164
  v_mfma_f32_32x32x16_bf16 a[208:223], v[208:211], v[144:147], a[208:223]
  v_exp_f32 v165, v165
  v_exp_f32 v166, v166
  s_waitcnt lgkmcnt(4)
  v_mfma_f32_32x32x16_bf16 a[192:207], v[212:215], v[136:139], a[192:207]
  ds_read_b128 v[192:195], v224 offset:0
  v_exp_f32 v167, v167
  v_add_f32 v232, v232, v164
  v_add_f32 v232, v232, v165
  v_add_f32 v232, v232, v166
  v_mfma_f32_32x32x16_bf16 a[208:223], v[212:215], v[152:155], a[208:223]
  v_add_f32 v232, v232, v167
  v_cvt_pk_bf16_f32 v162, v164, v165
  v_cvt_pk_bf16_f32 v163, v166, v167
  v_fma_f32 v168, v168, s44, -v228
  s_waitcnt lgkmcnt(3)
  v_mfma_f32_32x32x16_bf16 a[224:239], v[216:219], v[128:131], a[224:239]
  ds_read_b128 v[196:199], v224 offset:32
  v_fma_f32 v169, v169, s44, -v228
  v_fma_f32 v170, v170, s44, -v228
  v_fma_f32 v171, v171, s44, -v228
  v_exp_f32 v168, v168
  v_mfma_f32_32x32x16_bf16 a[240:255], v[216:219], v[144:147], a[240:255]
  v_exp_f32 v169, v169
  v_exp_f32 v170, v170
  s_waitcnt lgkmcnt(2)
  v_mfma_f32_32x32x16_bf16 a[224:239], v[220:223], v[136:139], a[224:239]
  ds_read_b128 v[200:203], v224 offset:64
  v_exp_f32 v171, v171
  v_add_f32 v232, v232, v168
  v_mfma_f32_32x32x16_bf16 a[240:255], v[220:223], v[152:155], a[240:255]
  v_add_f32 v232, v232, v169
  v_add_f32 v232, v232, v170
  v_add_f32 v232, v232, v171
  v_cvt_pk_bf16_f32 v168, v168, v169
  v_cvt_pk_bf16_f32 v169, v170, v171
  s_waitcnt lgkmcnt(2)
  v_mfma_f32_32x32x16_bf16 v[128:143], v[192:195], v[0:3], 0
  ds_read_b128 v[204:207], v224 offset:96
  v_fma_f32 v172, v172, s44, -v228
  v_fma_f32 v173, v173, s44, -v228
  v_fma_f32 v174, v174, s44, -v228
  v_mfma_f32_32x32x16_bf16 v[144:159], v[192:195], v[64:67], 0
  v_fma_f32 v175, v175, s44, -v228
  v_exp_f32 v172, v172
  s_waitcnt lgkmcnt(2)
  v_mfma_f32_32x32x16_bf16 v[128:143], v[196:199], v[4:7], v[128:143]
  ds_read_b128 v[192:195], v224 offset:128
  v_exp_f32 v173, v173
  v_mfma_f32_32x32x16_bf16 v[144:159], v[196:199], v[68:71], v[144:159]
  v_exp_f32 v174, v174
  v_exp_f32 v175, v175
  s_waitcnt lgkmcnt(2)
  v_mfma_f32_32x32x16_bf16 v[128:143], v[200:203], v[8:11], v[128:143]
  ds_read_b128 v[196:199], v224 offset:160
  v_add_f32 v232, v232, v172
  v_add_f32 v232, v232, v173
  v_add_f32 v232, v232, v174
  v_mfma_f32_32x32x16_bf16 v[144:159], v[200:203], v[72:75], v[144:159]
  v_add_f32 v232, v232, v175
  v_cvt_pk_bf16_f32 v170, v172, v173
  v_cvt_pk_bf16_f32 v171, v174, v175
  s_waitcnt lgkmcnt(2)
  v_mfma_f32_32x32x16_bf16 v[128:143], v[204:207], v[12:15], v[128:143]
  ds_read_b128 v[200:203], v224 offset:192
  v_fma_f32 v176, v176, s44, -v229
  v_fma_f32 v177, v177, s44, -v229
  v_fma_f32 v178, v178, s44, -v229
  v_mfma_f32_32x32x16_bf16 v[144:159], v[204:207], v[76:79], v[144:159]
  v_fma_f32 v179, v179, s44, -v229
  v_exp_f32 v176, v176
  s_waitcnt lgkmcnt(2)
  v_mfma_f32_32x32x16_bf16 v[128:143], v[192:195], v[16:19], v[128:143]
  ds_read_b128 v[204:207], v224 offset:224
  v_exp_f32 v177, v177
  v_exp_f32 v178, v178
  v_mfma_f32_32x32x16_bf16 v[144:159], v[192:195], v[80:83], v[144:159]
  v_exp_f32 v179, v179
  s_waitcnt lgkmcnt(2)
  v_mfma_f32_32x32x16_bf16 v[128:143], v[196:199], v[20:23], v[128:143]
  ds_read_b128 v[192:195], v224 offset:256
  v_add_f32 v233, v233, v176
  v_add_f32 v233, v233, v177
  v_add_f32 v233, v233, v178
  v_mfma_f32_32x32x16_bf16 v[144:159], v[196:199], v[84:87], v[144:159]
  v_add_f32 v233, v233, v179
  v_cvt_pk_bf16_f32 v176, v176, v177
  v_cvt_pk_bf16_f32 v177, v178, v179
  s_waitcnt lgkmcnt(2)
  v_mfma_f32_32x32x16_bf16 v[128:143], v[200:203], v[24:27], v[128:143]
  ds_read_b128 v[196:199], v224 offset:288
  v_fma_f32 v180, v180, s44, -v229
  v_fma_f32 v181, v181, s44, -v229
  v_fma_f32 v182, v182, s44, -v229
  v_mfma_f32_32x32x16_bf16 v[144:159], v[200:203], v[88:91], v[144:159]
  v_fma_f32 v183, v183, s44, -v229
  v_exp_f32 v180, v180
  s_waitcnt lgkmcnt(2)
  v_mfma_f32_32x32x16_bf16 v[128:143], v[204:207], v[28:31], v[128:143]
  ds_read_b128 v[200:203], v224 offset:320
  v_exp_f32 v181, v181
  v_exp_f32 v182, v182
  v_mfma_f32_32x32x16_bf16 v[144:159], v[204:207], v[92:95], v[144:159]
  v_exp_f32 v183, v183
  v_add_f32 v233, v233, v180
  s_waitcnt lgkmcnt(2)
  v_mfma_f32_32x32x16_bf16 v[128:143], v[192:195], v[32:35], v[128:143]
  ds_read_b128 v[204:207], v224 offset:352
  v_add_f32 v233, v233, v181
  v_add_f32 v233, v233, v182
  v_mfma_f32_32x32x16_bf16 v[144:159], v[192:195], v[96:99], v[144:159]
  v_add_f32 v233, v233, v183
  v_cvt_pk_bf16_f32 v178, v180, v181
  v_cvt_pk_bf16_f32 v179, v182, v183
  v_fma_f32 v184, v184, s44, -v229
  s_waitcnt lgkmcnt(2)
  v_mfma_f32_32x32x16_bf16 v[128:143], v[196:199], v[36:39], v[128:143]
  ds_read_b128 v[192:195], v224 offset:384
  v_fma_f32 v185, v185, s44, -v229
  v_fma_f32 v186, v186, s44, -v229
  v_mfma_f32_32x32x16_bf16 v[144:159], v[196:199], v[100:103], v[144:159]
  v_fma_f32 v187, v187, s44, -v229
  v_exp_f32 v184, v184
  s_waitcnt lgkmcnt(2)
  v_mfma_f32_32x32x16_bf16 v[128:143], v[200:203], v[40:43], v[128:143]
  ds_read_b128 v[196:199], v224 offset:416
  v_exp_f32 v185, v185
  v_exp_f32 v186, v186
  v_mfma_f32_32x32x16_bf16 v[144:159], v[200:203], v[104:107], v[144:159]
  v_exp_f32 v187, v187
  v_add_f32 v233, v233, v184
  s_waitcnt lgkmcnt(2)
  v_mfma_f32_32x32x16_bf16 v[128:143], v[204:207], v[44:47], v[128:143]
  ds_read_b128 v[200:203], v224 offset:448
  v_add_f32 v233, v233, v185
  v_add_f32 v233, v233, v186
  v_add_f32 v233, v233, v187
  v_mfma_f32_32x32x16_bf16 v[144:159], v[204:207], v[108:111], v[144:159]
  v_cvt_pk_bf16_f32 v184, v184, v185
  v_cvt_pk_bf16_f32 v185, v186, v187
  v_fma_f32 v188, v188, s44, -v229
  s_waitcnt lgkmcnt(2)
  v_mfma_f32_32x32x16_bf16 v[128:143], v[192:195], v[48:51], v[128:143]
  ds_read_b128 v[204:207], v224 offset:480
  v_fma_f32 v189, v189, s44, -v229
  v_fma_f32 v190, v190, s44, -v229
  v_fma_f32 v191, v191, s44, -v229
  v_mfma_f32_32x32x16_bf16 v[144:159], v[192:195], v[112:115], v[144:159]
  v_exp_f32 v188, v188
  s_waitcnt lgkmcnt(2)
  v_mfma_f32_32x32x16_bf16 v[128:143], v[196:199], v[52:55], v[128:143]
  ds_read_b64_tr_b16 v[208:209], v225 offset:34816
  ds_read_b64_tr_b16 v[210:211], v225 offset:39168
  v_exp_f32 v189, v189
  v_exp_f32 v190, v190
  v_mfma_f32_32x32x16_bf16 v[144:159], v[196:199], v[116:119], v[144:159]
  v_exp_f32 v191, v191
  s_waitcnt lgkmcnt(3)
  v_mfma_f32_32x32x16_bf16 v[128:143], v[200:203], v[56:59], v[128:143]
  ds_read_b64_tr_b16 v[212:213], v225 offset:35328
  ds_read_b64_tr_b16 v[214:215], v225 offset:39680
  v_add_f32 v233, v233, v188
  v_add_f32 v233, v233, v189
  v_add_f32 v233, v233, v190
  v_mfma_f32_32x32x16_bf16 v[144:159], v[200:203], v[120:123], v[144:159]
  v_add_f32 v233, v233, v191
  v_cvt_pk_bf16_f32 v186, v188, v189
  v_cvt_pk_bf16_f32 v187, v190, v191
  s_waitcnt lgkmcnt(4)
  v_mfma_f32_32x32x16_bf16 v[128:143], v[204:207], v[60:63], v[128:143]
  ds_read_b64_tr_b16 v[216:217], v225 offset:34880
  ds_read_b64_tr_b16 v[218:219], v225 offset:39232
  v_mfma_f32_32x32x16_bf16 v[144:159], v[204:207], v[124:127], v[144:159]
  s_cmp_eq_u32 s56, 0
  s_cbranch_scc1 L_nores14
  s_call_b64 s[58:59], L_resc
L_nores14:
  s_waitcnt lgkmcnt(4)
  v_mfma_f32_32x32x16_bf16 a[0:15], v[208:211], v[160:163], a[0:15]
  ds_read_b64_tr_b16 v[220:221], v225 offset:35392
  ds_read_b64_tr_b16 v[222:223], v225 offset:39744
  v_mfma_f32_32x32x16_bf16 a[16:31], v[208:211], v[176:179], a[16:31]
  s_waitcnt vmcnt(16)
  s_barrier
  s_waitcnt lgkmcnt(4)
  v_mfma_f32_32x32x16_bf16 a[0:15], v[212:215], v[168:171], a[0:15]
  ds_read_b64_tr_b16 v[208:209], v225 offset:34944
  ds_read_b64_tr_b16 v[210:211], v225 offset:39296
  s_add_u32 s51, s49, 180224
  s_add_u32 m0, s45, 83968
  s_nop 0
  buffer_load_dwordx4 v226, s[24:27], s51 offen nt lds
  v_mfma_f32_32x32x16_bf16 a[16:31], v[212:215], v[184:187], a[16:31]
  s_add_u32 m0, s45, 84544
  s_nop 0
  buffer_load_dwordx4 v226, s[24:27], s51 offen offset:512 nt lds
  s_waitcnt lgkmcnt(4)
  v_mfma_f32_32x32x16_bf16 a[32:47], v[216:219], v[160:163], a[32:47]
  ds_read_b64_tr_b16 v[212:213], v225 offset:35456
  ds_read_b64_tr_b16 v[214:215], v225 offset:39808
  s_add_u32 m0, s45, 85120
  v_mfma_f32_32x32x16_bf16 a[48:63], v[216:219], v[176:179], a[48:63]
  buffer_load_dwordx4 v226, s[24:27], s51 offen offset:1024 nt lds
  s_add_u32 m0, s45, 85696
  s_waitcnt lgkmcnt(4)
  v_mfma_f32_32x32x16_bf16 a[32:47], v[220:223], v[168:171], a[32:47]
  ds_read_b64_tr_b16 v[216:217], v225 offset:35008
  ds_read_b64_tr_b16 v[218:219], v225 offset:39360
  buffer_load_dwordx4 v226, s[24:27], s51 offen offset:1536 nt lds
  v_mfma_f32_32x32x16_bf16 a[48:63], v[220:223], v[184:187], a[48:63]
  s_add_u32 s51, s49, 196608
  s_add_u32 m0, s47, 0
  s_nop 0
  buffer_load_dwordx4 v226, s[20:23], s51 offen nt lds
  s_waitcnt lgkmcnt(4)
  v_mfma_f32_32x32x16_bf16 a[64:79], v[208:211], v[160:163], a[64:79]
  ds_read_b64_tr_b16 v[220:221], v225 offset:35520
  ds_read_b64_tr_b16 v[222:223], v225 offset:39872
  s_add_u32 m0, s47, 528
  v_mfma_f32_32x32x16_bf16 a[80:95], v[208:211], v[176:179], a[80:95]
  buffer_load_dwordx4 v226, s[20:23], s51 offen offset:512 nt lds
  s_add_u32 m0, s47, 1056
  s_waitcnt lgkmcnt(4)
  v_mfma_f32_32x32x16_bf16 a[64:79], v[212:215], v[168:171], a[64:79]
  ds_read_b64_tr_b16 v[208:209], v225 offset:35072
  ds_read_b64_tr_b16 v[210:211], v225 offset:39424
  buffer_load_dwordx4 v226, s[20:23], s51 offen offset:1024 nt lds
  s_add_u32 m0, s47, 1584
  v_mfma_f32_32x32x16_bf16 a[80:95], v[212:215], v[184:187], a[80:95]
  buffer_load_dwordx4 v226, s[20:23], s51 offen offset:1536 nt lds
  v_max3_f32 v236, v128, v129, v130
  s_waitcnt lgkmcnt(4)
  v_mfma_f32_32x32x16_bf16 a[96:111], v[216:219], v[160:163], a[96:111]
  ds_read_b64_tr_b16 v[212:213], v225 offset:35584
  ds_read_b64_tr_b16 v[214:215], v225 offset:39936
  v_max3_f32 v236, v236, v131, v132
  v_max3_f32 v236, v236, v133, v134
  v_max3_f32 v236, v236, v135, v136
  v_mfma_f32_32x32x16_bf16 a[112:127], v[216:219], v[176:179], a[112:127]
  v_max3_f32 v236, v236, v137, v138
  v_max3_f32 v236, v236, v139, v140
  v_max3_f32 v236, v236, v141, v142
  v_max_f32 v236, v236, v143
  v_max3_f32 v237, v144, v145, v146
  s_waitcnt lgkmcnt(4)
  v_mfma_f32_32x32x16_bf16 a[96:111], v[220:223], v[168:171], a[96:111]
  ds_read_b64_tr_b16 v[216:217], v225 offset:35136
  ds_read_b64_tr_b16 v[218:219], v225 offset:39488
  v_max3_f32 v237, v237, v147, v148
  v_max3_f32 v237, v237, v149, v150
  v_max3_f32 v237, v237, v151, v152
  v_mfma_f32_32x32x16_bf16 a[112:127], v[220:223], v[184:187], a[112:127]
  v_max3_f32 v237, v237, v153, v154
  v_max3_f32 v237, v237, v155, v156
  v_max3_f32 v237, v237, v157, v158
  v_max_f32 v237, v237, v159
  s_waitcnt lgkmcnt(4)
  v_mfma_f32_32x32x16_bf16 a[128:143], v[208:211], v[160:163], a[128:143]
  ds_read_b64_tr_b16 v[220:221], v225 offset:35648
  ds_read_b64_tr_b16 v[222:223], v225 offset:40000
  v_mov_b32 v238, v236
  v_mov_b32 v239, v237
  s_nop 0
  v_permlane32_swap_b32 v236, v238
  v_mfma_f32_32x32x16_bf16 a[144:159], v[208:211], v[176:179], a[144:159]
  v_permlane32_swap_b32 v237, v239
  v_max_f32 v236, v236, v238
  v_max_f32 v237, v237, v239
  v_cmp_gt_f32 s[52:53], v236, v230
  v_cmp_gt_f32 s[54:55], v237, v231
  s_waitcnt lgkmcnt(4)
  v_mfma_f32_32x32x16_bf16 a[128:143], v[212:215], v[168:171], a[128:143]
  ds_read_b64_tr_b16 v[208:209], v225 offset:35200
  ds_read_b64_tr_b16 v[210:211], v225 offset:39552
  s_or_b64 s[52:53], s[52:53], s[54:55]
  s_cbranch_scc0 L_noslow15
  s_call_b64 s[58:59], L_slow
L_noslow15:
  v_fma_f32 v128, v128, s44, -v228
  v_mfma_f32_32x32x16_bf16 a[144:159], v[212:215], v[184:187], a[144:159]
  v_fma_f32 v129, v129, s44, -v228
  v_fma_f32 v130, v130, s44, -v228
  v_fma_f32 v131, v131, s44, -v228
  v_exp_f32 v128, v128
  s_waitcnt lgkmcnt(4)
  v_mfma_f32_32x32x16_bf16 a[160:175], v[216:219], v[160:163], a[160:175]
  ds_read_b64_tr_b16 v[212:213], v225 offset:35712
  ds_read_b64_tr_b16 v[214:215], v225 offset:40064
  v_exp_f32 v129, v129
  v_exp_f32 v130, v130
  v_mfma_f32_32x32x16_bf16 a[176:191], v[216:219], v[176:179], a[176:191]
  v_exp_f32 v131, v131
  v_add_f32 v232, v232, v128
  v_add_f32 v232, v232, v129
  s_waitcnt lgkmcnt(4)
  v_mfma_f32_32x32x16_bf16 a[160:175], v[220:223], v[168:171], a[160:175]
  ds_read_b64_tr_b16 v[216:217], v225 offset:35264
  ds_read_b64_tr_b16 v[218:219], v225 offset:39616
  v_add_f32 v232, v232, v130
  v_add_f32 v232, v232, v131
  v_cvt_pk_bf16_f32 v128, v128, v129
  v_mfma_f32_32x32x16_bf16 a[176:191], v[220:223], v[184:187], a[176:191]
  v_cvt_pk_bf16_f32 v129, v130, v131
  v_fma_f32 v132, v132, s44, -v228
  v_fma_f32 v133, v133, s44, -v228
  v_fma_f32 v134, v134, s44, -v228
  s_waitcnt lgkmcnt(4)
  v_mfma_f32_32x32x16_bf16 a[192:207], v[208:211], v[160:163], a[192:207]
  ds_read_b64_tr_b16 v[220:221], v225 offset:35776
  ds_read_b64_tr_b16 v[222:223], v225 offset:40128
  v_fma_f32 v135, v135, s44, -v228
  v_exp_f32 v132, v132
  v_mfma_f32_32x32x16_bf16 a[208:223], v[208:211], v[176:179], a[208:223]
  v_exp_f32 v133, v133
  v_exp_f32 v134, v134
  s_waitcnt lgkmcnt(4)
  v_mfma_f32_32x32x16_bf16 a[192:207], v[212:215], v[168:171], a[192:207]
  ds_read_b128 v[192:195], v224 offset:16640
  v_exp_f32 v135, v135
  v_add_f32 v232, v232, v132
  v_add_f32 v232, v232, v133
  v_add_f32 v232, v232, v134
  v_mfma_f32_32x32x16_bf16 a[208:223], v[212:215], v[184:187], a[208:223]
  v_add_f32 v232, v232, v135
  v_cvt_pk_bf16_f32 v130, v132, v133
  v_cvt_pk_bf16_f32 v131, v134, v135
  v_fma_f32 v136, v136, s44, -v228
  s_waitcnt lgkmcnt(3)
  v_mfma_f32_32x32x16_bf16 a[224:239], v[216:219], v[160:163], a[224:239]
  ds_read_b128 v[196:199], v224 offset:16672
  v_fma_f32 v137, v137, s44, -v228
  v_fma_f32 v138, v138, s44, -v228
  v_fma_f32 v139, v139, s44, -v228
  v_exp_f32 v136, v136
  v_mfma_f32_32x32x16_bf16 a[240:255], v[216:219], v[176:179], a[240:255]
  v_exp_f32 v137, v137
  v_exp_f32 v138, v138
  s_waitcnt lgkmcnt(2)
  v_mfma_f32_32x32x16_bf16 a[224:239], v[220:223], v[168:171], a[224:239]
  ds_read_b128 v[200:203], v224 offset:16704
  v_exp_f32 v139, v139
  v_add_f32 v232, v232, v136
  v_mfma_f32_32x32x16_bf16 a[240:255], v[220:223], v[184:187], a[240:255]
  v_add_f32 v232, v232, v137
  v_add_f32 v232, v232, v138
  v_add_f32 v232, v232, v139
  v_cvt_pk_bf16_f32 v136, v136, v137
  v_cvt_pk_bf16_f32 v137, v138, v139
  s_waitcnt lgkmcnt(2)
  v_mfma_f32_32x32x16_bf16 v[160:175], v[192:195], v[0:3], 0
  ds_read_b128 v[204:207], v224 offset:16736
  v_fma_f32 v140, v140, s44, -v228
  v_fma_f32 v141, v141, s44, -v228
  v_fma_f32 v142, v142, s44, -v228
  v_mfma_f32_32x32x16_bf16 v[176:191], v[192:195], v[64:67], 0
  v_fma_f32 v143, v143, s44, -v228
  v_exp_f32 v140, v140
  s_waitcnt lgkmcnt(2)
  v_mfma_f32_32x32x16_bf16 v[160:175], v[196:199], v[4:7], v[160:175]
  ds_read_b128 v[192:195], v224 offset:16768
  v_exp_f32 v141, v141
  v_mfma_f32_32x32x16_bf16 v[176:191], v[196:199], v[68:71], v[176:191]
  v_exp_f32 v142, v142
  v_exp_f32 v143, v143
  s_waitcnt lgkmcnt(2)
  v_mfma_f32_32x32x16_bf16 v[160:175], v[200:203], v[8:11], v[160:175]
  ds_read_b128 v[196:199], v224 offset:16800
  v_add_f32 v232, v232, v140
  v_add_f32 v232, v232, v141
  v_add_f32 v232, v232, v142
  v_mfma_f32_32x32x16_bf16 v[176:191], v[200:203], v[72:75], v[176:191]
  v_add_f32 v232, v232, v143
  v_cvt_pk_bf16_f32 v138, v140, v141
  v_cvt_pk_bf16_f32 v139, v142, v143
  s_waitcnt lgkmcnt(2)
  v_mfma_f32_32x32x16_bf16 v[160:175], v[204:207], v[12:15], v[160:175]
  ds_read_b128 v[200:203], v224 offset:16832
  v_fma_f32 v144, v144, s44, -v229
  v_fma_f32 v145, v145, s44, -v229
  v_fma_f32 v146, v146, s44, -v229
  v_mfma_f32_32x32x16_bf16 v[176:191], v[204:207], v[76:79], v[176:191]
  v_fma_f32 v147, v147, s44, -v229
  v_exp_f32 v144, v144
  s_waitcnt lgkmcnt(2)
  v_mfma_f32_32x32x16_bf16 v[160:175], v[192:195], v[16:19], v[160:175]
  ds_read_b128 v[204:207], v224 offset:16864
  v_exp_f32 v145, v145
  v_exp_f32 v146, v146
  v_mfma_f32_32x32x16_bf16 v[176:191], v[192:195], v[80:83], v[176:191]
  v_exp_f32 v147, v147
  s_waitcnt lgkmcnt(2)
  v_mfma_f32_32x32x16_bf16 v[160:175], v[196:199], v[20:23], v[160:175]
  ds_read_b128 v[192:195], v224 offset:16896
  v_add_f32 v233, v233, v144
  v_add_f32 v233, v233, v145
  v_add_f32 v233, v233, v146
  v_mfma_f32_32x32x16_bf16 v[176:191], v[196:199], v[84:87], v[176:191]
  v_add_f32 v233, v233, v147
  v_cvt_pk_bf16_f32 v144, v144, v145
  v_cvt_pk_bf16_f32 v145, v146, v147
  s_waitcnt lgkmcnt(2)
  v_mfma_f32_32x32x16_bf16 v[160:175], v[200:203], v[24:27], v[160:175]
  ds_read_b128 v[196:199], v224 offset:16928
  v_fma_f32 v148, v148, s44, -v229
  v_fma_f32 v149, v149, s44, -v229
  v_fma_f32 v150, v150, s44, -v229
  v_mfma_f32_32x32x16_bf16 v[176:191], v[200:203], v[88:91], v[176:191]
  v_fma_f32 v151, v151, s44, -v229
  v_exp_f32 v148, v148
  s_waitcnt lgkmcnt(2)
  v_mfma_f32_32x32x16_bf16 v[160:175], v[204:207], v[28:31], v[160:175]
  ds_read_b128 v[200:203], v224 offset:16960
  v_exp_f32 v149, v149
  v_exp_f32 v150, v150
  v_mfma_f32_32x32x16_bf16 v[176:191], v[204:207], v[92:95], v[176:191]
  v_exp_f32 v151, v151
  v_add_f32 v233, v233, v148
  s_waitcnt lgkmcnt(2)
  v_mfma_f32_32x32x16_bf16 v[160:175], v[192:195], v[32:35], v[160:175]
  ds_read_b128 v[204:207], v224 offset:16992
  v_add_f32 v233, v233, v149
  v_add_f32 v233, v233, v150
  v_mfma_f32_32x32x16_bf16 v[176:191], v[192:195], v[96:99], v[176:191]
  v_add_f32 v233, v233, v151
  v_cvt_pk_bf16_f32 v146, v148, v149
  v_cvt_pk_bf16_f32 v147, v150, v151
  v_fma_f32 v152, v152, s44, -v229
  s_waitcnt lgkmcnt(2)
  v_mfma_f32_32x32x16_bf16 v[160:175], v[196:199], v[36:39], v[160:175]
  ds_read_b128 v[192:195], v224 offset:17024
  v_fma_f32 v153, v153, s44, -v229
  v_fma_f32 v154, v154, s44, -v229
  v_mfma_f32_32x32x16_bf16 v[176:191], v[196:199], v[100:103], v[176:191]
  v_fma_f32 v155, v155, s44, -v229
  v_exp_f32 v152, v152
  s_waitcnt lgkmcnt(2)
  v_mfma_f32_32x32x16_bf16 v[160:175], v[200:203], v[40:43], v[160:175]
  ds_read_b128 v[196:199], v224 offset:17056
  v_exp_f32 v153, v153
  v_exp_f32 v154, v154
  v_mfma_f32_32x32x16_bf16 v[176:191], v[200:203], v[104:107], v[176:191]
  v_exp_f32 v155, v155
  v_add_f32 v233, v233, v152
  s_waitcnt lgkmcnt(2)
  v_mfma_f32_32x32x16_bf16 v[160:175], v[204:207], v[44:47], v[160:175]
  ds_read_b128 v[200:203], v224 offset:17088
  v_add_f32 v233, v233, v153
  v_add_f32 v233, v233, v154
  v_add_f32 v233, v233, v155
  v_mfma_f32_32x32x16_bf16 v[176:191], v[204:207], v[108:111], v[176:191]
  v_cvt_pk_bf16_f32 v152, v152, v153
  v_cvt_pk_bf16_f32 v153, v154, v155
  v_fma_f32 v156, v156, s44, -v229
  s_waitcnt lgkmcnt(2)
  v_mfma_f32_32x32x16_bf16 v[160:175], v[192:195], v[48:51], v[160:175]
  ds_read_b128 v[204:207], v224 offset:17120
  v_fma_f32 v157, v157, s44, -v229
  v_fma_f32 v158, v158, s44, -v229
  v_fma_f32 v159, v159, s44, -v229
  v_mfma_f32_32x32x16_bf16 v[176:191], v[192:195], v[112:115], v[176:191]
  v_exp_f32 v156, v156
  s_waitcnt lgkmcnt(2)
  v_mfma_f32_32x32x16_bf16 v[160:175], v[196:199], v[52:55], v[160:175]
  ds_read_b64_tr_b16 v[208:209], v225 offset:52224
  ds_read_b64_tr_b16 v[210:211], v225 offset:56576
  v_exp_f32 v157, v157
  v_exp_f32 v158, v158
  v_mfma_f32_32x32x16_bf16 v[176:191], v[196:199], v[116:119], v[176:191]
  v_exp_f32 v159, v159
  s_waitcnt lgkmcnt(3)
  v_mfma_f32_32x32x16_bf16 v[160:175], v[200:203], v[56:59], v[160:175]
  ds_read_b64_tr_b16 v[212:213], v225 offset:52736
  ds_read_b64_tr_b16 v[214:215], v225 offset:57088
  v_add_f32 v233, v233, v156
  v_add_f32 v233, v233, v157
  v_add_f32 v233, v233, v158
  v_mfma_f32_32x32x16_bf16 v[176:191], v[200:203], v[120:123], v[176:191]
  v_add_f32 v233, v233, v159
  v_cvt_pk_bf16_f32 v154, v156, v157
  v_cvt_pk_bf16_f32 v155, v158, v159
  s_waitcnt lgkmcnt(4)
  v_mfma_f32_32x32x16_bf16 v[160:175], v[204:207], v[60:63], v[160:175]
  ds_read_b64_tr_b16 v[216:217], v225 offset:52288
  ds_read_b64_tr_b16 v[218:219], v225 offset:56640
  v_mfma_f32_32x32x16_bf16 v[176:191], v[204:207], v[124:127], v[176:191]
  s_cmp_eq_u32 s56, 0
  s_cbranch_scc1 L_nores16
  s_call_b64 s[58:59], L_resc
L_nores16:
  s_waitcnt lgkmcnt(4)
  v_mfma_f32_32x32x16_bf16 a[0:15], v[208:211], v[128:131], a[0:15]
  ds_read_b64_tr_b16 v[220:221], v225 offset:52800
  ds_read_b64_tr_b16 v[222:223], v225 offset:57152
  v_mfma_f32_32x32x16_bf16 a[16:31], v[208:211], v[144:147], a[16:31]
  s_waitcnt vmcnt(16)
  s_barrier
  s_waitcnt lgkmcnt(4)
  v_mfma_f32_32x32x16_bf16 a[0:15], v[212:215], v[136:139], a[0:15]
  ds_read_b64_tr_b16 v[208:209], v225 offset:52352
  ds_read_b64_tr_b16 v[210:211], v225 offset:56704
  s_add_u32 s51, s49, 196608
  s_add_u32 m0, s45, 101376
  s_nop 0
  buffer_load_dwordx4 v226, s[24:27], s51 offen nt lds
  v_mfma_f32_32x32x16_bf16 a[16:31], v[212:215], v[152:155], a[16:31]
  s_add_u32 m0, s45, 101952
  s_nop 0
  buffer_load_dwordx4 v226, s[24:27], s51 offen offset:512 nt lds
  s_waitcnt lgkmcnt(4)
  v_mfma_f32_32x32x16_bf16 a[32:47], v[216:219], v[128:131], a[32:47]
  ds_read_b64_tr_b16 v[212:213], v225 offset:52864
  ds_read_b64_tr_b16 v[214:215], v225 offset:57216
  s_add_u32 m0, s45, 102528
  v_mfma_f32_32x32x16_bf16 a[48:63], v[216:219], v[144:147], a[48:63]
  buffer_load_dwordx4 v226, s[24:27], s51 offen offset:1024 nt lds
  s_add_u32 m0, s45, 103104
  s_waitcnt lgkmcnt(4)
  v_mfma_f32_32x32x16_bf16 a[32:47], v[220:223], v[136:139], a[32:47]
  ds_read_b64_tr_b16 v[216:217], v225 offset:52416
  ds_read_b64_tr_b16 v[218:219], v225 offset:56768
  buffer_load_dwordx4 v226, s[24:27], s51 offen offset:1536 nt lds
  v_mfma_f32_32x32x16_bf16 a[48:63], v[220:223], v[152:155], a[48:63]
  s_add_u32 s51, s49, 212992
  s_add_u32 m0, s47, 16640
  s_nop 0
  buffer_load_dwordx4 v226, s[20:23], s51 offen nt lds
  s_waitcnt lgkmcnt(4)
  v_mfma_f32_32x32x16_bf16 a[64:79], v[208:211], v[128:131], a[64:79]
  ds_read_b64_tr_b16 v[220:221], v225 offset:52928
  ds_read_b64_tr_b16 v[222:223], v225 offset:57280
  s_add_u32 m0, s47, 17168
  v_mfma_f32_32x32x16_bf16 a[80:95], v[208:211], v[144:147], a[80:95]
  buffer_load_dwordx4 v226, s[20:23], s51 offen offset:512 nt lds
  s_add_u32 m0, s47, 17696
  s_waitcnt lgkmcnt(4)
  v_mfma_f32_32x32x16_bf16 a[64:79], v[212:215], v[136:139], a[64:79]
  ds_read_b64_tr_b16 v[208:209], v225 offset:52480
  ds_read_b64_tr_b16 v[210:211], v225 offset:56832
  buffer_load_dwordx4 v226, s[20:23], s51 offen offset:1024 nt lds
  s_add_u32 m0, s47, 18224
  v_mfma_f32_32x32x16_bf16 a[80:95], v[212:215], v[152:155], a[80:95]
  buffer_load_dwordx4 v226, s[20:23], s51 offen offset:1536 nt lds
  v_max3_f32 v236, v160, v161, v162
  s_waitcnt lgkmcnt(4)
  v_mfma_f32_32x32x16_bf16 a[96:111], v[216:219], v[128:131], a[96:111]
  ds_read_b64_tr_b16 v[212:213], v225 offset:52992
  ds_read_b64_tr_b16 v[214:215], v225 offset:57344
  v_max3_f32 v236, v236, v163, v164
  v_max3_f32 v236, v236, v165, v166
  v_max3_f32 v236, v236, v167, v168
  v_mfma_f32_32x32x16_bf16 a[112:127], v[216:219], v[144:147], a[112:127]
  v_max3_f32 v236, v236, v169, v170
  v_max3_f32 v236, v236, v171, v172
  v_max3_f32 v236, v236, v173, v174
  v_max_f32 v236, v236, v175
  v_max3_f32 v237, v176, v177, v178
  s_waitcnt lgkmcnt(4)
  v_mfma_f32_32x32x16_bf16 a[96:111], v[220:223], v[136:139], a[96:111]
  ds_read_b64_tr_b16 v[216:217], v225 offset:52544
  ds_read_b64_tr_b16 v[218:219], v225 offset:56896
  v_max3_f32 v237, v237, v179, v180
  v_max3_f32 v237, v237, v181, v182
  v_max3_f32 v237, v237, v183, v184
  v_mfma_f32_32x32x16_bf16 a[112:127], v[220:223], v[152:155], a[112:127]
  v_max3_f32 v237, v237, v185, v186
  v_max3_f32 v237, v237, v187, v188
  v_max3_f32 v237, v237, v189, v190
  v_max_f32 v237, v237, v191
  s_waitcnt lgkmcnt(4)
  v_mfma_f32_32x32x16_bf16 a[128:143], v[208:211], v[128:131], a[128:143]
  ds_read_b64_tr_b16 v[220:221], v225 offset:53056
  ds_read_b64_tr_b16 v[222:223], v225 offset:57408
  v_mov_b32 v238, v236
  v_mov_b32 v239, v237
  s_nop 0
  v_permlane32_swap_b32 v236, v238
  v_mfma_f32_32x32x16_bf16 a[144:159], v[208:211], v[144:147], a[144:159]
  v_permlane32_swap_b32 v237, v239
  v_max_f32 v236, v236, v238
  v_max_f32 v237, v237, v239
  v_cmp_gt_f32 s[52:53], v236, v230
  v_cmp_gt_f32 s[54:55], v237, v231
  s_waitcnt lgkmcnt(4)
  v_mfma_f32_32x32x16_bf16 a[128:143], v[212:215], v[136:139], a[128:143]
  ds_read_b64_tr_b16 v[208:209], v225 offset:52608
  ds_read_b64_tr_b16 v[210:211], v225 offset:56960
  s_or_b64 s[52:53], s[52:53], s[54:55]
  s_cbranch_scc0 L_noslow17
  s_call_b64 s[58:59], L_slow
L_noslow17:
  v_fma_f32 v160, v160, s44, -v228
  v_mfma_f32_32x32x16_bf16 a[144:159], v[212:215], v[152:155], a[144:159]
  v_fma_f32 v161, v161, s44, -v228
  v_fma_f32 v162, v162, s44, -v228
  v_fma_f32 v163, v163, s44, -v228
  v_exp_f32 v160, v160
  s_waitcnt lgkmcnt(4)
  v_mfma_f32_32x32x16_bf16 a[160:175], v[216:219], v[128:131], a[160:175]
  ds_read_b64_tr_b16 v[212:213], v225 offset:53120
  ds_read_b64_tr_b16 v[214:215], v225 offset:57472
  v_exp_f32 v161, v161
  v_exp_f32 v162, v162
  v_mfma_f32_32x32x16_bf16 a[176:191], v[216:219], v[144:147], a[176:191]
  v_exp_f32 v163, v163
  v_add_f32 v232, v232, v160
  v_add_f32 v232, v232, v161
  s_waitcnt lgkmcnt(4)
  v_mfma_f32_32x32x16_bf16 a[160:175], v[220:223], v[136:139], a[160:175]
  ds_read_b64_tr_b16 v[216:217], v225 offset:52672
  ds_read_b64_tr_b16 v[218:219], v225 offset:57024
  v_add_f32 v232, v232, v162
  v_add_f32 v232, v232, v163
  v_cvt_pk_bf16_f32 v160, v160, v161
  v_mfma_f32_32x32x16_bf16 a[176:191], v[220:223], v[152:155], a[176:191]
  v_cvt_pk_bf16_f32 v161, v162, v163
  v_fma_f32 v164, v164, s44, -v228
  v_fma_f32 v165, v165, s44, -v228
  v_fma_f32 v166, v166, s44, -v228
  s_waitcnt lgkmcnt(4)
  v_mfma_f32_32x32x16_bf16 a[192:207], v[208:211], v[128:131], a[192:207]
  ds_read_b64_tr_b16 v[220:221], v225 offset:53184
  ds_read_b64_tr_b16 v[222:223], v225 offset:57536
  v_fma_f32 v167, v167, s44, -v228
  v_exp_f32 v164, v164
  v_mfma_f32_32x32x16_bf16 a[208:223], v[208:211], v[144:147], a[208:223]
  v_exp_f32 v165, v165
  v_exp_f32 v166, v166
  s_waitcnt lgkmcnt(4)
  v_mfma_f32_32x32x16_bf16 a[192:207], v[212:215], v[136:139], a[192:207]
  ds_read_b128 v[192:195], v224 offset:33280
  v_exp_f32 v167, v167
  v_add_f32 v232, v232, v164
  v_add_f32 v232, v232, v165
  v_add_f32 v232, v232, v166
  v_mfma_f32_32x32x16_bf16 a[208:223], v[212:215], v[152:155], a[208:223]
  v_add_f32 v232, v232, v167
  v_cvt_pk_bf16_f32 v162, v164, v165
  v_cvt_pk_bf16_f32 v163, v166, v167
  v_fma_f32 v168, v168, s44, -v228
  s_waitcnt lgkmcnt(3)
  v_mfma_f32_32x32x16_bf16 a[224:239], v[216:219], v[128:131], a[224:239]
  ds_read_b128 v[196:199], v224 offset:33312
  v_fma_f32 v169, v169, s44, -v228
  v_fma_f32 v170, v170, s44, -v228
  v_fma_f32 v171, v171, s44, -v228
  v_exp_f32 v168, v168
  v_mfma_f32_32x32x16_bf16 a[240:255], v[216:219], v[144:147], a[240:255]
  v_exp_f32 v169, v169
  v_exp_f32 v170, v170
  s_waitcnt lgkmcnt(2)
  v_mfma_f32_32x32x16_bf16 a[224:239], v[220:223], v[136:139], a[224:239]
  ds_read_b128 v[200:203], v224 offset:33344
  v_exp_f32 v171, v171
  v_add_f32 v232, v232, v168
  v_mfma_f32_32x32x16_bf16 a[240:255], v[220:223], v[152:155], a[240:255]
  v_add_f32 v232, v232, v169
  v_add_f32 v232, v232, v170
  v_add_f32 v232, v232, v171
  v_cvt_pk_bf16_f32 v168, v168, v169
  v_cvt_pk_bf16_f32 v169, v170, v171
  s_waitcnt lgkmcnt(2)
  v_mfma_f32_32x32x16_bf16 v[128:143], v[192:195], v[0:3], 0
  ds_read_b128 v[204:207], v224 offset:33376
  v_fma_f32 v172, v172, s44, -v228
  v_fma_f32 v173, v173, s44, -v228
  v_fma_f32 v174, v174, s44, -v228
  v_mfma_f32_32x32x16_bf16 v[144:159], v[192:195], v[64:67], 0
  v_fma_f32 v175, v175, s44, -v228
  v_exp_f32 v172, v172
  s_waitcnt lgkmcnt(2)
  v_mfma_f32_32x32x16_bf16 v[128:143], v[196:199], v[4:7], v[128:143]
  ds_read_b128 v[192:195], v224 offset:33408
  v_exp_f32 v173, v173
  v_mfma_f32_32x32x16_bf16 v[144:159], v[196:199], v[68:71], v[144:159]
  v_exp_f32 v174, v174
  v_exp_f32 v175, v175
  s_waitcnt lgkmcnt(2)
  v_mfma_f32_32x32x16_bf16 v[128:143], v[200:203], v[8:11], v[128:143]
  ds_read_b128 v[196:199], v224 offset:33440
  v_add_f32 v232, v232, v172
  v_add_f32 v232, v232, v173
  v_add_f32 v232, v232, v174
  v_mfma_f32_32x32x16_bf16 v[144:159], v[200:203], v[72:75], v[144:159]
  v_add_f32 v232, v232, v175
  v_cvt_pk_bf16_f32 v170, v172, v173
  v_cvt_pk_bf16_f32 v171, v174, v175
  s_waitcnt lgkmcnt(2)
  v_mfma_f32_32x32x16_bf16 v[128:143], v[204:207], v[12:15], v[128:143]
  ds_read_b128 v[200:203], v224 offset:33472
  v_fma_f32 v176, v176, s44, -v229
  v_fma_f32 v177, v177, s44, -v229
  v_fma_f32 v178, v178, s44, -v229
  v_mfma_f32_32x32x16_bf16 v[144:159], v[204:207], v[76:79], v[144:159]
  v_fma_f32 v179, v179, s44, -v229
  v_exp_f32 v176, v176
  s_waitcnt lgkmcnt(2)
  v_mfma_f32_32x32x16_bf16 v[128:143], v[192:195], v[16:19], v[128:143]
  ds_read_b128 v[204:207], v224 offset:33504
  v_exp_f32 v177, v177
  v_exp_f32 v178, v178
  v_mfma_f32_32x32x16_bf16 v[144:159], v[192:195], v[80:83], v[144:159]
  v_exp_f32 v179, v179
  s_waitcnt lgkmcnt(2)
  v_mfma_f32_32x32x16_bf16 v[128:143], v[196:199], v[20:23], v[128:143]
  ds_read_b128 v[192:195], v224 offset:33536
  v_add_f32 v233, v233, v176
  v_add_f32 v233, v233, v177
  v_add_f32 v233, v233, v178
  v_mfma_f32_32x32x16_bf16 v[144:159], v[196:199], v[84:87], v[144:159]
  v_add_f32 v233, v233, v179
  v_cvt_pk_bf16_f32 v176, v176, v177
  v_cvt_pk_bf16_f32 v177, v178, v179
  s_waitcnt lgkmcnt(2)
  v_mfma_f32_32x32x16_bf16 v[128:143], v[200:203], v[24:27], v[128:143]
  ds_read_b128 v[196:199], v224 offset:33568
  v_fma_f32 v180, v180, s44, -v229
  v_fma_f32 v181, v181, s44, -v229
  v_fma_f32 v182, v182, s44, -v229
  v_mfma_f32_32x32x16_bf16 v[144:159], v[200:203], v[88:91], v[144:159]
  v_fma_f32 v183, v183, s44, -v229
  v_exp_f32 v180, v180
  s_waitcnt lgkmcnt(2)
  v_mfma_f32_32x32x16_bf16 v[128:143], v[204:207], v[28:31], v[128:143]
  ds_read_b128 v[200:203], v224 offset:33600
  v_exp_f32 v181, v181
  v_exp_f32 v182, v182
  v_mfma_f32_32x32x16_bf16 v[144:159], v[204:207], v[92:95], v[144:159]
  v_exp_f32 v183, v183
  v_add_f32 v233, v233, v180
  s_waitcnt lgkmcnt(2)
  v_mfma_f32_32x32x16_bf16 v[128:143], v[192:195], v[32:35], v[128:143]
  ds_read_b128 v[204:207], v224 offset:33632
  v_add_f32 v233, v233, v181
  v_add_f32 v233, v233, v182
  v_mfma_f32_32x32x16_bf16 v[144:159], v[192:195], v[96:99], v[144:159]
  v_add_f32 v233, v233, v183
  v_cvt_pk_bf16_f32 v178, v180, v181
  v_cvt_pk_bf16_f32 v179, v182, v183
  v_fma_f32 v184, v184, s44, -v229
  s_waitcnt lgkmcnt(2)
  v_mfma_f32_32x32x16_bf16 v[128:143], v[196:199], v[36:39], v[128:143]
  ds_read_b128 v[192:195], v224 offset:33664
  v_fma_f32 v185, v185, s44, -v229
  v_fma_f32 v186, v186, s44, -v229
  v_mfma_f32_32x32x16_bf16 v[144:159], v[196:199], v[100:103], v[144:159]
  v_fma_f32 v187, v187, s44, -v229
  v_exp_f32 v184, v184
  s_waitcnt lgkmcnt(2)
  v_mfma_f32_32x32x16_bf16 v[128:143], v[200:203], v[40:43], v[128:143]
  ds_read_b128 v[196:199], v224 offset:33696
  v_exp_f32 v185, v185
  v_exp_f32 v186, v186
  v_mfma_f32_32x32x16_bf16 v[144:159], v[200:203], v[104:107], v[144:159]
  v_exp_f32 v187, v187
  v_add_f32 v233, v233, v184
  s_waitcnt lgkmcnt(2)
  v_mfma_f32_32x32x16_bf16 v[128:143], v[204:207], v[44:47], v[128:143]
  ds_read_b128 v[200:203], v224 offset:33728
  v_add_f32 v233, v233, v185
  v_add_f32 v233, v233, v186
  v_add_f32 v233, v233, v187
  v_mfma_f32_32x32x16_bf16 v[144:159], v[204:207], v[108:111], v[144:159]
  v_cvt_pk_bf16_f32 v184, v184, v185
  v_cvt_pk_bf16_f32 v185, v186, v187
  v_fma_f32 v188, v188, s44, -v229
  s_waitcnt lgkmcnt(2)
  v_mfma_f32_32x32x16_bf16 v[128:143], v[192:195], v[48:51], v[128:143]
  ds_read_b128 v[204:207], v224 offset:33760
  v_fma_f32 v189, v189, s44, -v229
  v_fma_f32 v190, v190, s44, -v229
  v_fma_f32 v191, v191, s44, -v229
  v_mfma_f32_32x32x16_bf16 v[144:159], v[192:195], v[112:115], v[144:159]
  v_exp_f32 v188, v188
  s_waitcnt lgkmcnt(2)
  v_mfma_f32_32x32x16_bf16 v[128:143], v[196:199], v[52:55], v[128:143]
  ds_read_b64_tr_b16 v[208:209], v250 offset:0
  ds_read_b64_tr_b16 v[210:211], v250 offset:4352
  v_exp_f32 v189, v189
  v_exp_f32 v190, v190
  v_mfma_f32_32x32x16_bf16 v[144:159], v[196:199], v[116:119], v[144:159]
  v_exp_f32 v191, v191
  s_waitcnt lgkmcnt(3)
  v_mfma_f32_32x32x16_bf16 v[128:143], v[200:203], v[56:59], v[128:143]
  ds_read_b64_tr_b16 v[212:213], v250 offset:512
  ds_read_b64_tr_b16 v[214:215], v250 offset:4864
  v_add_f32 v233, v233, v188
  v_add_f32 v233, v233, v189
  v_add_f32 v233, v233, v190
  v_mfma_f32_32x32x16_bf16 v[144:159], v[200:203], v[120:123], v[144:159]
  v_add_f32 v233, v233, v191
  v_cvt_pk_bf16_f32 v186, v188, v189
  v_cvt_pk_bf16_f32 v187, v190, v191
  s_waitcnt lgkmcnt(4)
  v_mfma_f32_32x32x16_bf16 v[128:143], v[204:207], v[60:63], v[128:143]
  ds_read_b64_tr_b16 v[216:217], v250 offset:64
  ds_read_b64_tr_b16 v[218:219], v250 offset:4416
  v_mfma_f32_32x32x16_bf16 v[144:159], v[204:207], v[124:127], v[144:159]
  s_cmp_eq_u32 s56, 0
  s_cbranch_scc1 L_nores18
  s_call_b64 s[58:59], L_resc
L_nores18:
  s_waitcnt lgkmcnt(4)
  v_mfma_f32_32x32x16_bf16 a[0:15], v[208:211], v[160:163], a[0:15]
  ds_read_b64_tr_b16 v[220:221], v250 offset:576
  ds_read_b64_tr_b16 v[222:223], v250 offset:4928
  v_mfma_f32_32x32x16_bf16 a[16:31], v[208:211], v[176:179], a[16:31]
  s_waitcnt vmcnt(16)
  s_barrier
  s_waitcnt lgkmcnt(4)
  v_mfma_f32_32x32x16_bf16 a[0:15], v[212:215], v[168:171], a[0:15]
  ds_read_b64_tr_b16 v[208:209], v250 offset:128
  ds_read_b64_tr_b16 v[210:211], v250 offset:4480
  s_add_u32 s51, s49, 212992
  s_add_u32 m0, s45, 118784
  s_nop 0
  buffer_load_dwordx4 v226, s[24:27], s51 offen nt lds
  v_mfma_f32_32x32x16_bf16 a[16:31], v[212:215], v[184:187], a[16:31]
  s_add_u32 m0, s45, 119360
  s_nop 0
  buffer_load_dwordx4 v226, s[24:27], s51 offen offset:512 nt lds
  s_waitcnt lgkmcnt(4)
  v_mfma_f32_32x32x16_bf16 a[32:47], v[216:219], v[160:163], a[32:47]
  ds_read_b64_tr_b16 v[212:213], v250 offset:640
  ds_read_b64_tr_b16 v[214:215], v250 offset:4992
  s_add_u32 m0, s45, 119936
  v_mfma_f32_32x32x16_bf16 a[48:63], v[216:219], v[176:179], a[48:63]
  buffer_load_dwordx4 v226, s[24:27], s51 offen offset:1024 nt lds
  s_add_u32 m0, s45, 120512
  s_waitcnt lgkmcnt(4)
  v_mfma_f32_32x32x16_bf16 a[32:47], v[220:223], v[168:171], a[32:47]
  ds_read_b64_tr_b16 v[216:217], v250 offset:192
  ds_read_b64_tr_b16 v[218:219], v250 offset:4544
  buffer_load_dwordx4 v226, s[24:27], s51 offen offset:1536 nt lds
  v_mfma_f32_32x32x16_bf16 a[48:63], v[220:223], v[184:187], a[48:63]
  s_add_u32 s51, s49, 229376
  s_add_u32 m0, s47, 33280
  s_nop 0
  buffer_load_dwordx4 v226, s[20:23], s51 offen nt lds
  s_waitcnt lgkmcnt(4)
  v_mfma_f32_32x32x16_bf16 a[64:79], v[208:211], v[160:163], a[64:79]
  ds_read_b64_tr_b16 v[220:221], v250 offset:704
  ds_read_b64_tr_b16 v[222:223], v250 offset:5056
  s_add_u32 m0, s47, 33808
  v_mfma_f32_32x32x16_bf16 a[80:95], v[208:211], v[176:179], a[80:95]
  buffer_load_dwordx4 v226, s[20:23], s51 offen offset:512 nt lds
  s_add_u32 m0, s47, 34336
  s_waitcnt lgkmcnt(4)
  v_mfma_f32_32x32x16_bf16 a[64:79], v[212:215], v[168:171], a[64:79]
  ds_read_b64_tr_b16 v[208:209], v250 offset:256
  ds_read_b64_tr_b16 v[210:211], v250 offset:4608
  buffer_load_dwordx4 v226, s[20:23], s51 offen offset:1024 nt lds
  s_add_u32 m0, s47, 34864
  v_mfma_f32_32x32x16_bf16 a[80:95], v[212:215], v[184:187], a[80:95]
  buffer_load_dwordx4 v226, s[20:23], s51 offen offset:1536 nt lds
  v_max3_f32 v236, v128, v129, v130
  s_waitcnt lgkmcnt(4)
  v_mfma_f32_32x32x16_bf16 a[96:111], v[216:219], v[160:163], a[96:111]
  ds_read_b64_tr_b16 v[212:213], v250 offset:768
  ds_read_b64_tr_b16 v[214:215], v250 offset:5120
  v_max3_f32 v236, v236, v131, v132
  v_max3_f32 v236, v236, v133, v134
  v_max3_f32 v236, v236, v135, v136
  v_mfma_f32_32x32x16_bf16 a[112:127], v[216:219], v[176:179], a[112:127]
  v_max3_f32 v236, v236, v137, v138
  v_max3_f32 v236, v236, v139, v140
  v_max3_f32 v236, v236, v141, v142
  v_max_f32 v236, v236, v143
  v_max3_f32 v237, v144, v145, v146
  s_waitcnt lgkmcnt(4)
  v_mfma_f32_32x32x16_bf16 a[96:111], v[220:223], v[168:171], a[96:111]
  ds_read_b64_tr_b16 v[216:217], v250 offset:320
  ds_read_b64_tr_b16 v[218:219], v250 offset:4672
  v_max3_f32 v237, v237, v147, v148
  v_max3_f32 v237, v237, v149, v150
  v_max3_f32 v237, v237, v151, v152
  v_mfma_f32_32x32x16_bf16 a[112:127], v[220:223], v[184:187], a[112:127]
  v_max3_f32 v237, v237, v153, v154
  v_max3_f32 v237, v237, v155, v156
  v_max3_f32 v237, v237, v157, v158
  v_max_f32 v237, v237, v159
  s_waitcnt lgkmcnt(4)
  v_mfma_f32_32x32x16_bf16 a[128:143], v[208:211], v[160:163], a[128:143]
  ds_read_b64_tr_b16 v[220:221], v250 offset:832
  ds_read_b64_tr_b16 v[222:223], v250 offset:5184
  v_mov_b32 v238, v236
  v_mov_b32 v239, v237
  s_nop 0
  v_permlane32_swap_b32 v236, v238
  v_mfma_f32_32x32x16_bf16 a[144:159], v[208:211], v[176:179], a[144:159]
  v_permlane32_swap_b32 v237, v239
  v_max_f32 v236, v236, v238
  v_max_f32 v237, v237, v239
  v_cmp_gt_f32 s[52:53], v236, v230
  v_cmp_gt_f32 s[54:55], v237, v231
  s_waitcnt lgkmcnt(4)
  v_mfma_f32_32x32x16_bf16 a[128:143], v[212:215], v[168:171], a[128:143]
  ds_read_b64_tr_b16 v[208:209], v250 offset:384
  ds_read_b64_tr_b16 v[210:211], v250 offset:4736
  s_or_b64 s[52:53], s[52:53], s[54:55]
  s_cbranch_scc0 L_noslow19
  s_call_b64 s[58:59], L_slow
L_noslow19:
  v_fma_f32 v128, v128, s44, -v228
  v_mfma_f32_32x32x16_bf16 a[144:159], v[212:215], v[184:187], a[144:159]
  v_fma_f32 v129, v129, s44, -v228
  v_fma_f32 v130, v130, s44, -v228
  v_fma_f32 v131, v131, s44, -v228
  v_exp_f32 v128, v128
  s_waitcnt lgkmcnt(4)
  v_mfma_f32_32x32x16_bf16 a[160:175], v[216:219], v[160:163], a[160:175]
  ds_read_b64_tr_b16 v[212:213], v250 offset:896
  ds_read_b64_tr_b16 v[214:215], v250 offset:5248
  v_exp_f32 v129, v129
  v_exp_f32 v130, v130
  v_mfma_f32_32x32x16_bf16 a[176:191], v[216:219], v[176:179], a[176:191]
  v_exp_f32 v131, v131
  v_add_f32 v232, v232, v128
  v_add_f32 v232, v232, v129
  s_waitcnt lgkmcnt(4)
  v_mfma_f32_32x32x16_bf16 a[160:175], v[220:223], v[168:171], a[160:175]
  ds_read_b64_tr_b16 v[216:217], v250 offset:448
  ds_read_b64_tr_b16 v[218:219], v250 offset:4800
  v_add_f32 v232, v232, v130
  v_add_f32 v232, v232, v131
  v_cvt_pk_bf16_f32 v128, v128, v129
  v_mfma_f32_32x32x16_bf16 a[176:191], v[220:223], v[184:187], a[176:191]
  v_cvt_pk_bf16_f32 v129, v130, v131
  v_fma_f32 v132, v132, s44, -v228
  v_fma_f32 v133, v133, s44, -v228
  v_fma_f32 v134, v134, s44, -v228
  s_waitcnt lgkmcnt(4)
  v_mfma_f32_32x32x16_bf16 a[192:207], v[208:211], v[160:163], a[192:207]
  ds_read_b64_tr_b16 v[220:221], v250 offset:960
  ds_read_b64_tr_b16 v[222:223], v250 offset:5312
  v_fma_f32 v135, v135, s44, -v228
  v_exp_f32 v132, v132
  v_mfma_f32_32x32x16_bf16 a[208:223], v[208:211], v[176:179], a[208:223]
  v_exp_f32 v133, v133
  v_exp_f32 v134, v134
  s_waitcnt lgkmcnt(4)
  v_mfma_f32_32x32x16_bf16 a[192:207], v[212:215], v[168:171], a[192:207]
  ds_read_b128 v[192:195], v224 offset:49920
  v_exp_f32 v135, v135
  v_add_f32 v232, v232, v132
  v_add_f32 v232, v232, v133
  v_add_f32 v232, v232, v134
  v_mfma_f32_32x32x16_bf16 a[208:223], v[212:215], v[184:187], a[208:223]
  v_add_f32 v232, v232, v135
  v_cvt_pk_bf16_f32 v130, v132, v133
  v_cvt_pk_bf16_f32 v131, v134, v135
  v_fma_f32 v136, v136, s44, -v228
  s_waitcnt lgkmcnt(3)
  v_mfma_f32_32x32x16_bf16 a[224:239], v[216:219], v[160:163], a[224:239]
  ds_read_b128 v[196:199], v224 offset:49952
  v_fma_f32 v137, v137, s44, -v228
  v_fma_f32 v138, v138, s44, -v228
  v_fma_f32 v139, v139, s44, -v228
  v_exp_f32 v136, v136
  v_mfma_f32_32x32x16_bf16 a[240:255], v[216:219], v[176:179], a[240:255]
  v_exp_f32 v137, v137
  v_exp_f32 v138, v138
  s_waitcnt lgkmcnt(2)
  v_mfma_f32_32x32x16_bf16 a[224:239], v[220:223], v[168:171], a[224:239]
  ds_read_b128 v[200:203], v224 offset:49984
  v_exp_f32 v139, v139
  v_add_f32 v232, v232, v136
  v_mfma_f32_32x32x16_bf16 a[240:255], v[220:223], v[184:187], a[240:255]
  v_add_f32 v232, v232, v137
  v_add_f32 v232, v232, v138
  v_add_f32 v232, v232, v139
  v_cvt_pk_bf16_f32 v136, v136, v137
  v_cvt_pk_bf16_f32 v137, v138, v139
  s_waitcnt lgkmcnt(2)
  v_mfma_f32_32x32x16_bf16 v[160:175], v[192:195], v[0:3], 0
  ds_read_b128 v[204:207], v224 offset:50016
  v_fma_f32 v140, v140, s44, -v228
  v_fma_f32 v141, v141, s44, -v228
  v_fma_f32 v142, v142, s44, -v228
  v_mfma_f32_32x32x16_bf16 v[176:191], v[192:195], v[64:67], 0
  v_fma_f32 v143, v143, s44, -v228
  v_exp_f32 v140, v140
  s_waitcnt lgkmcnt(2)
  v_mfma_f32_32x32x16_bf16 v[160:175], v[196:199], v[4:7], v[160:175]
  ds_read_b128 v[192:195], v224 offset:50048
  v_exp_f32 v141, v141
  v_mfma_f32_32x32x16_bf16 v[176:191], v[196:199], v[68:71], v[176:191]
  v_exp_f32 v142, v142
  v_exp_f32 v143, v143
  s_waitcnt lgkmcnt(2)
  v_mfma_f32_32x32x16_bf16 v[160:175], v[200:203], v[8:11], v[160:175]
  ds_read_b128 v[196:199], v224 offset:50080
  v_add_f32 v232, v232, v140
  v_add_f32 v232, v232, v141
  v_add_f32 v232, v232, v142
  v_mfma_f32_32x32x16_bf16 v[176:191], v[200:203], v[72:75], v[176:191]
  v_add_f32 v232, v232, v143
  v_cvt_pk_bf16_f32 v138, v140, v141
  v_cvt_pk_bf16_f32 v139, v142, v143
  s_waitcnt lgkmcnt(2)
  v_mfma_f32_32x32x16_bf16 v[160:175], v[204:207], v[12:15], v[160:175]
  ds_read_b128 v[200:203], v224 offset:50112
  v_fma_f32 v144, v144, s44, -v229
  v_fma_f32 v145, v145, s44, -v229
  v_fma_f32 v146, v146, s44, -v229
  v_mfma_f32_32x32x16_bf16 v[176:191], v[204:207], v[76:79], v[176:191]
  v_fma_f32 v147, v147, s44, -v229
  v_exp_f32 v144, v144
  s_waitcnt lgkmcnt(2)
  v_mfma_f32_32x32x16_bf16 v[160:175], v[192:195], v[16:19], v[160:175]
  ds_read_b128 v[204:207], v224 offset:50144
  v_exp_f32 v145, v145
  v_exp_f32 v146, v146
  v_mfma_f32_32x32x16_bf16 v[176:191], v[192:195], v[80:83], v[176:191]
  v_exp_f32 v147, v147
  s_waitcnt lgkmcnt(2)
  v_mfma_f32_32x32x16_bf16 v[160:175], v[196:199], v[20:23], v[160:175]
  ds_read_b128 v[192:195], v224 offset:50176
  v_add_f32 v233, v233, v144
  v_add_f32 v233, v233, v145
  v_add_f32 v233, v233, v146
  v_mfma_f32_32x32x16_bf16 v[176:191], v[196:199], v[84:87], v[176:191]
  v_add_f32 v233, v233, v147
  v_cvt_pk_bf16_f32 v144, v144, v145
  v_cvt_pk_bf16_f32 v145, v146, v147
  s_waitcnt lgkmcnt(2)
  v_mfma_f32_32x32x16_bf16 v[160:175], v[200:203], v[24:27], v[160:175]
  ds_read_b128 v[196:199], v224 offset:50208
  v_fma_f32 v148, v148, s44, -v229
  v_fma_f32 v149, v149, s44, -v229
  v_fma_f32 v150, v150, s44, -v229
  v_mfma_f32_32x32x16_bf16 v[176:191], v[200:203], v[88:91], v[176:191]
  v_fma_f32 v151, v151, s44, -v229
  v_exp_f32 v148, v148
  s_waitcnt lgkmcnt(2)
  v_mfma_f32_32x32x16_bf16 v[160:175], v[204:207], v[28:31], v[160:175]
  ds_read_b128 v[200:203], v224 offset:50240
  v_exp_f32 v149, v149
  v_exp_f32 v150, v150
  v_mfma_f32_32x32x16_bf16 v[176:191], v[204:207], v[92:95], v[176:191]
  v_exp_f32 v151, v151
  v_add_f32 v233, v233, v148
  s_waitcnt lgkmcnt(2)
  v_mfma_f32_32x32x16_bf16 v[160:175], v[192:195], v[32:35], v[160:175]
  ds_read_b128 v[204:207], v224 offset:50272
  v_add_f32 v233, v233, v149
  v_add_f32 v233, v233, v150
  v_mfma_f32_32x32x16_bf16 v[176:191], v[192:195], v[96:99], v[176:191]
  v_add_f32 v233, v233, v151
  v_cvt_pk_bf16_f32 v146, v148, v149
  v_cvt_pk_bf16_f32 v147, v150, v151
  v_fma_f32 v152, v152, s44, -v229
  s_waitcnt lgkmcnt(2)
  v_mfma_f32_32x32x16_bf16 v[160:175], v[196:199], v[36:39], v[160:175]
  ds_read_b128 v[192:195], v224 offset:50304
  v_fma_f32 v153, v153, s44, -v229
  v_fma_f32 v154, v154, s44, -v229
  v_mfma_f32_32x32x16_bf16 v[176:191], v[196:199], v[100:103], v[176:191]
  v_fma_f32 v155, v155, s44, -v229
  v_exp_f32 v152, v152
  s_waitcnt lgkmcnt(2)
  v_mfma_f32_32x32x16_bf16 v[160:175], v[200:203], v[40:43], v[160:175]
  ds_read_b128 v[196:199], v224 offset:50336
  v_exp_f32 v153, v153
  v_exp_f32 v154, v154
  v_mfma_f32_32x32x16_bf16 v[176:191], v[200:203], v[104:107], v[176:191]
  v_exp_f32 v155, v155
  v_add_f32 v233, v233, v152
  s_waitcnt lgkmcnt(2)
  v_mfma_f32_32x32x16_bf16 v[160:175], v[204:207], v[44:47], v[160:175]
  ds_read_b128 v[200:203], v224 offset:50368
  v_add_f32 v233, v233, v153
  v_add_f32 v233, v233, v154
  v_add_f32 v233, v233, v155
  v_mfma_f32_32x32x16_bf16 v[176:191], v[204:207], v[108:111], v[176:191]
  v_cvt_pk_bf16_f32 v152, v152, v153
  v_cvt_pk_bf16_f32 v153, v154, v155
  v_fma_f32 v156, v156, s44, -v229
  s_waitcnt lgkmcnt(2)
  v_mfma_f32_32x32x16_bf16 v[160:175], v[192:195], v[48:51], v[160:175]
  ds_read_b128 v[204:207], v224 offset:50400
  v_fma_f32 v157, v157, s44, -v229
  v_fma_f32 v158, v158, s44, -v229
  v_fma_f32 v159, v159, s44, -v229
  v_mfma_f32_32x32x16_bf16 v[176:191], v[192:195], v[112:115], v[176:191]
  v_exp_f32 v156, v156
  s_waitcnt lgkmcnt(2)
  v_mfma_f32_32x32x16_bf16 v[160:175], v[196:199], v[52:55], v[160:175]
  ds_read_b64_tr_b16 v[208:209], v225 offset:0
  ds_read_b64_tr_b16 v[210:211], v225 offset:4352
  v_exp_f32 v157, v157
  v_exp_f32 v158, v158
  v_mfma_f32_32x32x16_bf16 v[176:191], v[196:199], v[116:119], v[176:191]
  v_exp_f32 v159, v159
  s_waitcnt lgkmcnt(3)
  v_mfma_f32_32x32x16_bf16 v[160:175], v[200:203], v[56:59], v[160:175]
  ds_read_b64_tr_b16 v[212:213], v225 offset:512
  ds_read_b64_tr_b16 v[214:215], v225 offset:4864
  v_add_f32 v233, v233, v156
  v_add_f32 v233, v233, v157
  v_add_f32 v233, v233, v158
  v_mfma_f32_32x32x16_bf16 v[176:191], v[200:203], v[120:123], v[176:191]
  v_add_f32 v233, v233, v159
  v_cvt_pk_bf16_f32 v154, v156, v157
  v_cvt_pk_bf16_f32 v155, v158, v159
  s_waitcnt lgkmcnt(4)
  v_mfma_f32_32x32x16_bf16 v[160:175], v[204:207], v[60:63], v[160:175]
  ds_read_b64_tr_b16 v[216:217], v225 offset:64
  ds_read_b64_tr_b16 v[218:219], v225 offset:4416
  v_mfma_f32_32x32x16_bf16 v[176:191], v[204:207], v[124:127], v[176:191]
  s_cmp_eq_u32 s56, 0
  s_cbranch_scc1 L_nores20
  s_call_b64 s[58:59], L_resc
L_nores20:
  s_waitcnt lgkmcnt(4)
  v_mfma_f32_32x32x16_bf16 a[0:15], v[208:211], v[128:131], a[0:15]
  ds_read_b64_tr_b16 v[220:221], v225 offset:576
  ds_read_b64_tr_b16 v[222:223], v225 offset:4928
  v_mfma_f32_32x32x16_bf16 a[16:31], v[208:211], v[144:147], a[16:31]
  s_waitcnt vmcnt(16)
  s_barrier
  s_waitcnt lgkmcnt(4)
  v_mfma_f32_32x32x16_bf16 a[0:15], v[212:215], v[136:139], a[0:15]
  ds_read_b64_tr_b16 v[208:209], v225 offset:128
  ds_read_b64_tr_b16 v[210:211], v225 offset:4480
  s_add_u32 s51, s49, 229376
  s_add_u32 m0, s45, 136192
  s_nop 0
  buffer_load_dwordx4 v226, s[24:27], s51 offen nt lds
  v_mfma_f32_32x32x16_bf16 a[16:31], v[212:215], v[152:155], a[16:31]
  s_add_u32 m0, s45, 136768
  s_nop 0
  buffer_load_dwordx4 v226, s[24:27], s51 offen offset:512 nt lds
  s_waitcnt lgkmcnt(4)
  v_mfma_f32_32x32x16_bf16 a[32:47], v[216:219], v[128:131], a[32:47]
  ds_read_b64_tr_b16 v[212:213], v225 offset:640
  ds_read_b64_tr_b16 v[214:215], v225 offset:4992
  s_add_u32 m0, s45, 137344
  v_mfma_f32_32x32x16_bf16 a[48:63], v[216:219], v[144:147], a[48:63]
  buffer_load_dwordx4 v226, s[24:27], s51 offen offset:1024 nt lds
  s_add_u32 m0, s45, 137920
  s_waitcnt lgkmcnt(4)
  v_mfma_f32_32x32x16_bf16 a[32:47], v[220:223], v[136:139], a[32:47]
  ds_read_b64_tr_b16 v[216:217], v225 offset:192
  ds_read_b64_tr_b16 v[218:219], v225 offset:4544
  buffer_load_dwordx4 v226, s[24:27], s51 offen offset:1536 nt lds
  v_mfma_f32_32x32x16_bf16 a[48:63], v[220:223], v[152:155], a[48:63]
  s_add_u32 s51, s49, 245760
  s_add_u32 m0, s47, 49920
  s_nop 0
  buffer_load_dwordx4 v226, s[20:23], s51 offen nt lds
  s_waitcnt lgkmcnt(4)
  v_mfma_f32_32x32x16_bf16 a[64:79], v[208:211], v[128:131], a[64:79]
  ds_read_b64_tr_b16 v[220:221], v225 offset:704
  ds_read_b64_tr_b16 v[222:223], v225 offset:5056
  s_add_u32 m0, s47, 50448
  v_mfma_f32_32x32x16_bf16 a[80:95], v[208:211], v[144:147], a[80:95]
  buffer_load_dwordx4 v226, s[20:23], s51 offen offset:512 nt lds
  s_add_u32 m0, s47, 50976
  s_waitcnt lgkmcnt(4)
  v_mfma_f32_32x32x16_bf16 a[64:79], v[212:215], v[136:139], a[64:79]
  ds_read_b64_tr_b16 v[208:209], v225 offset:256
  ds_read_b64_tr_b16 v[210:211], v225 offset:4608
  buffer_load_dwordx4 v226, s[20:23], s51 offen offset:1024 nt lds
  s_add_u32 m0, s47, 51504
  v_mfma_f32_32x32x16_bf16 a[80:95], v[212:215], v[152:155], a[80:95]
  buffer_load_dwordx4 v226, s[20:23], s51 offen offset:1536 nt lds
  v_max3_f32 v236, v160, v161, v162
  s_waitcnt lgkmcnt(4)
  v_mfma_f32_32x32x16_bf16 a[96:111], v[216:219], v[128:131], a[96:111]
  ds_read_b64_tr_b16 v[212:213], v225 offset:768
  ds_read_b64_tr_b16 v[214:215], v225 offset:5120
  v_max3_f32 v236, v236, v163, v164
  v_max3_f32 v236, v236, v165, v166
  v_max3_f32 v236, v236, v167, v168
  v_mfma_f32_32x32x16_bf16 a[112:127], v[216:219], v[144:147], a[112:127]
  v_max3_f32 v236, v236, v169, v170
  v_max3_f32 v236, v236, v171, v172
  v_max3_f32 v236, v236, v173, v174
  v_max_f32 v236, v236, v175
  v_max3_f32 v237, v176, v177, v178
  s_waitcnt lgkmcnt(4)
  v_mfma_f32_32x32x16_bf16 a[96:111], v[220:223], v[136:139], a[96:111]
  ds_read_b64_tr_b16 v[216:217], v225 offset:320
  ds_read_b64_tr_b16 v[218:219], v225 offset:4672
  v_max3_f32 v237, v237, v179, v180
  v_max3_f32 v237, v237, v181, v182
  v_max3_f32 v237, v237, v183, v184
  v_mfma_f32_32x32x16_bf16 a[112:127], v[220:223], v[152:155], a[112:127]
  v_max3_f32 v237, v237, v185, v186
  v_max3_f32 v237, v237, v187, v188
  v_max3_f32 v237, v237, v189, v190
  v_max_f32 v237, v237, v191
  s_waitcnt lgkmcnt(4)
  v_mfma_f32_32x32x16_bf16 a[128:143], v[208:211], v[128:131], a[128:143]
  ds_read_b64_tr_b16 v[220:221], v225 offset:832
  ds_read_b64_tr_b16 v[222:223], v225 offset:5184
  v_mov_b32 v238, v236
  v_mov_b32 v239, v237
  s_nop 0
  v_permlane32_swap_b32 v236, v238
  v_mfma_f32_32x32x16_bf16 a[144:159], v[208:211], v[144:147], a[144:159]
  v_permlane32_swap_b32 v237, v239
  v_max_f32 v236, v236, v238
  v_max_f32 v237, v237, v239
  v_cmp_gt_f32 s[52:53], v236, v230
  v_cmp_gt_f32 s[54:55], v237, v231
  s_waitcnt lgkmcnt(4)
  v_mfma_f32_32x32x16_bf16 a[128:143], v[212:215], v[136:139], a[128:143]
  ds_read_b64_tr_b16 v[208:209], v225 offset:384
  ds_read_b64_tr_b16 v[210:211], v225 offset:4736
  s_or_b64 s[52:53], s[52:53], s[54:55]
  s_cbranch_scc0 L_noslow21
  s_call_b64 s[58:59], L_slow
L_noslow21:
  v_fma_f32 v160, v160, s44, -v228
  v_mfma_f32_32x32x16_bf16 a[144:159], v[212:215], v[152:155], a[144:159]
  v_fma_f32 v161, v161, s44, -v228
  v_fma_f32 v162, v162, s44, -v228
  v_fma_f32 v163, v163, s44, -v228
  v_exp_f32 v160, v160
  s_waitcnt lgkmcnt(4)
  v_mfma_f32_32x32x16_bf16 a[160:175], v[216:219], v[128:131], a[160:175]
  ds_read_b64_tr_b16 v[212:213], v225 offset:896
  ds_read_b64_tr_b16 v[214:215], v225 offset:5248
  v_exp_f32 v161, v161
  v_exp_f32 v162, v162
  v_mfma_f32_32x32x16_bf16 a[176:191], v[216:219], v[144:147], a[176:191]
  v_exp_f32 v163, v163
  v_add_f32 v232, v232, v160
  v_add_f32 v232, v232, v161
  s_waitcnt lgkmcnt(4)
  v_mfma_f32_32x32x16_bf16 a[160:175], v[220:223], v[136:139], a[160:175]
  ds_read_b64_tr_b16 v[216:217], v225 offset:448
  ds_read_b64_tr_b16 v[218:219], v225 offset:4800
  v_add_f32 v232, v232, v162
  v_add_f32 v232, v232, v163
  v_cvt_pk_bf16_f32 v160, v160, v161
  v_mfma_f32_32x32x16_bf16 a[176:191], v[220:223], v[152:155], a[176:191]
  v_cvt_pk_bf16_f32 v161, v162, v163
  v_fma_f32 v164, v164, s44, -v228
  v_fma_f32 v165, v165, s44, -v228
  v_fma_f32 v166, v166, s44, -v228
  s_waitcnt lgkmcnt(4)
  v_mfma_f32_32x32x16_bf16 a[192:207], v[208:211], v[128:131], a[192:207]
  ds_read_b64_tr_b16 v[220:221], v225 offset:960
  ds_read_b64_tr_b16 v[222:223], v225 offset:5312
  v_fma_f32 v167, v167, s44, -v228
  v_exp_f32 v164, v164
  v_mfma_f32_32x32x16_bf16 a[208:223], v[208:211], v[144:147], a[208:223]
  v_exp_f32 v165, v165
  v_exp_f32 v166, v166
  s_waitcnt lgkmcnt(4)
  v_mfma_f32_32x32x16_bf16 a[192:207], v[212:215], v[136:139], a[192:207]
  ds_read_b128 v[192:195], v224 offset:0
  v_exp_f32 v167, v167
  v_add_f32 v232, v232, v164
  v_add_f32 v232, v232, v165
  v_add_f32 v232, v232, v166
  v_mfma_f32_32x32x16_bf16 a[208:223], v[212:215], v[152:155], a[208:223]
  v_add_f32 v232, v232, v167
  v_cvt_pk_bf16_f32 v162, v164, v165
  v_cvt_pk_bf16_f32 v163, v166, v167
  v_fma_f32 v168, v168, s44, -v228
  s_waitcnt lgkmcnt(3)
  v_mfma_f32_32x32x16_bf16 a[224:239], v[216:219], v[128:131], a[224:239]
  ds_read_b128 v[196:199], v224 offset:32
  v_fma_f32 v169, v169, s44, -v228
  v_fma_f32 v170, v170, s44, -v228
  v_fma_f32 v171, v171, s44, -v228
  v_exp_f32 v168, v168
  v_mfma_f32_32x32x16_bf16 a[240:255], v[216:219], v[144:147], a[240:255]
  v_exp_f32 v169, v169
  v_exp_f32 v170, v170
  s_waitcnt lgkmcnt(2)
  v_mfma_f32_32x32x16_bf16 a[224:239], v[220:223], v[136:139], a[224:239]
  ds_read_b128 v[200:203], v224 offset:64
  v_exp_f32 v171, v171
  v_add_f32 v232, v232, v168
  v_mfma_f32_32x32x16_bf16 a[240:255], v[220:223], v[152:155], a[240:255]
  v_add_f32 v232, v232, v169
  v_add_f32 v232, v232, v170
  v_add_f32 v232, v232, v171
  v_cvt_pk_bf16_f32 v168, v168, v169
  v_cvt_pk_bf16_f32 v169, v170, v171
  s_waitcnt lgkmcnt(2)
  v_mfma_f32_32x32x16_bf16 v[128:143], v[192:195], v[0:3], 0
  ds_read_b128 v[204:207], v224 offset:96
  v_fma_f32 v172, v172, s44, -v228
  v_fma_f32 v173, v173, s44, -v228
  v_fma_f32 v174, v174, s44, -v228
  v_mfma_f32_32x32x16_bf16 v[144:159], v[192:195], v[64:67], 0
  v_fma_f32 v175, v175, s44, -v228
  v_exp_f32 v172, v172
  s_waitcnt lgkmcnt(2)
  v_mfma_f32_32x32x16_bf16 v[128:143], v[196:199], v[4:7], v[128:143]
  ds_read_b128 v[192:195], v224 offset:128
  v_exp_f32 v173, v173
  v_mfma_f32_32x32x16_bf16 v[144:159], v[196:199], v[68:71], v[144:159]
  v_exp_f32 v174, v174
  v_exp_f32 v175, v175
  s_waitcnt lgkmcnt(2)
  v_mfma_f32_32x32x16_bf16 v[128:143], v[200:203], v[8:11], v[128:143]
  ds_read_b128 v[196:199], v224 offset:160
  v_add_f32 v232, v232, v172
  v_add_f32 v232, v232, v173
  v_add_f32 v232, v232, v174
  v_mfma_f32_32x32x16_bf16 v[144:159], v[200:203], v[72:75], v[144:159]
  v_add_f32 v232, v232, v175
  v_cvt_pk_bf16_f32 v170, v172, v173
  v_cvt_pk_bf16_f32 v171, v174, v175
  s_waitcnt lgkmcnt(2)
  v_mfma_f32_32x32x16_bf16 v[128:143], v[204:207], v[12:15], v[128:143]
  ds_read_b128 v[200:203], v224 offset:192
  v_fma_f32 v176, v176, s44, -v229
  v_fma_f32 v177, v177, s44, -v229
  v_fma_f32 v178, v178, s44, -v229
  v_mfma_f32_32x32x16_bf16 v[144:159], v[204:207], v[76:79], v[144:159]
  v_fma_f32 v179, v179, s44, -v229
  v_exp_f32 v176, v176
  s_waitcnt lgkmcnt(2)
  v_mfma_f32_32x32x16_bf16 v[128:143], v[192:195], v[16:19], v[128:143]
  ds_read_b128 v[204:207], v224 offset:224
  v_exp_f32 v177, v177
  v_exp_f32 v178, v178
  v_mfma_f32_32x32x16_bf16 v[144:159], v[192:195], v[80:83], v[144:159]
  v_exp_f32 v179, v179
  s_waitcnt lgkmcnt(2)
  v_mfma_f32_32x32x16_bf16 v[128:143], v[196:199], v[20:23], v[128:143]
  ds_read_b128 v[192:195], v224 offset:256
  v_add_f32 v233, v233, v176
  v_add_f32 v233, v233, v177
  v_add_f32 v233, v233, v178
  v_mfma_f32_32x32x16_bf16 v[144:159], v[196:199], v[84:87], v[144:159]
  v_add_f32 v233, v233, v179
  v_cvt_pk_bf16_f32 v176, v176, v177
  v_cvt_pk_bf16_f32 v177, v178, v179
  s_waitcnt lgkmcnt(2)
  v_mfma_f32_32x32x16_bf16 v[128:143], v[200:203], v[24:27], v[128:143]
  ds_read_b128 v[196:199], v224 offset:288
  v_fma_f32 v180, v180, s44, -v229
  v_fma_f32 v181, v181, s44, -v229
  v_fma_f32 v182, v182, s44, -v229
  v_mfma_f32_32x32x16_bf16 v[144:159], v[200:203], v[88:91], v[144:159]
  v_fma_f32 v183, v183, s44, -v229
  v_exp_f32 v180, v180
  s_waitcnt lgkmcnt(2)
  v_mfma_f32_32x32x16_bf16 v[128:143], v[204:207], v[28:31], v[128:143]
  ds_read_b128 v[200:203], v224 offset:320
  v_exp_f32 v181, v181
  v_exp_f32 v182, v182
  v_mfma_f32_32x32x16_bf16 v[144:159], v[204:207], v[92:95], v[144:159]
  v_exp_f32 v183, v183
  v_add_f32 v233, v233, v180
  s_waitcnt lgkmcnt(2)
  v_mfma_f32_32x32x16_bf16 v[128:143], v[192:195], v[32:35], v[128:143]
  ds_read_b128 v[204:207], v224 offset:352
  v_add_f32 v233, v233, v181
  v_add_f32 v233, v233, v182
  v_mfma_f32_32x32x16_bf16 v[144:159], v[192:195], v[96:99], v[144:159]
  v_add_f32 v233, v233, v183
  v_cvt_pk_bf16_f32 v178, v180, v181
  v_cvt_pk_bf16_f32 v179, v182, v183
  v_fma_f32 v184, v184, s44, -v229
  s_waitcnt lgkmcnt(2)
  v_mfma_f32_32x32x16_bf16 v[128:143], v[196:199], v[36:39], v[128:143]
  ds_read_b128 v[192:195], v224 offset:384
  v_fma_f32 v185, v185, s44, -v229
  v_fma_f32 v186, v186, s44, -v229
  v_mfma_f32_32x32x16_bf16 v[144:159], v[196:199], v[100:103], v[144:159]
  v_fma_f32 v187, v187, s44, -v229
  v_exp_f32 v184, v184
  s_waitcnt lgkmcnt(2)
  v_mfma_f32_32x32x16_bf16 v[128:143], v[200:203], v[40:43], v[128:143]
  ds_read_b128 v[196:199], v224 offset:416
  v_exp_f32 v185, v185
  v_exp_f32 v186, v186
  v_mfma_f32_32x32x16_bf16 v[144:159], v[200:203], v[104:107], v[144:159]
  v_exp_f32 v187, v187
  v_add_f32 v233, v233, v184
  s_waitcnt lgkmcnt(2)
  v_mfma_f32_32x32x16_bf16 v[128:143], v[204:207], v[44:47], v[128:143]
  ds_read_b128 v[200:203], v224 offset:448
  v_add_f32 v233, v233, v185
  v_add_f32 v233, v233, v186
  v_add_f32 v233, v233, v187
  v_mfma_f32_32x32x16_bf16 v[144:159], v[204:207], v[108:111], v[144:159]
  v_cvt_pk_bf16_f32 v184, v184, v185
  v_cvt_pk_bf16_f32 v185, v186, v187
  v_fma_f32 v188, v188, s44, -v229
  s_waitcnt lgkmcnt(2)
  v_mfma_f32_32x32x16_bf16 v[128:143], v[192:195], v[48:51], v[128:143]
  ds_read_b128 v[204:207], v224 offset:480
  v_fma_f32 v189, v189, s44, -v229
  v_fma_f32 v190, v190, s44, -v229
  v_fma_f32 v191, v191, s44, -v229
  v_mfma_f32_32x32x16_bf16 v[144:159], v[192:195], v[112:115], v[144:159]
  v_exp_f32 v188, v188
  s_waitcnt lgkmcnt(2)
  v_mfma_f32_32x32x16_bf16 v[128:143], v[196:199], v[52:55], v[128:143]
  ds_read_b64_tr_b16 v[208:209], v225 offset:17408
  ds_read_b64_tr_b16 v[210:211], v225 offset:21760
  v_exp_f32 v189, v189
  v_exp_f32 v190, v190
  v_mfma_f32_32x32x16_bf16 v[144:159], v[196:199], v[116:119], v[144:159]
  v_exp_f32 v191, v191
  s_waitcnt lgkmcnt(3)
  v_mfma_f32_32x32x16_bf16 v[128:143], v[200:203], v[56:59], v[128:143]
  ds_read_b64_tr_b16 v[212:213], v225 offset:17920
  ds_read_b64_tr_b16 v[214:215], v225 offset:22272
  v_add_f32 v233, v233, v188
  v_add_f32 v233, v233, v189
  v_add_f32 v233, v233, v190
  v_mfma_f32_32x32x16_bf16 v[144:159], v[200:203], v[120:123], v[144:159]
  v_add_f32 v233, v233, v191
  v_cvt_pk_bf16_f32 v186, v188, v189
  v_cvt_pk_bf16_f32 v187, v190, v191
  s_waitcnt lgkmcnt(4)
  v_mfma_f32_32x32x16_bf16 v[128:143], v[204:207], v[60:63], v[128:143]
  ds_read_b64_tr_b16 v[216:217], v225 offset:17472
  ds_read_b64_tr_b16 v[218:219], v225 offset:21824
  v_mfma_f32_32x32x16_bf16 v[144:159], v[204:207], v[124:127], v[144:159]
  s_cmp_eq_u32 s56, 0
  s_cbranch_scc1 L_nores22
  s_call_b64 s[58:59], L_resc
L_nores22:
  s_waitcnt lgkmcnt(4)
  v_mfma_f32_32x32x16_bf16 a[0:15], v[208:211], v[160:163], a[0:15]
  ds_read_b64_tr_b16 v[220:221], v225 offset:17984
  ds_read_b64_tr_b16 v[222:223], v225 offset:22336
  v_mfma_f32_32x32x16_bf16 a[16:31], v[208:211], v[176:179], a[16:31]
  s_waitcnt vmcnt(16)
  s_barrier
  s_waitcnt lgkmcnt(4)
  v_mfma_f32_32x32x16_bf16 a[0:15], v[212:215], v[168:171], a[0:15]
  ds_read_b64_tr_b16 v[208:209], v225 offset:17536
  ds_read_b64_tr_b16 v[210:211], v225 offset:21888
  s_add_u32 s51, s49, 245760
  s_add_u32 m0, s45, 66560
  v_mfma_f32_32x32x16_bf16 a[16:31], v[212:215], v[184:187], a[16:31]
  buffer_load_dwordx4 v226, s[24:27], s51 offen nt lds
  s_add_u32 m0, s45, 67136
  s_waitcnt lgkmcnt(4)
  v_mfma_f32_32x32x16_bf16 a[32:47], v[216:219], v[160:163], a[32:47]
  ds_read_b64_tr_b16 v[212:213], v225 offset:18048
  ds_read_b64_tr_b16 v[214:215], v225 offset:22400
  buffer_load_dwordx4 v226, s[24:27], s51 offen offset:512 nt lds
  v_mfma_f32_32x32x16_bf16 a[48:63], v[216:219], v[176:179], a[48:63]
  s_add_u32 m0, s45, 67712
  s_nop 0
  buffer_load_dwordx4 v226, s[24:27], s51 offen offset:1024 nt lds
  s_waitcnt lgkmcnt(4)
  v_mfma_f32_32x32x16_bf16 a[32:47], v[220:223], v[168:171], a[32:47]
  ds_read_b64_tr_b16 v[216:217], v225 offset:17600
  ds_read_b64_tr_b16 v[218:219], v225 offset:21952
  s_add_u32 m0, s45, 68288
  v_mfma_f32_32x32x16_bf16 a[48:63], v[220:223], v[184:187], a[48:63]
  buffer_load_dwordx4 v226, s[24:27], s51 offen offset:1536 nt lds
  v_lshlrev_b32 v240, 2, v227
  s_mul_i32 s3, s42, 28672
  s_lshl_b32 s100, s40, 12
  s_waitcnt lgkmcnt(4)
  v_mfma_f32_32x32x16_bf16 a[64:79], v[208:211], v[160:163], a[64:79]
  ds_read_b64_tr_b16 v[220:221], v225 offset:18112
  ds_read_b64_tr_b16 v[222:223], v225 offset:22464
  s_add_u32 s100, s100, s3
  buffer_load_dword v241, v240, s[32:35], s100 offen
  s_add_u32 s100, s100, 16384
  v_mfma_f32_32x32x16_bf16 a[80:95], v[208:211], v[176:179], a[80:95]
  buffer_load_dword v241, v240, s[32:35], s100 offen
  v_max3_f32 v236, v128, v129, v130
  v_max3_f32 v236, v236, v131, v132
  s_waitcnt lgkmcnt(4)
  v_mfma_f32_32x32x16_bf16 a[64:79], v[212:215], v[168:171], a[64:79]
  ds_read_b64_tr_b16 v[208:209], v225 offset:17664
  ds_read_b64_tr_b16 v[210:211], v225 offset:22016
  v_max3_f32 v236, v236, v133, v134
  v_max3_f32 v236, v236, v135, v136
  v_max3_f32 v236, v236, v137, v138
  v_mfma_f32_32x32x16_bf16 a[80:95], v[212:215], v[184:187], a[80:95]
  v_max3_f32 v236, v236, v139, v140
  v_max3_f32 v236, v236, v141, v142
  v_max_f32 v236, v236, v143
  v_max3_f32 v237, v144, v145, v146
  s_waitcnt lgkmcnt(4)
  v_mfma_f32_32x32x16_bf16 a[96:111], v[216:219], v[160:163], a[96:111]
  ds_read_b64_tr_b16 v[212:213], v225 offset:18176
  ds_read_b64_tr_b16 v[214:215], v225 offset:22528
  v_max3_f32 v237, v237, v147, v148
  v_max3_f32 v237, v237, v149, v150
  v_max3_f32 v237, v237, v151, v152
  v_mfma_f32_32x32x16_bf16 a[112:127], v[216:219], v[176:179], a[112:127]
  v_max3_f32 v237, v237, v153, v154
  v_max3_f32 v237, v237, v155, v156
  v_max3_f32 v237, v237, v157, v158
  v_max_f32 v237, v237, v159
  s_waitcnt lgkmcnt(4)
  v_mfma_f32_32x32x16_bf16 a[96:111], v[220:223], v[168:171], a[96:111]
  ds_read_b64_tr_b16 v[216:217], v225 offset:17728
  ds_read_b64_tr_b16 v[218:219], v225 offset:22080
  v_mov_b32 v238, v236
  v_mov_b32 v239, v237
  v_mfma_f32_32x32x16_bf16 a[112:127], v[220:223], v[184:187], a[112:127]
  v_permlane32_swap_b32 v236, v238
  v_permlane32_swap_b32 v237, v239
  v_max_f32 v236, v236, v238
  v_max_f32 v237, v237, v239
  v_cmp_gt_f32 s[52:53], v236, v230
  s_waitcnt lgkmcnt(4)
  v_mfma_f32_32x32x16_bf16 a[128:143], v[208:211], v[160:163], a[128:143]
  ds_read_b64_tr_b16 v[220:221], v225 offset:18240
  ds_read_b64_tr_b16 v[222:223], v225 offset:22592
  v_cmp_gt_f32 s[54:55], v237, v231
  s_nop 1
  s_or_b64 s[52:53], s[52:53], s[54:55]
  s_cbranch_scc0 L_noslow23
  s_call_b64 s[58:59], L_slow
L_noslow23:
  v_mfma_f32_32x32x16_bf16 a[144:159], v[208:211], v[176:179], a[144:159]
  v_fma_f32 v128, v128, s44, -v228
  v_fma_f32 v129, v129, s44, -v228
  v_fma_f32 v130, v130, s44, -v228
  v_fma_f32 v131, v131, s44, -v228
  s_waitcnt lgkmcnt(4)
  v_mfma_f32_32x32x16_bf16 a[128:143], v[212:215], v[168:171], a[128:143]
  ds_read_b64_tr_b16 v[208:209], v225 offset:17792
  ds_read_b64_tr_b16 v[210:211], v225 offset:22144
  v_exp_f32 v128, v128
  v_mfma_f32_32x32x16_bf16 a[144:159], v[212:215], v[184:187], a[144:159]
  v_exp_f32 v129, v129
  v_exp_f32 v130, v130
  s_waitcnt lgkmcnt(4)
  v_mfma_f32_32x32x16_bf16 a[160:175], v[216:219], v[160:163], a[160:175]
  ds_read_b64_tr_b16 v[212:213], v225 offset:18304
  ds_read_b64_tr_b16 v[214:215], v225 offset:22656
  v_exp_f32 v131, v131
  v_add_f32 v232, v232, v128
  v_add_f32 v232, v232, v129
  v_mfma_f32_32x32x16_bf16 a[176:191], v[216:219], v[176:179], a[176:191]
  v_add_f32 v232, v232, v130
  v_add_f32 v232, v232, v131
  v_cvt_pk_bf16_f32 v128, v128, v129
  v_cvt_pk_bf16_f32 v129, v130, v131
  s_waitcnt lgkmcnt(4)
  v_mfma_f32_32x32x16_bf16 a[160:175], v[220:223], v[168:171], a[160:175]
  ds_read_b64_tr_b16 v[216:217], v225 offset:17856
  ds_read_b64_tr_b16 v[218:219], v225 offset:22208
  v_fma_f32 v132, v132, s44, -v228
  v_fma_f32 v133, v133, s44, -v228
  v_mfma_f32_32x32x16_bf16 a[176:191], v[220:223], v[184:187], a[176:191]
  v_fma_f32 v134, v134, s44, -v228
  v_fma_f32 v135, v135, s44, -v228
  v_exp_f32 v132, v132
  s_waitcnt lgkmcnt(4)
  v_mfma_f32_32x32x16_bf16 a[192:207], v[208:211], v[160:163], a[192:207]
  ds_read_b64_tr_b16 v[220:221], v225 offset:18368
  ds_read_b64_tr_b16 v[222:223], v225 offset:22720
  v_exp_f32 v133, v133
  v_exp_f32 v134, v134
  v_mfma_f32_32x32x16_bf16 a[208:223], v[208:211], v[176:179], a[208:223]
  v_exp_f32 v135, v135
  v_add_f32 v232, v232, v132
  s_waitcnt lgkmcnt(4)
  v_mfma_f32_32x32x16_bf16 a[192:207], v[212:215], v[168:171], a[192:207]
  ds_read_b128 v[192:195], v224 offset:16640
  v_add_f32 v232, v232, v133
  v_add_f32 v232, v232, v134
  v_add_f32 v232, v232, v135
  v_cvt_pk_bf16_f32 v130, v132, v133
  v_mfma_f32_32x32x16_bf16 a[208:223], v[212:215], v[184:187], a[208:223]
  v_cvt_pk_bf16_f32 v131, v134, v135
  v_fma_f32 v136, v136, s44, -v228
  v_fma_f32 v137, v137, s44, -v228
  v_fma_f32 v138, v138, s44, -v228
  s_waitcnt lgkmcnt(3)
  v_mfma_f32_32x32x16_bf16 a[224:239], v[216:219], v[160:163], a[224:239]
  ds_read_b128 v[196:199], v224 offset:16672
  v_fma_f32 v139, v139, s44, -v228
  v_exp_f32 v136, v136
  v_mfma_f32_32x32x16_bf16 a[240:255], v[216:219], v[176:179], a[240:255]
  v_exp_f32 v137, v137
  v_exp_f32 v138, v138
  s_waitcnt lgkmcnt(2)
  v_mfma_f32_32x32x16_bf16 a[224:239], v[220:223], v[168:171], a[224:239]
  ds_read_b128 v[200:203], v224 offset:16704
  v_exp_f32 v139, v139
  v_add_f32 v232, v232, v136
  v_add_f32 v232, v232, v137
  v_mfma_f32_32x32x16_bf16 a[240:255], v[220:223], v[184:187], a[240:255]
  v_add_f32 v232, v232, v138
  v_add_f32 v232, v232, v139
  v_cvt_pk_bf16_f32 v136, v136, v137
  v_cvt_pk_bf16_f32 v137, v138, v139
  s_waitcnt lgkmcnt(2)
  v_mfma_f32_32x32x16_bf16 v[160:175], v[192:195], v[0:3], 0
  ds_read_b128 v[204:207], v224 offset:16736
  v_fma_f32 v140, v140, s44, -v228
  v_fma_f32 v141, v141, s44, -v228
  v_fma_f32 v142, v142, s44, -v228
  v_mfma_f32_32x32x16_bf16 v[176:191], v[192:195], v[64:67], 0
  v_fma_f32 v143, v143, s44, -v228
  v_exp_f32 v140, v140
  s_waitcnt lgkmcnt(2)
  v_mfma_f32_32x32x16_bf16 v[160:175], v[196:199], v[4:7], v[160:175]
  ds_read_b128 v[192:195], v224 offset:16768
  v_exp_f32 v141, v141
  v_mfma_f32_32x32x16_bf16 v[176:191], v[196:199], v[68:71], v[176:191]
  v_exp_f32 v142, v142
  v_exp_f32 v143, v143
  s_waitcnt lgkmcnt(2)
  v_mfma_f32_32x32x16_bf16 v[160:175], v[200:203], v[8:11], v[160:175]
  ds_read_b128 v[196:199], v224 offset:16800
  v_add_f32 v232, v232, v140
  v_add_f32 v232, v232, v141
  v_add_f32 v232, v232, v142
  v_mfma_f32_32x32x16_bf16 v[176:191], v[200:203], v[72:75], v[176:191]
  v_add_f32 v232, v232, v143
  v_cvt_pk_bf16_f32 v138, v140, v141
  v_cvt_pk_bf16_f32 v139, v142, v143
  s_waitcnt lgkmcnt(2)
  v_mfma_f32_32x32x16_bf16 v[160:175], v[204:207], v[12:15], v[160:175]
  ds_read_b128 v[200:203], v224 offset:16832
  v_fma_f32 v144, v144, s44, -v229
  v_fma_f32 v145, v145, s44, -v229
  v_fma_f32 v146, v146, s44, -v229
  v_mfma_f32_32x32x16_bf16 v[176:191], v[204:207], v[76:79], v[176:191]
  v_fma_f32 v147, v147, s44, -v229
  v_exp_f32 v144, v144
  s_waitcnt lgkmcnt(2)
  v_mfma_f32_32x32x16_bf16 v[160:175], v[192:195], v[16:19], v[160:175]
  ds_read_b128 v[204:207], v224 offset:16864
  v_exp_f32 v145, v145
  v_exp_f32 v146, v146
  v_mfma_f32_32x32x16_bf16 v[176:191], v[192:195], v[80:83], v[176:191]
  v_exp_f32 v147, v147
  s_waitcnt lgkmcnt(2)
  v_mfma_f32_32x32x16_bf16 v[160:175], v[196:199], v[20:23], v[160:175]
  ds_read_b128 v[192:195], v224 offset:16896
  v_add_f32 v233, v233, v144
  v_add_f32 v233, v233, v145
  v_add_f32 v233, v233, v146
  v_mfma_f32_32x32x16_bf16 v[176:191], v[196:199], v[84:87], v[176:191]
  v_add_f32 v233, v233, v147
  v_cvt_pk_bf16_f32 v144, v144, v145
  v_cvt_pk_bf16_f32 v145, v146, v147
  s_waitcnt lgkmcnt(2)
  v_mfma_f32_32x32x16_bf16 v[160:175], v[200:203], v[24:27], v[160:175]
  ds_read_b128 v[196:199], v224 offset:16928
  v_fma_f32 v148, v148, s44, -v229
  v_fma_f32 v149, v149, s44, -v229
  v_fma_f32 v150, v150, s44, -v229
  v_mfma_f32_32x32x16_bf16 v[176:191], v[200:203], v[88:91], v[176:191]
  v_fma_f32 v151, v151, s44, -v229
  v_exp_f32 v148, v148
  s_waitcnt lgkmcnt(2)
  v_mfma_f32_32x32x16_bf16 v[160:175], v[204:207], v[28:31], v[160:175]
  ds_read_b128 v[200:203], v224 offset:16960
  v_exp_f32 v149, v149
  v_exp_f32 v150, v150
  v_mfma_f32_32x32x16_bf16 v[176:191], v[204:207], v[92:95], v[176:191]
  v_exp_f32 v151, v151
  v_add_f32 v233, v233, v148
  s_waitcnt lgkmcnt(2)
  v_mfma_f32_32x32x16_bf16 v[160:175], v[192:195], v[32:35], v[160:175]
  ds_read_b128 v[204:207], v224 offset:16992
  v_add_f32 v233, v233, v149
  v_add_f32 v233, v233, v150
  v_mfma_f32_32x32x16_bf16 v[176:191], v[192:195], v[96:99], v[176:191]
  v_add_f32 v233, v233, v151
  v_cvt_pk_bf16_f32 v146, v148, v149
  v_cvt_pk_bf16_f32 v147, v150, v151
  v_fma_f32 v152, v152, s44, -v229
  s_waitcnt lgkmcnt(2)
  v_mfma_f32_32x32x16_bf16 v[160:175], v[196:199], v[36:39], v[160:175]
  ds_read_b128 v[192:195], v224 offset:17024
  v_fma_f32 v153, v153, s44, -v229
  v_fma_f32 v154, v154, s44, -v229
  v_mfma_f32_32x32x16_bf16 v[176:191], v[196:199], v[100:103], v[176:191]
  v_fma_f32 v155, v155, s44, -v229
  v_exp_f32 v152, v152
  s_waitcnt lgkmcnt(2)
  v_mfma_f32_32x32x16_bf16 v[160:175], v[200:203], v[40:43], v[160:175]
  ds_read_b128 v[196:199], v224 offset:17056
  v_exp_f32 v153, v153
  v_exp_f32 v154, v154
  v_mfma_f32_32x32x16_bf16 v[176:191], v[200:203], v[104:107], v[176:191]
  v_exp_f32 v155, v155
  v_add_f32 v233, v233, v152
  s_waitcnt lgkmcnt(2)
  v_mfma_f32_32x32x16_bf16 v[160:175], v[204:207], v[44:47], v[160:175]
  ds_read_b128 v[200:203], v224 offset:17088
  v_add_f32 v233, v233, v153
  v_add_f32 v233, v233, v154
  v_add_f32 v233, v233, v155
  v_mfma_f32_32x32x16_bf16 v[176:191], v[204:207], v[108:111], v[176:191]
  v_cvt_pk_bf16_f32 v152, v152, v153
  v_cvt_pk_bf16_f32 v153, v154, v155
  v_fma_f32 v156, v156, s44, -v229
  s_waitcnt lgkmcnt(2)
  v_mfma_f32_32x32x16_bf16 v[160:175], v[192:195], v[48:51], v[160:175]
  ds_read_b128 v[204:207], v224 offset:17120
  v_fma_f32 v157, v157, s44, -v229
  v_fma_f32 v158, v158, s44, -v229
  v_fma_f32 v159, v159, s44, -v229
  v_mfma_f32_32x32x16_bf16 v[176:191], v[192:195], v[112:115], v[176:191]
  v_exp_f32 v156, v156
  s_waitcnt lgkmcnt(2)
  v_mfma_f32_32x32x16_bf16 v[160:175], v[196:199], v[52:55], v[160:175]
  ds_read_b64_tr_b16 v[208:209], v225 offset:34816
  ds_read_b64_tr_b16 v[210:211], v225 offset:39168
  v_exp_f32 v157, v157
  v_exp_f32 v158, v158
  v_mfma_f32_32x32x16_bf16 v[176:191], v[196:199], v[116:119], v[176:191]
  v_exp_f32 v159, v159
  s_waitcnt lgkmcnt(3)
  v_mfma_f32_32x32x16_bf16 v[160:175], v[200:203], v[56:59], v[160:175]
  ds_read_b64_tr_b16 v[212:213], v225 offset:35328
  ds_read_b64_tr_b16 v[214:215], v225 offset:39680
  v_add_f32 v233, v233, v156
  v_add_f32 v233, v233, v157
  v_add_f32 v233, v233, v158
  v_mfma_f32_32x32x16_bf16 v[176:191], v[200:203], v[120:123], v[176:191]
  v_add_f32 v233, v233, v159
  v_cvt_pk_bf16_f32 v154, v156, v157
  v_cvt_pk_bf16_f32 v155, v158, v159
  s_waitcnt lgkmcnt(4)
  v_mfma_f32_32x32x16_bf16 v[160:175], v[204:207], v[60:63], v[160:175]
  ds_read_b64_tr_b16 v[216:217], v225 offset:34880
  ds_read_b64_tr_b16 v[218:219], v225 offset:39232
  v_mfma_f32_32x32x16_bf16 v[176:191], v[204:207], v[124:127], v[176:191]
  s_cmp_eq_u32 s56, 0
  s_cbranch_scc1 L_nores24
  s_call_b64 s[58:59], L_resc
L_nores24:
  s_waitcnt lgkmcnt(4)
  v_mfma_f32_32x32x16_bf16 a[0:15], v[208:211], v[128:131], a[0:15]
  ds_read_b64_tr_b16 v[220:221], v225 offset:35392
  ds_read_b64_tr_b16 v[222:223], v225 offset:39744
  v_mfma_f32_32x32x16_bf16 a[16:31], v[208:211], v[144:147], a[16:31]
  s_waitcnt vmcnt(14)
  s_barrier
  s_waitcnt lgkmcnt(4)
  v_mfma_f32_32x32x16_bf16 a[0:15], v[212:215], v[136:139], a[0:15]
  ds_read_b64_tr_b16 v[208:209], v225 offset:34944
  ds_read_b64_tr_b16 v[210:211], v225 offset:39296
  s_add_u32 m0, s60, 0
  s_add_u32 s51, s63, 0
  buffer_load_dwordx4 v251, s[32:35], s51 offen lds
  v_mfma_f32_32x32x16_bf16 a[16:31], v[212:215], v[152:155], a[16:31]
  s_add_u32 m0, s60, 1024
  s_add_u32 s51, s63, 7168
  s_waitcnt lgkmcnt(4)
  v_mfma_f32_32x32x16_bf16 a[32:47], v[216:219], v[128:131], a[32:47]
  ds_read_b64_tr_b16 v[212:213], v225 offset:35456
  ds_read_b64_tr_b16 v[214:215], v225 offset:39808
  buffer_load_dwordx4 v251, s[32:35], s51 offen lds
  s_add_u32 m0, s60, 2048
  s_add_u32 s51, s63, 14336
  v_mfma_f32_32x32x16_bf16 a[48:63], v[216:219], v[144:147], a[48:63]
  buffer_load_dwordx4 v251, s[32:35], s51 offen lds
  s_add_u32 m0, s60, 3072
  s_waitcnt lgkmcnt(4)
  v_mfma_f32_32x32x16_bf16 a[32:47], v[220:223], v[136:139], a[32:47]
  ds_read_b64_tr_b16 v[216:217], v225 offset:35008
  ds_read_b64_tr_b16 v[218:219], v225 offset:39360
  s_add_u32 s51, s63, 21504
  buffer_load_dwordx4 v251, s[32:35], s51 offen lds
  v_mfma_f32_32x32x16_bf16 a[48:63], v[220:223], v[152:155], a[48:63]
  s_add_u32 m0, s60, 4096
  s_add_u32 s51, s63, 28672
  buffer_load_dwordx4 v251, s[32:35], s51 offen lds
  s_waitcnt lgkmcnt(4)
  v_mfma_f32_32x32x16_bf16 a[64:79], v[208:211], v[128:131], a[64:79]
  ds_read_b64_tr_b16 v[220:221], v225 offset:35520
  ds_read_b64_tr_b16 v[222:223], v225 offset:39872
  s_add_u32 m0, s60, 5120
  s_add_u32 s51, s63, 35840
  v_mfma_f32_32x32x16_bf16 a[80:95], v[208:211], v[144:147], a[80:95]
  buffer_load_dwordx4 v251, s[32:35], s51 offen lds
  s_add_u32 m0, s60, 6144
  s_add_u32 s51, s63, 43008
  s_waitcnt lgkmcnt(4)
  v_mfma_f32_32x32x16_bf16 a[64:79], v[212:215], v[136:139], a[64:79]
  ds_read_b64_tr_b16 v[208:209], v225 offset:35072
  ds_read_b64_tr_b16 v[210:211], v225 offset:39424
  buffer_load_dwordx4 v251, s[32:35], s51 offen lds
  v_mfma_f32_32x32x16_bf16 a[80:95], v[212:215], v[152:155], a[80:95]
  s_add_u32 m0, s60, 7168
  s_add_u32 s51, s63, 50176
  buffer_load_dwordx4 v251, s[32:35], s51 offen lds
  s_waitcnt lgkmcnt(4)
  v_mfma_f32_32x32x16_bf16 a[96:111], v[216:219], v[128:131], a[96:111]
  ds_read_b64_tr_b16 v[212:213], v225 offset:35584
  ds_read_b64_tr_b16 v[214:215], v225 offset:39936
  v_max3_f32 v236, v160, v161, v162
  v_max3_f32 v236, v236, v163, v164
  v_mfma_f32_32x32x16_bf16 a[112:127], v[216:219], v[144:147], a[112:127]
  v_max3_f32 v236, v236, v165, v166
  v_max3_f32 v236, v236, v167, v168
  v_max3_f32 v236, v236, v169, v170
  v_max3_f32 v236, v236, v171, v172
  v_max3_f32 v236, v236, v173, v174
  s_waitcnt lgkmcnt(4)
  v_mfma_f32_32x32x16_bf16 a[96:111], v[220:223], v[136:139], a[96:111]
  ds_read_b64_tr_b16 v[216:217], v225 offset:35136
  ds_read_b64_tr_b16 v[218:219], v225 offset:39488
  v_max_f32 v236, v236, v175
  v_max3_f32 v237, v176, v177, v178
  v_max3_f32 v237, v237, v179, v180
  v_mfma_f32_32x32x16_bf16 a[112:127], v[220:223], v[152:155], a[112:127]
  v_max3_f32 v237, v237, v181, v182
  v_max3_f32 v237, v237, v183, v184
  v_max3_f32 v237, v237, v185, v186
  v_max3_f32 v237, v237, v187, v188
  v_max3_f32 v237, v237, v189, v190
  s_waitcnt lgkmcnt(4)
  v_mfma_f32_32x32x16_bf16 a[128:143], v[208:211], v[128:131], a[128:143]
  ds_read_b64_tr_b16 v[220:221], v225 offset:35648
  ds_read_b64_tr_b16 v[222:223], v225 offset:40000
  v_max_f32 v237, v237, v191
  v_mov_b32 v238, v236
  v_mov_b32 v239, v237
  v_mfma_f32_32x32x16_bf16 a[144:159], v[208:211], v[144:147], a[144:159]
  v_permlane32_swap_b32 v236, v238
  v_permlane32_swap_b32 v237, v239
  v_max_f32 v236, v236, v238
  v_max_f32 v237, v237, v239
  s_waitcnt lgkmcnt(4)
  v_mfma_f32_32x32x16_bf16 a[128:143], v[212:215], v[136:139], a[128:143]
  ds_read_b64_tr_b16 v[208:209], v225 offset:35200
  ds_read_b64_tr_b16 v[210:211], v225 offset:39552
  v_cmp_gt_f32 s[52:53], v236, v230
  v_cmp_gt_f32 s[54:55], v237, v231
  s_nop 1
  s_or_b64 s[52:53], s[52:53], s[54:55]
  s_cbranch_scc0 L_noslow25
  s_call_b64 s[58:59], L_slow
L_noslow25:
  v_mfma_f32_32x32x16_bf16 a[144:159], v[212:215], v[152:155], a[144:159]
  v_fma_f32 v160, v160, s44, -v228
  v_fma_f32 v161, v161, s44, -v228
  v_fma_f32 v162, v162, s44, -v228
  v_fma_f32 v163, v163, s44, -v228
  s_waitcnt lgkmcnt(4)
  v_mfma_f32_32x32x16_bf16 a[160:175], v[216:219], v[128:131], a[160:175]
  ds_read_b64_tr_b16 v[212:213], v225 offset:35712
  ds_read_b64_tr_b16 v[214:215], v225 offset:40064
  v_exp_f32 v160, v160
  v_exp_f32 v161, v161
  v_mfma_f32_32x32x16_bf16 a[176:191], v[216:219], v[144:147], a[176:191]
  v_exp_f32 v162, v162
  v_exp_f32 v163, v163
  v_add_f32 v232, v232, v160
  s_waitcnt lgkmcnt(4)
  v_mfma_f32_32x32x16_bf16 a[160:175], v[220:223], v[136:139], a[160:175]
  ds_read_b64_tr_b16 v[216:217], v225 offset:35264
  ds_read_b64_tr_b16 v[218:219], v225 offset:39616
  v_add_f32 v232, v232, v161
  v_add_f32 v232, v232, v162
  v_add_f32 v232, v232, v163
  v_mfma_f32_32x32x16_bf16 a[176:191], v[220:223], v[152:155], a[176:191]
  v_cvt_pk_bf16_f32 v160, v160, v161
  v_cvt_pk_bf16_f32 v161, v162, v163
  v_fma_f32 v164, v164, s44, -v228
  v_fma_f32 v165, v165, s44, -v228
  s_waitcnt lgkmcnt(4)
  v_mfma_f32_32x32x16_bf16 a[192:207], v[208:211], v[128:131], a[192:207]
  ds_read_b64_tr_b16 v[220:221], v225 offset:35776
  ds_read_b64_tr_b16 v[222:223], v225 offset:40128
  v_fma_f32 v166, v166, s44, -v228
  v_fma_f32 v167, v167, s44, -v228
  v_exp_f32 v164, v164
  v_mfma_f32_32x32x16_bf16 a[208:223], v[208:211], v[144:147], a[208:223]
  v_exp_f32 v165, v165
  v_exp_f32 v166, v166
  s_waitcnt lgkmcnt(4)
  v_mfma_f32_32x32x16_bf16 a[192:207], v[212:215], v[136:139], a[192:207]
  ds_read_b128 v[192:195], v224 offset:33280
  v_exp_f32 v167, v167
  v_add_f32 v232, v232, v164
  v_add_f32 v232, v232, v165
  v_mfma_f32_32x32x16_bf16 a[208:223], v[212:215], v[152:155], a[208:223]
  v_add_f32 v232, v232, v166
  v_add_f32 v232, v232, v167
  v_cvt_pk_bf16_f32 v162, v164, v165
  v_cvt_pk_bf16_f32 v163, v166, v167
  v_fma_f32 v168, v168, s44, -v228
  s_waitcnt lgkmcnt(3)
  v_mfma_f32_32x32x16_bf16 a[224:239], v[216:219], v[128:131], a[224:239]
  ds_read_b128 v[196:199], v224 offset:33312
  v_fma_f32 v169, v169, s44, -v228
  v_fma_f32 v170, v170, s44, -v228
  v_fma_f32 v171, v171, s44, -v228
  v_mfma_f32_32x32x16_bf16 a[240:255], v[216:219], v[144:147], a[240:255]
  v_exp_f32 v168, v168
  v_exp_f32 v169, v169
  v_exp_f32 v170, v170
  s_waitcnt lgkmcnt(2)
  v_mfma_f32_32x32x16_bf16 a[224:239], v[220:223], v[136:139], a[224:239]
  ds_read_b128 v[200:203], v224 offset:33344
  v_exp_f32 v171, v171
  v_add_f32 v232, v232, v168
  v_mfma_f32_32x32x16_bf16 a[240:255], v[220:223], v[152:155], a[240:255]
  v_add_f32 v232, v232, v169
  v_add_f32 v232, v232, v170
  v_add_f32 v232, v232, v171
  v_cvt_pk_bf16_f32 v168, v168, v169
  v_cvt_pk_bf16_f32 v169, v170, v171
  s_waitcnt lgkmcnt(2)
  v_mfma_f32_32x32x16_bf16 v[128:143], v[192:195], v[0:3], 0
  ds_read_b128 v[204:207], v224 offset:33376
  v_fma_f32 v172, v172, s44, -v228
  v_fma_f32 v173, v173, s44, -v228
  v_fma_f32 v174, v174, s44, -v228
  v_mfma_f32_32x32x16_bf16 v[144:159], v[192:195], v[64:67], 0
  v_fma_f32 v175, v175, s44, -v228
  v_exp_f32 v172, v172
  s_waitcnt lgkmcnt(2)
  v_mfma_f32_32x32x16_bf16 v[128:143], v[196:199], v[4:7], v[128:143]
  ds_read_b128 v[192:195], v224 offset:33408
  v_exp_f32 v173, v173
  v_mfma_f32_32x32x16_bf16 v[144:159], v[196:199], v[68:71], v[144:159]
  v_exp_f32 v174, v174
  v_exp_f32 v175, v175
  s_waitcnt lgkmcnt(2)
  v_mfma_f32_32x32x16_bf16 v[128:143], v[200:203], v[8:11], v[128:143]
  ds_read_b128 v[196:199], v224 offset:33440
  v_add_f32 v232, v232, v172
  v_add_f32 v232, v232, v173
  v_add_f32 v232, v232, v174
  v_mfma_f32_32x32x16_bf16 v[144:159], v[200:203], v[72:75], v[144:159]
  v_add_f32 v232, v232, v175
  v_cvt_pk_bf16_f32 v170, v172, v173
  v_cvt_pk_bf16_f32 v171, v174, v175
  s_waitcnt lgkmcnt(2)
  v_mfma_f32_32x32x16_bf16 v[128:143], v[204:207], v[12:15], v[128:143]
  ds_read_b128 v[200:203], v224 offset:33472
  v_fma_f32 v176, v176, s44, -v229
  v_fma_f32 v177, v177, s44, -v229
  v_fma_f32 v178, v178, s44, -v229
  v_mfma_f32_32x32x16_bf16 v[144:159], v[204:207], v[76:79], v[144:159]
  v_fma_f32 v179, v179, s44, -v229
  v_exp_f32 v176, v176
  s_waitcnt lgkmcnt(2)
  v_mfma_f32_32x32x16_bf16 v[128:143], v[192:195], v[16:19], v[128:143]
  ds_read_b128 v[204:207], v224 offset:33504
  v_exp_f32 v177, v177
  v_exp_f32 v178, v178
  v_mfma_f32_32x32x16_bf16 v[144:159], v[192:195], v[80:83], v[144:159]
  v_exp_f32 v179, v179
  s_waitcnt lgkmcnt(2)
  v_mfma_f32_32x32x16_bf16 v[128:143], v[196:199], v[20:23], v[128:143]
  ds_read_b128 v[192:195], v224 offset:33536
  v_add_f32 v233, v233, v176
  v_add_f32 v233, v233, v177
  v_add_f32 v233, v233, v178
  v_mfma_f32_32x32x16_bf16 v[144:159], v[196:199], v[84:87], v[144:159]
  v_add_f32 v233, v233, v179
  v_cvt_pk_bf16_f32 v176, v176, v177
  v_cvt_pk_bf16_f32 v177, v178, v179
  s_waitcnt lgkmcnt(2)
  v_mfma_f32_32x32x16_bf16 v[128:143], v[200:203], v[24:27], v[128:143]
  ds_read_b128 v[196:199], v224 offset:33568
  v_fma_f32 v180, v180, s44, -v229
  v_fma_f32 v181, v181, s44, -v229
  v_fma_f32 v182, v182, s44, -v229
  v_mfma_f32_32x32x16_bf16 v[144:159], v[200:203], v[88:91], v[144:159]
  v_fma_f32 v183, v183, s44, -v229
  v_exp_f32 v180, v180
  s_waitcnt lgkmcnt(2)
  v_mfma_f32_32x32x16_bf16 v[128:143], v[204:207], v[28:31], v[128:143]
  ds_read_b128 v[200:203], v224 offset:33600
  v_exp_f32 v181, v181
  v_exp_f32 v182, v182
  v_mfma_f32_32x32x16_bf16 v[144:159], v[204:207], v[92:95], v[144:159]
  v_exp_f32 v183, v183
  v_add_f32 v233, v233, v180
  s_waitcnt lgkmcnt(2)
  v_mfma_f32_32x32x16_bf16 v[128:143], v[192:195], v[32:35], v[128:143]
  ds_read_b128 v[204:207], v224 offset:33632
  v_add_f32 v233, v233, v181
  v_add_f32 v233, v233, v182
  v_mfma_f32_32x32x16_bf16 v[144:159], v[192:195], v[96:99], v[144:159]
  v_add_f32 v233, v233, v183
  v_cvt_pk_bf16_f32 v178, v180, v181
  v_cvt_pk_bf16_f32 v179, v182, v183
  v_fma_f32 v184, v184, s44, -v229
  s_waitcnt lgkmcnt(2)
  v_mfma_f32_32x32x16_bf16 v[128:143], v[196:199], v[36:39], v[128:143]
  ds_read_b128 v[192:195], v224 offset:33664
  v_fma_f32 v185, v185, s44, -v229
  v_fma_f32 v186, v186, s44, -v229
  v_mfma_f32_32x32x16_bf16 v[144:159], v[196:199], v[100:103], v[144:159]
  v_fma_f32 v187, v187, s44, -v229
  v_exp_f32 v184, v184
  s_waitcnt lgkmcnt(2)
  v_mfma_f32_32x32x16_bf16 v[128:143], v[200:203], v[40:43], v[128:143]
  ds_read_b128 v[196:199], v224 offset:33696
  v_exp_f32 v185, v185
  v_exp_f32 v186, v186
  v_mfma_f32_32x32x16_bf16 v[144:159], v[200:203], v[104:107], v[144:159]
  v_exp_f32 v187, v187
  v_add_f32 v233, v233, v184
  s_waitcnt lgkmcnt(2)
  v_mfma_f32_32x32x16_bf16 v[128:143], v[204:207], v[44:47], v[128:143]
  ds_read_b128 v[200:203], v224 offset:33728
  v_add_f32 v233, v233, v185
  v_add_f32 v233, v233, v186
  v_add_f32 v233, v233, v187
  v_mfma_f32_32x32x16_bf16 v[144:159], v[204:207], v[108:111], v[144:159]
  v_cvt_pk_bf16_f32 v184, v184, v185
  v_cvt_pk_bf16_f32 v185, v186, v187
  v_fma_f32 v188, v188, s44, -v229
  s_waitcnt lgkmcnt(2)
  v_mfma_f32_32x32x16_bf16 v[128:143], v[192:195], v[48:51], v[128:143]
  ds_read_b128 v[204:207], v224 offset:33760
  v_fma_f32 v189, v189, s44, -v229
  v_fma_f32 v190, v190, s44, -v229
  v_fma_f32 v191, v191, s44, -v229
  v_mfma_f32_32x32x16_bf16 v[144:159], v[192:195], v[112:115], v[144:159]
  v_exp_f32 v188, v188
  s_waitcnt lgkmcnt(2)
  v_mfma_f32_32x32x16_bf16 v[128:143], v[196:199], v[52:55], v[128:143]
  ds_read_b64_tr_b16 v[208:209], v225 offset:52224
  ds_read_b64_tr_b16 v[210:211], v225 offset:56576
  v_exp_f32 v189, v189
  v_exp_f32 v190, v190
  v_mfma_f32_32x32x16_bf16 v[144:159], v[196:199], v[116:119], v[144:159]
  v_exp_f32 v191, v191
  s_waitcnt lgkmcnt(3)
  v_mfma_f32_32x32x16_bf16 v[128:143], v[200:203], v[56:59], v[128:143]
  ds_read_b64_tr_b16 v[212:213], v225 offset:52736
  ds_read_b64_tr_b16 v[214:215], v225 offset:57088
  v_add_f32 v233, v233, v188
  v_add_f32 v233, v233, v189
  v_add_f32 v233, v233, v190
  v_mfma_f32_32x32x16_bf16 v[144:159], v[200:203], v[120:123], v[144:159]
  v_add_f32 v233, v233, v191
  v_cvt_pk_bf16_f32 v186, v188, v189
  v_cvt_pk_bf16_f32 v187, v190, v191
  s_waitcnt lgkmcnt(4)
  v_mfma_f32_32x32x16_bf16 v[128:143], v[204:207], v[60:63], v[128:143]
  ds_read_b64_tr_b16 v[216:217], v225 offset:52288
  ds_read_b64_tr_b16 v[218:219], v225 offset:56640
  v_mfma_f32_32x32x16_bf16 v[144:159], v[204:207], v[124:127], v[144:159]
  s_cmp_eq_u32 s56, 0
  s_cbranch_scc1 L_nores26
  s_call_b64 s[58:59], L_resc
L_nores26:
  s_waitcnt lgkmcnt(4)
  v_mfma_f32_32x32x16_bf16 a[0:15], v[208:211], v[160:163], a[0:15]
  ds_read_b64_tr_b16 v[220:221], v225 offset:52800
  ds_read_b64_tr_b16 v[222:223], v225 offset:57152
  v_mfma_f32_32x32x16_bf16 a[16:31], v[208:211], v[176:179], a[16:31]
  s_waitcnt vmcnt(14)
  s_barrier
  s_waitcnt lgkmcnt(4)
  v_mfma_f32_32x32x16_bf16 a[0:15], v[212:215], v[168:171], a[0:15]
  ds_read_b64_tr_b16 v[208:209], v225 offset:52352
  ds_read_b64_tr_b16 v[210:211], v225 offset:56704
  v_max3_f32 v236, v128, v129, v130
  v_max3_f32 v236, v236, v131, v132
  v_mfma_f32_32x32x16_bf16 a[16:31], v[212:215], v[184:187], a[16:31]
  v_max3_f32 v236, v236, v133, v134
  v_max3_f32 v236, v236, v135, v136
  v_max3_f32 v236, v236, v137, v138
  s_waitcnt lgkmcnt(4)
  v_mfma_f32_32x32x16_bf16 a[32:47], v[216:219], v[160:163], a[32:47]
  ds_read_b64_tr_b16 v[212:213], v225 offset:52864
  ds_read_b64_tr_b16 v[214:215], v225 offset:57216
  v_max3_f32 v236, v236, v139, v140
  v_max3_f32 v236, v236, v141, v142
  v_mfma_f32_32x32x16_bf16 a[48:63], v[216:219], v[176:179], a[48:63]
  v_max_f32 v236, v236, v143
  v_max3_f32 v237, v144, v145, v146
  v_max3_f32 v237, v237, v147, v148
  s_waitcnt lgkmcnt(4)
  v_mfma_f32_32x32x16_bf16 a[32:47], v[220:223], v[168:171], a[32:47]
  ds_read_b64_tr_b16 v[216:217], v225 offset:52416
  ds_read_b64_tr_b16 v[218:219], v225 offset:56768
  v_max3_f32 v237, v237, v149, v150
  v_max3_f32 v237, v237, v151, v152
  v_mfma_f32_32x32x16_bf16 a[48:63], v[220:223], v[184:187], a[48:63]
  v_max3_f32 v237, v237, v153, v154
  v_max3_f32 v237, v237, v155, v156
  v_max3_f32 v237, v237, v157, v158
  v_max_f32 v237, v237, v159
  s_waitcnt lgkmcnt(4)
  v_mfma_f32_32x32x16_bf16 a[64:79], v[208:211], v[160:163], a[64:79]
  ds_read_b64_tr_b16 v[220:221], v225 offset:52928
  ds_read_b64_tr_b16 v[222:223], v225 offset:57280
  v_mov_b32 v238, v236
  v_mov_b32 v239, v237
  v_mfma_f32_32x32x16_bf16 a[80:95], v[208:211], v[176:179], a[80:95]
  v_permlane32_swap_b32 v236, v238
  v_permlane32_swap_b32 v237, v239
  v_max_f32 v236, v236, v238
  s_waitcnt lgkmcnt(4)
  v_mfma_f32_32x32x16_bf16 a[64:79], v[212:215], v[168:171], a[64:79]
  ds_read_b64_tr_b16 v[208:209], v225 offset:52480
  ds_read_b64_tr_b16 v[210:211], v225 offset:56832
  v_max_f32 v237, v237, v239
  v_cmp_gt_f32 s[52:53], v236, v230
  v_mfma_f32_32x32x16_bf16 a[80:95], v[212:215], v[184:187], a[80:95]
  v_cmp_gt_f32 s[54:55], v237, v231
  s_nop 1
  s_or_b64 s[52:53], s[52:53], s[54:55]
  s_cbranch_scc0 L_noslow27
  s_call_b64 s[58:59], L_slow
L_noslow27:
  s_waitcnt lgkmcnt(4)
  v_mfma_f32_32x32x16_bf16 a[96:111], v[216:219], v[160:163], a[96:111]
  ds_read_b64_tr_b16 v[212:213], v225 offset:52992
  ds_read_b64_tr_b16 v[214:215], v225 offset:57344
  v_fma_f32 v128, v128, s44, -v228
  v_fma_f32 v129, v129, s44, -v228
  v_fma_f32 v130, v130, s44, -v228
  v_mfma_f32_32x32x16_bf16 a[112:127], v[216:219], v[176:179], a[112:127]
  v_fma_f32 v131, v131, s44, -v228
  v_exp_f32 v128, v128
  s_waitcnt lgkmcnt(4)
  v_mfma_f32_32x32x16_bf16 a[96:111], v[220:223], v[168:171], a[96:111]
  ds_read_b64_tr_b16 v[216:217], v225 offset:52544
  ds_read_b64_tr_b16 v[218:219], v225 offset:56896
  v_exp_f32 v129, v129
  v_mfma_f32_32x32x16_bf16 a[112:127], v[220:223], v[184:187], a[112:127]
  v_exp_f32 v130, v130
  s_waitcnt lgkmcnt(4)
  v_mfma_f32_32x32x16_bf16 a[128:143], v[208:211], v[160:163], a[128:143]
  ds_read_b64_tr_b16 v[220:221], v225 offset:53056
  ds_read_b64_tr_b16 v[222:223], v225 offset:57408
  v_exp_f32 v131, v131
  v_add_f32 v232, v232, v128
  v_mfma_f32_32x32x16_bf16 a[144:159], v[208:211], v[176:179], a[144:159]
  v_add_f32 v232, v232, v129
  v_add_f32 v232, v232, v130
  v_add_f32 v232, v232, v131
  s_waitcnt lgkmcnt(4)
  v_mfma_f32_32x32x16_bf16 a[128:143], v[212:215], v[168:171], a[128:143]
  ds_read_b64_tr_b16 v[208:209], v225 offset:52608
  ds_read_b64_tr_b16 v[210:211], v225 offset:56960
  v_cvt_pk_bf16_f32 v128, v128, v129
  v_cvt_pk_bf16_f32 v129, v130, v131
  v_mfma_f32_32x32x16_bf16 a[144:159], v[212:215], v[184:187], a[144:159]
  v_fma_f32 v132, v132, s44, -v228
  v_fma_f32 v133, v133, s44, -v228
  v_fma_f32 v134, v134, s44, -v228
  s_waitcnt lgkmcnt(4)
  v_mfma_f32_32x32x16_bf16 a[160:175], v[216:219], v[160:163], a[160:175]
  ds_read_b64_tr_b16 v[212:213], v225 offset:53120
  ds_read_b64_tr_b16 v[214:215], v225 offset:57472
  v_fma_f32 v135, v135, s44, -v228
  v_exp_f32 v132, v132
  v_mfma_f32_32x32x16_bf16 a[176:191], v[216:219], v[176:179], a[176:191]
  v_exp_f32 v133, v133
  s_waitcnt lgkmcnt(4)
  v_mfma_f32_32x32x16_bf16 a[160:175], v[220:223], v[168:171], a[160:175]
  ds_read_b64_tr_b16 v[216:217], v225 offset:52672
  ds_read_b64_tr_b16 v[218:219], v225 offset:57024
  v_exp_f32 v134, v134
  v_mfma_f32_32x32x16_bf16 a[176:191], v[220:223], v[184:187], a[176:191]
  v_exp_f32 v135, v135
  v_add_f32 v232, v232, v132
  v_add_f32 v232, v232, v133
  s_waitcnt lgkmcnt(4)
  v_mfma_f32_32x32x16_bf16 a[192:207], v[208:211], v[160:163], a[192:207]
  ds_read_b64_tr_b16 v[220:221], v225 offset:53184
  ds_read_b64_tr_b16 v[222:223], v225 offset:57536
  v_add_f32 v232, v232, v134
  v_add_f32 v232, v232, v135
  v_mfma_f32_32x32x16_bf16 a[208:223], v[208:211], v[176:179], a[208:223]
  v_cvt_pk_bf16_f32 v130, v132, v133
  v_cvt_pk_bf16_f32 v131, v134, v135
  v_fma_f32 v136, v136, s44, -v228
  s_waitcnt lgkmcnt(4)
  v_mfma_f32_32x32x16_bf16 a[192:207], v[212:215], v[168:171], a[192:207]
  ds_read_b128 v[192:195], v224 offset:49920
  v_fma_f32 v137, v137, s44, -v228
  v_fma_f32 v138, v138, s44, -v228
  v_mfma_f32_32x32x16_bf16 a[208:223], v[212:215], v[184:187], a[208:223]
  v_fma_f32 v139, v139, s44, -v228
  v_exp_f32 v136, v136
  s_waitcnt lgkmcnt(3)
  v_mfma_f32_32x32x16_bf16 a[224:239], v[216:219], v[160:163], a[224:239]
  ds_read_b128 v[196:199], v224 offset:49952
  v_exp_f32 v137, v137
  v_exp_f32 v138, v138
  v_mfma_f32_32x32x16_bf16 a[240:255], v[216:219], v[176:179], a[240:255]
  v_exp_f32 v139, v139
  s_waitcnt lgkmcnt(2)
  v_mfma_f32_32x32x16_bf16 a[224:239], v[220:223], v[168:171], a[224:239]
  ds_read_b128 v[200:203], v224 offset:49984
  v_add_f32 v232, v232, v136
  v_add_f32 v232, v232, v137
  v_add_f32 v232, v232, v138
  v_mfma_f32_32x32x16_bf16 a[240:255], v[220:223], v[184:187], a[240:255]
  v_add_f32 v232, v232, v139
  v_cvt_pk_bf16_f32 v136, v136, v137
  v_cvt_pk_bf16_f32 v137, v138, v139
  s_waitcnt lgkmcnt(2)
  v_mfma_f32_32x32x16_bf16 v[160:175], v[192:195], v[0:3], 0
  ds_read_b128 v[204:207], v224 offset:50016
  v_fma_f32 v140, v140, s44, -v228
  v_fma_f32 v141, v141, s44, -v228
  v_fma_f32 v142, v142, s44, -v228
  v_mfma_f32_32x32x16_bf16 v[176:191], v[192:195], v[64:67], 0
  v_fma_f32 v143, v143, s44, -v228
  v_exp_f32 v140, v140
  s_waitcnt lgkmcnt(2)
  v_mfma_f32_32x32x16_bf16 v[160:175], v[196:199], v[4:7], v[160:175]
  ds_read_b128 v[192:195], v224 offset:50048
  v_exp_f32 v141, v141
  v_mfma_f32_32x32x16_bf16 v[176:191], v[196:199], v[68:71], v[176:191]
  v_exp_f32 v142, v142
  v_exp_f32 v143, v143
  s_waitcnt lgkmcnt(2)
  v_mfma_f32_32x32x16_bf16 v[160:175], v[200:203], v[8:11], v[160:175]
  ds_read_b128 v[196:199], v224 offset:50080
  v_add_f32 v232, v232, v140
  v_add_f32 v232, v232, v141
  v_add_f32 v232, v232, v142
  v_mfma_f32_32x32x16_bf16 v[176:191], v[200:203], v[72:75], v[176:191]
  v_add_f32 v232, v232, v143
  v_cvt_pk_bf16_f32 v138, v140, v141
  v_cvt_pk_bf16_f32 v139, v142, v143
  s_waitcnt lgkmcnt(2)
  v_mfma_f32_32x32x16_bf16 v[160:175], v[204:207], v[12:15], v[160:175]
  ds_read_b128 v[200:203], v224 offset:50112
  v_fma_f32 v144, v144, s44, -v229
  v_fma_f32 v145, v145, s44, -v229
  v_fma_f32 v146, v146, s44, -v229
  v_mfma_f32_32x32x16_bf16 v[176:191], v[204:207], v[76:79], v[176:191]
  v_fma_f32 v147, v147, s44, -v229
  v_exp_f32 v144, v144
  s_waitcnt lgkmcnt(2)
  v_mfma_f32_32x32x16_bf16 v[160:175], v[192:195], v[16:19], v[160:175]
  ds_read_b128 v[204:207], v224 offset:50144
  v_exp_f32 v145, v145
  v_exp_f32 v146, v146
  v_mfma_f32_32x32x16_bf16 v[176:191], v[192:195], v[80:83], v[176:191]
  v_exp_f32 v147, v147
  s_waitcnt lgkmcnt(2)
  v_mfma_f32_32x32x16_bf16 v[160:175], v[196:199], v[20:23], v[160:175]
  ds_read_b128 v[192:195], v224 offset:50176
  v_add_f32 v233, v233, v144
  v_add_f32 v233, v233, v145
  v_add_f32 v233, v233, v146
  v_mfma_f32_32x32x16_bf16 v[176:191], v[196:199], v[84:87], v[176:191]
  v_add_f32 v233, v233, v147
  v_cvt_pk_bf16_f32 v144, v144, v145
  v_cvt_pk_bf16_f32 v145, v146, v147
  s_waitcnt lgkmcnt(2)
  v_mfma_f32_32x32x16_bf16 v[160:175], v[200:203], v[24:27], v[160:175]
  ds_read_b128 v[196:199], v224 offset:50208
  v_fma_f32 v148, v148, s44, -v229
  v_fma_f32 v149, v149, s44, -v229
  v_fma_f32 v150, v150, s44, -v229
  v_mfma_f32_32x32x16_bf16 v[176:191], v[200:203], v[88:91], v[176:191]
  v_fma_f32 v151, v151, s44, -v229
  v_exp_f32 v148, v148
  s_waitcnt lgkmcnt(2)
  v_mfma_f32_32x32x16_bf16 v[160:175], v[204:207], v[28:31], v[160:175]
  ds_read_b128 v[200:203], v224 offset:50240
  v_exp_f32 v149, v149
  v_exp_f32 v150, v150
  v_mfma_f32_32x32x16_bf16 v[176:191], v[204:207], v[92:95], v[176:191]
  v_exp_f32 v151, v151
  v_add_f32 v233, v233, v148
  s_waitcnt lgkmcnt(2)
  v_mfma_f32_32x32x16_bf16 v[160:175], v[192:195], v[32:35], v[160:175]
  ds_read_b128 v[204:207], v224 offset:50272
  v_add_f32 v233, v233, v149
  v_add_f32 v233, v233, v150
  v_mfma_f32_32x32x16_bf16 v[176:191], v[192:195], v[96:99], v[176:191]
  v_add_f32 v233, v233, v151
  v_cvt_pk_bf16_f32 v146, v148, v149
  v_cvt_pk_bf16_f32 v147, v150, v151
  v_fma_f32 v152, v152, s44, -v229
  s_waitcnt lgkmcnt(2)
  v_mfma_f32_32x32x16_bf16 v[160:175], v[196:199], v[36:39], v[160:175]
  ds_read_b128 v[192:195], v224 offset:50304
  v_fma_f32 v153, v153, s44, -v229
  v_fma_f32 v154, v154, s44, -v229
  v_mfma_f32_32x32x16_bf16 v[176:191], v[196:199], v[100:103], v[176:191]
  v_fma_f32 v155, v155, s44, -v229
  v_exp_f32 v152, v152
  s_waitcnt lgkmcnt(2)
  v_mfma_f32_32x32x16_bf16 v[160:175], v[200:203], v[40:43], v[160:175]
  ds_read_b128 v[196:199], v224 offset:50336
  v_exp_f32 v153, v153
  v_exp_f32 v154, v154
  v_mfma_f32_32x32x16_bf16 v[176:191], v[200:203], v[104:107], v[176:191]
  v_exp_f32 v155, v155
  v_add_f32 v233, v233, v152
  s_waitcnt lgkmcnt(2)
  v_mfma_f32_32x32x16_bf16 v[160:175], v[204:207], v[44:47], v[160:175]
  ds_read_b128 v[200:203], v224 offset:50368
  v_add_f32 v233, v233, v153
  v_add_f32 v233, v233, v154
  v_add_f32 v233, v233, v155
  v_mfma_f32_32x32x16_bf16 v[176:191], v[204:207], v[108:111], v[176:191]
  v_cvt_pk_bf16_f32 v152, v152, v153
  v_cvt_pk_bf16_f32 v153, v154, v155
  v_fma_f32 v156, v156, s44, -v229
  s_waitcnt lgkmcnt(2)
  v_mfma_f32_32x32x16_bf16 v[160:175], v[192:195], v[48:51], v[160:175]
  ds_read_b128 v[204:207], v224 offset:50400
  v_fma_f32 v157, v157, s44, -v229
  v_fma_f32 v158, v158, s44, -v229
  v_fma_f32 v159, v159, s44, -v229
  v_mfma_f32_32x32x16_bf16 v[176:191], v[192:195], v[112:115], v[176:191]
  v_exp_f32 v156, v156
  s_waitcnt lgkmcnt(2)
  v_mfma_f32_32x32x16_bf16 v[160:175], v[196:199], v[52:55], v[160:175]
  ds_read_b64_tr_b16 v[208:209], v250 offset:0
  ds_read_b64_tr_b16 v[210:211], v250 offset:4352
  v_exp_f32 v157, v157
  v_exp_f32 v158, v158
  v_mfma_f32_32x32x16_bf16 v[176:191], v[196:199], v[116:119], v[176:191]
  v_exp_f32 v159, v159
  s_waitcnt lgkmcnt(3)
  v_mfma_f32_32x32x16_bf16 v[160:175], v[200:203], v[56:59], v[160:175]
  ds_read_b64_tr_b16 v[212:213], v250 offset:512
  ds_read_b64_tr_b16 v[214:215], v250 offset:4864
  v_add_f32 v233, v233, v156
  v_add_f32 v233, v233, v157
  v_add_f32 v233, v233, v158
  v_mfma_f32_32x32x16_bf16 v[176:191], v[200:203], v[120:123], v[176:191]
  v_add_f32 v233, v233, v159
  v_cvt_pk_bf16_f32 v154, v156, v157
  v_cvt_pk_bf16_f32 v155, v158, v159
  s_waitcnt lgkmcnt(4)
  v_mfma_f32_32x32x16_bf16 v[160:175], v[204:207], v[60:63], v[160:175]
  ds_read_b64_tr_b16 v[216:217], v250 offset:64
  ds_read_b64_tr_b16 v[218:219], v250 offset:4416
  v_mfma_f32_32x32x16_bf16 v[176:191], v[204:207], v[124:127], v[176:191]
  s_cmp_eq_u32 s56, 0
  s_cbranch_scc1 L_nores28
  s_call_b64 s[58:59], L_resc
L_nores28:
  s_waitcnt lgkmcnt(4)
  v_mfma_f32_32x32x16_bf16 a[0:15], v[208:211], v[128:131], a[0:15]
  ds_read_b64_tr_b16 v[220:221], v250 offset:576
  ds_read_b64_tr_b16 v[222:223], v250 offset:4928
  v_mfma_f32_32x32x16_bf16 a[16:31], v[208:211], v[144:147], a[16:31]
  s_waitcnt vmcnt(8)
  s_barrier
  s_waitcnt lgkmcnt(4)
  v_mfma_f32_32x32x16_bf16 a[0:15], v[212:215], v[136:139], a[0:15]
  ds_read_b64_tr_b16 v[208:209], v250 offset:128
  ds_read_b64_tr_b16 v[210:211], v250 offset:4480
  s_add_u32 m0, s60, 32768
  s_add_u32 s51, s63, 229376
  buffer_load_dwordx4 v251, s[32:35], s51 offen lds
  s_add_u32 m0, s60, 33792
  s_add_u32 s51, s63, 236544
  v_mfma_f32_32x32x16_bf16 a[16:31], v[212:215], v[152:155], a[16:31]
  buffer_load_dwordx4 v251, s[32:35], s51 offen lds
  s_add_u32 m0, s60, 34816
  s_add_u32 s51, s63, 243712
  buffer_load_dwordx4 v251, s[32:35], s51 offen lds
  s_add_u32 m0, s60, 35840
  s_add_u32 s51, s63, 250880
  s_waitcnt lgkmcnt(4)
  v_mfma_f32_32x32x16_bf16 a[32:47], v[216:219], v[128:131], a[32:47]
  ds_read_b64_tr_b16 v[212:213], v250 offset:640
  ds_read_b64_tr_b16 v[214:215], v250 offset:4992
  buffer_load_dwordx4 v251, s[32:35], s51 offen lds
  s_add_u32 m0, s60, 36864
  s_add_u32 s51, s63, 258048
  buffer_load_dwordx4 v251, s[32:35], s51 offen lds
  v_mfma_f32_32x32x16_bf16 a[48:63], v[216:219], v[144:147], a[48:63]
  s_add_u32 m0, s60, 37888
  s_add_u32 s51, s63, 265216
  buffer_load_dwordx4 v251, s[32:35], s51 offen lds
  s_add_u32 m0, s60, 38912
  s_add_u32 s51, s63, 272384
  buffer_load_dwordx4 v251, s[32:35], s51 offen lds
  s_waitcnt lgkmcnt(4)
  v_mfma_f32_32x32x16_bf16 a[32:47], v[220:223], v[136:139], a[32:47]
  ds_read_b64_tr_b16 v[216:217], v250 offset:192
  ds_read_b64_tr_b16 v[218:219], v250 offset:4544
  s_add_u32 m0, s60, 39936
  s_add_u32 s51, s63, 279552
  buffer_load_dwordx4 v251, s[32:35], s51 offen lds
  v_mfma_f32_32x32x16_bf16 a[48:63], v[220:223], v[152:155], a[48:63]
  s_add_u32 m0, s60, 98304
  s_add_u32 s51, s63, 229504
  buffer_load_dwordx4 v251, s[32:35], s51 offen lds
  s_add_u32 m0, s60, 99328
  s_add_u32 s51, s63, 236672
  buffer_load_dwordx4 v251, s[32:35], s51 offen lds
  s_waitcnt lgkmcnt(4)
  v_mfma_f32_32x32x16_bf16 a[64:79], v[208:211], v[128:131], a[64:79]
  ds_read_b64_tr_b16 v[220:221], v250 offset:704
  ds_read_b64_tr_b16 v[222:223], v250 offset:5056
  s_add_u32 m0, s60, 100352
  s_add_u32 s51, s63, 243840
  buffer_load_dwordx4 v251, s[32:35], s51 offen lds
  s_add_u32 m0, s60, 101376
  s_add_u32 s51, s63, 251008
  v_mfma_f32_32x32x16_bf16 a[80:95], v[208:211], v[144:147], a[80:95]
  buffer_load_dwordx4 v251, s[32:35], s51 offen lds
  s_add_u32 m0, s60, 102400
  s_add_u32 s51, s63, 258176
  buffer_load_dwordx4 v251, s[32:35], s51 offen lds
  s_add_u32 m0, s60, 103424
  s_add_u32 s51, s63, 265344
  s_waitcnt lgkmcnt(4)
  v_mfma_f32_32x32x16_bf16 a[64:79], v[212:215], v[136:139], a[64:79]
  ds_read_b64_tr_b16 v[208:209], v250 offset:256
  ds_read_b64_tr_b16 v[210:211], v250 offset:4608
  buffer_load_dwordx4 v251, s[32:35], s51 offen lds
  s_add_u32 m0, s60, 104448
  s_add_u32 s51, s63, 272512
  buffer_load_dwordx4 v251, s[32:35], s51 offen lds
  v_mfma_f32_32x32x16_bf16 a[80:95], v[212:215], v[152:155], a[80:95]
  s_add_u32 m0, s60, 105472
  s_add_u32 s51, s63, 279680
  buffer_load_dwordx4 v251, s[32:35], s51 offen lds
  v_max3_f32 v236, v160, v161, v162
  v_max3_f32 v236, v236, v163, v164
  v_max3_f32 v236, v236, v165, v166
  s_waitcnt lgkmcnt(4)
  v_mfma_f32_32x32x16_bf16 a[96:111], v[216:219], v[128:131], a[96:111]
  ds_read_b64_tr_b16 v[212:213], v250 offset:768
  ds_read_b64_tr_b16 v[214:215], v250 offset:5120
  v_max3_f32 v236, v236, v167, v168
  v_max3_f32 v236, v236, v169, v170
  v_max3_f32 v236, v236, v171, v172
  v_max3_f32 v236, v236, v173, v174
  v_max_f32 v236, v236, v175
  v_max3_f32 v237, v176, v177, v178
  v_max3_f32 v237, v237, v179, v180
  v_mfma_f32_32x32x16_bf16 a[112:127], v[216:219], v[144:147], a[112:127]
  v_max3_f32 v237, v237, v181, v182
  v_max3_f32 v237, v237, v183, v184
  v_max3_f32 v237, v237, v185, v186
  v_max3_f32 v237, v237, v187, v188
  v_max3_f32 v237, v237, v189, v190
  v_max_f32 v237, v237, v191
  v_mov_b32 v238, v236
  v_mov_b32 v239, v237
  s_nop 0
  v_permlane32_swap_b32 v236, v238
  v_permlane32_swap_b32 v237, v239
  s_waitcnt lgkmcnt(4)
  v_mfma_f32_32x32x16_bf16 a[96:111], v[220:223], v[136:139], a[96:111]
  ds_read_b64_tr_b16 v[216:217], v250 offset:320
  ds_read_b64_tr_b16 v[218:219], v250 offset:4672
  v_max_f32 v236, v236, v238
  v_max_f32 v237, v237, v239
  v_cmp_gt_f32 s[52:53], v236, v230
  v_cmp_gt_f32 s[54:55], v237, v231
  s_nop 1
  s_or_b64 s[52:53], s[52:53], s[54:55]
  s_cbranch_scc0 L_noslow29
  s_call_b64 s[58:59], L_slow
L_noslow29:
  v_fma_f32 v160, v160, s44, -v228
  v_mfma_f32_32x32x16_bf16 a[112:127], v[220:223], v[152:155], a[112:127]
  v_fma_f32 v161, v161, s44, -v228
  v_fma_f32 v162, v162, s44, -v228
  v_fma_f32 v163, v163, s44, -v228
  v_exp_f32 v160, v160
  v_exp_f32 v161, v161
  v_exp_f32 v162, v162
  s_waitcnt lgkmcnt(4)
  v_mfma_f32_32x32x16_bf16 a[128:143], v[208:211], v[128:131], a[128:143]
  ds_read_b64_tr_b16 v[220:221], v250 offset:832
  ds_read_b64_tr_b16 v[222:223], v250 offset:5184
  v_exp_f32 v163, v163
  v_add_f32 v232, v232, v160
  v_add_f32 v232, v232, v161
  v_add_f32 v232, v232, v162
  v_add_f32 v232, v232, v163
  v_cvt_pk_bf16_f32 v160, v160, v161
  v_cvt_pk_bf16_f32 v161, v162, v163
  v_mfma_f32_32x32x16_bf16 a[144:159], v[208:211], v[144:147], a[144:159]
  v_fma_f32 v164, v164, s44, -v228
  v_fma_f32 v165, v165, s44, -v228
  v_fma_f32 v166, v166, s44, -v228
  v_fma_f32 v167, v167, s44, -v228
  v_exp_f32 v164, v164
  v_exp_f32 v165, v165
  v_exp_f32 v166, v166
  s_waitcnt lgkmcnt(4)
  v_mfma_f32_32x32x16_bf16 a[128:143], v[212:215], v[136:139], a[128:143]
  ds_read_b64_tr_b16 v[208:209], v250 offset:384
  ds_read_b64_tr_b16 v[210:211], v250 offset:4736
  v_exp_f32 v167, v167
  v_add_f32 v232, v232, v164
  v_add_f32 v232, v232, v165
  v_add_f32 v232, v232, v166
  v_add_f32 v232, v232, v167
  v_mfma_f32_32x32x16_bf16 a[144:159], v[212:215], v[152:155], a[144:159]
  v_cvt_pk_bf16_f32 v162, v164, v165
  v_cvt_pk_bf16_f32 v163, v166, v167
  v_fma_f32 v168, v168, s44, -v228
  v_fma_f32 v169, v169, s44, -v228
  v_fma_f32 v170, v170, s44, -v228
  v_fma_f32 v171, v171, s44, -v228
  v_exp_f32 v168, v168
  v_exp_f32 v169, v169
  s_waitcnt lgkmcnt(4)
  v_mfma_f32_32x32x16_bf16 a[160:175], v[216:219], v[128:131], a[160:175]
  ds_read_b64_tr_b16 v[212:213], v250 offset:896
  ds_read_b64_tr_b16 v[214:215], v250 offset:5248
  v_exp_f32 v170, v170
  v_exp_f32 v171, v171
  v_add_f32 v232, v232, v168
  v_add_f32 v232, v232, v169
  v_add_f32 v232, v232, v170
  v_mfma_f32_32x32x16_bf16 a[176:191], v[216:219], v[144:147], a[176:191]
  v_add_f32 v232, v232, v171
  v_cvt_pk_bf16_f32 v168, v168, v169
  v_cvt_pk_bf16_f32 v169, v170, v171
  v_fma_f32 v172, v172, s44, -v228
  v_fma_f32 v173, v173, s44, -v228
  v_fma_f32 v174, v174, s44, -v228
  v_fma_f32 v175, v175, s44, -v228
  v_exp_f32 v172, v172
  s_waitcnt lgkmcnt(4)
  v_mfma_f32_32x32x16_bf16 a[160:175], v[220:223], v[136:139], a[160:175]
  ds_read_b64_tr_b16 v[216:217], v250 offset:448
  ds_read_b64_tr_b16 v[218:219], v250 offset:4800
  v_exp_f32 v173, v173
  v_exp_f32 v174, v174
  v_exp_f32 v175, v175
  v_add_f32 v232, v232, v172
  v_mfma_f32_32x32x16_bf16 a[176:191], v[220:223], v[152:155], a[176:191]
  v_add_f32 v232, v232, v173
  v_add_f32 v232, v232, v174
  v_add_f32 v232, v232, v175
  v_cvt_pk_bf16_f32 v170, v172, v173
  v_cvt_pk_bf16_f32 v171, v174, v175
  v_fma_f32 v176, v176, s44, -v229
  v_fma_f32 v177, v177, s44, -v229
  v_fma_f32 v178, v178, s44, -v229
  v_fma_f32 v179, v179, s44, -v229
  v_exp_f32 v176, v176
  s_waitcnt lgkmcnt(4)
  v_mfma_f32_32x32x16_bf16 a[192:207], v[208:211], v[128:131], a[192:207]
  ds_read_b64_tr_b16 v[220:221], v250 offset:960
  ds_read_b64_tr_b16 v[222:223], v250 offset:5312
  v_exp_f32 v177, v177
  v_exp_f32 v178, v178
  v_exp_f32 v179, v179
  v_mfma_f32_32x32x16_bf16 a[208:223], v[208:211], v[144:147], a[208:223]
  v_add_f32 v233, v233, v176
  v_add_f32 v233, v233, v177
  v_add_f32 v233, v233, v178
  v_add_f32 v233, v233, v179
  v_cvt_pk_bf16_f32 v176, v176, v177
  v_cvt_pk_bf16_f32 v177, v178, v179
  v_fma_f32 v180, v180, s44, -v229
  v_fma_f32 v181, v181, s44, -v229
  v_fma_f32 v182, v182, s44, -v229
  v_fma_f32 v183, v183, s44, -v229
  s_waitcnt lgkmcnt(4)
  v_mfma_f32_32x32x16_bf16 a[192:207], v[212:215], v[136:139], a[192:207]
  ds_read_b64_tr_b16 v[208:209], v225 offset:0
  ds_read_b64_tr_b16 v[210:211], v225 offset:4352
  v_exp_f32 v180, v180
  v_exp_f32 v181, v181
  v_exp_f32 v182, v182
  v_mfma_f32_32x32x16_bf16 a[208:223], v[212:215], v[152:155], a[208:223]
  v_exp_f32 v183, v183
  v_add_f32 v233, v233, v180
  v_add_f32 v233, v233, v181
  v_add_f32 v233, v233, v182
  v_add_f32 v233, v233, v183
  v_cvt_pk_bf16_f32 v178, v180, v181
  v_cvt_pk_bf16_f32 v179, v182, v183
  v_fma_f32 v184, v184, s44, -v229
  v_fma_f32 v185, v185, s44, -v229
  v_fma_f32 v186, v186, s44, -v229
  s_waitcnt lgkmcnt(4)
  v_mfma_f32_32x32x16_bf16 a[224:239], v[216:219], v[128:131], a[224:239]
  ds_read_b64_tr_b16 v[212:213], v225 offset:512
  ds_read_b64_tr_b16 v[214:215], v225 offset:4864
  v_fma_f32 v187, v187, s44, -v229
  v_exp_f32 v184, v184
  v_exp_f32 v185, v185
  v_exp_f32 v186, v186
  v_mfma_f32_32x32x16_bf16 a[240:255], v[216:219], v[144:147], a[240:255]
  v_exp_f32 v187, v187
  v_add_f32 v233, v233, v184
  v_add_f32 v233, v233, v185
  v_add_f32 v233, v233, v186
  v_add_f32 v233, v233, v187
  v_cvt_pk_bf16_f32 v184, v184, v185
  v_cvt_pk_bf16_f32 v185, v186, v187
  v_fma_f32 v188, v188, s44, -v229
  s_waitcnt lgkmcnt(4)
  v_mfma_f32_32x32x16_bf16 a[224:239], v[220:223], v[136:139], a[224:239]
  ds_read_b64_tr_b16 v[216:217], v225 offset:64
  ds_read_b64_tr_b16 v[218:219], v225 offset:4416
  v_fma_f32 v189, v189, s44, -v229
  v_fma_f32 v190, v190, s44, -v229
  v_fma_f32 v191, v191, s44, -v229
  v_exp_f32 v188, v188
  v_exp_f32 v189, v189
  v_mfma_f32_32x32x16_bf16 a[240:255], v[220:223], v[152:155], a[240:255]
  v_exp_f32 v190, v190
  v_exp_f32 v191, v191
  v_add_f32 v233, v233, v188
  v_add_f32 v233, v233, v189
  v_add_f32 v233, v233, v190
  v_add_f32 v233, v233, v191
  v_cvt_pk_bf16_f32 v186, v188, v189
  v_cvt_pk_bf16_f32 v187, v190, v191
  s_cmp_eq_u32 s56, 0
  s_cbranch_scc1 L_nores30
  s_call_b64 s[58:59], L_resc
L_nores30:
  s_waitcnt lgkmcnt(4)
  v_mfma_f32_32x32x16_bf16 a[0:15], v[208:211], v[160:163], a[0:15]
  ds_read_b64_tr_b16 v[220:221], v225 offset:576
  ds_read_b64_tr_b16 v[222:223], v225 offset:4928
  v_mov_b32 v238, v232
  v_mfma_f32_32x32x16_bf16 a[16:31], v[208:211], v[176:179], a[16:31]
  v_mov_b32 v239, v233
  v_permlane32_swap_b32 v232, v238
  s_waitcnt lgkmcnt(4)
  v_mfma_f32_32x32x16_bf16 a[0:15], v[212:215], v[168:171], a[0:15]
  ds_read_b64_tr_b16 v[208:209], v225 offset:128
  ds_read_b64_tr_b16 v[210:211], v225 offset:4480
  v_permlane32_swap_b32 v233, v239
  v_add_f32 v232, v232, v238
  v_mfma_f32_32x32x16_bf16 a[16:31], v[212:215], v[184:187], a[16:31]
  v_add_f32 v233, v233, v239
  s_waitcnt lgkmcnt(4)
  v_mfma_f32_32x32x16_bf16 a[32:47], v[216:219], v[160:163], a[32:47]
  ds_read_b64_tr_b16 v[212:213], v225 offset:640
  ds_read_b64_tr_b16 v[214:215], v225 offset:4992
  v_rcp_f32 v232, v232
  v_mfma_f32_32x32x16_bf16 a[48:63], v[216:219], v[176:179], a[48:63]
  v_rcp_f32 v233, v233
  s_waitcnt lgkmcnt(4)
  v_mfma_f32_32x32x16_bf16 a[32:47], v[220:223], v[168:171], a[32:47]
  ds_read_b64_tr_b16 v[216:217], v225 offset:192
  ds_read_b64_tr_b16 v[218:219], v225 offset:4544
  v_mfma_f32_32x32x16_bf16 a[48:63], v[220:223], v[184:187], a[48:63]
  v_accvgpr_read_b32 v240, a0
  v_accvgpr_read_b32 v241, a1
  v_accvgpr_read_b32 v242, a2
  v_accvgpr_read_b32 v243, a3
  v_accvgpr_read_b32 v244, a4
  s_waitcnt lgkmcnt(4)
  v_mfma_f32_32x32x16_bf16 a[64:79], v[208:211], v[160:163], a[64:79]
  ds_read_b64_tr_b16 v[220:221], v225 offset:704
  ds_read_b64_tr_b16 v[222:223], v225 offset:5056
  v_accvgpr_read_b32 v245, a5
  v_accvgpr_read_b32 v246, a6
  v_accvgpr_read_b32 v247, a7
  v_mul_f32 v240, v240, v232
  v_mul_f32 v241, v241, v232
  v_mfma_f32_32x32x16_bf16 a[80:95], v[208:211], v[176:179], a[80:95]
  v_mul_f32 v242, v242, v232
  v_mul_f32 v243, v243, v232
  v_mul_f32 v244, v244, v232
  v_mul_f32 v245, v245, v232
  v_mul_f32 v246, v246, v232
  s_waitcnt lgkmcnt(4)
  v_mfma_f32_32x32x16_bf16 a[64:79], v[212:215], v[168:171], a[64:79]
  ds_read_b64_tr_b16 v[208:209], v225 offset:256
  ds_read_b64_tr_b16 v[210:211], v225 offset:4608
  v_mul_f32 v247, v247, v232
  v_cvt_pk_bf16_f32 v0, v240, v241
  v_cvt_pk_bf16_f32 v1, v242, v243
  v_cvt_pk_bf16_f32 v2, v244, v245
  v_cvt_pk_bf16_f32 v3, v246, v247
  v_mfma_f32_32x32x16_bf16 a[80:95], v[212:215], v[184:187], a[80:95]
  v_accvgpr_read_b32 v240, a8
  v_accvgpr_read_b32 v241, a9
  v_accvgpr_read_b32 v242, a10
  v_accvgpr_read_b32 v243, a11
  v_accvgpr_read_b32 v244, a12
  s_waitcnt lgkmcnt(4)
  v_mfma_f32_32x32x16_bf16 a[96:111], v[216:219], v[160:163], a[96:111]
  ds_read_b64_tr_b16 v[212:213], v225 offset:768
  ds_read_b64_tr_b16 v[214:215], v225 offset:5120
  v_accvgpr_read_b32 v245, a13
  v_accvgpr_read_b32 v246, a14
  v_accvgpr_read_b32 v247, a15
  v_mul_f32 v240, v240, v232
  v_mul_f32 v241, v241, v232
  v_mfma_f32_32x32x16_bf16 a[112:127], v[216:219], v[176:179], a[112:127]
  v_mul_f32 v242, v242, v232
  v_mul_f32 v243, v243, v232
  v_mul_f32 v244, v244, v232
  v_mul_f32 v245, v245, v232
  v_mul_f32 v246, v246, v232
  s_waitcnt lgkmcnt(4)
  v_mfma_f32_32x32x16_bf16 a[96:111], v[220:223], v[168:171], a[96:111]
  ds_read_b64_tr_b16 v[216:217], v225 offset:320
  ds_read_b64_tr_b16 v[218:219], v225 offset:4672
  v_mul_f32 v247, v247, v232
  v_cvt_pk_bf16_f32 v4, v240, v241
  v_cvt_pk_bf16_f32 v5, v242, v243
  v_cvt_pk_bf16_f32 v6, v244, v245
  v_cvt_pk_bf16_f32 v7, v246, v247
  v_mfma_f32_32x32x16_bf16 a[112:127], v[220:223], v[184:187], a[112:127]
  v_accvgpr_read_b32 v240, a32
  v_accvgpr_read_b32 v241, a33
  v_accvgpr_read_b32 v242, a34
  v_accvgpr_read_b32 v243, a35
  v_accvgpr_read_b32 v244, a36
  s_waitcnt lgkmcnt(4)
  v_mfma_f32_32x32x16_bf16 a[128:143], v[208:211], v[160:163], a[128:143]
  ds_read_b64_tr_b16 v[220:221], v225 offset:832
  ds_read_b64_tr_b16 v[222:223], v225 offset:5184
  v_accvgpr_read_b32 v245, a37
  v_accvgpr_read_b32 v246, a38
  v_accvgpr_read_b32 v247, a39
  v_mul_f32 v240, v240, v232
  v_mul_f32 v241, v241, v232
  v_mfma_f32_32x32x16_bf16 a[144:159], v[208:211], v[176:179], a[144:159]
  v_mul_f32 v242, v242, v232
  v_mul_f32 v243, v243, v232
  v_mul_f32 v244, v244, v232
  v_mul_f32 v245, v245, v232
  v_mul_f32 v246, v246, v232
  s_waitcnt lgkmcnt(4)
  v_mfma_f32_32x32x16_bf16 a[128:143], v[212:215], v[168:171], a[128:143]
  ds_read_b64_tr_b16 v[208:209], v225 offset:384
  ds_read_b64_tr_b16 v[210:211], v225 offset:4736
  v_mul_f32 v247, v247, v232
  v_cvt_pk_bf16_f32 v8, v240, v241
  v_cvt_pk_bf16_f32 v9, v242, v243
  v_cvt_pk_bf16_f32 v10, v244, v245
  v_cvt_pk_bf16_f32 v11, v246, v247
  v_mfma_f32_32x32x16_bf16 a[144:159], v[212:215], v[184:187], a[144:159]
  v_accvgpr_read_b32 v240, a40
  v_accvgpr_read_b32 v241, a41
  v_accvgpr_read_b32 v242, a42
  v_accvgpr_read_b32 v243, a43
  v_accvgpr_read_b32 v244, a44
  s_waitcnt lgkmcnt(4)
  v_mfma_f32_32x32x16_bf16 a[160:175], v[216:219], v[160:163], a[160:175]
  ds_read_b64_tr_b16 v[212:213], v225 offset:896
  ds_read_b64_tr_b16 v[214:215], v225 offset:5248
  v_accvgpr_read_b32 v245, a45
  v_accvgpr_read_b32 v246, a46
  v_accvgpr_read_b32 v247, a47
  v_mul_f32 v240, v240, v232
  v_mul_f32 v241, v241, v232
  v_mfma_f32_32x32x16_bf16 a[176:191], v[216:219], v[176:179], a[176:191]
  v_mul_f32 v242, v242, v232
  v_mul_f32 v243, v243, v232
  v_mul_f32 v244, v244, v232
  v_mul_f32 v245, v245, v232
  v_mul_f32 v246, v246, v232
  s_waitcnt lgkmcnt(4)
  v_mfma_f32_32x32x16_bf16 a[160:175], v[220:223], v[168:171], a[160:175]
  ds_read_b64_tr_b16 v[216:217], v225 offset:448
  ds_read_b64_tr_b16 v[218:219], v225 offset:4800
  v_mul_f32 v247, v247, v232
  v_cvt_pk_bf16_f32 v12, v240, v241
  v_cvt_pk_bf16_f32 v13, v242, v243
  v_cvt_pk_bf16_f32 v14, v244, v245
  v_cvt_pk_bf16_f32 v15, v246, v247
  v_mfma_f32_32x32x16_bf16 a[176:191], v[220:223], v[184:187], a[176:191]
  v_accvgpr_read_b32 v240, a64
  v_accvgpr_read_b32 v241, a65
  v_accvgpr_read_b32 v242, a66
  v_accvgpr_read_b32 v243, a67
  v_accvgpr_read_b32 v244, a68
  s_waitcnt lgkmcnt(4)
  v_mfma_f32_32x32x16_bf16 a[192:207], v[208:211], v[160:163], a[192:207]
  ds_read_b64_tr_b16 v[220:221], v225 offset:960
  ds_read_b64_tr_b16 v[222:223], v225 offset:5312
  v_accvgpr_read_b32 v245, a69
  v_accvgpr_read_b32 v246, a70
  v_accvgpr_read_b32 v247, a71
  v_mul_f32 v240, v240, v232
  v_mul_f32 v241, v241, v232
  v_mfma_f32_32x32x16_bf16 a[208:223], v[208:211], v[176:179], a[208:223]
  v_mul_f32 v242, v242, v232
  v_mul_f32 v243, v243, v232
  v_mul_f32 v244, v244, v232
  v_mul_f32 v245, v245, v232
  v_mul_f32 v246, v246, v232
  s_waitcnt lgkmcnt(4)
  v_mfma_f32_32x32x16_bf16 a[192:207], v[212:215], v[168:171], a[192:207]
  v_mul_f32 v247, v247, v232
  v_cvt_pk_bf16_f32 v16, v240, v241
  v_cvt_pk_bf16_f32 v17, v242, v243
  v_cvt_pk_bf16_f32 v18, v244, v245
  v_cvt_pk_bf16_f32 v19, v246, v247
  v_mfma_f32_32x32x16_bf16 a[208:223], v[212:215], v[184:187], a[208:223]
  v_accvgpr_read_b32 v240, a72
  v_accvgpr_read_b32 v241, a73
  v_accvgpr_read_b32 v242, a74
  v_accvgpr_read_b32 v243, a75
  v_accvgpr_read_b32 v244, a76
  s_waitcnt lgkmcnt(2)
  v_mfma_f32_32x32x16_bf16 a[224:239], v[216:219], v[160:163], a[224:239]
  v_accvgpr_read_b32 v245, a77
  v_accvgpr_read_b32 v246, a78
  v_accvgpr_read_b32 v247, a79
  v_mul_f32 v240, v240, v232
  v_mul_f32 v241, v241, v232
  v_mfma_f32_32x32x16_bf16 a[240:255], v[216:219], v[176:179], a[240:255]
  v_mul_f32 v242, v242, v232
  v_mul_f32 v243, v243, v232
  v_mul_f32 v244, v244, v232
  v_mul_f32 v245, v245, v232
  v_mul_f32 v246, v246, v232
  s_waitcnt lgkmcnt(0)
  v_mfma_f32_32x32x16_bf16 a[224:239], v[220:223], v[168:171], a[224:239]
  v_mul_f32 v247, v247, v232
  v_cvt_pk_bf16_f32 v20, v240, v241
  v_cvt_pk_bf16_f32 v21, v242, v243
  v_cvt_pk_bf16_f32 v22, v244, v245
  v_cvt_pk_bf16_f32 v23, v246, v247
  v_mfma_f32_32x32x16_bf16 a[240:255], v[220:223], v[184:187], a[240:255]
  s_waitcnt vmcnt(16)
  s_barrier
  s_add_u32 m0, s60, 65536
  s_add_u32 s51, s63, 128
  buffer_load_dwordx4 v251, s[32:35], s51 offen lds
  s_add_u32 m0, s60, 66560
  s_add_u32 s51, s63, 7296
  buffer_load_dwordx4 v251, s[32:35], s51 offen lds
  s_add_u32 m0, s60, 67584
  s_add_u32 s51, s63, 14464
  buffer_load_dwordx4 v251, s[32:35], s51 offen lds
  s_add_u32 m0, s60, 68608
  s_add_u32 s51, s63, 21632
  buffer_load_dwordx4 v251, s[32:35], s51 offen lds
  s_add_u32 m0, s60, 69632
  s_add_u32 s51, s63, 28800
  buffer_load_dwordx4 v251, s[32:35], s51 offen lds
  s_add_u32 m0, s60, 70656
  s_add_u32 s51, s63, 35968
  buffer_load_dwordx4 v251, s[32:35], s51 offen lds
  s_add_u32 m0, s60, 71680
  s_add_u32 s51, s63, 43136
  buffer_load_dwordx4 v251, s[32:35], s51 offen lds
  s_add_u32 m0, s60, 72704
  s_add_u32 s51, s63, 50304
  buffer_load_dwordx4 v251, s[32:35], s51 offen lds
  ds_read_b64_tr_b16 v[192:193], v252 offset:0
  ds_read_b64_tr_b16 v[194:195], v252 offset:512
  ds_read_b64_tr_b16 v[196:197], v253 offset:0
  ds_read_b64_tr_b16 v[198:199], v253 offset:512
  ds_read_b64_tr_b16 v[200:201], v252 offset:2048
  ds_read_b64_tr_b16 v[202:203], v252 offset:2560
  ds_read_b64_tr_b16 v[204:205], v253 offset:2048
  ds_read_b64_tr_b16 v[206:207], v253 offset:2560
  ds_read_b64_tr_b16 v[208:209], v252 offset:4096
  ds_read_b64_tr_b16 v[210:211], v252 offset:4608
  ds_read_b64_tr_b16 v[212:213], v253 offset:4096
  ds_read_b64_tr_b16 v[214:215], v253 offset:4608
  s_waitcnt lgkmcnt(10)
  v_mfma_f32_32x32x16_bf16 v[128:143], v[192:195], v[0:3], 0
  ds_read_b64_tr_b16 v[216:217], v252 offset:6144
  ds_read_b64_tr_b16 v[218:219], v252 offset:6656
  v_accvgpr_read_b32 v240, a96
  v_accvgpr_read_b32 v241, a97
  v_accvgpr_read_b32 v242, a98
  v_accvgpr_read_b32 v243, a99
  v_accvgpr_read_b32 v244, a100
  v_accvgpr_read_b32 v245, a101
  v_accvgpr_read_b32 v246, a102
  v_accvgpr_read_b32 v247, a103
  s_waitcnt lgkmcnt(10)
  v_mfma_f32_32x32x16_bf16 v[144:159], v[196:199], v[0:3], 0
  ds_read_b64_tr_b16 v[220:221], v253 offset:6144
  ds_read_b64_tr_b16 v[222:223], v253 offset:6656
  v_mul_f32 v240, v240, v232
  v_mul_f32 v241, v241, v232
  v_mul_f32 v242, v242, v232
  v_mul_f32 v243, v243, v232
  v_mul_f32 v244, v244, v232
  v_mul_f32 v245, v245, v232
  v_mul_f32 v246, v246, v232
  v_mul_f32 v247, v247, v232
  v_cvt_pk_bf16_f32 v24, v240, v241
  s_waitcnt lgkmcnt(10)
  v_mfma_f32_32x32x16_bf16 v[128:143], v[200:203], v[4:7], v[128:143]
  ds_read_b64_tr_b16 v[192:193], v252 offset:8192
  ds_read_b64_tr_b16 v[194:195], v252 offset:8704
  v_cvt_pk_bf16_f32 v25, v242, v243
  v_cvt_pk_bf16_f32 v26, v244, v245
  v_cvt_pk_bf16_f32 v27, v246, v247
  v_accvgpr_read_b32 v240, a104
  v_accvgpr_read_b32 v241, a105
  v_accvgpr_read_b32 v242, a106
  v_accvgpr_read_b32 v243, a107
  v_accvgpr_read_b32 v244, a108
  v_accvgpr_read_b32 v245, a109
  s_waitcnt lgkmcnt(10)
  v_mfma_f32_32x32x16_bf16 v[144:159], v[204:207], v[4:7], v[144:159]
  ds_read_b64_tr_b16 v[196:197], v253 offset:8192
  ds_read_b64_tr_b16 v[198:199], v253 offset:8704
  v_accvgpr_read_b32 v246, a110
  v_accvgpr_read_b32 v247, a111
  v_mul_f32 v240, v240, v232
  v_mul_f32 v241, v241, v232
  v_mul_f32 v242, v242, v232
  v_mul_f32 v243, v243, v232
  v_mul_f32 v244, v244, v232
  v_mul_f32 v245, v245, v232
  s_waitcnt vmcnt(16)
  s_barrier
  s_waitcnt lgkmcnt(10)
  v_mfma_f32_32x32x16_bf16 v[128:143], v[208:211], v[8:11], v[128:143]
  ds_read_b64_tr_b16 v[200:201], v252 offset:10240
  ds_read_b64_tr_b16 v[202:203], v252 offset:10752
  v_mul_f32 v246, v246, v232
  v_mul_f32 v247, v247, v232
  v_cvt_pk_bf16_f32 v28, v240, v241
  v_cvt_pk_bf16_f32 v29, v242, v243
  v_cvt_pk_bf16_f32 v30, v244, v245
  v_cvt_pk_bf16_f32 v31, v246, v247
  v_accvgpr_read_b32 v240, a128
  v_accvgpr_read_b32 v241, a129
  v_accvgpr_read_b32 v242, a130
  s_waitcnt lgkmcnt(10)
  v_mfma_f32_32x32x16_bf16 v[144:159], v[212:215], v[8:11], v[144:159]
  ds_read_b64_tr_b16 v[204:205], v253 offset:10240
  ds_read_b64_tr_b16 v[206:207], v253 offset:10752
  v_accvgpr_read_b32 v243, a131
  v_accvgpr_read_b32 v244, a132
  v_accvgpr_read_b32 v245, a133
  v_accvgpr_read_b32 v246, a134
  v_accvgpr_read_b32 v247, a135
  v_mul_f32 v240, v240, v232
  v_mul_f32 v241, v241, v232
  v_mul_f32 v242, v242, v232
  v_mul_f32 v243, v243, v232
  s_waitcnt lgkmcnt(10)
  v_mfma_f32_32x32x16_bf16 v[128:143], v[216:219], v[12:15], v[128:143]
  ds_read_b64_tr_b16 v[208:209], v252 offset:12288
  ds_read_b64_tr_b16 v[210:211], v252 offset:12800
  v_mul_f32 v244, v244, v232
  v_mul_f32 v245, v245, v232
  v_mul_f32 v246, v246, v232
  v_mul_f32 v247, v247, v232
  v_cvt_pk_bf16_f32 v32, v240, v241
  v_cvt_pk_bf16_f32 v33, v242, v243
  v_cvt_pk_bf16_f32 v34, v244, v245
  v_cvt_pk_bf16_f32 v35, v246, v247
  s_waitcnt lgkmcnt(10)
  v_mfma_f32_32x32x16_bf16 v[144:159], v[220:223], v[12:15], v[144:159]
  ds_read_b64_tr_b16 v[212:213], v253 offset:12288
  ds_read_b64_tr_b16 v[214:215], v253 offset:12800
  v_accvgpr_read_b32 v240, a136
  v_accvgpr_read_b32 v241, a137
  v_accvgpr_read_b32 v242, a138
  v_accvgpr_read_b32 v243, a139
  v_accvgpr_read_b32 v244, a140
  v_accvgpr_read_b32 v245, a141
  v_accvgpr_read_b32 v246, a142
  v_accvgpr_read_b32 v247, a143
  v_mul_f32 v240, v240, v232
  s_waitcnt lgkmcnt(10)
  v_mfma_f32_32x32x16_bf16 v[128:143], v[192:195], v[16:19], v[128:143]
  ds_read_b64_tr_b16 v[216:217], v252 offset:14336
  ds_read_b64_tr_b16 v[218:219], v252 offset:14848
  v_mul_f32 v241, v241, v232
  v_mul_f32 v242, v242, v232
  v_mul_f32 v243, v243, v232
  v_mul_f32 v244, v244, v232
  v_mul_f32 v245, v245, v232
  v_mul_f32 v246, v246, v232
  v_mul_f32 v247, v247, v232
  v_cvt_pk_bf16_f32 v36, v240, v241
  v_cvt_pk_bf16_f32 v37, v242, v243
  s_waitcnt lgkmcnt(10)
  v_mfma_f32_32x32x16_bf16 v[144:159], v[196:199], v[16:19], v[144:159]
  ds_read_b64_tr_b16 v[220:221], v253 offset:14336
  ds_read_b64_tr_b16 v[222:223], v253 offset:14848
  v_cvt_pk_bf16_f32 v38, v244, v245
  v_cvt_pk_bf16_f32 v39, v246, v247
  v_accvgpr_read_b32 v240, a160
  v_accvgpr_read_b32 v241, a161
  v_accvgpr_read_b32 v242, a162
  v_accvgpr_read_b32 v243, a163
  v_accvgpr_read_b32 v244, a164
  v_accvgpr_read_b32 v245, a165
  s_waitcnt lgkmcnt(10)
  v_mfma_f32_32x32x16_bf16 v[128:143], v[200:203], v[20:23], v[128:143]
  ds_read_b64_tr_b16 v[192:193], v252 offset:16384
  ds_read_b64_tr_b16 v[194:195], v252 offset:16896
  v_accvgpr_read_b32 v246, a166
  v_accvgpr_read_b32 v247, a167
  v_mul_f32 v240, v240, v232
  v_mul_f32 v241, v241, v232
  v_mul_f32 v242, v242, v232
  v_mul_f32 v243, v243, v232
  v_mul_f32 v244, v244, v232
  v_mul_f32 v245, v245, v232
  v_mul_f32 v246, v246, v232
  s_waitcnt lgkmcnt(10)
  v_mfma_f32_32x32x16_bf16 v[144:159], v[204:207], v[20:23], v[144:159]
  ds_read_b64_tr_b16 v[196:197], v253 offset:16384
  ds_read_b64_tr_b16 v[198:199], v253 offset:16896
  v_mul_f32 v247, v247, v232
  v_cvt_pk_bf16_f32 v40, v240, v241
  v_cvt_pk_bf16_f32 v41, v242, v243
  v_cvt_pk_bf16_f32 v42, v244, v245
  v_cvt_pk_bf16_f32 v43, v246, v247
  v_accvgpr_read_b32 v240, a168
  v_accvgpr_read_b32 v241, a169
  v_accvgpr_read_b32 v242, a170
  v_accvgpr_read_b32 v243, a171
  s_waitcnt lgkmcnt(10)
  v_mfma_f32_32x32x16_bf16 v[128:143], v[208:211], v[24:27], v[128:143]
  ds_read_b64_tr_b16 v[200:201], v252 offset:18432
  ds_read_b64_tr_b16 v[202:203], v252 offset:18944
  v_accvgpr_read_b32 v244, a172
  v_accvgpr_read_b32 v245, a173
  v_accvgpr_read_b32 v246, a174
  v_accvgpr_read_b32 v247, a175
  v_mul_f32 v240, v240, v232
  v_mul_f32 v241, v241, v232
  v_mul_f32 v242, v242, v232
  v_mul_f32 v243, v243, v232
  s_waitcnt lgkmcnt(10)
  v_mfma_f32_32x32x16_bf16 v[144:159], v[212:215], v[24:27], v[144:159]
  ds_read_b64_tr_b16 v[204:205], v253 offset:18432
  ds_read_b64_tr_b16 v[206:207], v253 offset:18944
  v_mul_f32 v244, v244, v232
  v_mul_f32 v245, v245, v232
  v_mul_f32 v246, v246, v232
  v_mul_f32 v247, v247, v232
  v_cvt_pk_bf16_f32 v44, v240, v241
  v_cvt_pk_bf16_f32 v45, v242, v243
  v_cvt_pk_bf16_f32 v46, v244, v245
  v_cvt_pk_bf16_f32 v47, v246, v247
  v_accvgpr_read_b32 v240, a192
  s_waitcnt lgkmcnt(10)
  v_mfma_f32_32x32x16_bf16 v[128:143], v[216:219], v[28:31], v[128:143]
  ds_read_b64_tr_b16 v[208:209], v252 offset:20480
  ds_read_b64_tr_b16 v[210:211], v252 offset:20992
  v_accvgpr_read_b32 v241, a193
  v_accvgpr_read_b32 v242, a194
  v_accvgpr_read_b32 v243, a195
  v_accvgpr_read_b32 v244, a196
  v_accvgpr_read_b32 v245, a197
  v_accvgpr_read_b32 v246, a198
  v_accvgpr_read_b32 v247, a199
  v_mul_f32 v240, v240, v232
  v_mul_f32 v241, v241, v232
  s_waitcnt lgkmcnt(10)
  v_mfma_f32_32x32x16_bf16 v[144:159], v[220:223], v[28:31], v[144:159]
  ds_read_b64_tr_b16 v[212:213], v253 offset:20480
  ds_read_b64_tr_b16 v[214:215], v253 offset:20992
  v_mul_f32 v242, v242, v232
  v_mul_f32 v243, v243, v232
  v_mul_f32 v244, v244, v232
  v_mul_f32 v245, v245, v232
  v_mul_f32 v246, v246, v232
  v_mul_f32 v247, v247, v232
  v_cvt_pk_bf16_f32 v48, v240, v241
  v_cvt_pk_bf16_f32 v49, v242, v243
  s_waitcnt lgkmcnt(10)
  v_mfma_f32_32x32x16_bf16 v[128:143], v[192:195], v[32:35], v[128:143]
  ds_read_b64_tr_b16 v[216:217], v252 offset:22528
  ds_read_b64_tr_b16 v[218:219], v252 offset:23040
  v_cvt_pk_bf16_f32 v50, v244, v245
  v_cvt_pk_bf16_f32 v51, v246, v247
  v_accvgpr_read_b32 v240, a200
  v_accvgpr_read_b32 v241, a201
  v_accvgpr_read_b32 v242, a202
  v_accvgpr_read_b32 v243, a203
  v_accvgpr_read_b32 v244, a204
  v_accvgpr_read_b32 v245, a205
  v_accvgpr_read_b32 v246, a206
  s_waitcnt lgkmcnt(10)
  v_mfma_f32_32x32x16_bf16 v[144:159], v[196:199], v[32:35], v[144:159]
  ds_read_b64_tr_b16 v[220:221], v253 offset:22528
  ds_read_b64_tr_b16 v[222:223], v253 offset:23040
  v_accvgpr_read_b32 v247, a207
  v_mul_f32 v240, v240, v232
  v_mul_f32 v241, v241, v232
  v_mul_f32 v242, v242, v232
  v_mul_f32 v243, v243, v232
  v_mul_f32 v244, v244, v232
  v_mul_f32 v245, v245, v232
  v_mul_f32 v246, v246, v232
  v_mul_f32 v247, v247, v232
  s_waitcnt lgkmcnt(10)
  v_mfma_f32_32x32x16_bf16 v[128:143], v[200:203], v[36:39], v[128:143]
  ds_read_b64_tr_b16 v[192:193], v252 offset:24576
  ds_read_b64_tr_b16 v[194:195], v252 offset:25088
  v_cvt_pk_bf16_f32 v52, v240, v241
  v_cvt_pk_bf16_f32 v53, v242, v243
  v_cvt_pk_bf16_f32 v54, v244, v245
  v_cvt_pk_bf16_f32 v55, v246, v247
  v_accvgpr_read_b32 v240, a224
  v_accvgpr_read_b32 v241, a225
  v_accvgpr_read_b32 v242, a226
  v_accvgpr_read_b32 v243, a227
  s_waitcnt lgkmcnt(10)
  v_mfma_f32_32x32x16_bf16 v[144:159], v[204:207], v[36:39], v[144:159]
  ds_read_b64_tr_b16 v[196:197], v253 offset:24576
  ds_read_b64_tr_b16 v[198:199], v253 offset:25088
  v_accvgpr_read_b32 v244, a228
  v_accvgpr_read_b32 v245, a229
  v_accvgpr_read_b32 v246, a230
  v_accvgpr_read_b32 v247, a231
  v_mul_f32 v240, v240, v232
  v_mul_f32 v241, v241, v232
  v_mul_f32 v242, v242, v232
  v_mul_f32 v243, v243, v232
  v_mul_f32 v244, v244, v232
  s_waitcnt lgkmcnt(10)
  v_mfma_f32_32x32x16_bf16 v[128:143], v[208:211], v[40:43], v[128:143]
  ds_read_b64_tr_b16 v[200:201], v252 offset:26624
  ds_read_b64_tr_b16 v[202:203], v252 offset:27136
  v_mul_f32 v245, v245, v232
  v_mul_f32 v246, v246, v232
  v_mul_f32 v247, v247, v232
  v_cvt_pk_bf16_f32 v56, v240, v241
  v_cvt_pk_bf16_f32 v57, v242, v243
  v_cvt_pk_bf16_f32 v58, v244, v245
  v_cvt_pk_bf16_f32 v59, v246, v247
  v_accvgpr_read_b32 v240, a232
  v_accvgpr_read_b32 v241, a233
  s_waitcnt lgkmcnt(10)
  v_mfma_f32_32x32x16_bf16 v[144:159], v[212:215], v[40:43], v[144:159]
  ds_read_b64_tr_b16 v[204:205], v253 offset:26624
  ds_read_b64_tr_b16 v[206:207], v253 offset:27136
  v_accvgpr_read_b32 v242, a234
  v_accvgpr_read_b32 v243, a235
  v_accvgpr_read_b32 v244, a236
  v_accvgpr_read_b32 v245, a237
  v_accvgpr_read_b32 v246, a238
  v_accvgpr_read_b32 v247, a239
  v_mul_f32 v240, v240, v232
  v_mul_f32 v241, v241, v232
  s_waitcnt lgkmcnt(10)
  v_mfma_f32_32x32x16_bf16 v[128:143], v[216:219], v[44:47], v[128:143]
  ds_read_b64_tr_b16 v[208:209], v252 offset:28672
  ds_read_b64_tr_b16 v[210:211], v252 offset:29184
  v_mul_f32 v242, v242, v232
  v_mul_f32 v243, v243, v232
  v_mul_f32 v244, v244, v232
  v_mul_f32 v245, v245, v232
  v_mul_f32 v246, v246, v232
  v_mul_f32 v247, v247, v232
  v_cvt_pk_bf16_f32 v60, v240, v241
  v_cvt_pk_bf16_f32 v61, v242, v243
  v_cvt_pk_bf16_f32 v62, v244, v245
  s_waitcnt lgkmcnt(10)
  v_mfma_f32_32x32x16_bf16 v[144:159], v[220:223], v[44:47], v[144:159]
  ds_read_b64_tr_b16 v[212:213], v253 offset:28672
  ds_read_b64_tr_b16 v[214:215], v253 offset:29184
  v_cvt_pk_bf16_f32 v63, v246, v247
  v_accvgpr_read_b32 v240, a16
  v_accvgpr_read_b32 v241, a17
  v_accvgpr_read_b32 v242, a18
  v_accvgpr_read_b32 v243, a19
  v_accvgpr_read_b32 v244, a20
  v_accvgpr_read_b32 v245, a21
  v_accvgpr_read_b32 v246, a22
  v_accvgpr_read_b32 v247, a23
  s_waitcnt lgkmcnt(10)
  v_mfma_f32_32x32x16_bf16 v[128:143], v[192:195], v[48:51], v[128:143]
  ds_read_b64_tr_b16 v[216:217], v252 offset:30720
  ds_read_b64_tr_b16 v[218:219], v252 offset:31232
  v_mul_f32 v240, v240, v233
  v_mul_f32 v241, v241, v233
  v_mul_f32 v242, v242, v233
  v_mul_f32 v243, v243, v233
  v_mul_f32 v244, v244, v233
  v_mul_f32 v245, v245, v233
  v_mul_f32 v246, v246, v233
  v_mul_f32 v247, v247, v233
  s_waitcnt lgkmcnt(10)
  v_mfma_f32_32x32x16_bf16 v[144:159], v[196:199], v[48:51], v[144:159]
  ds_read_b64_tr_b16 v[220:221], v253 offset:30720
  ds_read_b64_tr_b16 v[222:223], v253 offset:31232
  v_cvt_pk_bf16_f32 v64, v240, v241
  v_cvt_pk_bf16_f32 v65, v242, v243
  v_cvt_pk_bf16_f32 v66, v244, v245
  v_cvt_pk_bf16_f32 v67, v246, v247
  v_accvgpr_read_b32 v240, a24
  v_accvgpr_read_b32 v241, a25
  v_accvgpr_read_b32 v242, a26
  v_accvgpr_read_b32 v243, a27
  v_accvgpr_read_b32 v244, a28
  s_waitcnt lgkmcnt(10)
  v_mfma_f32_32x32x16_bf16 v[128:143], v[200:203], v[52:55], v[128:143]
  ds_read_b64_tr_b16 v[192:193], v252 offset:32768
  ds_read_b64_tr_b16 v[194:195], v252 offset:33280
  v_accvgpr_read_b32 v245, a29
  v_accvgpr_read_b32 v246, a30
  v_accvgpr_read_b32 v247, a31
  v_mul_f32 v240, v240, v233
  v_mul_f32 v241, v241, v233
  v_mul_f32 v242, v242, v233
  v_mul_f32 v243, v243, v233
  v_mul_f32 v244, v244, v233
  v_mul_f32 v245, v245, v233
  s_waitcnt lgkmcnt(10)
  v_mfma_f32_32x32x16_bf16 v[144:159], v[204:207], v[52:55], v[144:159]
  ds_read_b64_tr_b16 v[196:197], v253 offset:32768
  ds_read_b64_tr_b16 v[198:199], v253 offset:33280
  v_mul_f32 v246, v246, v233
  v_mul_f32 v247, v247, v233
  v_cvt_pk_bf16_f32 v68, v240, v241
  v_cvt_pk_bf16_f32 v69, v242, v243
  v_cvt_pk_bf16_f32 v70, v244, v245
  v_cvt_pk_bf16_f32 v71, v246, v247
  v_accvgpr_read_b32 v240, a48
  v_accvgpr_read_b32 v241, a49
  s_waitcnt lgkmcnt(10)
  v_mfma_f32_32x32x16_bf16 v[128:143], v[208:211], v[56:59], v[128:143]
  ds_read_b64_tr_b16 v[200:201], v252 offset:34816
  ds_read_b64_tr_b16 v[202:203], v252 offset:35328
  v_accvgpr_read_b32 v242, a50
  v_accvgpr_read_b32 v243, a51
  v_accvgpr_read_b32 v244, a52
  v_accvgpr_read_b32 v245, a53
  v_accvgpr_read_b32 v246, a54
  v_accvgpr_read_b32 v247, a55
  v_mul_f32 v240, v240, v233
  v_mul_f32 v241, v241, v233
  v_mul_f32 v242, v242, v233
  s_waitcnt lgkmcnt(10)
  v_mfma_f32_32x32x16_bf16 v[144:159], v[212:215], v[56:59], v[144:159]
  ds_read_b64_tr_b16 v[204:205], v253 offset:34816
  ds_read_b64_tr_b16 v[206:207], v253 offset:35328
  v_mul_f32 v243, v243, v233
  v_mul_f32 v244, v244, v233
  v_mul_f32 v245, v245, v233
  v_mul_f32 v246, v246, v233
  v_mul_f32 v247, v247, v233
  v_cvt_pk_bf16_f32 v72, v240, v241
  v_cvt_pk_bf16_f32 v73, v242, v243
  v_cvt_pk_bf16_f32 v74, v244, v245
  v_cvt_pk_bf16_f32 v75, v246, v247
  s_waitcnt lgkmcnt(10)
  v_mfma_f32_32x32x16_bf16 v[128:143], v[216:219], v[60:63], v[128:143]
  ds_read_b64_tr_b16 v[208:209], v252 offset:36864
  ds_read_b64_tr_b16 v[210:211], v252 offset:37376
  v_accvgpr_read_b32 v240, a56
  v_accvgpr_read_b32 v241, a57
  v_accvgpr_read_b32 v242, a58
  v_accvgpr_read_b32 v243, a59
  v_accvgpr_read_b32 v244, a60
  v_accvgpr_read_b32 v245, a61
  v_accvgpr_read_b32 v246, a62
  v_accvgpr_read_b32 v247, a63
  s_waitcnt lgkmcnt(10)
  v_mfma_f32_32x32x16_bf16 v[144:159], v[220:223], v[60:63], v[144:159]
  ds_read_b64_tr_b16 v[212:213], v253 offset:36864
  ds_read_b64_tr_b16 v[214:215], v253 offset:37376
  v_mul_f32 v240, v240, v233
  v_mul_f32 v241, v241, v233
  v_mul_f32 v242, v242, v233
  v_mul_f32 v243, v243, v233
  v_mul_f32 v244, v244, v233
  v_mul_f32 v245, v245, v233
  v_mul_f32 v246, v246, v233
  v_mul_f32 v247, v247, v233
  v_cvt_pk_bf16_f32 v76, v240, v241
  s_waitcnt lgkmcnt(10)
  v_mfma_f32_32x32x16_bf16 v[128:143], v[192:195], v[64:67], v[128:143]
  ds_read_b64_tr_b16 v[216:217], v252 offset:38912
  ds_read_b64_tr_b16 v[218:219], v252 offset:39424
  v_cvt_pk_bf16_f32 v77, v242, v243
  v_cvt_pk_bf16_f32 v78, v244, v245
  v_cvt_pk_bf16_f32 v79, v246, v247
  v_accvgpr_read_b32 v240, a80
  v_accvgpr_read_b32 v241, a81
  v_accvgpr_read_b32 v242, a82
  v_accvgpr_read_b32 v243, a83
  v_accvgpr_read_b32 v244, a84
  v_accvgpr_read_b32 v245, a85
  s_waitcnt lgkmcnt(10)
  v_mfma_f32_32x32x16_bf16 v[144:159], v[196:199], v[64:67], v[144:159]
  ds_read_b64_tr_b16 v[220:221], v253 offset:38912
  ds_read_b64_tr_b16 v[222:223], v253 offset:39424
  v_accvgpr_read_b32 v246, a86
  v_accvgpr_read_b32 v247, a87
  v_mul_f32 v240, v240, v233
  v_mul_f32 v241, v241, v233
  v_mul_f32 v242, v242, v233
  v_mul_f32 v243, v243, v233
  v_mul_f32 v244, v244, v233
  v_mul_f32 v245, v245, v233
  s_waitcnt lgkmcnt(10)
  v_mfma_f32_32x32x16_bf16 v[128:143], v[200:203], v[68:71], v[128:143]
  ds_read_b64_tr_b16 v[192:193], v252 offset:40960
  ds_read_b64_tr_b16 v[194:195], v252 offset:41472
  v_mul_f32 v246, v246, v233
  v_mul_f32 v247, v247, v233
  v_cvt_pk_bf16_f32 v80, v240, v241
  v_cvt_pk_bf16_f32 v81, v242, v243
  v_cvt_pk_bf16_f32 v82, v244, v245
  v_cvt_pk_bf16_f32 v83, v246, v247
  v_accvgpr_read_b32 v240, a88
  v_accvgpr_read_b32 v241, a89
  v_accvgpr_read_b32 v242, a90
  s_waitcnt lgkmcnt(10)
  v_mfma_f32_32x32x16_bf16 v[144:159], v[204:207], v[68:71], v[144:159]
  ds_read_b64_tr_b16 v[196:197], v253 offset:40960
  ds_read_b64_tr_b16 v[198:199], v253 offset:41472
  v_accvgpr_read_b32 v243, a91
  v_accvgpr_read_b32 v244, a92
  v_accvgpr_read_b32 v245, a93
  v_accvgpr_read_b32 v246, a94
  v_accvgpr_read_b32 v247, a95
  v_mul_f32 v240, v240, v233
  v_mul_f32 v241, v241, v233
  v_mul_f32 v242, v242, v233
  v_mul_f32 v243, v243, v233
  s_waitcnt vmcnt(0)
  s_barrier
  s_waitcnt lgkmcnt(10)
  v_mfma_f32_32x32x16_bf16 v[128:143], v[208:211], v[72:75], v[128:143]
  ds_read_b64_tr_b16 v[200:201], v252 offset:43008
  ds_read_b64_tr_b16 v[202:203], v252 offset:43520
  v_mul_f32 v244, v244, v233
  v_mul_f32 v245, v245, v233
  v_mul_f32 v246, v246, v233
  v_mul_f32 v247, v247, v233
  v_cvt_pk_bf16_f32 v84, v240, v241
  v_cvt_pk_bf16_f32 v85, v242, v243
  v_cvt_pk_bf16_f32 v86, v244, v245
  v_cvt_pk_bf16_f32 v87, v246, v247
  s_add_u32 m0, s60, 0
  s_add_u32 s51, s63, 256
  s_waitcnt lgkmcnt(10)
  v_mfma_f32_32x32x16_bf16 v[144:159], v[212:215], v[72:75], v[144:159]
  ds_read_b64_tr_b16 v[204:205], v253 offset:43008
  ds_read_b64_tr_b16 v[206:207], v253 offset:43520
  v_accvgpr_read_b32 v240, a112
  v_accvgpr_read_b32 v241, a113
  v_accvgpr_read_b32 v242, a114
  v_accvgpr_read_b32 v243, a115
  v_accvgpr_read_b32 v244, a116
  v_accvgpr_read_b32 v245, a117
  v_accvgpr_read_b32 v246, a118
  v_accvgpr_read_b32 v247, a119
  v_mul_f32 v240, v240, v233
  buffer_load_dwordx4 v251, s[32:35], s51 offen lds
  s_waitcnt lgkmcnt(10)
  v_mfma_f32_32x32x16_bf16 v[128:143], v[216:219], v[76:79], v[128:143]
  ds_read_b64_tr_b16 v[208:209], v252 offset:45056
  ds_read_b64_tr_b16 v[210:211], v252 offset:45568
  v_mul_f32 v241, v241, v233
  v_mul_f32 v242, v242, v233
  v_mul_f32 v243, v243, v233
  v_mul_f32 v244, v244, v233
  v_mul_f32 v245, v245, v233
  v_mul_f32 v246, v246, v233
  v_mul_f32 v247, v247, v233
  v_cvt_pk_bf16_f32 v88, v240, v241
  v_cvt_pk_bf16_f32 v89, v242, v243
  s_add_u32 m0, s60, 1024
  s_waitcnt lgkmcnt(10)
  v_mfma_f32_32x32x16_bf16 v[144:159], v[220:223], v[76:79], v[144:159]
  ds_read_b64_tr_b16 v[212:213], v253 offset:45056
  ds_read_b64_tr_b16 v[214:215], v253 offset:45568
  v_cvt_pk_bf16_f32 v90, v244, v245
  v_cvt_pk_bf16_f32 v91, v246, v247
  v_accvgpr_read_b32 v240, a120
  v_accvgpr_read_b32 v241, a121
  v_accvgpr_read_b32 v242, a122
  v_accvgpr_read_b32 v243, a123
  v_accvgpr_read_b32 v244, a124
  v_accvgpr_read_b32 v245, a125
  s_add_u32 s51, s63, 7424
  s_waitcnt lgkmcnt(10)
  v_mfma_f32_32x32x16_bf16 v[128:143], v[192:195], v[80:83], v[128:143]
  ds_read_b64_tr_b16 v[216:217], v252 offset:47104
  ds_read_b64_tr_b16 v[218:219], v252 offset:47616
  v_accvgpr_read_b32 v246, a126
  v_accvgpr_read_b32 v247, a127
  v_mul_f32 v240, v240, v233
  v_mul_f32 v241, v241, v233
  v_mul_f32 v242, v242, v233
  v_mul_f32 v243, v243, v233
  v_mul_f32 v244, v244, v233
  v_mul_f32 v245, v245, v233
  v_mul_f32 v246, v246, v233
  buffer_load_dwordx4 v251, s[32:35], s51 offen lds
  s_waitcnt lgkmcnt(10)
  v_mfma_f32_32x32x16_bf16 v[144:159], v[196:199], v[80:83], v[144:159]
  ds_read_b64_tr_b16 v[220:221], v253 offset:47104
  ds_read_b64_tr_b16 v[222:223], v253 offset:47616
  v_mul_f32 v247, v247, v233
  v_cvt_pk_bf16_f32 v92, v240, v241
  v_cvt_pk_bf16_f32 v93, v242, v243
  v_cvt_pk_bf16_f32 v94, v244, v245
  v_cvt_pk_bf16_f32 v95, v246, v247
  v_accvgpr_read_b32 v240, a144
  v_accvgpr_read_b32 v241, a145
  v_accvgpr_read_b32 v242, a146
  v_accvgpr_read_b32 v243, a147
  s_add_u32 m0, s60, 2048
  s_add_u32 s51, s63, 14592
  s_waitcnt lgkmcnt(10)
  v_mfma_f32_32x32x16_bf16 v[128:143], v[200:203], v[84:87], v[128:143]
  ds_read_b64_tr_b16 v[192:193], v252 offset:49152
  ds_read_b64_tr_b16 v[194:195], v252 offset:49664
  v_accvgpr_read_b32 v244, a148
  v_accvgpr_read_b32 v245, a149
  v_accvgpr_read_b32 v246, a150
  v_accvgpr_read_b32 v247, a151
  v_mul_f32 v240, v240, v233
  v_mul_f32 v241, v241, v233
  v_mul_f32 v242, v242, v233
  v_mul_f32 v243, v243, v233
  s_waitcnt lgkmcnt(10)
  v_mfma_f32_32x32x16_bf16 v[144:159], v[204:207], v[84:87], v[144:159]
  ds_read_b64_tr_b16 v[196:197], v253 offset:49152
  ds_read_b64_tr_b16 v[198:199], v253 offset:49664
  v_mul_f32 v244, v244, v233
  v_mul_f32 v245, v245, v233
  v_mul_f32 v246, v246, v233
  v_mul_f32 v247, v247, v233
  v_cvt_pk_bf16_f32 v96, v240, v241
  v_cvt_pk_bf16_f32 v97, v242, v243
  v_cvt_pk_bf16_f32 v98, v244, v245
  v_cvt_pk_bf16_f32 v99, v246, v247
  v_accvgpr_read_b32 v240, a152
  buffer_load_dwordx4 v251, s[32:35], s51 offen lds
  s_waitcnt lgkmcnt(10)
  v_mfma_f32_32x32x16_bf16 v[128:143], v[208:211], v[88:91], v[128:143]
  ds_read_b64_tr_b16 v[200:201], v252 offset:51200
  ds_read_b64_tr_b16 v[202:203], v252 offset:51712
  v_accvgpr_read_b32 v241, a153
  v_accvgpr_read_b32 v242, a154
  v_accvgpr_read_b32 v243, a155
  v_accvgpr_read_b32 v244, a156
  v_accvgpr_read_b32 v245, a157
  v_accvgpr_read_b32 v246, a158
  v_accvgpr_read_b32 v247, a159
  v_mul_f32 v240, v240, v233
  v_mul_f32 v241, v241, v233
  s_add_u32 m0, s60, 3072
  s_add_u32 s51, s63, 21760
  s_waitcnt lgkmcnt(10)
  v_mfma_f32_32x32x16_bf16 v[144:159], v[212:215], v[88:91], v[144:159]
  ds_read_b64_tr_b16 v[204:205], v253 offset:51200
  ds_read_b64_tr_b16 v[206:207], v253 offset:51712
  v_mul_f32 v242, v242, v233
  v_mul_f32 v243, v243, v233
  v_mul_f32 v244, v244, v233
  v_mul_f32 v245, v245, v233
  v_mul_f32 v246, v246, v233
  v_mul_f32 v247, v247, v233
  v_cvt_pk_bf16_f32 v100, v240, v241
  v_cvt_pk_bf16_f32 v101, v242, v243
  buffer_load_dwordx4 v251, s[32:35], s51 offen lds
  s_waitcnt lgkmcnt(10)
  v_mfma_f32_32x32x16_bf16 v[128:143], v[216:219], v[92:95], v[128:143]
  ds_read_b64_tr_b16 v[208:209], v252 offset:53248
  ds_read_b64_tr_b16 v[210:211], v252 offset:53760
  v_cvt_pk_bf16_f32 v102, v244, v245
  v_cvt_pk_bf16_f32 v103, v246, v247
  v_accvgpr_read_b32 v240, a176
  v_accvgpr_read_b32 v241, a177
  v_accvgpr_read_b32 v242, a178
  v_accvgpr_read_b32 v243, a179
  v_accvgpr_read_b32 v244, a180
  v_accvgpr_read_b32 v245, a181
  v_accvgpr_read_b32 v246, a182
  s_waitcnt lgkmcnt(10)
  v_mfma_f32_32x32x16_bf16 v[144:159], v[220:223], v[92:95], v[144:159]
  ds_read_b64_tr_b16 v[212:213], v253 offset:53248
  ds_read_b64_tr_b16 v[214:215], v253 offset:53760
  v_accvgpr_read_b32 v247, a183
  v_mul_f32 v240, v240, v233
  v_mul_f32 v241, v241, v233
  v_mul_f32 v242, v242, v233
  v_mul_f32 v243, v243, v233
  v_mul_f32 v244, v244, v233
  v_mul_f32 v245, v245, v233
  v_mul_f32 v246, v246, v233
  v_mul_f32 v247, v247, v233
  s_add_u32 m0, s60, 4096
  s_add_u32 s51, s63, 28928
  s_waitcnt lgkmcnt(10)
  v_mfma_f32_32x32x16_bf16 v[128:143], v[192:195], v[96:99], v[128:143]
  ds_read_b64_tr_b16 v[216:217], v252 offset:55296
  ds_read_b64_tr_b16 v[218:219], v252 offset:55808
  v_cvt_pk_bf16_f32 v104, v240, v241
  v_cvt_pk_bf16_f32 v105, v242, v243
  v_cvt_pk_bf16_f32 v106, v244, v245
  v_cvt_pk_bf16_f32 v107, v246, v247
  v_accvgpr_read_b32 v240, a184
  v_accvgpr_read_b32 v241, a185
  v_accvgpr_read_b32 v242, a186
  v_accvgpr_read_b32 v243, a187
  buffer_load_dwordx4 v251, s[32:35], s51 offen lds
  s_waitcnt lgkmcnt(10)
  v_mfma_f32_32x32x16_bf16 v[144:159], v[196:199], v[96:99], v[144:159]
  ds_read_b64_tr_b16 v[220:221], v253 offset:55296
  ds_read_b64_tr_b16 v[222:223], v253 offset:55808
  v_accvgpr_read_b32 v244, a188
  v_accvgpr_read_b32 v245, a189
  v_accvgpr_read_b32 v246, a190
  v_accvgpr_read_b32 v247, a191
  v_mul_f32 v240, v240, v233
  v_mul_f32 v241, v241, v233
  v_mul_f32 v242, v242, v233
  v_mul_f32 v243, v243, v233
  v_mul_f32 v244, v244, v233
  s_add_u32 m0, s60, 5120
  s_waitcnt lgkmcnt(10)
  v_mfma_f32_32x32x16_bf16 v[128:143], v[200:203], v[100:103], v[128:143]
  ds_read_b64_tr_b16 v[192:193], v252 offset:57344
  ds_read_b64_tr_b16 v[194:195], v252 offset:57856
  v_mul_f32 v245, v245, v233
  v_mul_f32 v246, v246, v233
  v_mul_f32 v247, v247, v233
  v_cvt_pk_bf16_f32 v108, v240, v241
  v_cvt_pk_bf16_f32 v109, v242, v243
  v_cvt_pk_bf16_f32 v110, v244, v245
  v_cvt_pk_bf16_f32 v111, v246, v247
  v_accvgpr_read_b32 v240, a208
  v_accvgpr_read_b32 v241, a209
  s_add_u32 s51, s63, 36096
  s_waitcnt lgkmcnt(10)
  v_mfma_f32_32x32x16_bf16 v[144:159], v[204:207], v[100:103], v[144:159]
  ds_read_b64_tr_b16 v[196:197], v253 offset:57344
  ds_read_b64_tr_b16 v[198:199], v253 offset:57856
  v_accvgpr_read_b32 v242, a210
  v_accvgpr_read_b32 v243, a211
  v_accvgpr_read_b32 v244, a212
  v_accvgpr_read_b32 v245, a213
  v_accvgpr_read_b32 v246, a214
  v_accvgpr_read_b32 v247, a215
  v_mul_f32 v240, v240, v233
  v_mul_f32 v241, v241, v233
  buffer_load_dwordx4 v251, s[32:35], s51 offen lds
  s_waitcnt lgkmcnt(10)
  v_mfma_f32_32x32x16_bf16 v[128:143], v[208:211], v[104:107], v[128:143]
  ds_read_b64_tr_b16 v[200:201], v252 offset:59392
  ds_read_b64_tr_b16 v[202:203], v252 offset:59904
  v_mul_f32 v242, v242, v233
  v_mul_f32 v243, v243, v233
  v_mul_f32 v244, v244, v233
  v_mul_f32 v245, v245, v233
  v_mul_f32 v246, v246, v233
  v_mul_f32 v247, v247, v233
  v_cvt_pk_bf16_f32 v112, v240, v241
  v_cvt_pk_bf16_f32 v113, v242, v243
  v_cvt_pk_bf16_f32 v114, v244, v245
  s_add_u32 m0, s60, 6144
  s_add_u32 s51, s63, 43264
  s_waitcnt lgkmcnt(10)
  v_mfma_f32_32x32x16_bf16 v[144:159], v[212:215], v[104:107], v[144:159]
  ds_read_b64_tr_b16 v[204:205], v253 offset:59392
  ds_read_b64_tr_b16 v[206:207], v253 offset:59904
  v_cvt_pk_bf16_f32 v115, v246, v247
  v_accvgpr_read_b32 v240, a216
  v_accvgpr_read_b32 v241, a217
  v_accvgpr_read_b32 v242, a218
  v_accvgpr_read_b32 v243, a219
  v_accvgpr_read_b32 v244, a220
  v_accvgpr_read_b32 v245, a221
  v_accvgpr_read_b32 v246, a222
  v_accvgpr_read_b32 v247, a223
  s_waitcnt lgkmcnt(10)
  v_mfma_f32_32x32x16_bf16 v[128:143], v[216:219], v[108:111], v[128:143]
  ds_read_b64_tr_b16 v[208:209], v252 offset:61440
  ds_read_b64_tr_b16 v[210:211], v252 offset:61952
  v_mul_f32 v240, v240, v233
  v_mul_f32 v241, v241, v233
  v_mul_f32 v242, v242, v233
  v_mul_f32 v243, v243, v233
  v_mul_f32 v244, v244, v233
  v_mul_f32 v245, v245, v233
  v_mul_f32 v246, v246, v233
  v_mul_f32 v247, v247, v233
  buffer_load_dwordx4 v251, s[32:35], s51 offen lds
  s_waitcnt lgkmcnt(10)
  v_mfma_f32_32x32x16_bf16 v[144:159], v[220:223], v[108:111], v[144:159]
  ds_read_b64_tr_b16 v[212:213], v253 offset:61440
  ds_read_b64_tr_b16 v[214:215], v253 offset:61952
  v_cvt_pk_bf16_f32 v116, v240, v241
  v_cvt_pk_bf16_f32 v117, v242, v243
  v_cvt_pk_bf16_f32 v118, v244, v245
  v_cvt_pk_bf16_f32 v119, v246, v247
  v_accvgpr_read_b32 v240, a240
  v_accvgpr_read_b32 v241, a241
  v_accvgpr_read_b32 v242, a242
  v_accvgpr_read_b32 v243, a243
  v_accvgpr_read_b32 v244, a244
  s_add_u32 m0, s60, 7168
  s_add_u32 s51, s63, 50432
  s_waitcnt lgkmcnt(10)
  v_mfma_f32_32x32x16_bf16 v[128:143], v[192:195], v[112:115], v[128:143]
  ds_read_b64_tr_b16 v[216:217], v252 offset:63488
  ds_read_b64_tr_b16 v[218:219], v252 offset:64000
  v_accvgpr_read_b32 v245, a245
  v_accvgpr_read_b32 v246, a246
  v_accvgpr_read_b32 v247, a247
  v_mul_f32 v240, v240, v233
  v_mul_f32 v241, v241, v233
  v_mul_f32 v242, v242, v233
  v_mul_f32 v243, v243, v233
  v_mul_f32 v244, v244, v233
  v_mul_f32 v245, v245, v233
  buffer_load_dwordx4 v251, s[32:35], s51 offen lds
  s_waitcnt lgkmcnt(10)
  v_mfma_f32_32x32x16_bf16 v[144:159], v[196:199], v[112:115], v[144:159]
  ds_read_b64_tr_b16 v[220:221], v253 offset:63488
  ds_read_b64_tr_b16 v[222:223], v253 offset:64000
  v_mul_f32 v246, v246, v233
  v_mul_f32 v247, v247, v233
  v_cvt_pk_bf16_f32 v120, v240, v241
  v_cvt_pk_bf16_f32 v121, v242, v243
  v_cvt_pk_bf16_f32 v122, v244, v245
  v_cvt_pk_bf16_f32 v123, v246, v247
  v_accvgpr_read_b32 v240, a248
  v_accvgpr_read_b32 v241, a249
  s_waitcnt lgkmcnt(10)
  v_mfma_f32_32x32x16_bf16 v[128:143], v[200:203], v[116:119], v[128:143]
  ds_read_b64_tr_b16 v[192:193], v254 offset:0
  ds_read_b64_tr_b16 v[194:195], v254 offset:512
  v_accvgpr_read_b32 v242, a250
  v_accvgpr_read_b32 v243, a251
  v_accvgpr_read_b32 v244, a252
  v_accvgpr_read_b32 v245, a253
  v_accvgpr_read_b32 v246, a254
  v_accvgpr_read_b32 v247, a255
  v_mul_f32 v240, v240, v233
  v_mul_f32 v241, v241, v233
  v_mul_f32 v242, v242, v233
  s_waitcnt lgkmcnt(10)
  v_mfma_f32_32x32x16_bf16 v[144:159], v[204:207], v[116:119], v[144:159]
  ds_read_b64_tr_b16 v[196:197], v255 offset:0
  ds_read_b64_tr_b16 v[198:199], v255 offset:512
  v_mul_f32 v243, v243, v233
  v_mul_f32 v244, v244, v233
  v_mul_f32 v245, v245, v233
  v_mul_f32 v246, v246, v233
  v_mul_f32 v247, v247, v233
  v_cvt_pk_bf16_f32 v124, v240, v241
  v_cvt_pk_bf16_f32 v125, v242, v243
  v_cvt_pk_bf16_f32 v126, v244, v245
  v_cvt_pk_bf16_f32 v127, v246, v247
  s_waitcnt lgkmcnt(10)
  v_mfma_f32_32x32x16_bf16 v[128:143], v[208:211], v[120:123], v[128:143]
  ds_read_b64_tr_b16 v[200:201], v254 offset:2048
  ds_read_b64_tr_b16 v[202:203], v254 offset:2560
  s_waitcnt lgkmcnt(10)
  v_mfma_f32_32x32x16_bf16 v[144:159], v[212:215], v[120:123], v[144:159]
  ds_read_b64_tr_b16 v[204:205], v255 offset:2048
  ds_read_b64_tr_b16 v[206:207], v255 offset:2560
  s_waitcnt lgkmcnt(10)
  v_mfma_f32_32x32x16_bf16 v[128:143], v[216:219], v[124:127], v[128:143]
  ds_read_b64_tr_b16 v[208:209], v254 offset:4096
  ds_read_b64_tr_b16 v[210:211], v254 offset:4608
  s_waitcnt lgkmcnt(10)
  v_mfma_f32_32x32x16_bf16 v[144:159], v[220:223], v[124:127], v[144:159]
  ds_read_b64_tr_b16 v[212:213], v255 offset:4096
  ds_read_b64_tr_b16 v[214:215], v255 offset:4608
  s_waitcnt lgkmcnt(10)
  v_mfma_f32_32x32x16_bf16 v[160:175], v[192:195], v[0:3], 0
  ds_read_b64_tr_b16 v[216:217], v254 offset:6144
  ds_read_b64_tr_b16 v[218:219], v254 offset:6656
  s_waitcnt lgkmcnt(10)
  v_mfma_f32_32x32x16_bf16 v[176:191], v[196:199], v[0:3], 0
  ds_read_b64_tr_b16 v[220:221], v255 offset:6144
  ds_read_b64_tr_b16 v[222:223], v255 offset:6656
  s_waitcnt lgkmcnt(10)
  v_mfma_f32_32x32x16_bf16 v[160:175], v[200:203], v[4:7], v[160:175]
  ds_read_b64_tr_b16 v[192:193], v254 offset:8192
  ds_read_b64_tr_b16 v[194:195], v254 offset:8704
  s_waitcnt lgkmcnt(10)
  v_mfma_f32_32x32x16_bf16 v[176:191], v[204:207], v[4:7], v[176:191]
  ds_read_b64_tr_b16 v[196:197], v255 offset:8192
  ds_read_b64_tr_b16 v[198:199], v255 offset:8704
  s_barrier
  s_waitcnt lgkmcnt(10)
  v_mfma_f32_32x32x16_bf16 v[160:175], v[208:211], v[8:11], v[160:175]
  ds_read_b64_tr_b16 v[200:201], v254 offset:10240
  ds_read_b64_tr_b16 v[202:203], v254 offset:10752
  s_add_u32 m0, s60, 32768
  s_add_u32 s51, s63, 229632
  s_waitcnt lgkmcnt(10)
  v_mfma_f32_32x32x16_bf16 v[176:191], v[212:215], v[8:11], v[176:191]
  ds_read_b64_tr_b16 v[204:205], v255 offset:10240
  ds_read_b64_tr_b16 v[206:207], v255 offset:10752
  buffer_load_dwordx4 v251, s[32:35], s51 offen lds
  s_waitcnt lgkmcnt(10)
  v_mfma_f32_32x32x16_bf16 v[160:175], v[216:219], v[12:15], v[160:175]
  ds_read_b64_tr_b16 v[208:209], v254 offset:12288
  ds_read_b64_tr_b16 v[210:211], v254 offset:12800
  s_add_u32 m0, s60, 33792
  s_add_u32 s51, s63, 236800
  s_waitcnt lgkmcnt(10)
  v_mfma_f32_32x32x16_bf16 v[176:191], v[220:223], v[12:15], v[176:191]
  ds_read_b64_tr_b16 v[212:213], v255 offset:12288
  ds_read_b64_tr_b16 v[214:215], v255 offset:12800
  s_waitcnt lgkmcnt(10)
  v_mfma_f32_32x32x16_bf16 v[160:175], v[192:195], v[16:19], v[160:175]
  ds_read_b64_tr_b16 v[216:217], v254 offset:14336
  ds_read_b64_tr_b16 v[218:219], v254 offset:14848
  buffer_load_dwordx4 v251, s[32:35], s51 offen lds
  s_waitcnt lgkmcnt(10)
  v_mfma_f32_32x32x16_bf16 v[176:191], v[196:199], v[16:19], v[176:191]
  ds_read_b64_tr_b16 v[220:221], v255 offset:14336
  ds_read_b64_tr_b16 v[222:223], v255 offset:14848
  s_add_u32 m0, s60, 34816
  s_add_u32 s51, s63, 243968
  s_waitcnt lgkmcnt(10)
  v_mfma_f32_32x32x16_bf16 v[160:175], v[200:203], v[20:23], v[160:175]
  ds_read_b64_tr_b16 v[192:193], v254 offset:16384
  ds_read_b64_tr_b16 v[194:195], v254 offset:16896
  v_cvt_pk_bf16_f32 v128, v128, v129
  v_cvt_pk_bf16_f32 v129, v130, v131
  v_cvt_pk_bf16_f32 v130, v132, v133
  v_cvt_pk_bf16_f32 v131, v134, v135
  s_add_u32 s50, s61, 0
  buffer_store_dwordx4 v[128:131], v227, s[36:39], s50 offen sc1
  s_waitcnt lgkmcnt(10)
  v_mfma_f32_32x32x16_bf16 v[176:191], v[204:207], v[20:23], v[176:191]
  ds_read_b64_tr_b16 v[196:197], v255 offset:16384
  ds_read_b64_tr_b16 v[198:199], v255 offset:16896
  buffer_load_dwordx4 v251, s[32:35], s51 offen lds
  s_waitcnt lgkmcnt(10)
  v_mfma_f32_32x32x16_bf16 v[160:175], v[208:211], v[24:27], v[160:175]
  ds_read_b64_tr_b16 v[200:201], v254 offset:18432
  ds_read_b64_tr_b16 v[202:203], v254 offset:18944
  s_add_u32 m0, s60, 35840
  s_add_u32 s51, s63, 251136
  s_waitcnt lgkmcnt(10)
  v_mfma_f32_32x32x16_bf16 v[176:191], v[212:215], v[24:27], v[176:191]
  ds_read_b64_tr_b16 v[204:205], v255 offset:18432
  ds_read_b64_tr_b16 v[206:207], v255 offset:18944
  buffer_load_dwordx4 v251, s[32:35], s51 offen lds
  s_waitcnt lgkmcnt(10)
  v_mfma_f32_32x32x16_bf16 v[160:175], v[216:219], v[28:31], v[160:175]
  ds_read_b64_tr_b16 v[208:209], v254 offset:20480
  ds_read_b64_tr_b16 v[210:211], v254 offset:20992
  s_waitcnt lgkmcnt(10)
  v_mfma_f32_32x32x16_bf16 v[176:191], v[220:223], v[28:31], v[176:191]
  ds_read_b64_tr_b16 v[212:213], v255 offset:20480
  ds_read_b64_tr_b16 v[214:215], v255 offset:20992
  s_add_u32 m0, s60, 36864
  s_add_u32 s51, s63, 258304
  s_waitcnt lgkmcnt(10)
  v_mfma_f32_32x32x16_bf16 v[160:175], v[192:195], v[32:35], v[160:175]
  ds_read_b64_tr_b16 v[216:217], v254 offset:22528
  ds_read_b64_tr_b16 v[218:219], v254 offset:23040
  buffer_load_dwordx4 v251, s[32:35], s51 offen lds
  s_waitcnt lgkmcnt(10)
  v_mfma_f32_32x32x16_bf16 v[176:191], v[196:199], v[32:35], v[176:191]
  ds_read_b64_tr_b16 v[220:221], v255 offset:22528
  ds_read_b64_tr_b16 v[222:223], v255 offset:23040
  s_add_u32 m0, s60, 37888
  s_add_u32 s51, s63, 265472
  s_waitcnt lgkmcnt(10)
  v_mfma_f32_32x32x16_bf16 v[160:175], v[200:203], v[36:39], v[160:175]
  ds_read_b64_tr_b16 v[192:193], v254 offset:24576
  ds_read_b64_tr_b16 v[194:195], v254 offset:25088
  s_waitcnt lgkmcnt(10)
  v_mfma_f32_32x32x16_bf16 v[176:191], v[204:207], v[36:39], v[176:191]
  ds_read_b64_tr_b16 v[196:197], v255 offset:24576
  ds_read_b64_tr_b16 v[198:199], v255 offset:25088
  buffer_load_dwordx4 v251, s[32:35], s51 offen lds
  s_waitcnt lgkmcnt(10)
  v_mfma_f32_32x32x16_bf16 v[160:175], v[208:211], v[40:43], v[160:175]
  ds_read_b64_tr_b16 v[200:201], v254 offset:26624
  ds_read_b64_tr_b16 v[202:203], v254 offset:27136
  s_add_u32 m0, s60, 38912
  s_add_u32 s51, s63, 272640
  s_waitcnt lgkmcnt(10)
  v_mfma_f32_32x32x16_bf16 v[176:191], v[212:215], v[40:43], v[176:191]
  ds_read_b64_tr_b16 v[204:205], v255 offset:26624
  ds_read_b64_tr_b16 v[206:207], v255 offset:27136
  buffer_load_dwordx4 v251, s[32:35], s51 offen lds
  s_waitcnt lgkmcnt(10)
  v_mfma_f32_32x32x16_bf16 v[160:175], v[216:219], v[44:47], v[160:175]
  ds_read_b64_tr_b16 v[208:209], v254 offset:28672
  ds_read_b64_tr_b16 v[210:211], v254 offset:29184
  v_cvt_pk_bf16_f32 v136, v136, v137
  v_cvt_pk_bf16_f32 v137, v138, v139
  v_cvt_pk_bf16_f32 v138, v140, v141
  v_cvt_pk_bf16_f32 v139, v142, v143
  s_add_u32 s50, s61, 0
  buffer_store_dwordx4 v[136:139], v227, s[36:39], s50 offen offset:1024 sc1
  s_waitcnt lgkmcnt(10)
  v_mfma_f32_32x32x16_bf16 v[176:191], v[220:223], v[44:47], v[176:191]
  ds_read_b64_tr_b16 v[212:213], v255 offset:28672
  ds_read_b64_tr_b16 v[214:215], v255 offset:29184
  s_add_u32 m0, s60, 39936
  s_add_u32 s51, s63, 279808
  s_waitcnt lgkmcnt(10)
  v_mfma_f32_32x32x16_bf16 v[160:175], v[192:195], v[48:51], v[160:175]
  ds_read_b64_tr_b16 v[216:217], v254 offset:30720
  ds_read_b64_tr_b16 v[218:219], v254 offset:31232
  buffer_load_dwordx4 v251, s[32:35], s51 offen lds
  s_waitcnt lgkmcnt(10)
  v_mfma_f32_32x32x16_bf16 v[176:191], v[196:199], v[48:51], v[176:191]
  ds_read_b64_tr_b16 v[220:221], v255 offset:30720
  ds_read_b64_tr_b16 v[222:223], v255 offset:31232
  s_waitcnt lgkmcnt(10)
  v_mfma_f32_32x32x16_bf16 v[160:175], v[200:203], v[52:55], v[160:175]
  ds_read_b64_tr_b16 v[192:193], v254 offset:32768
  ds_read_b64_tr_b16 v[194:195], v254 offset:33280
  s_waitcnt lgkmcnt(10)
  v_mfma_f32_32x32x16_bf16 v[176:191], v[204:207], v[52:55], v[176:191]
  ds_read_b64_tr_b16 v[196:197], v255 offset:32768
  ds_read_b64_tr_b16 v[198:199], v255 offset:33280
  s_waitcnt lgkmcnt(10)
  v_mfma_f32_32x32x16_bf16 v[160:175], v[208:211], v[56:59], v[160:175]
  ds_read_b64_tr_b16 v[200:201], v254 offset:34816
  ds_read_b64_tr_b16 v[202:203], v254 offset:35328
  s_waitcnt lgkmcnt(10)
  v_mfma_f32_32x32x16_bf16 v[176:191], v[212:215], v[56:59], v[176:191]
  ds_read_b64_tr_b16 v[204:205], v255 offset:34816
  ds_read_b64_tr_b16 v[206:207], v255 offset:35328
  s_waitcnt lgkmcnt(10)
  v_mfma_f32_32x32x16_bf16 v[160:175], v[216:219], v[60:63], v[160:175]
  ds_read_b64_tr_b16 v[208:209], v254 offset:36864
  ds_read_b64_tr_b16 v[210:211], v254 offset:37376
  s_waitcnt lgkmcnt(10)
  v_mfma_f32_32x32x16_bf16 v[176:191], v[220:223], v[60:63], v[176:191]
  ds_read_b64_tr_b16 v[212:213], v255 offset:36864
  ds_read_b64_tr_b16 v[214:215], v255 offset:37376
  s_waitcnt lgkmcnt(10)
  v_mfma_f32_32x32x16_bf16 v[160:175], v[192:195], v[64:67], v[160:175]
  ds_read_b64_tr_b16 v[216:217], v254 offset:38912
  ds_read_b64_tr_b16 v[218:219], v254 offset:39424
  s_waitcnt lgkmcnt(10)
  v_mfma_f32_32x32x16_bf16 v[176:191], v[196:199], v[64:67], v[176:191]
  ds_read_b64_tr_b16 v[220:221], v255 offset:38912
  ds_read_b64_tr_b16 v[222:223], v255 offset:39424
  s_waitcnt lgkmcnt(10)
  v_mfma_f32_32x32x16_bf16 v[160:175], v[200:203], v[68:71], v[160:175]
  ds_read_b64_tr_b16 v[192:193], v254 offset:40960
  ds_read_b64_tr_b16 v[194:195], v254 offset:41472
  s_waitcnt lgkmcnt(10)
  v_mfma_f32_32x32x16_bf16 v[176:191], v[204:207], v[68:71], v[176:191]
  ds_read_b64_tr_b16 v[196:197], v255 offset:40960
  ds_read_b64_tr_b16 v[198:199], v255 offset:41472
  s_waitcnt vmcnt(10)
  s_barrier
  s_waitcnt lgkmcnt(10)
  v_mfma_f32_32x32x16_bf16 v[160:175], v[208:211], v[72:75], v[160:175]
  ds_read_b64_tr_b16 v[200:201], v254 offset:43008
  ds_read_b64_tr_b16 v[202:203], v254 offset:43520
  s_add_u32 m0, s60, 65536
  s_add_u32 s51, s63, 384
  s_waitcnt lgkmcnt(10)
  v_mfma_f32_32x32x16_bf16 v[176:191], v[212:215], v[72:75], v[176:191]
  ds_read_b64_tr_b16 v[204:205], v255 offset:43008
  ds_read_b64_tr_b16 v[206:207], v255 offset:43520
  buffer_load_dwordx4 v251, s[32:35], s51 offen lds
  s_waitcnt lgkmcnt(10)
  v_mfma_f32_32x32x16_bf16 v[160:175], v[216:219], v[76:79], v[160:175]
  ds_read_b64_tr_b16 v[208:209], v254 offset:45056
  ds_read_b64_tr_b16 v[210:211], v254 offset:45568
  s_add_u32 m0, s60, 66560
  s_add_u32 s51, s63, 7552
  s_waitcnt lgkmcnt(10)
  v_mfma_f32_32x32x16_bf16 v[176:191], v[220:223], v[76:79], v[176:191]
  ds_read_b64_tr_b16 v[212:213], v255 offset:45056
  ds_read_b64_tr_b16 v[214:215], v255 offset:45568
  s_waitcnt lgkmcnt(10)
  v_mfma_f32_32x32x16_bf16 v[160:175], v[192:195], v[80:83], v[160:175]
  ds_read_b64_tr_b16 v[216:217], v254 offset:47104
  ds_read_b64_tr_b16 v[218:219], v254 offset:47616
  buffer_load_dwordx4 v251, s[32:35], s51 offen lds
  s_waitcnt lgkmcnt(10)
  v_mfma_f32_32x32x16_bf16 v[176:191], v[196:199], v[80:83], v[176:191]
  ds_read_b64_tr_b16 v[220:221], v255 offset:47104
  ds_read_b64_tr_b16 v[222:223], v255 offset:47616
  s_add_u32 m0, s60, 67584
  s_add_u32 s51, s63, 14720
  s_waitcnt lgkmcnt(10)
  v_mfma_f32_32x32x16_bf16 v[160:175], v[200:203], v[84:87], v[160:175]
  ds_read_b64_tr_b16 v[192:193], v254 offset:49152
  ds_read_b64_tr_b16 v[194:195], v254 offset:49664
  v_cvt_pk_bf16_f32 v144, v144, v145
  v_cvt_pk_bf16_f32 v145, v146, v147
  v_cvt_pk_bf16_f32 v146, v148, v149
  v_cvt_pk_bf16_f32 v147, v150, v151
  s_add_u32 s50, s61, 0
  buffer_store_dwordx4 v[144:147], v227, s[36:39], s50 offen offset:2048 sc1
  s_waitcnt lgkmcnt(10)
  v_mfma_f32_32x32x16_bf16 v[176:191], v[204:207], v[84:87], v[176:191]
  ds_read_b64_tr_b16 v[196:197], v255 offset:49152
  ds_read_b64_tr_b16 v[198:199], v255 offset:49664
  buffer_load_dwordx4 v251, s[32:35], s51 offen lds
  s_waitcnt lgkmcnt(10)
  v_mfma_f32_32x32x16_bf16 v[160:175], v[208:211], v[88:91], v[160:175]
  ds_read_b64_tr_b16 v[200:201], v254 offset:51200
  ds_read_b64_tr_b16 v[202:203], v254 offset:51712
  s_add_u32 m0, s60, 68608
  s_add_u32 s51, s63, 21888
  s_waitcnt lgkmcnt(10)
  v_mfma_f32_32x32x16_bf16 v[176:191], v[212:215], v[88:91], v[176:191]
  ds_read_b64_tr_b16 v[204:205], v255 offset:51200
  ds_read_b64_tr_b16 v[206:207], v255 offset:51712
  buffer_load_dwordx4 v251, s[32:35], s51 offen lds
  s_waitcnt lgkmcnt(10)
  v_mfma_f32_32x32x16_bf16 v[160:175], v[216:219], v[92:95], v[160:175]
  ds_read_b64_tr_b16 v[208:209], v254 offset:53248
  ds_read_b64_tr_b16 v[210:211], v254 offset:53760
  s_waitcnt lgkmcnt(10)
  v_mfma_f32_32x32x16_bf16 v[176:191], v[220:223], v[92:95], v[176:191]
  ds_read_b64_tr_b16 v[212:213], v255 offset:53248
  ds_read_b64_tr_b16 v[214:215], v255 offset:53760
  s_add_u32 m0, s60, 69632
  s_add_u32 s51, s63, 29056
  s_waitcnt lgkmcnt(10)
  v_mfma_f32_32x32x16_bf16 v[160:175], v[192:195], v[96:99], v[160:175]
  ds_read_b64_tr_b16 v[216:217], v254 offset:55296
  ds_read_b64_tr_b16 v[218:219], v254 offset:55808
  buffer_load_dwordx4 v251, s[32:35], s51 offen lds
  s_waitcnt lgkmcnt(10)
  v_mfma_f32_32x32x16_bf16 v[176:191], v[196:199], v[96:99], v[176:191]
  ds_read_b64_tr_b16 v[220:221], v255 offset:55296
  ds_read_b64_tr_b16 v[222:223], v255 offset:55808
  s_add_u32 m0, s60, 70656
  s_add_u32 s51, s63, 36224
  s_waitcnt lgkmcnt(10)
  v_mfma_f32_32x32x16_bf16 v[160:175], v[200:203], v[100:103], v[160:175]
  ds_read_b64_tr_b16 v[192:193], v254 offset:57344
  ds_read_b64_tr_b16 v[194:195], v254 offset:57856
  s_waitcnt lgkmcnt(10)
  v_mfma_f32_32x32x16_bf16 v[176:191], v[204:207], v[100:103], v[176:191]
  ds_read_b64_tr_b16 v[196:197], v255 offset:57344
  ds_read_b64_tr_b16 v[198:199], v255 offset:57856
  buffer_load_dwordx4 v251, s[32:35], s51 offen lds
  s_waitcnt lgkmcnt(10)
  v_mfma_f32_32x32x16_bf16 v[160:175], v[208:211], v[104:107], v[160:175]
  ds_read_b64_tr_b16 v[200:201], v254 offset:59392
  ds_read_b64_tr_b16 v[202:203], v254 offset:59904
  s_add_u32 m0, s60, 71680
  s_add_u32 s51, s63, 43392
  s_waitcnt lgkmcnt(10)
  v_mfma_f32_32x32x16_bf16 v[176:191], v[212:215], v[104:107], v[176:191]
  ds_read_b64_tr_b16 v[204:205], v255 offset:59392
  ds_read_b64_tr_b16 v[206:207], v255 offset:59904
  buffer_load_dwordx4 v251, s[32:35], s51 offen lds
  s_waitcnt lgkmcnt(10)
  v_mfma_f32_32x32x16_bf16 v[160:175], v[216:219], v[108:111], v[160:175]
  ds_read_b64_tr_b16 v[208:209], v254 offset:61440
  ds_read_b64_tr_b16 v[210:211], v254 offset:61952
  v_cvt_pk_bf16_f32 v152, v152, v153
  v_cvt_pk_bf16_f32 v153, v154, v155
  v_cvt_pk_bf16_f32 v154, v156, v157
  v_cvt_pk_bf16_f32 v155, v158, v159
  s_add_u32 s50, s61, 0
  buffer_store_dwordx4 v[152:155], v227, s[36:39], s50 offen offset:3072 sc1
  s_waitcnt lgkmcnt(10)
  v_mfma_f32_32x32x16_bf16 v[176:191], v[220:223], v[108:111], v[176:191]
  ds_read_b64_tr_b16 v[212:213], v255 offset:61440
  ds_read_b64_tr_b16 v[214:215], v255 offset:61952
  s_add_u32 m0, s60, 72704
  s_add_u32 s51, s63, 50560
  s_waitcnt lgkmcnt(10)
  v_mfma_f32_32x32x16_bf16 v[160:175], v[192:195], v[112:115], v[160:175]
  ds_read_b64_tr_b16 v[216:217], v254 offset:63488
  ds_read_b64_tr_b16 v[218:219], v254 offset:64000
  buffer_load_dwordx4 v251, s[32:35], s51 offen lds
  s_waitcnt lgkmcnt(10)
  v_mfma_f32_32x32x16_bf16 v[176:191], v[196:199], v[112:115], v[176:191]
  ds_read_b64_tr_b16 v[220:221], v255 offset:63488
  ds_read_b64_tr_b16 v[222:223], v255 offset:64000
  s_waitcnt lgkmcnt(10)
  v_mfma_f32_32x32x16_bf16 v[160:175], v[200:203], v[116:119], v[160:175]
  ds_read_b64_tr_b16 v[192:193], v252 offset:0
  ds_read_b64_tr_b16 v[194:195], v252 offset:512
  s_waitcnt lgkmcnt(10)
  v_mfma_f32_32x32x16_bf16 v[176:191], v[204:207], v[116:119], v[176:191]
  ds_read_b64_tr_b16 v[196:197], v253 offset:0
  ds_read_b64_tr_b16 v[198:199], v253 offset:512
  s_waitcnt lgkmcnt(10)
  v_mfma_f32_32x32x16_bf16 v[160:175], v[208:211], v[120:123], v[160:175]
  ds_read_b64_tr_b16 v[200:201], v252 offset:2048
  ds_read_b64_tr_b16 v[202:203], v252 offset:2560
  s_waitcnt lgkmcnt(10)
  v_mfma_f32_32x32x16_bf16 v[176:191], v[212:215], v[120:123], v[176:191]
  ds_read_b64_tr_b16 v[204:205], v253 offset:2048
  ds_read_b64_tr_b16 v[206:207], v253 offset:2560
  s_waitcnt lgkmcnt(10)
  v_mfma_f32_32x32x16_bf16 v[160:175], v[216:219], v[124:127], v[160:175]
  ds_read_b64_tr_b16 v[208:209], v252 offset:4096
  ds_read_b64_tr_b16 v[210:211], v252 offset:4608
  s_waitcnt lgkmcnt(10)
  v_mfma_f32_32x32x16_bf16 v[176:191], v[220:223], v[124:127], v[176:191]
  ds_read_b64_tr_b16 v[212:213], v253 offset:4096
  ds_read_b64_tr_b16 v[214:215], v253 offset:4608
  s_waitcnt lgkmcnt(10)
  v_mfma_f32_32x32x16_bf16 v[128:143], v[192:195], v[0:3], 0
  ds_read_b64_tr_b16 v[216:217], v252 offset:6144
  ds_read_b64_tr_b16 v[218:219], v252 offset:6656
  s_waitcnt lgkmcnt(10)
  v_mfma_f32_32x32x16_bf16 v[144:159], v[196:199], v[0:3], 0
  ds_read_b64_tr_b16 v[220:221], v253 offset:6144
  ds_read_b64_tr_b16 v[222:223], v253 offset:6656
  s_waitcnt lgkmcnt(10)
  v_mfma_f32_32x32x16_bf16 v[128:143], v[200:203], v[4:7], v[128:143]
  ds_read_b64_tr_b16 v[192:193], v252 offset:8192
  ds_read_b64_tr_b16 v[194:195], v252 offset:8704
  s_waitcnt lgkmcnt(10)
  v_mfma_f32_32x32x16_bf16 v[144:159], v[204:207], v[4:7], v[144:159]
  ds_read_b64_tr_b16 v[196:197], v253 offset:8192
  ds_read_b64_tr_b16 v[198:199], v253 offset:8704
  s_waitcnt vmcnt(10)
  s_barrier
  s_waitcnt lgkmcnt(10)
  v_mfma_f32_32x32x16_bf16 v[128:143], v[208:211], v[8:11], v[128:143]
  ds_read_b64_tr_b16 v[200:201], v252 offset:10240
  ds_read_b64_tr_b16 v[202:203], v252 offset:10752
  s_add_u32 m0, s60, 98304
  s_add_u32 s51, s63, 229760
  s_waitcnt lgkmcnt(10)
  v_mfma_f32_32x32x16_bf16 v[144:159], v[212:215], v[8:11], v[144:159]
  ds_read_b64_tr_b16 v[204:205], v253 offset:10240
  ds_read_b64_tr_b16 v[206:207], v253 offset:10752
  buffer_load_dwordx4 v251, s[32:35], s51 offen lds
  s_waitcnt lgkmcnt(10)
  v_mfma_f32_32x32x16_bf16 v[128:143], v[216:219], v[12:15], v[128:143]
  ds_read_b64_tr_b16 v[208:209], v252 offset:12288
  ds_read_b64_tr_b16 v[210:211], v252 offset:12800
  s_add_u32 m0, s60, 99328
  s_add_u32 s51, s63, 236928
  s_waitcnt lgkmcnt(10)
  v_mfma_f32_32x32x16_bf16 v[144:159], v[220:223], v[12:15], v[144:159]
  ds_read_b64_tr_b16 v[212:213], v253 offset:12288
  ds_read_b64_tr_b16 v[214:215], v253 offset:12800
  s_waitcnt lgkmcnt(10)
  v_mfma_f32_32x32x16_bf16 v[128:143], v[192:195], v[16:19], v[128:143]
  ds_read_b64_tr_b16 v[216:217], v252 offset:14336
  ds_read_b64_tr_b16 v[218:219], v252 offset:14848
  buffer_load_dwordx4 v251, s[32:35], s51 offen lds
  s_waitcnt lgkmcnt(10)
  v_mfma_f32_32x32x16_bf16 v[144:159], v[196:199], v[16:19], v[144:159]
  ds_read_b64_tr_b16 v[220:221], v253 offset:14336
  ds_read_b64_tr_b16 v[222:223], v253 offset:14848
  s_add_u32 m0, s60, 100352
  s_add_u32 s51, s63, 244096
  s_waitcnt lgkmcnt(10)
  v_mfma_f32_32x32x16_bf16 v[128:143], v[200:203], v[20:23], v[128:143]
  ds_read_b64_tr_b16 v[192:193], v252 offset:16384
  ds_read_b64_tr_b16 v[194:195], v252 offset:16896
  v_cvt_pk_bf16_f32 v160, v160, v161
  v_cvt_pk_bf16_f32 v161, v162, v163
  v_cvt_pk_bf16_f32 v162, v164, v165
  v_cvt_pk_bf16_f32 v163, v166, v167
  s_add_u32 s50, s61, 4096
  buffer_store_dwordx4 v[160:163], v227, s[36:39], s50 offen sc1
  s_waitcnt lgkmcnt(10)
  v_mfma_f32_32x32x16_bf16 v[144:159], v[204:207], v[20:23], v[144:159]
  ds_read_b64_tr_b16 v[196:197], v253 offset:16384
  ds_read_b64_tr_b16 v[198:199], v253 offset:16896
  buffer_load_dwordx4 v251, s[32:35], s51 offen lds
  s_waitcnt lgkmcnt(10)
  v_mfma_f32_32x32x16_bf16 v[128:143], v[208:211], v[24:27], v[128:143]
  ds_read_b64_tr_b16 v[200:201], v252 offset:18432
  ds_read_b64_tr_b16 v[202:203], v252 offset:18944
  s_add_u32 m0, s60, 101376
  s_add_u32 s51, s63, 251264
  s_waitcnt lgkmcnt(10)
  v_mfma_f32_32x32x16_bf16 v[144:159], v[212:215], v[24:27], v[144:159]
  ds_read_b64_tr_b16 v[204:205], v253 offset:18432
  ds_read_b64_tr_b16 v[206:207], v253 offset:18944
  buffer_load_dwordx4 v251, s[32:35], s51 offen lds
  s_waitcnt lgkmcnt(10)
  v_mfma_f32_32x32x16_bf16 v[128:143], v[216:219], v[28:31], v[128:143]
  ds_read_b64_tr_b16 v[208:209], v252 offset:20480
  ds_read_b64_tr_b16 v[210:211], v252 offset:20992
  s_waitcnt lgkmcnt(10)
  v_mfma_f32_32x32x16_bf16 v[144:159], v[220:223], v[28:31], v[144:159]
  ds_read_b64_tr_b16 v[212:213], v253 offset:20480
  ds_read_b64_tr_b16 v[214:215], v253 offset:20992
  s_add_u32 m0, s60, 102400
  s_add_u32 s51, s63, 258432
  s_waitcnt lgkmcnt(10)
  v_mfma_f32_32x32x16_bf16 v[128:143], v[192:195], v[32:35], v[128:143]
  ds_read_b64_tr_b16 v[216:217], v252 offset:22528
  ds_read_b64_tr_b16 v[218:219], v252 offset:23040
  buffer_load_dwordx4 v251, s[32:35], s51 offen lds
  s_waitcnt lgkmcnt(10)
  v_mfma_f32_32x32x16_bf16 v[144:159], v[196:199], v[32:35], v[144:159]
  ds_read_b64_tr_b16 v[220:221], v253 offset:22528
  ds_read_b64_tr_b16 v[222:223], v253 offset:23040
  s_add_u32 m0, s60, 103424
  s_add_u32 s51, s63, 265600
  s_waitcnt lgkmcnt(10)
  v_mfma_f32_32x32x16_bf16 v[128:143], v[200:203], v[36:39], v[128:143]
  ds_read_b64_tr_b16 v[192:193], v252 offset:24576
  ds_read_b64_tr_b16 v[194:195], v252 offset:25088
  s_waitcnt lgkmcnt(10)
  v_mfma_f32_32x32x16_bf16 v[144:159], v[204:207], v[36:39], v[144:159]
  ds_read_b64_tr_b16 v[196:197], v253 offset:24576
  ds_read_b64_tr_b16 v[198:199], v253 offset:25088
  buffer_load_dwordx4 v251, s[32:35], s51 offen lds
  s_waitcnt lgkmcnt(10)
  v_mfma_f32_32x32x16_bf16 v[128:143], v[208:211], v[40:43], v[128:143]
  ds_read_b64_tr_b16 v[200:201], v252 offset:26624
  ds_read_b64_tr_b16 v[202:203], v252 offset:27136
  s_add_u32 m0, s60, 104448
  s_add_u32 s51, s63, 272768
  s_waitcnt lgkmcnt(10)
  v_mfma_f32_32x32x16_bf16 v[144:159], v[212:215], v[40:43], v[144:159]
  ds_read_b64_tr_b16 v[204:205], v253 offset:26624
  ds_read_b64_tr_b16 v[206:207], v253 offset:27136
  buffer_load_dwordx4 v251, s[32:35], s51 offen lds
  s_waitcnt lgkmcnt(10)
  v_mfma_f32_32x32x16_bf16 v[128:143], v[216:219], v[44:47], v[128:143]
  ds_read_b64_tr_b16 v[208:209], v252 offset:28672
  ds_read_b64_tr_b16 v[210:211], v252 offset:29184
  v_cvt_pk_bf16_f32 v168, v168, v169
  v_cvt_pk_bf16_f32 v169, v170, v171
  v_cvt_pk_bf16_f32 v170, v172, v173
  v_cvt_pk_bf16_f32 v171, v174, v175
  s_add_u32 s50, s61, 4096
  buffer_store_dwordx4 v[168:171], v227, s[36:39], s50 offen offset:1024 sc1
  s_waitcnt lgkmcnt(10)
  v_mfma_f32_32x32x16_bf16 v[144:159], v[220:223], v[44:47], v[144:159]
  ds_read_b64_tr_b16 v[212:213], v253 offset:28672
  ds_read_b64_tr_b16 v[214:215], v253 offset:29184
  s_add_u32 m0, s60, 105472
  s_add_u32 s51, s63, 279936
  s_waitcnt lgkmcnt(10)
  v_mfma_f32_32x32x16_bf16 v[128:143], v[192:195], v[48:51], v[128:143]
  ds_read_b64_tr_b16 v[216:217], v252 offset:30720
  ds_read_b64_tr_b16 v[218:219], v252 offset:31232
  buffer_load_dwordx4 v251, s[32:35], s51 offen lds
  s_waitcnt lgkmcnt(10)
  v_mfma_f32_32x32x16_bf16 v[144:159], v[196:199], v[48:51], v[144:159]
  ds_read_b64_tr_b16 v[220:221], v253 offset:30720
  ds_read_b64_tr_b16 v[222:223], v253 offset:31232
  s_waitcnt lgkmcnt(10)
  v_mfma_f32_32x32x16_bf16 v[128:143], v[200:203], v[52:55], v[128:143]
  ds_read_b64_tr_b16 v[192:193], v252 offset:32768
  ds_read_b64_tr_b16 v[194:195], v252 offset:33280
  s_waitcnt lgkmcnt(10)
  v_mfma_f32_32x32x16_bf16 v[144:159], v[204:207], v[52:55], v[144:159]
  ds_read_b64_tr_b16 v[196:197], v253 offset:32768
  ds_read_b64_tr_b16 v[198:199], v253 offset:33280
  s_waitcnt lgkmcnt(10)
  v_mfma_f32_32x32x16_bf16 v[128:143], v[208:211], v[56:59], v[128:143]
  ds_read_b64_tr_b16 v[200:201], v252 offset:34816
  ds_read_b64_tr_b16 v[202:203], v252 offset:35328
  s_waitcnt lgkmcnt(10)
  v_mfma_f32_32x32x16_bf16 v[144:159], v[212:215], v[56:59], v[144:159]
  ds_read_b64_tr_b16 v[204:205], v253 offset:34816
  ds_read_b64_tr_b16 v[206:207], v253 offset:35328
  s_waitcnt lgkmcnt(10)
  v_mfma_f32_32x32x16_bf16 v[128:143], v[216:219], v[60:63], v[128:143]
  ds_read_b64_tr_b16 v[208:209], v252 offset:36864
  ds_read_b64_tr_b16 v[210:211], v252 offset:37376
  s_waitcnt lgkmcnt(10)
  v_mfma_f32_32x32x16_bf16 v[144:159], v[220:223], v[60:63], v[144:159]
  ds_read_b64_tr_b16 v[212:213], v253 offset:36864
  ds_read_b64_tr_b16 v[214:215], v253 offset:37376
  s_waitcnt lgkmcnt(10)
  v_mfma_f32_32x32x16_bf16 v[128:143], v[192:195], v[64:67], v[128:143]
  ds_read_b64_tr_b16 v[216:217], v252 offset:38912
  ds_read_b64_tr_b16 v[218:219], v252 offset:39424
  s_waitcnt lgkmcnt(10)
  v_mfma_f32_32x32x16_bf16 v[144:159], v[196:199], v[64:67], v[144:159]
  ds_read_b64_tr_b16 v[220:221], v253 offset:38912
  ds_read_b64_tr_b16 v[222:223], v253 offset:39424
  s_waitcnt lgkmcnt(10)
  v_mfma_f32_32x32x16_bf16 v[128:143], v[200:203], v[68:71], v[128:143]
  ds_read_b64_tr_b16 v[192:193], v252 offset:40960
  ds_read_b64_tr_b16 v[194:195], v252 offset:41472
  s_waitcnt lgkmcnt(10)
  v_mfma_f32_32x32x16_bf16 v[144:159], v[204:207], v[68:71], v[144:159]
  ds_read_b64_tr_b16 v[196:197], v253 offset:40960
  ds_read_b64_tr_b16 v[198:199], v253 offset:41472
  s_waitcnt vmcnt(10)
  s_barrier
  s_waitcnt lgkmcnt(10)
  v_mfma_f32_32x32x16_bf16 v[128:143], v[208:211], v[72:75], v[128:143]
  ds_read_b64_tr_b16 v[200:201], v252 offset:43008
  ds_read_b64_tr_b16 v[202:203], v252 offset:43520
  s_add_u32 m0, s60, 0
  s_add_u32 s51, s63, 512
  s_waitcnt lgkmcnt(10)
  v_mfma_f32_32x32x16_bf16 v[144:159], v[212:215], v[72:75], v[144:159]
  ds_read_b64_tr_b16 v[204:205], v253 offset:43008
  ds_read_b64_tr_b16 v[206:207], v253 offset:43520
  buffer_load_dwordx4 v251, s[32:35], s51 offen lds
  s_waitcnt lgkmcnt(10)
  v_mfma_f32_32x32x16_bf16 v[128:143], v[216:219], v[76:79], v[128:143]
  ds_read_b64_tr_b16 v[208:209], v252 offset:45056
  ds_read_b64_tr_b16 v[210:211], v252 offset:45568
  s_add_u32 m0, s60, 1024
  s_add_u32 s51, s63, 7680
  s_waitcnt lgkmcnt(10)
  v_mfma_f32_32x32x16_bf16 v[144:159], v[220:223], v[76:79], v[144:159]
  ds_read_b64_tr_b16 v[212:213], v253 offset:45056
  ds_read_b64_tr_b16 v[214:215], v253 offset:45568
  s_waitcnt lgkmcnt(10)
  v_mfma_f32_32x32x16_bf16 v[128:143], v[192:195], v[80:83], v[128:143]
  ds_read_b64_tr_b16 v[216:217], v252 offset:47104
  ds_read_b64_tr_b16 v[218:219], v252 offset:47616
  buffer_load_dwordx4 v251, s[32:35], s51 offen lds
  s_waitcnt lgkmcnt(10)
  v_mfma_f32_32x32x16_bf16 v[144:159], v[196:199], v[80:83], v[144:159]
  ds_read_b64_tr_b16 v[220:221], v253 offset:47104
  ds_read_b64_tr_b16 v[222:223], v253 offset:47616
  s_add_u32 m0, s60, 2048
  s_add_u32 s51, s63, 14848
  s_waitcnt lgkmcnt(10)
  v_mfma_f32_32x32x16_bf16 v[128:143], v[200:203], v[84:87], v[128:143]
  ds_read_b64_tr_b16 v[192:193], v252 offset:49152
  ds_read_b64_tr_b16 v[194:195], v252 offset:49664
  v_cvt_pk_bf16_f32 v176, v176, v177
  v_cvt_pk_bf16_f32 v177, v178, v179
  v_cvt_pk_bf16_f32 v178, v180, v181
  v_cvt_pk_bf16_f32 v179, v182, v183
  s_add_u32 s50, s61, 4096
  buffer_store_dwordx4 v[176:179], v227, s[36:39], s50 offen offset:2048 sc1
  s_waitcnt lgkmcnt(10)
  v_mfma_f32_32x32x16_bf16 v[144:159], v[204:207], v[84:87], v[144:159]
  ds_read_b64_tr_b16 v[196:197], v253 offset:49152
  ds_read_b64_tr_b16 v[198:199], v253 offset:49664
  buffer_load_dwordx4 v251, s[32:35], s51 offen lds
  s_waitcnt lgkmcnt(10)
  v_mfma_f32_32x32x16_bf16 v[128:143], v[208:211], v[88:91], v[128:143]
  ds_read_b64_tr_b16 v[200:201], v252 offset:51200
  ds_read_b64_tr_b16 v[202:203], v252 offset:51712
  s_add_u32 m0, s60, 3072
  s_add_u32 s51, s63, 22016
  s_waitcnt lgkmcnt(10)
  v_mfma_f32_32x32x16_bf16 v[144:159], v[212:215], v[88:91], v[144:159]
  ds_read_b64_tr_b16 v[204:205], v253 offset:51200
  ds_read_b64_tr_b16 v[206:207], v253 offset:51712
  buffer_load_dwordx4 v251, s[32:35], s51 offen lds
  s_waitcnt lgkmcnt(10)
  v_mfma_f32_32x32x16_bf16 v[128:143], v[216:219], v[92:95], v[128:143]
  ds_read_b64_tr_b16 v[208:209], v252 offset:53248
  ds_read_b64_tr_b16 v[210:211], v252 offset:53760
  s_waitcnt lgkmcnt(10)
  v_mfma_f32_32x32x16_bf16 v[144:159], v[220:223], v[92:95], v[144:159]
  ds_read_b64_tr_b16 v[212:213], v253 offset:53248
  ds_read_b64_tr_b16 v[214:215], v253 offset:53760
  s_add_u32 m0, s60, 4096
  s_add_u32 s51, s63, 29184
  s_waitcnt lgkmcnt(10)
  v_mfma_f32_32x32x16_bf16 v[128:143], v[192:195], v[96:99], v[128:143]
  ds_read_b64_tr_b16 v[216:217], v252 offset:55296
  ds_read_b64_tr_b16 v[218:219], v252 offset:55808
  buffer_load_dwordx4 v251, s[32:35], s51 offen lds
  s_waitcnt lgkmcnt(10)
  v_mfma_f32_32x32x16_bf16 v[144:159], v[196:199], v[96:99], v[144:159]
  ds_read_b64_tr_b16 v[220:221], v253 offset:55296
  ds_read_b64_tr_b16 v[222:223], v253 offset:55808
  s_add_u32 m0, s60, 5120
  s_add_u32 s51, s63, 36352
  s_waitcnt lgkmcnt(10)
  v_mfma_f32_32x32x16_bf16 v[128:143], v[200:203], v[100:103], v[128:143]
  ds_read_b64_tr_b16 v[192:193], v252 offset:57344
  ds_read_b64_tr_b16 v[194:195], v252 offset:57856
  s_waitcnt lgkmcnt(10)
  v_mfma_f32_32x32x16_bf16 v[144:159], v[204:207], v[100:103], v[144:159]
  ds_read_b64_tr_b16 v[196:197], v253 offset:57344
  ds_read_b64_tr_b16 v[198:199], v253 offset:57856
  buffer_load_dwordx4 v251, s[32:35], s51 offen lds
  s_waitcnt lgkmcnt(10)
  v_mfma_f32_32x32x16_bf16 v[128:143], v[208:211], v[104:107], v[128:143]
  ds_read_b64_tr_b16 v[200:201], v252 offset:59392
  ds_read_b64_tr_b16 v[202:203], v252 offset:59904
  s_add_u32 m0, s60, 6144
  s_add_u32 s51, s63, 43520
  s_waitcnt lgkmcnt(10)
  v_mfma_f32_32x32x16_bf16 v[144:159], v[212:215], v[104:107], v[144:159]
  ds_read_b64_tr_b16 v[204:205], v253 offset:59392
  ds_read_b64_tr_b16 v[206:207], v253 offset:59904
  buffer_load_dwordx4 v251, s[32:35], s51 offen lds
  s_waitcnt lgkmcnt(10)
  v_mfma_f32_32x32x16_bf16 v[128:143], v[216:219], v[108:111], v[128:143]
  ds_read_b64_tr_b16 v[208:209], v252 offset:61440
  ds_read_b64_tr_b16 v[210:211], v252 offset:61952
  v_cvt_pk_bf16_f32 v184, v184, v185
  v_cvt_pk_bf16_f32 v185, v186, v187
  v_cvt_pk_bf16_f32 v186, v188, v189
  v_cvt_pk_bf16_f32 v187, v190, v191
  s_add_u32 s50, s61, 4096
  buffer_store_dwordx4 v[184:187], v227, s[36:39], s50 offen offset:3072 sc1
  s_waitcnt lgkmcnt(10)
  v_mfma_f32_32x32x16_bf16 v[144:159], v[220:223], v[108:111], v[144:159]
  ds_read_b64_tr_b16 v[212:213], v253 offset:61440
  ds_read_b64_tr_b16 v[214:215], v253 offset:61952
  s_add_u32 m0, s60, 7168
  s_add_u32 s51, s63, 50688
  s_waitcnt lgkmcnt(10)
  v_mfma_f32_32x32x16_bf16 v[128:143], v[192:195], v[112:115], v[128:143]
  ds_read_b64_tr_b16 v[216:217], v252 offset:63488
  ds_read_b64_tr_b16 v[218:219], v252 offset:64000
  buffer_load_dwordx4 v251, s[32:35], s51 offen lds
  s_waitcnt lgkmcnt(10)
  v_mfma_f32_32x32x16_bf16 v[144:159], v[196:199], v[112:115], v[144:159]
  ds_read_b64_tr_b16 v[220:221], v253 offset:63488
  ds_read_b64_tr_b16 v[222:223], v253 offset:64000
  s_waitcnt lgkmcnt(10)
  v_mfma_f32_32x32x16_bf16 v[128:143], v[200:203], v[116:119], v[128:143]
  ds_read_b64_tr_b16 v[192:193], v254 offset:0
  ds_read_b64_tr_b16 v[194:195], v254 offset:512
  s_waitcnt lgkmcnt(10)
  v_mfma_f32_32x32x16_bf16 v[144:159], v[204:207], v[116:119], v[144:159]
  ds_read_b64_tr_b16 v[196:197], v255 offset:0
  ds_read_b64_tr_b16 v[198:199], v255 offset:512
  s_waitcnt lgkmcnt(10)
  v_mfma_f32_32x32x16_bf16 v[128:143], v[208:211], v[120:123], v[128:143]
  ds_read_b64_tr_b16 v[200:201], v254 offset:2048
  ds_read_b64_tr_b16 v[202:203], v254 offset:2560
  s_waitcnt lgkmcnt(10)
  v_mfma_f32_32x32x16_bf16 v[144:159], v[212:215], v[120:123], v[144:159]
  ds_read_b64_tr_b16 v[204:205], v255 offset:2048
  ds_read_b64_tr_b16 v[206:207], v255 offset:2560
  s_waitcnt lgkmcnt(10)
  v_mfma_f32_32x32x16_bf16 v[128:143], v[216:219], v[124:127], v[128:143]
  ds_read_b64_tr_b16 v[208:209], v254 offset:4096
  ds_read_b64_tr_b16 v[210:211], v254 offset:4608
  s_waitcnt lgkmcnt(10)
  v_mfma_f32_32x32x16_bf16 v[144:159], v[220:223], v[124:127], v[144:159]
  ds_read_b64_tr_b16 v[212:213], v255 offset:4096
  ds_read_b64_tr_b16 v[214:215], v255 offset:4608
  s_waitcnt lgkmcnt(10)
  v_mfma_f32_32x32x16_bf16 v[160:175], v[192:195], v[0:3], 0
  ds_read_b64_tr_b16 v[216:217], v254 offset:6144
  ds_read_b64_tr_b16 v[218:219], v254 offset:6656
  s_waitcnt lgkmcnt(10)
  v_mfma_f32_32x32x16_bf16 v[176:191], v[196:199], v[0:3], 0
  ds_read_b64_tr_b16 v[220:221], v255 offset:6144
  ds_read_b64_tr_b16 v[222:223], v255 offset:6656
  s_waitcnt lgkmcnt(10)
  v_mfma_f32_32x32x16_bf16 v[160:175], v[200:203], v[4:7], v[160:175]
  ds_read_b64_tr_b16 v[192:193], v254 offset:8192
  ds_read_b64_tr_b16 v[194:195], v254 offset:8704
  s_waitcnt lgkmcnt(10)
  v_mfma_f32_32x32x16_bf16 v[176:191], v[204:207], v[4:7], v[176:191]
  ds_read_b64_tr_b16 v[196:197], v255 offset:8192
  ds_read_b64_tr_b16 v[198:199], v255 offset:8704
  s_waitcnt vmcnt(10)
  s_barrier
  s_waitcnt lgkmcnt(10)
  v_mfma_f32_32x32x16_bf16 v[160:175], v[208:211], v[8:11], v[160:175]
  ds_read_b64_tr_b16 v[200:201], v254 offset:10240
  ds_read_b64_tr_b16 v[202:203], v254 offset:10752
  s_add_u32 m0, s60, 32768
  s_add_u32 s51, s63, 229888
  s_waitcnt lgkmcnt(10)
  v_mfma_f32_32x32x16_bf16 v[176:191], v[212:215], v[8:11], v[176:191]
  ds_read_b64_tr_b16 v[204:205], v255 offset:10240
  ds_read_b64_tr_b16 v[206:207], v255 offset:10752
  buffer_load_dwordx4 v251, s[32:35], s51 offen lds
  s_waitcnt lgkmcnt(10)
  v_mfma_f32_32x32x16_bf16 v[160:175], v[216:219], v[12:15], v[160:175]
  ds_read_b64_tr_b16 v[208:209], v254 offset:12288
  ds_read_b64_tr_b16 v[210:211], v254 offset:12800
  s_add_u32 m0, s60, 33792
  s_add_u32 s51, s63, 237056
  s_waitcnt lgkmcnt(10)
  v_mfma_f32_32x32x16_bf16 v[176:191], v[220:223], v[12:15], v[176:191]
  ds_read_b64_tr_b16 v[212:213], v255 offset:12288
  ds_read_b64_tr_b16 v[214:215], v255 offset:12800
  s_waitcnt lgkmcnt(10)
  v_mfma_f32_32x32x16_bf16 v[160:175], v[192:195], v[16:19], v[160:175]
  ds_read_b64_tr_b16 v[216:217], v254 offset:14336
  ds_read_b64_tr_b16 v[218:219], v254 offset:14848
  buffer_load_dwordx4 v251, s[32:35], s51 offen lds
  s_waitcnt lgkmcnt(10)
  v_mfma_f32_32x32x16_bf16 v[176:191], v[196:199], v[16:19], v[176:191]
  ds_read_b64_tr_b16 v[220:221], v255 offset:14336
  ds_read_b64_tr_b16 v[222:223], v255 offset:14848
  s_add_u32 m0, s60, 34816
  s_add_u32 s51, s63, 244224
  s_waitcnt lgkmcnt(10)
  v_mfma_f32_32x32x16_bf16 v[160:175], v[200:203], v[20:23], v[160:175]
  ds_read_b64_tr_b16 v[192:193], v254 offset:16384
  ds_read_b64_tr_b16 v[194:195], v254 offset:16896
  v_cvt_pk_bf16_f32 v128, v128, v129
  v_cvt_pk_bf16_f32 v129, v130, v131
  v_cvt_pk_bf16_f32 v130, v132, v133
  v_cvt_pk_bf16_f32 v131, v134, v135
  s_add_u32 s50, s61, 8192
  buffer_store_dwordx4 v[128:131], v227, s[36:39], s50 offen sc1
  s_waitcnt lgkmcnt(10)
  v_mfma_f32_32x32x16_bf16 v[176:191], v[204:207], v[20:23], v[176:191]
  ds_read_b64_tr_b16 v[196:197], v255 offset:16384
  ds_read_b64_tr_b16 v[198:199], v255 offset:16896
  buffer_load_dwordx4 v251, s[32:35], s51 offen lds
  s_waitcnt lgkmcnt(10)
  v_mfma_f32_32x32x16_bf16 v[160:175], v[208:211], v[24:27], v[160:175]
  ds_read_b64_tr_b16 v[200:201], v254 offset:18432
  ds_read_b64_tr_b16 v[202:203], v254 offset:18944
  s_add_u32 m0, s60, 35840
  s_add_u32 s51, s63, 251392
  s_waitcnt lgkmcnt(10)
  v_mfma_f32_32x32x16_bf16 v[176:191], v[212:215], v[24:27], v[176:191]
  ds_read_b64_tr_b16 v[204:205], v255 offset:18432
  ds_read_b64_tr_b16 v[206:207], v255 offset:18944
  buffer_load_dwordx4 v251, s[32:35], s51 offen lds
  s_waitcnt lgkmcnt(10)
  v_mfma_f32_32x32x16_bf16 v[160:175], v[216:219], v[28:31], v[160:175]
  ds_read_b64_tr_b16 v[208:209], v254 offset:20480
  ds_read_b64_tr_b16 v[210:211], v254 offset:20992
  s_waitcnt lgkmcnt(10)
  v_mfma_f32_32x32x16_bf16 v[176:191], v[220:223], v[28:31], v[176:191]
  ds_read_b64_tr_b16 v[212:213], v255 offset:20480
  ds_read_b64_tr_b16 v[214:215], v255 offset:20992
  s_add_u32 m0, s60, 36864
  s_add_u32 s51, s63, 258560
  s_waitcnt lgkmcnt(10)
  v_mfma_f32_32x32x16_bf16 v[160:175], v[192:195], v[32:35], v[160:175]
  ds_read_b64_tr_b16 v[216:217], v254 offset:22528
  ds_read_b64_tr_b16 v[218:219], v254 offset:23040
  buffer_load_dwordx4 v251, s[32:35], s51 offen lds
  s_waitcnt lgkmcnt(10)
  v_mfma_f32_32x32x16_bf16 v[176:191], v[196:199], v[32:35], v[176:191]
  ds_read_b64_tr_b16 v[220:221], v255 offset:22528
  ds_read_b64_tr_b16 v[222:223], v255 offset:23040
  s_add_u32 m0, s60, 37888
  s_add_u32 s51, s63, 265728
  s_waitcnt lgkmcnt(10)
  v_mfma_f32_32x32x16_bf16 v[160:175], v[200:203], v[36:39], v[160:175]
  ds_read_b64_tr_b16 v[192:193], v254 offset:24576
  ds_read_b64_tr_b16 v[194:195], v254 offset:25088
  s_waitcnt lgkmcnt(10)
  v_mfma_f32_32x32x16_bf16 v[176:191], v[204:207], v[36:39], v[176:191]
  ds_read_b64_tr_b16 v[196:197], v255 offset:24576
  ds_read_b64_tr_b16 v[198:199], v255 offset:25088
  buffer_load_dwordx4 v251, s[32:35], s51 offen lds
  s_waitcnt lgkmcnt(10)
  v_mfma_f32_32x32x16_bf16 v[160:175], v[208:211], v[40:43], v[160:175]
  ds_read_b64_tr_b16 v[200:201], v254 offset:26624
  ds_read_b64_tr_b16 v[202:203], v254 offset:27136
  s_add_u32 m0, s60, 38912
  s_add_u32 s51, s63, 272896
  s_waitcnt lgkmcnt(10)
  v_mfma_f32_32x32x16_bf16 v[176:191], v[212:215], v[40:43], v[176:191]
  ds_read_b64_tr_b16 v[204:205], v255 offset:26624
  ds_read_b64_tr_b16 v[206:207], v255 offset:27136
  buffer_load_dwordx4 v251, s[32:35], s51 offen lds
  s_waitcnt lgkmcnt(10)
  v_mfma_f32_32x32x16_bf16 v[160:175], v[216:219], v[44:47], v[160:175]
  ds_read_b64_tr_b16 v[208:209], v254 offset:28672
  ds_read_b64_tr_b16 v[210:211], v254 offset:29184
  v_cvt_pk_bf16_f32 v136, v136, v137
  v_cvt_pk_bf16_f32 v137, v138, v139
  v_cvt_pk_bf16_f32 v138, v140, v141
  v_cvt_pk_bf16_f32 v139, v142, v143
  s_add_u32 s50, s61, 8192
  buffer_store_dwordx4 v[136:139], v227, s[36:39], s50 offen offset:1024 sc1
  s_waitcnt lgkmcnt(10)
  v_mfma_f32_32x32x16_bf16 v[176:191], v[220:223], v[44:47], v[176:191]
  ds_read_b64_tr_b16 v[212:213], v255 offset:28672
  ds_read_b64_tr_b16 v[214:215], v255 offset:29184
  s_add_u32 m0, s60, 39936
  s_add_u32 s51, s63, 280064
  s_waitcnt lgkmcnt(10)
  v_mfma_f32_32x32x16_bf16 v[160:175], v[192:195], v[48:51], v[160:175]
  ds_read_b64_tr_b16 v[216:217], v254 offset:30720
  ds_read_b64_tr_b16 v[218:219], v254 offset:31232
  buffer_load_dwordx4 v251, s[32:35], s51 offen lds
  s_waitcnt lgkmcnt(10)
  v_mfma_f32_32x32x16_bf16 v[176:191], v[196:199], v[48:51], v[176:191]
  ds_read_b64_tr_b16 v[220:221], v255 offset:30720
  ds_read_b64_tr_b16 v[222:223], v255 offset:31232
  s_waitcnt lgkmcnt(10)
  v_mfma_f32_32x32x16_bf16 v[160:175], v[200:203], v[52:55], v[160:175]
  ds_read_b64_tr_b16 v[192:193], v254 offset:32768
  ds_read_b64_tr_b16 v[194:195], v254 offset:33280
  s_waitcnt lgkmcnt(10)
  v_mfma_f32_32x32x16_bf16 v[176:191], v[204:207], v[52:55], v[176:191]
  ds_read_b64_tr_b16 v[196:197], v255 offset:32768
  ds_read_b64_tr_b16 v[198:199], v255 offset:33280
  s_waitcnt lgkmcnt(10)
  v_mfma_f32_32x32x16_bf16 v[160:175], v[208:211], v[56:59], v[160:175]
  ds_read_b64_tr_b16 v[200:201], v254 offset:34816
  ds_read_b64_tr_b16 v[202:203], v254 offset:35328
  s_waitcnt lgkmcnt(10)
  v_mfma_f32_32x32x16_bf16 v[176:191], v[212:215], v[56:59], v[176:191]
  ds_read_b64_tr_b16 v[204:205], v255 offset:34816
  ds_read_b64_tr_b16 v[206:207], v255 offset:35328
  s_waitcnt lgkmcnt(10)
  v_mfma_f32_32x32x16_bf16 v[160:175], v[216:219], v[60:63], v[160:175]
  ds_read_b64_tr_b16 v[208:209], v254 offset:36864
  ds_read_b64_tr_b16 v[210:211], v254 offset:37376
  s_waitcnt lgkmcnt(10)
  v_mfma_f32_32x32x16_bf16 v[176:191], v[220:223], v[60:63], v[176:191]
  ds_read_b64_tr_b16 v[212:213], v255 offset:36864
  ds_read_b64_tr_b16 v[214:215], v255 offset:37376
  s_waitcnt lgkmcnt(10)
  v_mfma_f32_32x32x16_bf16 v[160:175], v[192:195], v[64:67], v[160:175]
  ds_read_b64_tr_b16 v[216:217], v254 offset:38912
  ds_read_b64_tr_b16 v[218:219], v254 offset:39424
  s_waitcnt lgkmcnt(10)
  v_mfma_f32_32x32x16_bf16 v[176:191], v[196:199], v[64:67], v[176:191]
  ds_read_b64_tr_b16 v[220:221], v255 offset:38912
  ds_read_b64_tr_b16 v[222:223], v255 offset:39424
  s_waitcnt lgkmcnt(10)
  v_mfma_f32_32x32x16_bf16 v[160:175], v[200:203], v[68:71], v[160:175]
  ds_read_b64_tr_b16 v[192:193], v254 offset:40960
  ds_read_b64_tr_b16 v[194:195], v254 offset:41472
  s_waitcnt lgkmcnt(10)
  v_mfma_f32_32x32x16_bf16 v[176:191], v[204:207], v[68:71], v[176:191]
  ds_read_b64_tr_b16 v[196:197], v255 offset:40960
  ds_read_b64_tr_b16 v[198:199], v255 offset:41472
  s_waitcnt vmcnt(10)
  s_barrier
  s_waitcnt lgkmcnt(10)
  v_mfma_f32_32x32x16_bf16 v[160:175], v[208:211], v[72:75], v[160:175]
  ds_read_b64_tr_b16 v[200:201], v254 offset:43008
  ds_read_b64_tr_b16 v[202:203], v254 offset:43520
  s_add_u32 m0, s60, 65536
  s_add_u32 s51, s63, 640
  s_waitcnt lgkmcnt(10)
  v_mfma_f32_32x32x16_bf16 v[176:191], v[212:215], v[72:75], v[176:191]
  ds_read_b64_tr_b16 v[204:205], v255 offset:43008
  ds_read_b64_tr_b16 v[206:207], v255 offset:43520
  buffer_load_dwordx4 v251, s[32:35], s51 offen lds
  s_waitcnt lgkmcnt(10)
  v_mfma_f32_32x32x16_bf16 v[160:175], v[216:219], v[76:79], v[160:175]
  ds_read_b64_tr_b16 v[208:209], v254 offset:45056
  ds_read_b64_tr_b16 v[210:211], v254 offset:45568
  s_add_u32 m0, s60, 66560
  s_add_u32 s51, s63, 7808
  s_waitcnt lgkmcnt(10)
  v_mfma_f32_32x32x16_bf16 v[176:191], v[220:223], v[76:79], v[176:191]
  ds_read_b64_tr_b16 v[212:213], v255 offset:45056
  ds_read_b64_tr_b16 v[214:215], v255 offset:45568
  s_waitcnt lgkmcnt(10)
  v_mfma_f32_32x32x16_bf16 v[160:175], v[192:195], v[80:83], v[160:175]
  ds_read_b64_tr_b16 v[216:217], v254 offset:47104
  ds_read_b64_tr_b16 v[218:219], v254 offset:47616
  buffer_load_dwordx4 v251, s[32:35], s51 offen lds
  s_waitcnt lgkmcnt(10)
  v_mfma_f32_32x32x16_bf16 v[176:191], v[196:199], v[80:83], v[176:191]
  ds_read_b64_tr_b16 v[220:221], v255 offset:47104
  ds_read_b64_tr_b16 v[222:223], v255 offset:47616
  s_add_u32 m0, s60, 67584
  s_add_u32 s51, s63, 14976
  s_waitcnt lgkmcnt(10)
  v_mfma_f32_32x32x16_bf16 v[160:175], v[200:203], v[84:87], v[160:175]
  ds_read_b64_tr_b16 v[192:193], v254 offset:49152
  ds_read_b64_tr_b16 v[194:195], v254 offset:49664
  v_cvt_pk_bf16_f32 v144, v144, v145
  v_cvt_pk_bf16_f32 v145, v146, v147
  v_cvt_pk_bf16_f32 v146, v148, v149
  v_cvt_pk_bf16_f32 v147, v150, v151
  s_add_u32 s50, s61, 8192
  buffer_store_dwordx4 v[144:147], v227, s[36:39], s50 offen offset:2048 sc1
  s_waitcnt lgkmcnt(10)
  v_mfma_f32_32x32x16_bf16 v[176:191], v[204:207], v[84:87], v[176:191]
  ds_read_b64_tr_b16 v[196:197], v255 offset:49152
  ds_read_b64_tr_b16 v[198:199], v255 offset:49664
  buffer_load_dwordx4 v251, s[32:35], s51 offen lds
  s_waitcnt lgkmcnt(10)
  v_mfma_f32_32x32x16_bf16 v[160:175], v[208:211], v[88:91], v[160:175]
  ds_read_b64_tr_b16 v[200:201], v254 offset:51200
  ds_read_b64_tr_b16 v[202:203], v254 offset:51712
  s_add_u32 m0, s60, 68608
  s_add_u32 s51, s63, 22144
  s_waitcnt lgkmcnt(10)
  v_mfma_f32_32x32x16_bf16 v[176:191], v[212:215], v[88:91], v[176:191]
  ds_read_b64_tr_b16 v[204:205], v255 offset:51200
  ds_read_b64_tr_b16 v[206:207], v255 offset:51712
  buffer_load_dwordx4 v251, s[32:35], s51 offen lds
  s_waitcnt lgkmcnt(10)
  v_mfma_f32_32x32x16_bf16 v[160:175], v[216:219], v[92:95], v[160:175]
  ds_read_b64_tr_b16 v[208:209], v254 offset:53248
  ds_read_b64_tr_b16 v[210:211], v254 offset:53760
  s_waitcnt lgkmcnt(10)
  v_mfma_f32_32x32x16_bf16 v[176:191], v[220:223], v[92:95], v[176:191]
  ds_read_b64_tr_b16 v[212:213], v255 offset:53248
  ds_read_b64_tr_b16 v[214:215], v255 offset:53760
  s_add_u32 m0, s60, 69632
  s_add_u32 s51, s63, 29312
  s_waitcnt lgkmcnt(10)
  v_mfma_f32_32x32x16_bf16 v[160:175], v[192:195], v[96:99], v[160:175]
  ds_read_b64_tr_b16 v[216:217], v254 offset:55296
  ds_read_b64_tr_b16 v[218:219], v254 offset:55808
  buffer_load_dwordx4 v251, s[32:35], s51 offen lds
  s_waitcnt lgkmcnt(10)
  v_mfma_f32_32x32x16_bf16 v[176:191], v[196:199], v[96:99], v[176:191]
  ds_read_b64_tr_b16 v[220:221], v255 offset:55296
  ds_read_b64_tr_b16 v[222:223], v255 offset:55808
  s_add_u32 m0, s60, 70656
  s_add_u32 s51, s63, 36480
  s_waitcnt lgkmcnt(10)
  v_mfma_f32_32x32x16_bf16 v[160:175], v[200:203], v[100:103], v[160:175]
  ds_read_b64_tr_b16 v[192:193], v254 offset:57344
  ds_read_b64_tr_b16 v[194:195], v254 offset:57856
  s_waitcnt lgkmcnt(10)
  v_mfma_f32_32x32x16_bf16 v[176:191], v[204:207], v[100:103], v[176:191]
  ds_read_b64_tr_b16 v[196:197], v255 offset:57344
  ds_read_b64_tr_b16 v[198:199], v255 offset:57856
  buffer_load_dwordx4 v251, s[32:35], s51 offen lds
  s_waitcnt lgkmcnt(10)
  v_mfma_f32_32x32x16_bf16 v[160:175], v[208:211], v[104:107], v[160:175]
  ds_read_b64_tr_b16 v[200:201], v254 offset:59392
  ds_read_b64_tr_b16 v[202:203], v254 offset:59904
  s_add_u32 m0, s60, 71680
  s_add_u32 s51, s63, 43648
  s_waitcnt lgkmcnt(10)
  v_mfma_f32_32x32x16_bf16 v[176:191], v[212:215], v[104:107], v[176:191]
  ds_read_b64_tr_b16 v[204:205], v255 offset:59392
  ds_read_b64_tr_b16 v[206:207], v255 offset:59904
  buffer_load_dwordx4 v251, s[32:35], s51 offen lds
  s_waitcnt lgkmcnt(10)
  v_mfma_f32_32x32x16_bf16 v[160:175], v[216:219], v[108:111], v[160:175]
  ds_read_b64_tr_b16 v[208:209], v254 offset:61440
  ds_read_b64_tr_b16 v[210:211], v254 offset:61952
  v_cvt_pk_bf16_f32 v152, v152, v153
  v_cvt_pk_bf16_f32 v153, v154, v155
  v_cvt_pk_bf16_f32 v154, v156, v157
  v_cvt_pk_bf16_f32 v155, v158, v159
  s_add_u32 s50, s61, 8192
  buffer_store_dwordx4 v[152:155], v227, s[36:39], s50 offen offset:3072 sc1
  s_waitcnt lgkmcnt(10)
  v_mfma_f32_32x32x16_bf16 v[176:191], v[220:223], v[108:111], v[176:191]
  ds_read_b64_tr_b16 v[212:213], v255 offset:61440
  ds_read_b64_tr_b16 v[214:215], v255 offset:61952
  s_add_u32 m0, s60, 72704
  s_add_u32 s51, s63, 50816
  s_waitcnt lgkmcnt(10)
  v_mfma_f32_32x32x16_bf16 v[160:175], v[192:195], v[112:115], v[160:175]
  ds_read_b64_tr_b16 v[216:217], v254 offset:63488
  ds_read_b64_tr_b16 v[218:219], v254 offset:64000
  buffer_load_dwordx4 v251, s[32:35], s51 offen lds
  s_waitcnt lgkmcnt(10)
  v_mfma_f32_32x32x16_bf16 v[176:191], v[196:199], v[112:115], v[176:191]
  ds_read_b64_tr_b16 v[220:221], v255 offset:63488
  ds_read_b64_tr_b16 v[222:223], v255 offset:64000
  s_waitcnt lgkmcnt(10)
  v_mfma_f32_32x32x16_bf16 v[160:175], v[200:203], v[116:119], v[160:175]
  ds_read_b64_tr_b16 v[192:193], v252 offset:0
  ds_read_b64_tr_b16 v[194:195], v252 offset:512
  s_waitcnt lgkmcnt(10)
  v_mfma_f32_32x32x16_bf16 v[176:191], v[204:207], v[116:119], v[176:191]
  ds_read_b64_tr_b16 v[196:197], v253 offset:0
  ds_read_b64_tr_b16 v[198:199], v253 offset:512
  s_waitcnt lgkmcnt(10)
  v_mfma_f32_32x32x16_bf16 v[160:175], v[208:211], v[120:123], v[160:175]
  ds_read_b64_tr_b16 v[200:201], v252 offset:2048
  ds_read_b64_tr_b16 v[202:203], v252 offset:2560
  s_waitcnt lgkmcnt(10)
  v_mfma_f32_32x32x16_bf16 v[176:191], v[212:215], v[120:123], v[176:191]
  ds_read_b64_tr_b16 v[204:205], v253 offset:2048
  ds_read_b64_tr_b16 v[206:207], v253 offset:2560
  s_waitcnt lgkmcnt(10)
  v_mfma_f32_32x32x16_bf16 v[160:175], v[216:219], v[124:127], v[160:175]
  ds_read_b64_tr_b16 v[208:209], v252 offset:4096
  ds_read_b64_tr_b16 v[210:211], v252 offset:4608
  s_waitcnt lgkmcnt(10)
  v_mfma_f32_32x32x16_bf16 v[176:191], v[220:223], v[124:127], v[176:191]
  ds_read_b64_tr_b16 v[212:213], v253 offset:4096
  ds_read_b64_tr_b16 v[214:215], v253 offset:4608
  s_waitcnt lgkmcnt(10)
  v_mfma_f32_32x32x16_bf16 v[128:143], v[192:195], v[0:3], 0
  ds_read_b64_tr_b16 v[216:217], v252 offset:6144
  ds_read_b64_tr_b16 v[218:219], v252 offset:6656
  s_waitcnt lgkmcnt(10)
  v_mfma_f32_32x32x16_bf16 v[144:159], v[196:199], v[0:3], 0
  ds_read_b64_tr_b16 v[220:221], v253 offset:6144
  ds_read_b64_tr_b16 v[222:223], v253 offset:6656
  s_waitcnt lgkmcnt(10)
  v_mfma_f32_32x32x16_bf16 v[128:143], v[200:203], v[4:7], v[128:143]
  ds_read_b64_tr_b16 v[192:193], v252 offset:8192
  ds_read_b64_tr_b16 v[194:195], v252 offset:8704
  s_waitcnt lgkmcnt(10)
  v_mfma_f32_32x32x16_bf16 v[144:159], v[204:207], v[4:7], v[144:159]
  ds_read_b64_tr_b16 v[196:197], v253 offset:8192
  ds_read_b64_tr_b16 v[198:199], v253 offset:8704
  s_waitcnt vmcnt(10)
  s_barrier
  s_waitcnt lgkmcnt(10)
  v_mfma_f32_32x32x16_bf16 v[128:143], v[208:211], v[8:11], v[128:143]
  ds_read_b64_tr_b16 v[200:201], v252 offset:10240
  ds_read_b64_tr_b16 v[202:203], v252 offset:10752
  s_add_u32 m0, s60, 98304
  s_add_u32 s51, s63, 230016
  s_waitcnt lgkmcnt(10)
  v_mfma_f32_32x32x16_bf16 v[144:159], v[212:215], v[8:11], v[144:159]
  ds_read_b64_tr_b16 v[204:205], v253 offset:10240
  ds_read_b64_tr_b16 v[206:207], v253 offset:10752
  buffer_load_dwordx4 v251, s[32:35], s51 offen lds
  s_waitcnt lgkmcnt(10)
  v_mfma_f32_32x32x16_bf16 v[128:143], v[216:219], v[12:15], v[128:143]
  ds_read_b64_tr_b16 v[208:209], v252 offset:12288
  ds_read_b64_tr_b16 v[210:211], v252 offset:12800
  s_add_u32 m0, s60, 99328
  s_add_u32 s51, s63, 237184
  s_waitcnt lgkmcnt(10)
  v_mfma_f32_32x32x16_bf16 v[144:159], v[220:223], v[12:15], v[144:159]
  ds_read_b64_tr_b16 v[212:213], v253 offset:12288
  ds_read_b64_tr_b16 v[214:215], v253 offset:12800
  s_waitcnt lgkmcnt(10)
  v_mfma_f32_32x32x16_bf16 v[128:143], v[192:195], v[16:19], v[128:143]
  ds_read_b64_tr_b16 v[216:217], v252 offset:14336
  ds_read_b64_tr_b16 v[218:219], v252 offset:14848
  buffer_load_dwordx4 v251, s[32:35], s51 offen lds
  s_waitcnt lgkmcnt(10)
  v_mfma_f32_32x32x16_bf16 v[144:159], v[196:199], v[16:19], v[144:159]
  ds_read_b64_tr_b16 v[220:221], v253 offset:14336
  ds_read_b64_tr_b16 v[222:223], v253 offset:14848
  s_add_u32 m0, s60, 100352
  s_add_u32 s51, s63, 244352
  s_waitcnt lgkmcnt(10)
  v_mfma_f32_32x32x16_bf16 v[128:143], v[200:203], v[20:23], v[128:143]
  ds_read_b64_tr_b16 v[192:193], v252 offset:16384
  ds_read_b64_tr_b16 v[194:195], v252 offset:16896
  v_cvt_pk_bf16_f32 v160, v160, v161
  v_cvt_pk_bf16_f32 v161, v162, v163
  v_cvt_pk_bf16_f32 v162, v164, v165
  v_cvt_pk_bf16_f32 v163, v166, v167
  s_add_u32 s50, s61, 12288
  buffer_store_dwordx4 v[160:163], v227, s[36:39], s50 offen sc1
  s_waitcnt lgkmcnt(10)
  v_mfma_f32_32x32x16_bf16 v[144:159], v[204:207], v[20:23], v[144:159]
  ds_read_b64_tr_b16 v[196:197], v253 offset:16384
  ds_read_b64_tr_b16 v[198:199], v253 offset:16896
  buffer_load_dwordx4 v251, s[32:35], s51 offen lds
  s_waitcnt lgkmcnt(10)
  v_mfma_f32_32x32x16_bf16 v[128:143], v[208:211], v[24:27], v[128:143]
  ds_read_b64_tr_b16 v[200:201], v252 offset:18432
  ds_read_b64_tr_b16 v[202:203], v252 offset:18944
  s_add_u32 m0, s60, 101376
  s_add_u32 s51, s63, 251520
  s_waitcnt lgkmcnt(10)
  v_mfma_f32_32x32x16_bf16 v[144:159], v[212:215], v[24:27], v[144:159]
  ds_read_b64_tr_b16 v[204:205], v253 offset:18432
  ds_read_b64_tr_b16 v[206:207], v253 offset:18944
  buffer_load_dwordx4 v251, s[32:35], s51 offen lds
  s_waitcnt lgkmcnt(10)
  v_mfma_f32_32x32x16_bf16 v[128:143], v[216:219], v[28:31], v[128:143]
  ds_read_b64_tr_b16 v[208:209], v252 offset:20480
  ds_read_b64_tr_b16 v[210:211], v252 offset:20992
  s_waitcnt lgkmcnt(10)
  v_mfma_f32_32x32x16_bf16 v[144:159], v[220:223], v[28:31], v[144:159]
  ds_read_b64_tr_b16 v[212:213], v253 offset:20480
  ds_read_b64_tr_b16 v[214:215], v253 offset:20992
  s_add_u32 m0, s60, 102400
  s_add_u32 s51, s63, 258688
  s_waitcnt lgkmcnt(10)
  v_mfma_f32_32x32x16_bf16 v[128:143], v[192:195], v[32:35], v[128:143]
  ds_read_b64_tr_b16 v[216:217], v252 offset:22528
  ds_read_b64_tr_b16 v[218:219], v252 offset:23040
  buffer_load_dwordx4 v251, s[32:35], s51 offen lds
  s_waitcnt lgkmcnt(10)
  v_mfma_f32_32x32x16_bf16 v[144:159], v[196:199], v[32:35], v[144:159]
  ds_read_b64_tr_b16 v[220:221], v253 offset:22528
  ds_read_b64_tr_b16 v[222:223], v253 offset:23040
  s_add_u32 m0, s60, 103424
  s_add_u32 s51, s63, 265856
  s_waitcnt lgkmcnt(10)
  v_mfma_f32_32x32x16_bf16 v[128:143], v[200:203], v[36:39], v[128:143]
  ds_read_b64_tr_b16 v[192:193], v252 offset:24576
  ds_read_b64_tr_b16 v[194:195], v252 offset:25088
  s_waitcnt lgkmcnt(10)
  v_mfma_f32_32x32x16_bf16 v[144:159], v[204:207], v[36:39], v[144:159]
  ds_read_b64_tr_b16 v[196:197], v253 offset:24576
  ds_read_b64_tr_b16 v[198:199], v253 offset:25088
  buffer_load_dwordx4 v251, s[32:35], s51 offen lds
  s_waitcnt lgkmcnt(10)
  v_mfma_f32_32x32x16_bf16 v[128:143], v[208:211], v[40:43], v[128:143]
  ds_read_b64_tr_b16 v[200:201], v252 offset:26624
  ds_read_b64_tr_b16 v[202:203], v252 offset:27136
  s_add_u32 m0, s60, 104448
  s_add_u32 s51, s63, 273024
  s_waitcnt lgkmcnt(10)
  v_mfma_f32_32x32x16_bf16 v[144:159], v[212:215], v[40:43], v[144:159]
  ds_read_b64_tr_b16 v[204:205], v253 offset:26624
  ds_read_b64_tr_b16 v[206:207], v253 offset:27136
  buffer_load_dwordx4 v251, s[32:35], s51 offen lds
  s_waitcnt lgkmcnt(10)
  v_mfma_f32_32x32x16_bf16 v[128:143], v[216:219], v[44:47], v[128:143]
  ds_read_b64_tr_b16 v[208:209], v252 offset:28672
  ds_read_b64_tr_b16 v[210:211], v252 offset:29184
  v_cvt_pk_bf16_f32 v168, v168, v169
  v_cvt_pk_bf16_f32 v169, v170, v171
  v_cvt_pk_bf16_f32 v170, v172, v173
  v_cvt_pk_bf16_f32 v171, v174, v175
  s_add_u32 s50, s61, 12288
  buffer_store_dwordx4 v[168:171], v227, s[36:39], s50 offen offset:1024 sc1
  s_waitcnt lgkmcnt(10)
  v_mfma_f32_32x32x16_bf16 v[144:159], v[220:223], v[44:47], v[144:159]
  ds_read_b64_tr_b16 v[212:213], v253 offset:28672
  ds_read_b64_tr_b16 v[214:215], v253 offset:29184
  s_add_u32 m0, s60, 105472
  s_add_u32 s51, s63, 280192
  s_waitcnt lgkmcnt(10)
  v_mfma_f32_32x32x16_bf16 v[128:143], v[192:195], v[48:51], v[128:143]
  ds_read_b64_tr_b16 v[216:217], v252 offset:30720
  ds_read_b64_tr_b16 v[218:219], v252 offset:31232
  buffer_load_dwordx4 v251, s[32:35], s51 offen lds
  s_waitcnt lgkmcnt(10)
  v_mfma_f32_32x32x16_bf16 v[144:159], v[196:199], v[48:51], v[144:159]
  ds_read_b64_tr_b16 v[220:221], v253 offset:30720
  ds_read_b64_tr_b16 v[222:223], v253 offset:31232
  s_waitcnt lgkmcnt(10)
  v_mfma_f32_32x32x16_bf16 v[128:143], v[200:203], v[52:55], v[128:143]
  ds_read_b64_tr_b16 v[192:193], v252 offset:32768
  ds_read_b64_tr_b16 v[194:195], v252 offset:33280
  s_waitcnt lgkmcnt(10)
  v_mfma_f32_32x32x16_bf16 v[144:159], v[204:207], v[52:55], v[144:159]
  ds_read_b64_tr_b16 v[196:197], v253 offset:32768
  ds_read_b64_tr_b16 v[198:199], v253 offset:33280
  s_waitcnt lgkmcnt(10)
  v_mfma_f32_32x32x16_bf16 v[128:143], v[208:211], v[56:59], v[128:143]
  ds_read_b64_tr_b16 v[200:201], v252 offset:34816
  ds_read_b64_tr_b16 v[202:203], v252 offset:35328
  s_waitcnt lgkmcnt(10)
  v_mfma_f32_32x32x16_bf16 v[144:159], v[212:215], v[56:59], v[144:159]
  ds_read_b64_tr_b16 v[204:205], v253 offset:34816
  ds_read_b64_tr_b16 v[206:207], v253 offset:35328
  s_waitcnt lgkmcnt(10)
  v_mfma_f32_32x32x16_bf16 v[128:143], v[216:219], v[60:63], v[128:143]
  ds_read_b64_tr_b16 v[208:209], v252 offset:36864
  ds_read_b64_tr_b16 v[210:211], v252 offset:37376
  s_waitcnt lgkmcnt(10)
  v_mfma_f32_32x32x16_bf16 v[144:159], v[220:223], v[60:63], v[144:159]
  ds_read_b64_tr_b16 v[212:213], v253 offset:36864
  ds_read_b64_tr_b16 v[214:215], v253 offset:37376
  s_waitcnt lgkmcnt(10)
  v_mfma_f32_32x32x16_bf16 v[128:143], v[192:195], v[64:67], v[128:143]
  ds_read_b64_tr_b16 v[216:217], v252 offset:38912
  ds_read_b64_tr_b16 v[218:219], v252 offset:39424
  s_waitcnt lgkmcnt(10)
  v_mfma_f32_32x32x16_bf16 v[144:159], v[196:199], v[64:67], v[144:159]
  ds_read_b64_tr_b16 v[220:221], v253 offset:38912
  ds_read_b64_tr_b16 v[222:223], v253 offset:39424
  s_waitcnt lgkmcnt(10)
  v_mfma_f32_32x32x16_bf16 v[128:143], v[200:203], v[68:71], v[128:143]
  ds_read_b64_tr_b16 v[192:193], v252 offset:40960
  ds_read_b64_tr_b16 v[194:195], v252 offset:41472
  s_waitcnt lgkmcnt(10)
  v_mfma_f32_32x32x16_bf16 v[144:159], v[204:207], v[68:71], v[144:159]
  ds_read_b64_tr_b16 v[196:197], v253 offset:40960
  ds_read_b64_tr_b16 v[198:199], v253 offset:41472
  s_waitcnt vmcnt(10)
  s_barrier
  s_waitcnt lgkmcnt(10)
  v_mfma_f32_32x32x16_bf16 v[128:143], v[208:211], v[72:75], v[128:143]
  ds_read_b64_tr_b16 v[200:201], v252 offset:43008
  ds_read_b64_tr_b16 v[202:203], v252 offset:43520
  s_add_u32 m0, s60, 0
  s_add_u32 s51, s63, 768
  s_waitcnt lgkmcnt(10)
  v_mfma_f32_32x32x16_bf16 v[144:159], v[212:215], v[72:75], v[144:159]
  ds_read_b64_tr_b16 v[204:205], v253 offset:43008
  ds_read_b64_tr_b16 v[206:207], v253 offset:43520
  buffer_load_dwordx4 v251, s[32:35], s51 offen lds
  s_waitcnt lgkmcnt(10)
  v_mfma_f32_32x32x16_bf16 v[128:143], v[216:219], v[76:79], v[128:143]
  ds_read_b64_tr_b16 v[208:209], v252 offset:45056
  ds_read_b64_tr_b16 v[210:211], v252 offset:45568
  s_add_u32 m0, s60, 1024
  s_add_u32 s51, s63, 7936
  s_waitcnt lgkmcnt(10)
  v_mfma_f32_32x32x16_bf16 v[144:159], v[220:223], v[76:79], v[144:159]
  ds_read_b64_tr_b16 v[212:213], v253 offset:45056
  ds_read_b64_tr_b16 v[214:215], v253 offset:45568
  s_waitcnt lgkmcnt(10)
  v_mfma_f32_32x32x16_bf16 v[128:143], v[192:195], v[80:83], v[128:143]
  ds_read_b64_tr_b16 v[216:217], v252 offset:47104
  ds_read_b64_tr_b16 v[218:219], v252 offset:47616
  buffer_load_dwordx4 v251, s[32:35], s51 offen lds
  s_waitcnt lgkmcnt(10)
  v_mfma_f32_32x32x16_bf16 v[144:159], v[196:199], v[80:83], v[144:159]
  ds_read_b64_tr_b16 v[220:221], v253 offset:47104
  ds_read_b64_tr_b16 v[222:223], v253 offset:47616
  s_add_u32 m0, s60, 2048
  s_add_u32 s51, s63, 15104
  s_waitcnt lgkmcnt(10)
  v_mfma_f32_32x32x16_bf16 v[128:143], v[200:203], v[84:87], v[128:143]
  ds_read_b64_tr_b16 v[192:193], v252 offset:49152
  ds_read_b64_tr_b16 v[194:195], v252 offset:49664
  v_cvt_pk_bf16_f32 v176, v176, v177
  v_cvt_pk_bf16_f32 v177, v178, v179
  v_cvt_pk_bf16_f32 v178, v180, v181
  v_cvt_pk_bf16_f32 v179, v182, v183
  s_add_u32 s50, s61, 12288
  buffer_store_dwordx4 v[176:179], v227, s[36:39], s50 offen offset:2048 sc1
  s_waitcnt lgkmcnt(10)
  v_mfma_f32_32x32x16_bf16 v[144:159], v[204:207], v[84:87], v[144:159]
  ds_read_b64_tr_b16 v[196:197], v253 offset:49152
  ds_read_b64_tr_b16 v[198:199], v253 offset:49664
  buffer_load_dwordx4 v251, s[32:35], s51 offen lds
  s_waitcnt lgkmcnt(10)
  v_mfma_f32_32x32x16_bf16 v[128:143], v[208:211], v[88:91], v[128:143]
  ds_read_b64_tr_b16 v[200:201], v252 offset:51200
  ds_read_b64_tr_b16 v[202:203], v252 offset:51712
  s_add_u32 m0, s60, 3072
  s_add_u32 s51, s63, 22272
  s_waitcnt lgkmcnt(10)
  v_mfma_f32_32x32x16_bf16 v[144:159], v[212:215], v[88:91], v[144:159]
  ds_read_b64_tr_b16 v[204:205], v253 offset:51200
  ds_read_b64_tr_b16 v[206:207], v253 offset:51712
  buffer_load_dwordx4 v251, s[32:35], s51 offen lds
  s_waitcnt lgkmcnt(10)
  v_mfma_f32_32x32x16_bf16 v[128:143], v[216:219], v[92:95], v[128:143]
  ds_read_b64_tr_b16 v[208:209], v252 offset:53248
  ds_read_b64_tr_b16 v[210:211], v252 offset:53760
  s_waitcnt lgkmcnt(10)
  v_mfma_f32_32x32x16_bf16 v[144:159], v[220:223], v[92:95], v[144:159]
  ds_read_b64_tr_b16 v[212:213], v253 offset:53248
  ds_read_b64_tr_b16 v[214:215], v253 offset:53760
  s_add_u32 m0, s60, 4096
  s_add_u32 s51, s63, 29440
  s_waitcnt lgkmcnt(10)
  v_mfma_f32_32x32x16_bf16 v[128:143], v[192:195], v[96:99], v[128:143]
  ds_read_b64_tr_b16 v[216:217], v252 offset:55296
  ds_read_b64_tr_b16 v[218:219], v252 offset:55808
  buffer_load_dwordx4 v251, s[32:35], s51 offen lds
  s_waitcnt lgkmcnt(10)
  v_mfma_f32_32x32x16_bf16 v[144:159], v[196:199], v[96:99], v[144:159]
  ds_read_b64_tr_b16 v[220:221], v253 offset:55296
  ds_read_b64_tr_b16 v[222:223], v253 offset:55808
  s_add_u32 m0, s60, 5120
  s_add_u32 s51, s63, 36608
  s_waitcnt lgkmcnt(10)
  v_mfma_f32_32x32x16_bf16 v[128:143], v[200:203], v[100:103], v[128:143]
  ds_read_b64_tr_b16 v[192:193], v252 offset:57344
  ds_read_b64_tr_b16 v[194:195], v252 offset:57856
  s_waitcnt lgkmcnt(10)
  v_mfma_f32_32x32x16_bf16 v[144:159], v[204:207], v[100:103], v[144:159]
  ds_read_b64_tr_b16 v[196:197], v253 offset:57344
  ds_read_b64_tr_b16 v[198:199], v253 offset:57856
  buffer_load_dwordx4 v251, s[32:35], s51 offen lds
  s_waitcnt lgkmcnt(10)
  v_mfma_f32_32x32x16_bf16 v[128:143], v[208:211], v[104:107], v[128:143]
  ds_read_b64_tr_b16 v[200:201], v252 offset:59392
  ds_read_b64_tr_b16 v[202:203], v252 offset:59904
  s_add_u32 m0, s60, 6144
  s_add_u32 s51, s63, 43776
  s_waitcnt lgkmcnt(10)
  v_mfma_f32_32x32x16_bf16 v[144:159], v[212:215], v[104:107], v[144:159]
  ds_read_b64_tr_b16 v[204:205], v253 offset:59392
  ds_read_b64_tr_b16 v[206:207], v253 offset:59904
  buffer_load_dwordx4 v251, s[32:35], s51 offen lds
  s_waitcnt lgkmcnt(10)
  v_mfma_f32_32x32x16_bf16 v[128:143], v[216:219], v[108:111], v[128:143]
  ds_read_b64_tr_b16 v[208:209], v252 offset:61440
  ds_read_b64_tr_b16 v[210:211], v252 offset:61952
  v_cvt_pk_bf16_f32 v184, v184, v185
  v_cvt_pk_bf16_f32 v185, v186, v187
  v_cvt_pk_bf16_f32 v186, v188, v189
  v_cvt_pk_bf16_f32 v187, v190, v191
  s_add_u32 s50, s61, 12288
  buffer_store_dwordx4 v[184:187], v227, s[36:39], s50 offen offset:3072 sc1
  s_waitcnt lgkmcnt(10)
  v_mfma_f32_32x32x16_bf16 v[144:159], v[220:223], v[108:111], v[144:159]
  ds_read_b64_tr_b16 v[212:213], v253 offset:61440
  ds_read_b64_tr_b16 v[214:215], v253 offset:61952
  s_add_u32 m0, s60, 7168
  s_add_u32 s51, s63, 50944
  s_waitcnt lgkmcnt(10)
  v_mfma_f32_32x32x16_bf16 v[128:143], v[192:195], v[112:115], v[128:143]
  ds_read_b64_tr_b16 v[216:217], v252 offset:63488
  ds_read_b64_tr_b16 v[218:219], v252 offset:64000
  buffer_load_dwordx4 v251, s[32:35], s51 offen lds
  s_waitcnt lgkmcnt(10)
  v_mfma_f32_32x32x16_bf16 v[144:159], v[196:199], v[112:115], v[144:159]
  ds_read_b64_tr_b16 v[220:221], v253 offset:63488
  ds_read_b64_tr_b16 v[222:223], v253 offset:64000
  s_waitcnt lgkmcnt(10)
  v_mfma_f32_32x32x16_bf16 v[128:143], v[200:203], v[116:119], v[128:143]
  ds_read_b64_tr_b16 v[192:193], v254 offset:0
  ds_read_b64_tr_b16 v[194:195], v254 offset:512
  s_waitcnt lgkmcnt(10)
  v_mfma_f32_32x32x16_bf16 v[144:159], v[204:207], v[116:119], v[144:159]
  ds_read_b64_tr_b16 v[196:197], v255 offset:0
  ds_read_b64_tr_b16 v[198:199], v255 offset:512
  s_waitcnt lgkmcnt(10)
  v_mfma_f32_32x32x16_bf16 v[128:143], v[208:211], v[120:123], v[128:143]
  ds_read_b64_tr_b16 v[200:201], v254 offset:2048
  ds_read_b64_tr_b16 v[202:203], v254 offset:2560
  s_waitcnt lgkmcnt(10)
  v_mfma_f32_32x32x16_bf16 v[144:159], v[212:215], v[120:123], v[144:159]
  ds_read_b64_tr_b16 v[204:205], v255 offset:2048
  ds_read_b64_tr_b16 v[206:207], v255 offset:2560
  s_waitcnt lgkmcnt(10)
  v_mfma_f32_32x32x16_bf16 v[128:143], v[216:219], v[124:127], v[128:143]
  ds_read_b64_tr_b16 v[208:209], v254 offset:4096
  ds_read_b64_tr_b16 v[210:211], v254 offset:4608
  s_waitcnt lgkmcnt(10)
  v_mfma_f32_32x32x16_bf16 v[144:159], v[220:223], v[124:127], v[144:159]
  ds_read_b64_tr_b16 v[212:213], v255 offset:4096
  ds_read_b64_tr_b16 v[214:215], v255 offset:4608
  s_waitcnt lgkmcnt(10)
  v_mfma_f32_32x32x16_bf16 v[160:175], v[192:195], v[0:3], 0
  ds_read_b64_tr_b16 v[216:217], v254 offset:6144
  ds_read_b64_tr_b16 v[218:219], v254 offset:6656
  s_waitcnt lgkmcnt(10)
  v_mfma_f32_32x32x16_bf16 v[176:191], v[196:199], v[0:3], 0
  ds_read_b64_tr_b16 v[220:221], v255 offset:6144
  ds_read_b64_tr_b16 v[222:223], v255 offset:6656
  s_waitcnt lgkmcnt(10)
  v_mfma_f32_32x32x16_bf16 v[160:175], v[200:203], v[4:7], v[160:175]
  ds_read_b64_tr_b16 v[192:193], v254 offset:8192
  ds_read_b64_tr_b16 v[194:195], v254 offset:8704
  s_waitcnt lgkmcnt(10)
  v_mfma_f32_32x32x16_bf16 v[176:191], v[204:207], v[4:7], v[176:191]
  ds_read_b64_tr_b16 v[196:197], v255 offset:8192
  ds_read_b64_tr_b16 v[198:199], v255 offset:8704
  s_waitcnt vmcnt(10)
  s_barrier
  s_waitcnt lgkmcnt(10)
  v_mfma_f32_32x32x16_bf16 v[160:175], v[208:211], v[8:11], v[160:175]
  ds_read_b64_tr_b16 v[200:201], v254 offset:10240
  ds_read_b64_tr_b16 v[202:203], v254 offset:10752
  s_add_u32 m0, s60, 32768
  s_add_u32 s51, s63, 230144
  s_waitcnt lgkmcnt(10)
  v_mfma_f32_32x32x16_bf16 v[176:191], v[212:215], v[8:11], v[176:191]
  ds_read_b64_tr_b16 v[204:205], v255 offset:10240
  ds_read_b64_tr_b16 v[206:207], v255 offset:10752
  buffer_load_dwordx4 v251, s[32:35], s51 offen lds
  s_waitcnt lgkmcnt(10)
  v_mfma_f32_32x32x16_bf16 v[160:175], v[216:219], v[12:15], v[160:175]
  ds_read_b64_tr_b16 v[208:209], v254 offset:12288
  ds_read_b64_tr_b16 v[210:211], v254 offset:12800
  s_add_u32 m0, s60, 33792
  s_add_u32 s51, s63, 237312
  s_waitcnt lgkmcnt(10)
  v_mfma_f32_32x32x16_bf16 v[176:191], v[220:223], v[12:15], v[176:191]
  ds_read_b64_tr_b16 v[212:213], v255 offset:12288
  ds_read_b64_tr_b16 v[214:215], v255 offset:12800
  s_waitcnt lgkmcnt(10)
  v_mfma_f32_32x32x16_bf16 v[160:175], v[192:195], v[16:19], v[160:175]
  ds_read_b64_tr_b16 v[216:217], v254 offset:14336
  ds_read_b64_tr_b16 v[218:219], v254 offset:14848
  buffer_load_dwordx4 v251, s[32:35], s51 offen lds
  s_waitcnt lgkmcnt(10)
  v_mfma_f32_32x32x16_bf16 v[176:191], v[196:199], v[16:19], v[176:191]
  ds_read_b64_tr_b16 v[220:221], v255 offset:14336
  ds_read_b64_tr_b16 v[222:223], v255 offset:14848
  s_add_u32 m0, s60, 34816
  s_add_u32 s51, s63, 244480
  s_waitcnt lgkmcnt(10)
  v_mfma_f32_32x32x16_bf16 v[160:175], v[200:203], v[20:23], v[160:175]
  ds_read_b64_tr_b16 v[192:193], v254 offset:16384
  ds_read_b64_tr_b16 v[194:195], v254 offset:16896
  v_cvt_pk_bf16_f32 v128, v128, v129
  v_cvt_pk_bf16_f32 v129, v130, v131
  v_cvt_pk_bf16_f32 v130, v132, v133
  v_cvt_pk_bf16_f32 v131, v134, v135
  s_add_u32 s50, s61, 16384
  buffer_store_dwordx4 v[128:131], v227, s[36:39], s50 offen sc1
  s_waitcnt lgkmcnt(10)
  v_mfma_f32_32x32x16_bf16 v[176:191], v[204:207], v[20:23], v[176:191]
  ds_read_b64_tr_b16 v[196:197], v255 offset:16384
  ds_read_b64_tr_b16 v[198:199], v255 offset:16896
  buffer_load_dwordx4 v251, s[32:35], s51 offen lds
  s_waitcnt lgkmcnt(10)
  v_mfma_f32_32x32x16_bf16 v[160:175], v[208:211], v[24:27], v[160:175]
  ds_read_b64_tr_b16 v[200:201], v254 offset:18432
  ds_read_b64_tr_b16 v[202:203], v254 offset:18944
  s_add_u32 m0, s60, 35840
  s_add_u32 s51, s63, 251648
  s_waitcnt lgkmcnt(10)
  v_mfma_f32_32x32x16_bf16 v[176:191], v[212:215], v[24:27], v[176:191]
  ds_read_b64_tr_b16 v[204:205], v255 offset:18432
  ds_read_b64_tr_b16 v[206:207], v255 offset:18944
  buffer_load_dwordx4 v251, s[32:35], s51 offen lds
  s_waitcnt lgkmcnt(10)
  v_mfma_f32_32x32x16_bf16 v[160:175], v[216:219], v[28:31], v[160:175]
  ds_read_b64_tr_b16 v[208:209], v254 offset:20480
  ds_read_b64_tr_b16 v[210:211], v254 offset:20992
  s_waitcnt lgkmcnt(10)
  v_mfma_f32_32x32x16_bf16 v[176:191], v[220:223], v[28:31], v[176:191]
  ds_read_b64_tr_b16 v[212:213], v255 offset:20480
  ds_read_b64_tr_b16 v[214:215], v255 offset:20992
  s_add_u32 m0, s60, 36864
  s_add_u32 s51, s63, 258816
  s_waitcnt lgkmcnt(10)
  v_mfma_f32_32x32x16_bf16 v[160:175], v[192:195], v[32:35], v[160:175]
  ds_read_b64_tr_b16 v[216:217], v254 offset:22528
  ds_read_b64_tr_b16 v[218:219], v254 offset:23040
  buffer_load_dwordx4 v251, s[32:35], s51 offen lds
  s_waitcnt lgkmcnt(10)
  v_mfma_f32_32x32x16_bf16 v[176:191], v[196:199], v[32:35], v[176:191]
  ds_read_b64_tr_b16 v[220:221], v255 offset:22528
  ds_read_b64_tr_b16 v[222:223], v255 offset:23040
  s_add_u32 m0, s60, 37888
  s_add_u32 s51, s63, 265984
  s_waitcnt lgkmcnt(10)
  v_mfma_f32_32x32x16_bf16 v[160:175], v[200:203], v[36:39], v[160:175]
  ds_read_b64_tr_b16 v[192:193], v254 offset:24576
  ds_read_b64_tr_b16 v[194:195], v254 offset:25088
  s_waitcnt lgkmcnt(10)
  v_mfma_f32_32x32x16_bf16 v[176:191], v[204:207], v[36:39], v[176:191]
  ds_read_b64_tr_b16 v[196:197], v255 offset:24576
  ds_read_b64_tr_b16 v[198:199], v255 offset:25088
  buffer_load_dwordx4 v251, s[32:35], s51 offen lds
  s_waitcnt lgkmcnt(10)
  v_mfma_f32_32x32x16_bf16 v[160:175], v[208:211], v[40:43], v[160:175]
  ds_read_b64_tr_b16 v[200:201], v254 offset:26624
  ds_read_b64_tr_b16 v[202:203], v254 offset:27136
  s_add_u32 m0, s60, 38912
  s_add_u32 s51, s63, 273152
  s_waitcnt lgkmcnt(10)
  v_mfma_f32_32x32x16_bf16 v[176:191], v[212:215], v[40:43], v[176:191]
  ds_read_b64_tr_b16 v[204:205], v255 offset:26624
  ds_read_b64_tr_b16 v[206:207], v255 offset:27136
  buffer_load_dwordx4 v251, s[32:35], s51 offen lds
  s_waitcnt lgkmcnt(10)
  v_mfma_f32_32x32x16_bf16 v[160:175], v[216:219], v[44:47], v[160:175]
  ds_read_b64_tr_b16 v[208:209], v254 offset:28672
  ds_read_b64_tr_b16 v[210:211], v254 offset:29184
  v_cvt_pk_bf16_f32 v136, v136, v137
  v_cvt_pk_bf16_f32 v137, v138, v139
  v_cvt_pk_bf16_f32 v138, v140, v141
  v_cvt_pk_bf16_f32 v139, v142, v143
  s_add_u32 s50, s61, 16384
  buffer_store_dwordx4 v[136:139], v227, s[36:39], s50 offen offset:1024 sc1
  s_waitcnt lgkmcnt(10)
  v_mfma_f32_32x32x16_bf16 v[176:191], v[220:223], v[44:47], v[176:191]
  ds_read_b64_tr_b16 v[212:213], v255 offset:28672
  ds_read_b64_tr_b16 v[214:215], v255 offset:29184
  s_add_u32 m0, s60, 39936
  s_add_u32 s51, s63, 280320
  s_waitcnt lgkmcnt(10)
  v_mfma_f32_32x32x16_bf16 v[160:175], v[192:195], v[48:51], v[160:175]
  ds_read_b64_tr_b16 v[216:217], v254 offset:30720
  ds_read_b64_tr_b16 v[218:219], v254 offset:31232
  buffer_load_dwordx4 v251, s[32:35], s51 offen lds
  s_waitcnt lgkmcnt(10)
  v_mfma_f32_32x32x16_bf16 v[176:191], v[196:199], v[48:51], v[176:191]
  ds_read_b64_tr_b16 v[220:221], v255 offset:30720
  ds_read_b64_tr_b16 v[222:223], v255 offset:31232
  s_waitcnt lgkmcnt(10)
  v_mfma_f32_32x32x16_bf16 v[160:175], v[200:203], v[52:55], v[160:175]
  ds_read_b64_tr_b16 v[192:193], v254 offset:32768
  ds_read_b64_tr_b16 v[194:195], v254 offset:33280
  s_waitcnt lgkmcnt(10)
  v_mfma_f32_32x32x16_bf16 v[176:191], v[204:207], v[52:55], v[176:191]
  ds_read_b64_tr_b16 v[196:197], v255 offset:32768
  ds_read_b64_tr_b16 v[198:199], v255 offset:33280
  s_waitcnt lgkmcnt(10)
  v_mfma_f32_32x32x16_bf16 v[160:175], v[208:211], v[56:59], v[160:175]
  ds_read_b64_tr_b16 v[200:201], v254 offset:34816
  ds_read_b64_tr_b16 v[202:203], v254 offset:35328
  s_waitcnt lgkmcnt(10)
  v_mfma_f32_32x32x16_bf16 v[176:191], v[212:215], v[56:59], v[176:191]
  ds_read_b64_tr_b16 v[204:205], v255 offset:34816
  ds_read_b64_tr_b16 v[206:207], v255 offset:35328
  s_waitcnt lgkmcnt(10)
  v_mfma_f32_32x32x16_bf16 v[160:175], v[216:219], v[60:63], v[160:175]
  ds_read_b64_tr_b16 v[208:209], v254 offset:36864
  ds_read_b64_tr_b16 v[210:211], v254 offset:37376
  s_waitcnt lgkmcnt(10)
  v_mfma_f32_32x32x16_bf16 v[176:191], v[220:223], v[60:63], v[176:191]
  ds_read_b64_tr_b16 v[212:213], v255 offset:36864
  ds_read_b64_tr_b16 v[214:215], v255 offset:37376
  s_waitcnt lgkmcnt(10)
  v_mfma_f32_32x32x16_bf16 v[160:175], v[192:195], v[64:67], v[160:175]
  ds_read_b64_tr_b16 v[216:217], v254 offset:38912
  ds_read_b64_tr_b16 v[218:219], v254 offset:39424
  s_waitcnt lgkmcnt(10)
  v_mfma_f32_32x32x16_bf16 v[176:191], v[196:199], v[64:67], v[176:191]
  ds_read_b64_tr_b16 v[220:221], v255 offset:38912
  ds_read_b64_tr_b16 v[222:223], v255 offset:39424
  s_waitcnt lgkmcnt(10)
  v_mfma_f32_32x32x16_bf16 v[160:175], v[200:203], v[68:71], v[160:175]
  ds_read_b64_tr_b16 v[192:193], v254 offset:40960
  ds_read_b64_tr_b16 v[194:195], v254 offset:41472
  s_waitcnt lgkmcnt(10)
  v_mfma_f32_32x32x16_bf16 v[176:191], v[204:207], v[68:71], v[176:191]
  ds_read_b64_tr_b16 v[196:197], v255 offset:40960
  ds_read_b64_tr_b16 v[198:199], v255 offset:41472
  s_waitcnt vmcnt(10)
  s_barrier
  s_waitcnt lgkmcnt(10)
  v_mfma_f32_32x32x16_bf16 v[160:175], v[208:211], v[72:75], v[160:175]
  ds_read_b64_tr_b16 v[200:201], v254 offset:43008
  ds_read_b64_tr_b16 v[202:203], v254 offset:43520
  s_waitcnt lgkmcnt(10)
  v_mfma_f32_32x32x16_bf16 v[176:191], v[212:215], v[72:75], v[176:191]
  ds_read_b64_tr_b16 v[204:205], v255 offset:43008
  ds_read_b64_tr_b16 v[206:207], v255 offset:43520
  s_waitcnt lgkmcnt(10)
  v_mfma_f32_32x32x16_bf16 v[160:175], v[216:219], v[76:79], v[160:175]
  ds_read_b64_tr_b16 v[208:209], v254 offset:45056
  ds_read_b64_tr_b16 v[210:211], v254 offset:45568
  s_waitcnt lgkmcnt(10)
  v_mfma_f32_32x32x16_bf16 v[176:191], v[220:223], v[76:79], v[176:191]
  ds_read_b64_tr_b16 v[212:213], v255 offset:45056
  ds_read_b64_tr_b16 v[214:215], v255 offset:45568
  s_waitcnt lgkmcnt(10)
  v_mfma_f32_32x32x16_bf16 v[160:175], v[192:195], v[80:83], v[160:175]
  ds_read_b64_tr_b16 v[216:217], v254 offset:47104
  ds_read_b64_tr_b16 v[218:219], v254 offset:47616
  s_waitcnt lgkmcnt(10)
  v_mfma_f32_32x32x16_bf16 v[176:191], v[196:199], v[80:83], v[176:191]
  ds_read_b64_tr_b16 v[220:221], v255 offset:47104
  ds_read_b64_tr_b16 v[222:223], v255 offset:47616
  s_waitcnt lgkmcnt(10)
  v_mfma_f32_32x32x16_bf16 v[160:175], v[200:203], v[84:87], v[160:175]
  ds_read_b64_tr_b16 v[192:193], v254 offset:49152
  ds_read_b64_tr_b16 v[194:195], v254 offset:49664
  v_cvt_pk_bf16_f32 v144, v144, v145
  v_cvt_pk_bf16_f32 v145, v146, v147
  v_cvt_pk_bf16_f32 v146, v148, v149
  v_cvt_pk_bf16_f32 v147, v150, v151
  s_add_u32 s50, s61, 16384
  buffer_store_dwordx4 v[144:147], v227, s[36:39], s50 offen offset:2048 sc1
  s_waitcnt lgkmcnt(10)
  v_mfma_f32_32x32x16_bf16 v[176:191], v[204:207], v[84:87], v[176:191]
  ds_read_b64_tr_b16 v[196:197], v255 offset:49152
  ds_read_b64_tr_b16 v[198:199], v255 offset:49664
  s_waitcnt lgkmcnt(10)
  v_mfma_f32_32x32x16_bf16 v[160:175], v[208:211], v[88:91], v[160:175]
  ds_read_b64_tr_b16 v[200:201], v254 offset:51200
  ds_read_b64_tr_b16 v[202:203], v254 offset:51712
  s_waitcnt lgkmcnt(10)
  v_mfma_f32_32x32x16_bf16 v[176:191], v[212:215], v[88:91], v[176:191]
  ds_read_b64_tr_b16 v[204:205], v255 offset:51200
  ds_read_b64_tr_b16 v[206:207], v255 offset:51712
  s_waitcnt lgkmcnt(10)
  v_mfma_f32_32x32x16_bf16 v[160:175], v[216:219], v[92:95], v[160:175]
  ds_read_b64_tr_b16 v[208:209], v254 offset:53248
  ds_read_b64_tr_b16 v[210:211], v254 offset:53760
  s_waitcnt lgkmcnt(10)
  v_mfma_f32_32x32x16_bf16 v[176:191], v[220:223], v[92:95], v[176:191]
  ds_read_b64_tr_b16 v[212:213], v255 offset:53248
  ds_read_b64_tr_b16 v[214:215], v255 offset:53760
  s_waitcnt lgkmcnt(10)
  v_mfma_f32_32x32x16_bf16 v[160:175], v[192:195], v[96:99], v[160:175]
  ds_read_b64_tr_b16 v[216:217], v254 offset:55296
  ds_read_b64_tr_b16 v[218:219], v254 offset:55808
  s_waitcnt lgkmcnt(10)
  v_mfma_f32_32x32x16_bf16 v[176:191], v[196:199], v[96:99], v[176:191]
  ds_read_b64_tr_b16 v[220:221], v255 offset:55296
  ds_read_b64_tr_b16 v[222:223], v255 offset:55808
  s_waitcnt lgkmcnt(10)
  v_mfma_f32_32x32x16_bf16 v[160:175], v[200:203], v[100:103], v[160:175]
  ds_read_b64_tr_b16 v[192:193], v254 offset:57344
  ds_read_b64_tr_b16 v[194:195], v254 offset:57856
  s_waitcnt lgkmcnt(10)
  v_mfma_f32_32x32x16_bf16 v[176:191], v[204:207], v[100:103], v[176:191]
  ds_read_b64_tr_b16 v[196:197], v255 offset:57344
  ds_read_b64_tr_b16 v[198:199], v255 offset:57856
  s_waitcnt lgkmcnt(10)
  v_mfma_f32_32x32x16_bf16 v[160:175], v[208:211], v[104:107], v[160:175]
  ds_read_b64_tr_b16 v[200:201], v254 offset:59392
  ds_read_b64_tr_b16 v[202:203], v254 offset:59904
  s_waitcnt lgkmcnt(10)
  v_mfma_f32_32x32x16_bf16 v[176:191], v[212:215], v[104:107], v[176:191]
  ds_read_b64_tr_b16 v[204:205], v255 offset:59392
  ds_read_b64_tr_b16 v[206:207], v255 offset:59904
  s_waitcnt lgkmcnt(10)
  v_mfma_f32_32x32x16_bf16 v[160:175], v[216:219], v[108:111], v[160:175]
  ds_read_b64_tr_b16 v[208:209], v254 offset:61440
  ds_read_b64_tr_b16 v[210:211], v254 offset:61952
  v_cvt_pk_bf16_f32 v152, v152, v153
  v_cvt_pk_bf16_f32 v153, v154, v155
  v_cvt_pk_bf16_f32 v154, v156, v157
  v_cvt_pk_bf16_f32 v155, v158, v159
  s_add_u32 s50, s61, 16384
  buffer_store_dwordx4 v[152:155], v227, s[36:39], s50 offen offset:3072 sc1
  s_waitcnt lgkmcnt(10)
  v_mfma_f32_32x32x16_bf16 v[176:191], v[220:223], v[108:111], v[176:191]
  ds_read_b64_tr_b16 v[212:213], v255 offset:61440
  ds_read_b64_tr_b16 v[214:215], v255 offset:61952
  s_waitcnt lgkmcnt(10)
  v_mfma_f32_32x32x16_bf16 v[160:175], v[192:195], v[112:115], v[160:175]
  ds_read_b64_tr_b16 v[216:217], v254 offset:63488
  ds_read_b64_tr_b16 v[218:219], v254 offset:64000
  s_waitcnt lgkmcnt(10)
  v_mfma_f32_32x32x16_bf16 v[176:191], v[196:199], v[112:115], v[176:191]
  ds_read_b64_tr_b16 v[220:221], v255 offset:63488
  ds_read_b64_tr_b16 v[222:223], v255 offset:64000
  s_waitcnt lgkmcnt(10)
  v_mfma_f32_32x32x16_bf16 v[160:175], v[200:203], v[116:119], v[160:175]
  ds_read_b64_tr_b16 v[192:193], v252 offset:0
  ds_read_b64_tr_b16 v[194:195], v252 offset:512
  s_waitcnt lgkmcnt(10)
  v_mfma_f32_32x32x16_bf16 v[176:191], v[204:207], v[116:119], v[176:191]
  ds_read_b64_tr_b16 v[196:197], v253 offset:0
  ds_read_b64_tr_b16 v[198:199], v253 offset:512
  s_waitcnt lgkmcnt(10)
  v_mfma_f32_32x32x16_bf16 v[160:175], v[208:211], v[120:123], v[160:175]
  ds_read_b64_tr_b16 v[200:201], v252 offset:2048
  ds_read_b64_tr_b16 v[202:203], v252 offset:2560
  s_waitcnt lgkmcnt(10)
  v_mfma_f32_32x32x16_bf16 v[176:191], v[212:215], v[120:123], v[176:191]
  ds_read_b64_tr_b16 v[204:205], v253 offset:2048
  ds_read_b64_tr_b16 v[206:207], v253 offset:2560
  s_waitcnt lgkmcnt(10)
  v_mfma_f32_32x32x16_bf16 v[160:175], v[216:219], v[124:127], v[160:175]
  ds_read_b64_tr_b16 v[208:209], v252 offset:4096
  ds_read_b64_tr_b16 v[210:211], v252 offset:4608
  s_waitcnt lgkmcnt(10)
  v_mfma_f32_32x32x16_bf16 v[176:191], v[220:223], v[124:127], v[176:191]
  ds_read_b64_tr_b16 v[212:213], v253 offset:4096
  ds_read_b64_tr_b16 v[214:215], v253 offset:4608
  s_waitcnt lgkmcnt(10)
  v_mfma_f32_32x32x16_bf16 v[128:143], v[192:195], v[0:3], 0
  ds_read_b64_tr_b16 v[216:217], v252 offset:6144
  ds_read_b64_tr_b16 v[218:219], v252 offset:6656
  s_waitcnt lgkmcnt(10)
  v_mfma_f32_32x32x16_bf16 v[144:159], v[196:199], v[0:3], 0
  ds_read_b64_tr_b16 v[220:221], v253 offset:6144
  ds_read_b64_tr_b16 v[222:223], v253 offset:6656
  s_waitcnt lgkmcnt(10)
  v_mfma_f32_32x32x16_bf16 v[128:143], v[200:203], v[4:7], v[128:143]
  ds_read_b64_tr_b16 v[192:193], v252 offset:8192
  ds_read_b64_tr_b16 v[194:195], v252 offset:8704
  s_waitcnt lgkmcnt(10)
  v_mfma_f32_32x32x16_bf16 v[144:159], v[204:207], v[4:7], v[144:159]
  ds_read_b64_tr_b16 v[196:197], v253 offset:8192
  ds_read_b64_tr_b16 v[198:199], v253 offset:8704
  s_waitcnt vmcnt(2)
  s_barrier
  s_waitcnt lgkmcnt(10)
  v_mfma_f32_32x32x16_bf16 v[128:143], v[208:211], v[8:11], v[128:143]
  ds_read_b64_tr_b16 v[200:201], v252 offset:10240
  ds_read_b64_tr_b16 v[202:203], v252 offset:10752
  s_waitcnt lgkmcnt(10)
  v_mfma_f32_32x32x16_bf16 v[144:159], v[212:215], v[8:11], v[144:159]
  ds_read_b64_tr_b16 v[204:205], v253 offset:10240
  ds_read_b64_tr_b16 v[206:207], v253 offset:10752
  s_waitcnt lgkmcnt(10)
  v_mfma_f32_32x32x16_bf16 v[128:143], v[216:219], v[12:15], v[128:143]
  ds_read_b64_tr_b16 v[208:209], v252 offset:12288
  ds_read_b64_tr_b16 v[210:211], v252 offset:12800
  s_waitcnt lgkmcnt(10)
  v_mfma_f32_32x32x16_bf16 v[144:159], v[220:223], v[12:15], v[144:159]
  ds_read_b64_tr_b16 v[212:213], v253 offset:12288
  ds_read_b64_tr_b16 v[214:215], v253 offset:12800
  s_waitcnt lgkmcnt(10)
  v_mfma_f32_32x32x16_bf16 v[128:143], v[192:195], v[16:19], v[128:143]
  ds_read_b64_tr_b16 v[216:217], v252 offset:14336
  ds_read_b64_tr_b16 v[218:219], v252 offset:14848
  s_waitcnt lgkmcnt(10)
  v_mfma_f32_32x32x16_bf16 v[144:159], v[196:199], v[16:19], v[144:159]
  ds_read_b64_tr_b16 v[220:221], v253 offset:14336
  ds_read_b64_tr_b16 v[222:223], v253 offset:14848
  s_waitcnt lgkmcnt(10)
  v_mfma_f32_32x32x16_bf16 v[128:143], v[200:203], v[20:23], v[128:143]
  ds_read_b64_tr_b16 v[192:193], v252 offset:16384
  ds_read_b64_tr_b16 v[194:195], v252 offset:16896
  v_cvt_pk_bf16_f32 v160, v160, v161
  v_cvt_pk_bf16_f32 v161, v162, v163
  v_cvt_pk_bf16_f32 v162, v164, v165
  v_cvt_pk_bf16_f32 v163, v166, v167
  s_add_u32 s50, s61, 20480
  buffer_store_dwordx4 v[160:163], v227, s[36:39], s50 offen sc1
  s_waitcnt lgkmcnt(10)
  v_mfma_f32_32x32x16_bf16 v[144:159], v[204:207], v[20:23], v[144:159]
  ds_read_b64_tr_b16 v[196:197], v253 offset:16384
  ds_read_b64_tr_b16 v[198:199], v253 offset:16896
  s_waitcnt lgkmcnt(10)
  v_mfma_f32_32x32x16_bf16 v[128:143], v[208:211], v[24:27], v[128:143]
  ds_read_b64_tr_b16 v[200:201], v252 offset:18432
  ds_read_b64_tr_b16 v[202:203], v252 offset:18944
  s_waitcnt lgkmcnt(10)
  v_mfma_f32_32x32x16_bf16 v[144:159], v[212:215], v[24:27], v[144:159]
  ds_read_b64_tr_b16 v[204:205], v253 offset:18432
  ds_read_b64_tr_b16 v[206:207], v253 offset:18944
  s_waitcnt lgkmcnt(10)
  v_mfma_f32_32x32x16_bf16 v[128:143], v[216:219], v[28:31], v[128:143]
  ds_read_b64_tr_b16 v[208:209], v252 offset:20480
  ds_read_b64_tr_b16 v[210:211], v252 offset:20992
  s_waitcnt lgkmcnt(10)
  v_mfma_f32_32x32x16_bf16 v[144:159], v[220:223], v[28:31], v[144:159]
  ds_read_b64_tr_b16 v[212:213], v253 offset:20480
  ds_read_b64_tr_b16 v[214:215], v253 offset:20992
  s_waitcnt lgkmcnt(10)
  v_mfma_f32_32x32x16_bf16 v[128:143], v[192:195], v[32:35], v[128:143]
  ds_read_b64_tr_b16 v[216:217], v252 offset:22528
  ds_read_b64_tr_b16 v[218:219], v252 offset:23040
  s_waitcnt lgkmcnt(10)
  v_mfma_f32_32x32x16_bf16 v[144:159], v[196:199], v[32:35], v[144:159]
  ds_read_b64_tr_b16 v[220:221], v253 offset:22528
  ds_read_b64_tr_b16 v[222:223], v253 offset:23040
  s_waitcnt lgkmcnt(10)
  v_mfma_f32_32x32x16_bf16 v[128:143], v[200:203], v[36:39], v[128:143]
  ds_read_b64_tr_b16 v[192:193], v252 offset:24576
  ds_read_b64_tr_b16 v[194:195], v252 offset:25088
  s_waitcnt lgkmcnt(10)
  v_mfma_f32_32x32x16_bf16 v[144:159], v[204:207], v[36:39], v[144:159]
  ds_read_b64_tr_b16 v[196:197], v253 offset:24576
  ds_read_b64_tr_b16 v[198:199], v253 offset:25088
  s_waitcnt lgkmcnt(10)
  v_mfma_f32_32x32x16_bf16 v[128:143], v[208:211], v[40:43], v[128:143]
  ds_read_b64_tr_b16 v[200:201], v252 offset:26624
  ds_read_b64_tr_b16 v[202:203], v252 offset:27136
  s_waitcnt lgkmcnt(10)
  v_mfma_f32_32x32x16_bf16 v[144:159], v[212:215], v[40:43], v[144:159]
  ds_read_b64_tr_b16 v[204:205], v253 offset:26624
  ds_read_b64_tr_b16 v[206:207], v253 offset:27136
  s_waitcnt lgkmcnt(10)
  v_mfma_f32_32x32x16_bf16 v[128:143], v[216:219], v[44:47], v[128:143]
  ds_read_b64_tr_b16 v[208:209], v252 offset:28672
  ds_read_b64_tr_b16 v[210:211], v252 offset:29184
  v_cvt_pk_bf16_f32 v168, v168, v169
  v_cvt_pk_bf16_f32 v169, v170, v171
  v_cvt_pk_bf16_f32 v170, v172, v173
  v_cvt_pk_bf16_f32 v171, v174, v175
  s_add_u32 s50, s61, 20480
  buffer_store_dwordx4 v[168:171], v227, s[36:39], s50 offen offset:1024 sc1
  s_waitcnt lgkmcnt(10)
  v_mfma_f32_32x32x16_bf16 v[144:159], v[220:223], v[44:47], v[144:159]
  ds_read_b64_tr_b16 v[212:213], v253 offset:28672
  ds_read_b64_tr_b16 v[214:215], v253 offset:29184
  s_waitcnt lgkmcnt(10)
  v_mfma_f32_32x32x16_bf16 v[128:143], v[192:195], v[48:51], v[128:143]
  ds_read_b64_tr_b16 v[216:217], v252 offset:30720
  ds_read_b64_tr_b16 v[218:219], v252 offset:31232
  s_waitcnt lgkmcnt(10)
  v_mfma_f32_32x32x16_bf16 v[144:159], v[196:199], v[48:51], v[144:159]
  ds_read_b64_tr_b16 v[220:221], v253 offset:30720
  ds_read_b64_tr_b16 v[222:223], v253 offset:31232
  s_waitcnt lgkmcnt(10)
  v_mfma_f32_32x32x16_bf16 v[128:143], v[200:203], v[52:55], v[128:143]
  ds_read_b64_tr_b16 v[192:193], v252 offset:32768
  ds_read_b64_tr_b16 v[194:195], v252 offset:33280
  s_waitcnt lgkmcnt(10)
  v_mfma_f32_32x32x16_bf16 v[144:159], v[204:207], v[52:55], v[144:159]
  ds_read_b64_tr_b16 v[196:197], v253 offset:32768
  ds_read_b64_tr_b16 v[198:199], v253 offset:33280
  s_waitcnt lgkmcnt(10)
  v_mfma_f32_32x32x16_bf16 v[128:143], v[208:211], v[56:59], v[128:143]
  ds_read_b64_tr_b16 v[200:201], v252 offset:34816
  ds_read_b64_tr_b16 v[202:203], v252 offset:35328
  s_waitcnt lgkmcnt(10)
  v_mfma_f32_32x32x16_bf16 v[144:159], v[212:215], v[56:59], v[144:159]
  ds_read_b64_tr_b16 v[204:205], v253 offset:34816
  ds_read_b64_tr_b16 v[206:207], v253 offset:35328
  s_waitcnt lgkmcnt(10)
  v_mfma_f32_32x32x16_bf16 v[128:143], v[216:219], v[60:63], v[128:143]
  ds_read_b64_tr_b16 v[208:209], v252 offset:36864
  ds_read_b64_tr_b16 v[210:211], v252 offset:37376
  s_waitcnt lgkmcnt(10)
  v_mfma_f32_32x32x16_bf16 v[144:159], v[220:223], v[60:63], v[144:159]
  ds_read_b64_tr_b16 v[212:213], v253 offset:36864
  ds_read_b64_tr_b16 v[214:215], v253 offset:37376
  s_waitcnt lgkmcnt(10)
  v_mfma_f32_32x32x16_bf16 v[128:143], v[192:195], v[64:67], v[128:143]
  ds_read_b64_tr_b16 v[216:217], v252 offset:38912
  ds_read_b64_tr_b16 v[218:219], v252 offset:39424
  s_waitcnt lgkmcnt(10)
  v_mfma_f32_32x32x16_bf16 v[144:159], v[196:199], v[64:67], v[144:159]
  ds_read_b64_tr_b16 v[220:221], v253 offset:38912
  ds_read_b64_tr_b16 v[222:223], v253 offset:39424
  s_waitcnt lgkmcnt(10)
  v_mfma_f32_32x32x16_bf16 v[128:143], v[200:203], v[68:71], v[128:143]
  ds_read_b64_tr_b16 v[192:193], v252 offset:40960
  ds_read_b64_tr_b16 v[194:195], v252 offset:41472
  s_waitcnt lgkmcnt(10)
  v_mfma_f32_32x32x16_bf16 v[144:159], v[204:207], v[68:71], v[144:159]
  ds_read_b64_tr_b16 v[196:197], v253 offset:40960
  ds_read_b64_tr_b16 v[198:199], v253 offset:41472
  s_waitcnt lgkmcnt(10)
  v_mfma_f32_32x32x16_bf16 v[128:143], v[208:211], v[72:75], v[128:143]
  ds_read_b64_tr_b16 v[200:201], v252 offset:43008
  ds_read_b64_tr_b16 v[202:203], v252 offset:43520
  s_waitcnt lgkmcnt(10)
  v_mfma_f32_32x32x16_bf16 v[144:159], v[212:215], v[72:75], v[144:159]
  ds_read_b64_tr_b16 v[204:205], v253 offset:43008
  ds_read_b64_tr_b16 v[206:207], v253 offset:43520
  s_waitcnt lgkmcnt(10)
  v_mfma_f32_32x32x16_bf16 v[128:143], v[216:219], v[76:79], v[128:143]
  ds_read_b64_tr_b16 v[208:209], v252 offset:45056
  ds_read_b64_tr_b16 v[210:211], v252 offset:45568
  s_waitcnt lgkmcnt(10)
  v_mfma_f32_32x32x16_bf16 v[144:159], v[220:223], v[76:79], v[144:159]
  ds_read_b64_tr_b16 v[212:213], v253 offset:45056
  ds_read_b64_tr_b16 v[214:215], v253 offset:45568
  s_waitcnt lgkmcnt(10)
  v_mfma_f32_32x32x16_bf16 v[128:143], v[192:195], v[80:83], v[128:143]
  ds_read_b64_tr_b16 v[216:217], v252 offset:47104
  ds_read_b64_tr_b16 v[218:219], v252 offset:47616
  s_waitcnt lgkmcnt(10)
  v_mfma_f32_32x32x16_bf16 v[144:159], v[196:199], v[80:83], v[144:159]
  ds_read_b64_tr_b16 v[220:221], v253 offset:47104
  ds_read_b64_tr_b16 v[222:223], v253 offset:47616
  s_waitcnt lgkmcnt(10)
  v_mfma_f32_32x32x16_bf16 v[128:143], v[200:203], v[84:87], v[128:143]
  ds_read_b64_tr_b16 v[192:193], v252 offset:49152
  ds_read_b64_tr_b16 v[194:195], v252 offset:49664
  v_cvt_pk_bf16_f32 v176, v176, v177
  v_cvt_pk_bf16_f32 v177, v178, v179
  v_cvt_pk_bf16_f32 v178, v180, v181
  v_cvt_pk_bf16_f32 v179, v182, v183
  s_add_u32 s50, s61, 20480
  buffer_store_dwordx4 v[176:179], v227, s[36:39], s50 offen offset:2048 sc1
  s_waitcnt lgkmcnt(10)
  v_mfma_f32_32x32x16_bf16 v[144:159], v[204:207], v[84:87], v[144:159]
  ds_read_b64_tr_b16 v[196:197], v253 offset:49152
  ds_read_b64_tr_b16 v[198:199], v253 offset:49664
  s_waitcnt lgkmcnt(10)
  v_mfma_f32_32x32x16_bf16 v[128:143], v[208:211], v[88:91], v[128:143]
  ds_read_b64_tr_b16 v[200:201], v252 offset:51200
  ds_read_b64_tr_b16 v[202:203], v252 offset:51712
  s_waitcnt lgkmcnt(10)
  v_mfma_f32_32x32x16_bf16 v[144:159], v[212:215], v[88:91], v[144:159]
  ds_read_b64_tr_b16 v[204:205], v253 offset:51200
  ds_read_b64_tr_b16 v[206:207], v253 offset:51712
  s_waitcnt lgkmcnt(10)
  v_mfma_f32_32x32x16_bf16 v[128:143], v[216:219], v[92:95], v[128:143]
  ds_read_b64_tr_b16 v[208:209], v252 offset:53248
  ds_read_b64_tr_b16 v[210:211], v252 offset:53760
  s_waitcnt lgkmcnt(10)
  v_mfma_f32_32x32x16_bf16 v[144:159], v[220:223], v[92:95], v[144:159]
  ds_read_b64_tr_b16 v[212:213], v253 offset:53248
  ds_read_b64_tr_b16 v[214:215], v253 offset:53760
  s_waitcnt lgkmcnt(10)
  v_mfma_f32_32x32x16_bf16 v[128:143], v[192:195], v[96:99], v[128:143]
  ds_read_b64_tr_b16 v[216:217], v252 offset:55296
  ds_read_b64_tr_b16 v[218:219], v252 offset:55808
  s_waitcnt lgkmcnt(10)
  v_mfma_f32_32x32x16_bf16 v[144:159], v[196:199], v[96:99], v[144:159]
  ds_read_b64_tr_b16 v[220:221], v253 offset:55296
  ds_read_b64_tr_b16 v[222:223], v253 offset:55808
  s_waitcnt lgkmcnt(10)
  v_mfma_f32_32x32x16_bf16 v[128:143], v[200:203], v[100:103], v[128:143]
  ds_read_b64_tr_b16 v[192:193], v252 offset:57344
  ds_read_b64_tr_b16 v[194:195], v252 offset:57856
  s_waitcnt lgkmcnt(10)
  v_mfma_f32_32x32x16_bf16 v[144:159], v[204:207], v[100:103], v[144:159]
  ds_read_b64_tr_b16 v[196:197], v253 offset:57344
  ds_read_b64_tr_b16 v[198:199], v253 offset:57856
  s_waitcnt lgkmcnt(10)
  v_mfma_f32_32x32x16_bf16 v[128:143], v[208:211], v[104:107], v[128:143]
  ds_read_b64_tr_b16 v[200:201], v252 offset:59392
  ds_read_b64_tr_b16 v[202:203], v252 offset:59904
  s_waitcnt lgkmcnt(10)
  v_mfma_f32_32x32x16_bf16 v[144:159], v[212:215], v[104:107], v[144:159]
  ds_read_b64_tr_b16 v[204:205], v253 offset:59392
  ds_read_b64_tr_b16 v[206:207], v253 offset:59904
  s_waitcnt lgkmcnt(10)
  v_mfma_f32_32x32x16_bf16 v[128:143], v[216:219], v[108:111], v[128:143]
  ds_read_b64_tr_b16 v[208:209], v252 offset:61440
  ds_read_b64_tr_b16 v[210:211], v252 offset:61952
  v_cvt_pk_bf16_f32 v184, v184, v185
  v_cvt_pk_bf16_f32 v185, v186, v187
  v_cvt_pk_bf16_f32 v186, v188, v189
  v_cvt_pk_bf16_f32 v187, v190, v191
  s_add_u32 s50, s61, 20480
  buffer_store_dwordx4 v[184:187], v227, s[36:39], s50 offen offset:3072 sc1
  s_waitcnt lgkmcnt(10)
  v_mfma_f32_32x32x16_bf16 v[144:159], v[220:223], v[108:111], v[144:159]
  ds_read_b64_tr_b16 v[212:213], v253 offset:61440
  ds_read_b64_tr_b16 v[214:215], v253 offset:61952
  s_waitcnt lgkmcnt(10)
  v_mfma_f32_32x32x16_bf16 v[128:143], v[192:195], v[112:115], v[128:143]
  ds_read_b64_tr_b16 v[216:217], v252 offset:63488
  ds_read_b64_tr_b16 v[218:219], v252 offset:64000
  s_waitcnt lgkmcnt(10)
  v_mfma_f32_32x32x16_bf16 v[144:159], v[196:199], v[112:115], v[144:159]
  ds_read_b64_tr_b16 v[220:221], v253 offset:63488
  ds_read_b64_tr_b16 v[222:223], v253 offset:64000
  s_waitcnt lgkmcnt(10)
  v_mfma_f32_32x32x16_bf16 v[128:143], v[200:203], v[116:119], v[128:143]
  s_waitcnt lgkmcnt(8)
  v_mfma_f32_32x32x16_bf16 v[144:159], v[204:207], v[116:119], v[144:159]
  s_waitcnt lgkmcnt(6)
  v_mfma_f32_32x32x16_bf16 v[128:143], v[208:211], v[120:123], v[128:143]
  s_waitcnt lgkmcnt(4)
  v_mfma_f32_32x32x16_bf16 v[144:159], v[212:215], v[120:123], v[144:159]
  s_waitcnt lgkmcnt(2)
  v_mfma_f32_32x32x16_bf16 v[128:143], v[216:219], v[124:127], v[128:143]
  s_waitcnt lgkmcnt(0)
  v_mfma_f32_32x32x16_bf16 v[144:159], v[220:223], v[124:127], v[144:159]
  s_nop 9
  v_cvt_pk_bf16_f32 v128, v128, v129
  v_cvt_pk_bf16_f32 v129, v130, v131
  v_cvt_pk_bf16_f32 v130, v132, v133
  v_cvt_pk_bf16_f32 v131, v134, v135
  s_add_u32 s50, s61, 24576
  buffer_store_dwordx4 v[128:131], v227, s[36:39], s50 offen sc1
  v_cvt_pk_bf16_f32 v136, v136, v137
  v_cvt_pk_bf16_f32 v137, v138, v139
  v_cvt_pk_bf16_f32 v138, v140, v141
  v_cvt_pk_bf16_f32 v139, v142, v143
  s_add_u32 s50, s61, 24576
  buffer_store_dwordx4 v[136:139], v227, s[36:39], s50 offen offset:1024 sc1
  v_cvt_pk_bf16_f32 v144, v144, v145
  v_cvt_pk_bf16_f32 v145, v146, v147
  v_cvt_pk_bf16_f32 v146, v148, v149
  v_cvt_pk_bf16_f32 v147, v150, v151
  s_add_u32 s50, s61, 24576
  buffer_store_dwordx4 v[144:147], v227, s[36:39], s50 offen offset:2048 sc1
  v_cvt_pk_bf16_f32 v152, v152, v153
  v_cvt_pk_bf16_f32 v153, v154, v155
  v_cvt_pk_bf16_f32 v154, v156, v157
  v_cvt_pk_bf16_f32 v155, v158, v159
  s_add_u32 s50, s61, 24576
  buffer_store_dwordx4 v[152:155], v227, s[36:39], s50 offen offset:3072 sc1
L_end:
  s_endpgm
L_slow:
  s_nop 1
  v_max_f32 v248, v248, v236
  v_mul_f32 v238, s44, v248
  v_sub_f32 v234, v228, v238
  v_exp_f32 v234, v234
  v_mov_b32 v228, v238
  v_add_f32 v230, s62, v248
  v_mul_f32 v232, v232, v234
  v_max_f32 v249, v249, v237
  v_mul_f32 v239, s44, v249
  v_sub_f32 v235, v229, v239
  v_exp_f32 v235, v235
  v_mov_b32 v229, v239
  v_add_f32 v231, s62, v249
  v_mul_f32 v233, v233, v235
  s_mov_b32 s56, 1
  s_nop 1
  s_setpc_b64 s[58:59]
L_resc:
  s_nop 15
  v_accvgpr_read_b32 v238, a0
  v_accvgpr_read_b32 v239, a1
  v_accvgpr_read_b32 v236, a2
  v_accvgpr_read_b32 v237, a3
  v_mul_f32 v238, v238, v234
  v_mul_f32 v239, v239, v234
  v_mul_f32 v236, v236, v234
  v_mul_f32 v237, v237, v234
  v_accvgpr_write_b32 a0, v238
  v_accvgpr_write_b32 a1, v239
  v_accvgpr_write_b32 a2, v236
  v_accvgpr_write_b32 a3, v237
  v_accvgpr_read_b32 v238, a4
  v_accvgpr_read_b32 v239, a5
  v_accvgpr_read_b32 v236, a6
  v_accvgpr_read_b32 v237, a7
  v_mul_f32 v238, v238, v234
  v_mul_f32 v239, v239, v234
  v_mul_f32 v236, v236, v234
  v_mul_f32 v237, v237, v234
  v_accvgpr_write_b32 a4, v238
  v_accvgpr_write_b32 a5, v239
  v_accvgpr_write_b32 a6, v236
  v_accvgpr_write_b32 a7, v237
  v_accvgpr_read_b32 v238, a8
  v_accvgpr_read_b32 v239, a9
  v_accvgpr_read_b32 v236, a10
  v_accvgpr_read_b32 v237, a11
  v_mul_f32 v238, v238, v234
  v_mul_f32 v239, v239, v234
  v_mul_f32 v236, v236, v234
  v_mul_f32 v237, v237, v234
  v_accvgpr_write_b32 a8, v238
  v_accvgpr_write_b32 a9, v239
  v_accvgpr_write_b32 a10, v236
  v_accvgpr_write_b32 a11, v237
  v_accvgpr_read_b32 v238, a12
  v_accvgpr_read_b32 v239, a13
  v_accvgpr_read_b32 v236, a14
  v_accvgpr_read_b32 v237, a15
  v_mul_f32 v238, v238, v234
  v_mul_f32 v239, v239, v234
  v_mul_f32 v236, v236, v234
  v_mul_f32 v237, v237, v234
  v_accvgpr_write_b32 a12, v238
  v_accvgpr_write_b32 a13, v239
  v_accvgpr_write_b32 a14, v236
  v_accvgpr_write_b32 a15, v237
  v_accvgpr_read_b32 v238, a16
  v_accvgpr_read_b32 v239, a17
  v_accvgpr_read_b32 v236, a18
  v_accvgpr_read_b32 v237, a19
  v_mul_f32 v238, v238, v235
  v_mul_f32 v239, v239, v235
  v_mul_f32 v236, v236, v235
  v_mul_f32 v237, v237, v235
  v_accvgpr_write_b32 a16, v238
  v_accvgpr_write_b32 a17, v239
  v_accvgpr_write_b32 a18, v236
  v_accvgpr_write_b32 a19, v237
  v_accvgpr_read_b32 v238, a20
  v_accvgpr_read_b32 v239, a21
  v_accvgpr_read_b32 v236, a22
  v_accvgpr_read_b32 v237, a23
  v_mul_f32 v238, v238, v235
  v_mul_f32 v239, v239, v235
  v_mul_f32 v236, v236, v235
  v_mul_f32 v237, v237, v235
  v_accvgpr_write_b32 a20, v238
  v_accvgpr_write_b32 a21, v239
  v_accvgpr_write_b32 a22, v236
  v_accvgpr_write_b32 a23, v237
  v_accvgpr_read_b32 v238, a24
  v_accvgpr_read_b32 v239, a25
  v_accvgpr_read_b32 v236, a26
  v_accvgpr_read_b32 v237, a27
  v_mul_f32 v238, v238, v235
  v_mul_f32 v239, v239, v235
  v_mul_f32 v236, v236, v235
  v_mul_f32 v237, v237, v235
  v_accvgpr_write_b32 a24, v238
  v_accvgpr_write_b32 a25, v239
  v_accvgpr_write_b32 a26, v236
  v_accvgpr_write_b32 a27, v237
  v_accvgpr_read_b32 v238, a28
  v_accvgpr_read_b32 v239, a29
  v_accvgpr_read_b32 v236, a30
  v_accvgpr_read_b32 v237, a31
  v_mul_f32 v238, v238, v235
  v_mul_f32 v239, v239, v235
  v_mul_f32 v236, v236, v235
  v_mul_f32 v237, v237, v235
  v_accvgpr_write_b32 a28, v238
  v_accvgpr_write_b32 a29, v239
  v_accvgpr_write_b32 a30, v236
  v_accvgpr_write_b32 a31, v237
  v_accvgpr_read_b32 v238, a32
  v_accvgpr_read_b32 v239, a33
  v_accvgpr_read_b32 v236, a34
  v_accvgpr_read_b32 v237, a35
  v_mul_f32 v238, v238, v234
  v_mul_f32 v239, v239, v234
  v_mul_f32 v236, v236, v234
  v_mul_f32 v237, v237, v234
  v_accvgpr_write_b32 a32, v238
  v_accvgpr_write_b32 a33, v239
  v_accvgpr_write_b32 a34, v236
  v_accvgpr_write_b32 a35, v237
  v_accvgpr_read_b32 v238, a36
  v_accvgpr_read_b32 v239, a37
  v_accvgpr_read_b32 v236, a38
  v_accvgpr_read_b32 v237, a39
  v_mul_f32 v238, v238, v234
  v_mul_f32 v239, v239, v234
  v_mul_f32 v236, v236, v234
  v_mul_f32 v237, v237, v234
  v_accvgpr_write_b32 a36, v238
  v_accvgpr_write_b32 a37, v239
  v_accvgpr_write_b32 a38, v236
  v_accvgpr_write_b32 a39, v237
  v_accvgpr_read_b32 v238, a40
  v_accvgpr_read_b32 v239, a41
  v_accvgpr_read_b32 v236, a42
  v_accvgpr_read_b32 v237, a43
  v_mul_f32 v238, v238, v234
  v_mul_f32 v239, v239, v234
  v_mul_f32 v236, v236, v234
  v_mul_f32 v237, v237, v234
  v_accvgpr_write_b32 a40, v238
  v_accvgpr_write_b32 a41, v239
  v_accvgpr_write_b32 a42, v236
  v_accvgpr_write_b32 a43, v237
  v_accvgpr_read_b32 v238, a44
  v_accvgpr_read_b32 v239, a45
  v_accvgpr_read_b32 v236, a46
  v_accvgpr_read_b32 v237, a47
  v_mul_f32 v238, v238, v234
  v_mul_f32 v239, v239, v234
  v_mul_f32 v236, v236, v234
  v_mul_f32 v237, v237, v234
  v_accvgpr_write_b32 a44, v238
  v_accvgpr_write_b32 a45, v239
  v_accvgpr_write_b32 a46, v236
  v_accvgpr_write_b32 a47, v237
  v_accvgpr_read_b32 v238, a48
  v_accvgpr_read_b32 v239, a49
  v_accvgpr_read_b32 v236, a50
  v_accvgpr_read_b32 v237, a51
  v_mul_f32 v238, v238, v235
  v_mul_f32 v239, v239, v235
  v_mul_f32 v236, v236, v235
  v_mul_f32 v237, v237, v235
  v_accvgpr_write_b32 a48, v238
  v_accvgpr_write_b32 a49, v239
  v_accvgpr_write_b32 a50, v236
  v_accvgpr_write_b32 a51, v237
  v_accvgpr_read_b32 v238, a52
  v_accvgpr_read_b32 v239, a53
  v_accvgpr_read_b32 v236, a54
  v_accvgpr_read_b32 v237, a55
  v_mul_f32 v238, v238, v235
  v_mul_f32 v239, v239, v235
  v_mul_f32 v236, v236, v235
  v_mul_f32 v237, v237, v235
  v_accvgpr_write_b32 a52, v238
  v_accvgpr_write_b32 a53, v239
  v_accvgpr_write_b32 a54, v236
  v_accvgpr_write_b32 a55, v237
  v_accvgpr_read_b32 v238, a56
  v_accvgpr_read_b32 v239, a57
  v_accvgpr_read_b32 v236, a58
  v_accvgpr_read_b32 v237, a59
  v_mul_f32 v238, v238, v235
  v_mul_f32 v239, v239, v235
  v_mul_f32 v236, v236, v235
  v_mul_f32 v237, v237, v235
  v_accvgpr_write_b32 a56, v238
  v_accvgpr_write_b32 a57, v239
  v_accvgpr_write_b32 a58, v236
  v_accvgpr_write_b32 a59, v237
  v_accvgpr_read_b32 v238, a60
  v_accvgpr_read_b32 v239, a61
  v_accvgpr_read_b32 v236, a62
  v_accvgpr_read_b32 v237, a63
  v_mul_f32 v238, v238, v235
  v_mul_f32 v239, v239, v235
  v_mul_f32 v236, v236, v235
  v_mul_f32 v237, v237, v235
  v_accvgpr_write_b32 a60, v238
  v_accvgpr_write_b32 a61, v239
  v_accvgpr_write_b32 a62, v236
  v_accvgpr_write_b32 a63, v237
  v_accvgpr_read_b32 v238, a64
  v_accvgpr_read_b32 v239, a65
  v_accvgpr_read_b32 v236, a66
  v_accvgpr_read_b32 v237, a67
  v_mul_f32 v238, v238, v234
  v_mul_f32 v239, v239, v234
  v_mul_f32 v236, v236, v234
  v_mul_f32 v237, v237, v234
  v_accvgpr_write_b32 a64, v238
  v_accvgpr_write_b32 a65, v239
  v_accvgpr_write_b32 a66, v236
  v_accvgpr_write_b32 a67, v237
  v_accvgpr_read_b32 v238, a68
  v_accvgpr_read_b32 v239, a69
  v_accvgpr_read_b32 v236, a70
  v_accvgpr_read_b32 v237, a71
  v_mul_f32 v238, v238, v234
  v_mul_f32 v239, v239, v234
  v_mul_f32 v236, v236, v234
  v_mul_f32 v237, v237, v234
  v_accvgpr_write_b32 a68, v238
  v_accvgpr_write_b32 a69, v239
  v_accvgpr_write_b32 a70, v236
  v_accvgpr_write_b32 a71, v237
  v_accvgpr_read_b32 v238, a72
  v_accvgpr_read_b32 v239, a73
  v_accvgpr_read_b32 v236, a74
  v_accvgpr_read_b32 v237, a75
  v_mul_f32 v238, v238, v234
  v_mul_f32 v239, v239, v234
  v_mul_f32 v236, v236, v234
  v_mul_f32 v237, v237, v234
  v_accvgpr_write_b32 a72, v238
  v_accvgpr_write_b32 a73, v239
  v_accvgpr_write_b32 a74, v236
  v_accvgpr_write_b32 a75, v237
  v_accvgpr_read_b32 v238, a76
  v_accvgpr_read_b32 v239, a77
  v_accvgpr_read_b32 v236, a78
  v_accvgpr_read_b32 v237, a79
  v_mul_f32 v238, v238, v234
  v_mul_f32 v239, v239, v234
  v_mul_f32 v236, v236, v234
  v_mul_f32 v237, v237, v234
  v_accvgpr_write_b32 a76, v238
  v_accvgpr_write_b32 a77, v239
  v_accvgpr_write_b32 a78, v236
  v_accvgpr_write_b32 a79, v237
  v_accvgpr_read_b32 v238, a80
  v_accvgpr_read_b32 v239, a81
  v_accvgpr_read_b32 v236, a82
  v_accvgpr_read_b32 v237, a83
  v_mul_f32 v238, v238, v235
  v_mul_f32 v239, v239, v235
  v_mul_f32 v236, v236, v235
  v_mul_f32 v237, v237, v235
  v_accvgpr_write_b32 a80, v238
  v_accvgpr_write_b32 a81, v239
  v_accvgpr_write_b32 a82, v236
  v_accvgpr_write_b32 a83, v237
  v_accvgpr_read_b32 v238, a84
  v_accvgpr_read_b32 v239, a85
  v_accvgpr_read_b32 v236, a86
  v_accvgpr_read_b32 v237, a87
  v_mul_f32 v238, v238, v235
  v_mul_f32 v239, v239, v235
  v_mul_f32 v236, v236, v235
  v_mul_f32 v237, v237, v235
  v_accvgpr_write_b32 a84, v238
  v_accvgpr_write_b32 a85, v239
  v_accvgpr_write_b32 a86, v236
  v_accvgpr_write_b32 a87, v237
  v_accvgpr_read_b32 v238, a88
  v_accvgpr_read_b32 v239, a89
  v_accvgpr_read_b32 v236, a90
  v_accvgpr_read_b32 v237, a91
  v_mul_f32 v238, v238, v235
  v_mul_f32 v239, v239, v235
  v_mul_f32 v236, v236, v235
  v_mul_f32 v237, v237, v235
  v_accvgpr_write_b32 a88, v238
  v_accvgpr_write_b32 a89, v239
  v_accvgpr_write_b32 a90, v236
  v_accvgpr_write_b32 a91, v237
  v_accvgpr_read_b32 v238, a92
  v_accvgpr_read_b32 v239, a93
  v_accvgpr_read_b32 v236, a94
  v_accvgpr_read_b32 v237, a95
  v_mul_f32 v238, v238, v235
  v_mul_f32 v239, v239, v235
  v_mul_f32 v236, v236, v235
  v_mul_f32 v237, v237, v235
  v_accvgpr_write_b32 a92, v238
  v_accvgpr_write_b32 a93, v239
  v_accvgpr_write_b32 a94, v236
  v_accvgpr_write_b32 a95, v237
  v_accvgpr_read_b32 v238, a96
  v_accvgpr_read_b32 v239, a97
  v_accvgpr_read_b32 v236, a98
  v_accvgpr_read_b32 v237, a99
  v_mul_f32 v238, v238, v234
  v_mul_f32 v239, v239, v234
  v_mul_f32 v236, v236, v234
  v_mul_f32 v237, v237, v234
  v_accvgpr_write_b32 a96, v238
  v_accvgpr_write_b32 a97, v239
  v_accvgpr_write_b32 a98, v236
  v_accvgpr_write_b32 a99, v237
  v_accvgpr_read_b32 v238, a100
  v_accvgpr_read_b32 v239, a101
  v_accvgpr_read_b32 v236, a102
  v_accvgpr_read_b32 v237, a103
  v_mul_f32 v238, v238, v234
  v_mul_f32 v239, v239, v234
  v_mul_f32 v236, v236, v234
  v_mul_f32 v237, v237, v234
  v_accvgpr_write_b32 a100, v238
  v_accvgpr_write_b32 a101, v239
  v_accvgpr_write_b32 a102, v236
  v_accvgpr_write_b32 a103, v237
  v_accvgpr_read_b32 v238, a104
  v_accvgpr_read_b32 v239, a105
  v_accvgpr_read_b32 v236, a106
  v_accvgpr_read_b32 v237, a107
  v_mul_f32 v238, v238, v234
  v_mul_f32 v239, v239, v234
  v_mul_f32 v236, v236, v234
  v_mul_f32 v237, v237, v234
  v_accvgpr_write_b32 a104, v238
  v_accvgpr_write_b32 a105, v239
  v_accvgpr_write_b32 a106, v236
  v_accvgpr_write_b32 a107, v237
  v_accvgpr_read_b32 v238, a108
  v_accvgpr_read_b32 v239, a109
  v_accvgpr_read_b32 v236, a110
  v_accvgpr_read_b32 v237, a111
  v_mul_f32 v238, v238, v234
  v_mul_f32 v239, v239, v234
  v_mul_f32 v236, v236, v234
  v_mul_f32 v237, v237, v234
  v_accvgpr_write_b32 a108, v238
  v_accvgpr_write_b32 a109, v239
  v_accvgpr_write_b32 a110, v236
  v_accvgpr_write_b32 a111, v237
  v_accvgpr_read_b32 v238, a112
  v_accvgpr_read_b32 v239, a113
  v_accvgpr_read_b32 v236, a114
  v_accvgpr_read_b32 v237, a115
  v_mul_f32 v238, v238, v235
  v_mul_f32 v239, v239, v235
  v_mul_f32 v236, v236, v235
  v_mul_f32 v237, v237, v235
  v_accvgpr_write_b32 a112, v238
  v_accvgpr_write_b32 a113, v239
  v_accvgpr_write_b32 a114, v236
  v_accvgpr_write_b32 a115, v237
  v_accvgpr_read_b32 v238, a116
  v_accvgpr_read_b32 v239, a117
  v_accvgpr_read_b32 v236, a118
  v_accvgpr_read_b32 v237, a119
  v_mul_f32 v238, v238, v235
  v_mul_f32 v239, v239, v235
  v_mul_f32 v236, v236, v235
  v_mul_f32 v237, v237, v235
  v_accvgpr_write_b32 a116, v238
  v_accvgpr_write_b32 a117, v239
  v_accvgpr_write_b32 a118, v236
  v_accvgpr_write_b32 a119, v237
  v_accvgpr_read_b32 v238, a120
  v_accvgpr_read_b32 v239, a121
  v_accvgpr_read_b32 v236, a122
  v_accvgpr_read_b32 v237, a123
  v_mul_f32 v238, v238, v235
  v_mul_f32 v239, v239, v235
  v_mul_f32 v236, v236, v235
  v_mul_f32 v237, v237, v235
  v_accvgpr_write_b32 a120, v238
  v_accvgpr_write_b32 a121, v239
  v_accvgpr_write_b32 a122, v236
  v_accvgpr_write_b32 a123, v237
  v_accvgpr_read_b32 v238, a124
  v_accvgpr_read_b32 v239, a125
  v_accvgpr_read_b32 v236, a126
  v_accvgpr_read_b32 v237, a127
  v_mul_f32 v238, v238, v235
  v_mul_f32 v239, v239, v235
  v_mul_f32 v236, v236, v235
  v_mul_f32 v237, v237, v235
  v_accvgpr_write_b32 a124, v238
  v_accvgpr_write_b32 a125, v239
  v_accvgpr_write_b32 a126, v236
  v_accvgpr_write_b32 a127, v237
  v_accvgpr_read_b32 v238, a128
  v_accvgpr_read_b32 v239, a129
  v_accvgpr_read_b32 v236, a130
  v_accvgpr_read_b32 v237, a131
  v_mul_f32 v238, v238, v234
  v_mul_f32 v239, v239, v234
  v_mul_f32 v236, v236, v234
  v_mul_f32 v237, v237, v234
  v_accvgpr_write_b32 a128, v238
  v_accvgpr_write_b32 a129, v239
  v_accvgpr_write_b32 a130, v236
  v_accvgpr_write_b32 a131, v237
  v_accvgpr_read_b32 v238, a132
  v_accvgpr_read_b32 v239, a133
  v_accvgpr_read_b32 v236, a134
  v_accvgpr_read_b32 v237, a135
  v_mul_f32 v238, v238, v234
  v_mul_f32 v239, v239, v234
  v_mul_f32 v236, v236, v234
  v_mul_f32 v237, v237, v234
  v_accvgpr_write_b32 a132, v238
  v_accvgpr_write_b32 a133, v239
  v_accvgpr_write_b32 a134, v236
  v_accvgpr_write_b32 a135, v237
  v_accvgpr_read_b32 v238, a136
  v_accvgpr_read_b32 v239, a137
  v_accvgpr_read_b32 v236, a138
  v_accvgpr_read_b32 v237, a139
  v_mul_f32 v238, v238, v234
  v_mul_f32 v239, v239, v234
  v_mul_f32 v236, v236, v234
  v_mul_f32 v237, v237, v234
  v_accvgpr_write_b32 a136, v238
  v_accvgpr_write_b32 a137, v239
  v_accvgpr_write_b32 a138, v236
  v_accvgpr_write_b32 a139, v237
  v_accvgpr_read_b32 v238, a140
  v_accvgpr_read_b32 v239, a141
  v_accvgpr_read_b32 v236, a142
  v_accvgpr_read_b32 v237, a143
  v_mul_f32 v238, v238, v234
  v_mul_f32 v239, v239, v234
  v_mul_f32 v236, v236, v234
  v_mul_f32 v237, v237, v234
  v_accvgpr_write_b32 a140, v238
  v_accvgpr_write_b32 a141, v239
  v_accvgpr_write_b32 a142, v236
  v_accvgpr_write_b32 a143, v237
  v_accvgpr_read_b32 v238, a144
  v_accvgpr_read_b32 v239, a145
  v_accvgpr_read_b32 v236, a146
  v_accvgpr_read_b32 v237, a147
  v_mul_f32 v238, v238, v235
  v_mul_f32 v239, v239, v235
  v_mul_f32 v236, v236, v235
  v_mul_f32 v237, v237, v235
  v_accvgpr_write_b32 a144, v238
  v_accvgpr_write_b32 a145, v239
  v_accvgpr_write_b32 a146, v236
  v_accvgpr_write_b32 a147, v237
  v_accvgpr_read_b32 v238, a148
  v_accvgpr_read_b32 v239, a149
  v_accvgpr_read_b32 v236, a150
  v_accvgpr_read_b32 v237, a151
  v_mul_f32 v238, v238, v235
  v_mul_f32 v239, v239, v235
  v_mul_f32 v236, v236, v235
  v_mul_f32 v237, v237, v235
  v_accvgpr_write_b32 a148, v238
  v_accvgpr_write_b32 a149, v239
  v_accvgpr_write_b32 a150, v236
  v_accvgpr_write_b32 a151, v237
  v_accvgpr_read_b32 v238, a152
  v_accvgpr_read_b32 v239, a153
  v_accvgpr_read_b32 v236, a154
  v_accvgpr_read_b32 v237, a155
  v_mul_f32 v238, v238, v235
  v_mul_f32 v239, v239, v235
  v_mul_f32 v236, v236, v235
  v_mul_f32 v237, v237, v235
  v_accvgpr_write_b32 a152, v238
  v_accvgpr_write_b32 a153, v239
  v_accvgpr_write_b32 a154, v236
  v_accvgpr_write_b32 a155, v237
  v_accvgpr_read_b32 v238, a156
  v_accvgpr_read_b32 v239, a157
  v_accvgpr_read_b32 v236, a158
  v_accvgpr_read_b32 v237, a159
  v_mul_f32 v238, v238, v235
  v_mul_f32 v239, v239, v235
  v_mul_f32 v236, v236, v235
  v_mul_f32 v237, v237, v235
  v_accvgpr_write_b32 a156, v238
  v_accvgpr_write_b32 a157, v239
  v_accvgpr_write_b32 a158, v236
  v_accvgpr_write_b32 a159, v237
  v_accvgpr_read_b32 v238, a160
  v_accvgpr_read_b32 v239, a161
  v_accvgpr_read_b32 v236, a162
  v_accvgpr_read_b32 v237, a163
  v_mul_f32 v238, v238, v234
  v_mul_f32 v239, v239, v234
  v_mul_f32 v236, v236, v234
  v_mul_f32 v237, v237, v234
  v_accvgpr_write_b32 a160, v238
  v_accvgpr_write_b32 a161, v239
  v_accvgpr_write_b32 a162, v236
  v_accvgpr_write_b32 a163, v237
  v_accvgpr_read_b32 v238, a164
  v_accvgpr_read_b32 v239, a165
  v_accvgpr_read_b32 v236, a166
  v_accvgpr_read_b32 v237, a167
  v_mul_f32 v238, v238, v234
  v_mul_f32 v239, v239, v234
  v_mul_f32 v236, v236, v234
  v_mul_f32 v237, v237, v234
  v_accvgpr_write_b32 a164, v238
  v_accvgpr_write_b32 a165, v239
  v_accvgpr_write_b32 a166, v236
  v_accvgpr_write_b32 a167, v237
  v_accvgpr_read_b32 v238, a168
  v_accvgpr_read_b32 v239, a169
  v_accvgpr_read_b32 v236, a170
  v_accvgpr_read_b32 v237, a171
  v_mul_f32 v238, v238, v234
  v_mul_f32 v239, v239, v234
  v_mul_f32 v236, v236, v234
  v_mul_f32 v237, v237, v234
  v_accvgpr_write_b32 a168, v238
  v_accvgpr_write_b32 a169, v239
  v_accvgpr_write_b32 a170, v236
  v_accvgpr_write_b32 a171, v237
  v_accvgpr_read_b32 v238, a172
  v_accvgpr_read_b32 v239, a173
  v_accvgpr_read_b32 v236, a174
  v_accvgpr_read_b32 v237, a175
  v_mul_f32 v238, v238, v234
  v_mul_f32 v239, v239, v234
  v_mul_f32 v236, v236, v234
  v_mul_f32 v237, v237, v234
  v_accvgpr_write_b32 a172, v238
  v_accvgpr_write_b32 a173, v239
  v_accvgpr_write_b32 a174, v236
  v_accvgpr_write_b32 a175, v237
  v_accvgpr_read_b32 v238, a176
  v_accvgpr_read_b32 v239, a177
  v_accvgpr_read_b32 v236, a178
  v_accvgpr_read_b32 v237, a179
  v_mul_f32 v238, v238, v235
  v_mul_f32 v239, v239, v235
  v_mul_f32 v236, v236, v235
  v_mul_f32 v237, v237, v235
  v_accvgpr_write_b32 a176, v238
  v_accvgpr_write_b32 a177, v239
  v_accvgpr_write_b32 a178, v236
  v_accvgpr_write_b32 a179, v237
  v_accvgpr_read_b32 v238, a180
  v_accvgpr_read_b32 v239, a181
  v_accvgpr_read_b32 v236, a182
  v_accvgpr_read_b32 v237, a183
  v_mul_f32 v238, v238, v235
  v_mul_f32 v239, v239, v235
  v_mul_f32 v236, v236, v235
  v_mul_f32 v237, v237, v235
  v_accvgpr_write_b32 a180, v238
  v_accvgpr_write_b32 a181, v239
  v_accvgpr_write_b32 a182, v236
  v_accvgpr_write_b32 a183, v237
  v_accvgpr_read_b32 v238, a184
  v_accvgpr_read_b32 v239, a185
  v_accvgpr_read_b32 v236, a186
  v_accvgpr_read_b32 v237, a187
  v_mul_f32 v238, v238, v235
  v_mul_f32 v239, v239, v235
  v_mul_f32 v236, v236, v235
  v_mul_f32 v237, v237, v235
  v_accvgpr_write_b32 a184, v238
  v_accvgpr_write_b32 a185, v239
  v_accvgpr_write_b32 a186, v236
  v_accvgpr_write_b32 a187, v237
  v_accvgpr_read_b32 v238, a188
  v_accvgpr_read_b32 v239, a189
  v_accvgpr_read_b32 v236, a190
  v_accvgpr_read_b32 v237, a191
  v_mul_f32 v238, v238, v235
  v_mul_f32 v239, v239, v235
  v_mul_f32 v236, v236, v235
  v_mul_f32 v237, v237, v235
  v_accvgpr_write_b32 a188, v238
  v_accvgpr_write_b32 a189, v239
  v_accvgpr_write_b32 a190, v236
  v_accvgpr_write_b32 a191, v237
  v_accvgpr_read_b32 v238, a192
  v_accvgpr_read_b32 v239, a193
  v_accvgpr_read_b32 v236, a194
  v_accvgpr_read_b32 v237, a195
  v_mul_f32 v238, v238, v234
  v_mul_f32 v239, v239, v234
  v_mul_f32 v236, v236, v234
  v_mul_f32 v237, v237, v234
  v_accvgpr_write_b32 a192, v238
  v_accvgpr_write_b32 a193, v239
  v_accvgpr_write_b32 a194, v236
  v_accvgpr_write_b32 a195, v237
  v_accvgpr_read_b32 v238, a196
  v_accvgpr_read_b32 v239, a197
  v_accvgpr_read_b32 v236, a198
  v_accvgpr_read_b32 v237, a199
  v_mul_f32 v238, v238, v234
  v_mul_f32 v239, v239, v234
  v_mul_f32 v236, v236, v234
  v_mul_f32 v237, v237, v234
  v_accvgpr_write_b32 a196, v238
  v_accvgpr_write_b32 a197, v239
  v_accvgpr_write_b32 a198, v236
  v_accvgpr_write_b32 a199, v237
  v_accvgpr_read_b32 v238, a200
  v_accvgpr_read_b32 v239, a201
  v_accvgpr_read_b32 v236, a202
  v_accvgpr_read_b32 v237, a203
  v_mul_f32 v238, v238, v234
  v_mul_f32 v239, v239, v234
  v_mul_f32 v236, v236, v234
  v_mul_f32 v237, v237, v234
  v_accvgpr_write_b32 a200, v238
  v_accvgpr_write_b32 a201, v239
  v_accvgpr_write_b32 a202, v236
  v_accvgpr_write_b32 a203, v237
  v_accvgpr_read_b32 v238, a204
  v_accvgpr_read_b32 v239, a205
  v_accvgpr_read_b32 v236, a206
  v_accvgpr_read_b32 v237, a207
  v_mul_f32 v238, v238, v234
  v_mul_f32 v239, v239, v234
  v_mul_f32 v236, v236, v234
  v_mul_f32 v237, v237, v234
  v_accvgpr_write_b32 a204, v238
  v_accvgpr_write_b32 a205, v239
  v_accvgpr_write_b32 a206, v236
  v_accvgpr_write_b32 a207, v237
  v_accvgpr_read_b32 v238, a208
  v_accvgpr_read_b32 v239, a209
  v_accvgpr_read_b32 v236, a210
  v_accvgpr_read_b32 v237, a211
  v_mul_f32 v238, v238, v235
  v_mul_f32 v239, v239, v235
  v_mul_f32 v236, v236, v235
  v_mul_f32 v237, v237, v235
  v_accvgpr_write_b32 a208, v238
  v_accvgpr_write_b32 a209, v239
  v_accvgpr_write_b32 a210, v236
  v_accvgpr_write_b32 a211, v237
  v_accvgpr_read_b32 v238, a212
  v_accvgpr_read_b32 v239, a213
  v_accvgpr_read_b32 v236, a214
  v_accvgpr_read_b32 v237, a215
  v_mul_f32 v238, v238, v235
  v_mul_f32 v239, v239, v235
  v_mul_f32 v236, v236, v235
  v_mul_f32 v237, v237, v235
  v_accvgpr_write_b32 a212, v238
  v_accvgpr_write_b32 a213, v239
  v_accvgpr_write_b32 a214, v236
  v_accvgpr_write_b32 a215, v237
  v_accvgpr_read_b32 v238, a216
  v_accvgpr_read_b32 v239, a217
  v_accvgpr_read_b32 v236, a218
  v_accvgpr_read_b32 v237, a219
  v_mul_f32 v238, v238, v235
  v_mul_f32 v239, v239, v235
  v_mul_f32 v236, v236, v235
  v_mul_f32 v237, v237, v235
  v_accvgpr_write_b32 a216, v238
  v_accvgpr_write_b32 a217, v239
  v_accvgpr_write_b32 a218, v236
  v_accvgpr_write_b32 a219, v237
  v_accvgpr_read_b32 v238, a220
  v_accvgpr_read_b32 v239, a221
  v_accvgpr_read_b32 v236, a222
  v_accvgpr_read_b32 v237, a223
  v_mul_f32 v238, v238, v235
  v_mul_f32 v239, v239, v235
  v_mul_f32 v236, v236, v235
  v_mul_f32 v237, v237, v235
  v_accvgpr_write_b32 a220, v238
  v_accvgpr_write_b32 a221, v239
  v_accvgpr_write_b32 a222, v236
  v_accvgpr_write_b32 a223, v237
  v_accvgpr_read_b32 v238, a224
  v_accvgpr_read_b32 v239, a225
  v_accvgpr_read_b32 v236, a226
  v_accvgpr_read_b32 v237, a227
  v_mul_f32 v238, v238, v234
  v_mul_f32 v239, v239, v234
  v_mul_f32 v236, v236, v234
  v_mul_f32 v237, v237, v234
  v_accvgpr_write_b32 a224, v238
  v_accvgpr_write_b32 a225, v239
  v_accvgpr_write_b32 a226, v236
  v_accvgpr_write_b32 a227, v237
  v_accvgpr_read_b32 v238, a228
  v_accvgpr_read_b32 v239, a229
  v_accvgpr_read_b32 v236, a230
  v_accvgpr_read_b32 v237, a231
  v_mul_f32 v238, v238, v234
  v_mul_f32 v239, v239, v234
  v_mul_f32 v236, v236, v234
  v_mul_f32 v237, v237, v234
  v_accvgpr_write_b32 a228, v238
  v_accvgpr_write_b32 a229, v239
  v_accvgpr_write_b32 a230, v236
  v_accvgpr_write_b32 a231, v237
  v_accvgpr_read_b32 v238, a232
  v_accvgpr_read_b32 v239, a233
  v_accvgpr_read_b32 v236, a234
  v_accvgpr_read_b32 v237, a235
  v_mul_f32 v238, v238, v234
  v_mul_f32 v239, v239, v234
  v_mul_f32 v236, v236, v234
  v_mul_f32 v237, v237, v234
  v_accvgpr_write_b32 a232, v238
  v_accvgpr_write_b32 a233, v239
  v_accvgpr_write_b32 a234, v236
  v_accvgpr_write_b32 a235, v237
  v_accvgpr_read_b32 v238, a236
  v_accvgpr_read_b32 v239, a237
  v_accvgpr_read_b32 v236, a238
  v_accvgpr_read_b32 v237, a239
  v_mul_f32 v238, v238, v234
  v_mul_f32 v239, v239, v234
  v_mul_f32 v236, v236, v234
  v_mul_f32 v237, v237, v234
  v_accvgpr_write_b32 a236, v238
  v_accvgpr_write_b32 a237, v239
  v_accvgpr_write_b32 a238, v236
  v_accvgpr_write_b32 a239, v237
  v_accvgpr_read_b32 v238, a240
  v_accvgpr_read_b32 v239, a241
  v_accvgpr_read_b32 v236, a242
  v_accvgpr_read_b32 v237, a243
  v_mul_f32 v238, v238, v235
  v_mul_f32 v239, v239, v235
  v_mul_f32 v236, v236, v235
  v_mul_f32 v237, v237, v235
  v_accvgpr_write_b32 a240, v238
  v_accvgpr_write_b32 a241, v239
  v_accvgpr_write_b32 a242, v236
  v_accvgpr_write_b32 a243, v237
  v_accvgpr_read_b32 v238, a244
  v_accvgpr_read_b32 v239, a245
  v_accvgpr_read_b32 v236, a246
  v_accvgpr_read_b32 v237, a247
  v_mul_f32 v238, v238, v235
  v_mul_f32 v239, v239, v235
  v_mul_f32 v236, v236, v235
  v_mul_f32 v237, v237, v235
  v_accvgpr_write_b32 a244, v238
  v_accvgpr_write_b32 a245, v239
  v_accvgpr_write_b32 a246, v236
  v_accvgpr_write_b32 a247, v237
  v_accvgpr_read_b32 v238, a248
  v_accvgpr_read_b32 v239, a249
  v_accvgpr_read_b32 v236, a250
  v_accvgpr_read_b32 v237, a251
  v_mul_f32 v238, v238, v235
  v_mul_f32 v239, v239, v235
  v_mul_f32 v236, v236, v235
  v_mul_f32 v237, v237, v235
  v_accvgpr_write_b32 a248, v238
  v_accvgpr_write_b32 a249, v239
  v_accvgpr_write_b32 a250, v236
  v_accvgpr_write_b32 a251, v237
  v_accvgpr_read_b32 v238, a252
  v_accvgpr_read_b32 v239, a253
  v_accvgpr_read_b32 v236, a254
  v_accvgpr_read_b32 v237, a255
  v_mul_f32 v238, v238, v235
  v_mul_f32 v239, v239, v235
  v_mul_f32 v236, v236, v235
  v_mul_f32 v237, v237, v235
  v_accvgpr_write_b32 a252, v238
  v_accvgpr_write_b32 a253, v239
  v_accvgpr_write_b32 a254, v236
  v_accvgpr_write_b32 a255, v237
  s_mov_b32 s56, 0
  s_nop 3
  s_setpc_b64 s[58:59]
.globl reduce_out_kernel
.p2align 8
.type reduce_out_kernel,@function
reduce_out_kernel:
  s_cmp_ge_u32 s2, 224
  s_cbranch_scc1 L2_end
  s_load_dwordx2 s[4:5], s[0:1], 80
  s_load_dwordx2 s[6:7], s[0:1], 96
  s_mul_i32 s10, s2, 9363
  s_lshr_b32 s10, s10, 16
  s_mul_i32 s11, s10, 7
  s_sub_u32 s11, s2, s11
  s_mul_i32 s11, s11, 4
  v_and_b32 v1, 63, v0
  v_lshrrev_b32 v2, 6, v0
  v_mul_u32_u24 v3, 28672, v2
  v_lshl_add_u32 v3, v1, 4, v3
  s_lshl_b32 s12, s11, 10
  v_add_u32 v3, s12, v3
  s_and_b32 s13, s10, 15
  s_lshr_b32 s14, s10, 4
  s_mul_i32 s13, s13, 229376
  s_mul_i32 s14, s14, 896
  s_add_u32 s13, s13, s14
  s_lshl_b32 s14, s11, 5
  s_add_u32 s13, s13, s14
  v_and_b32 v4, 31, v1
  v_lshl_add_u32 v4, v2, 5, v4
  v_mul_u32_u24 v4, 1792, v4
  v_lshrrev_b32 v1, 5, v1
  v_lshl_add_u32 v4, v1, 4, v4
  v_add_u32 v4, s13, v4
  s_waitcnt lgkmcnt(0)
  s_mov_b32 s16, s4
  s_mov_b32 s17, s5
  s_mov_b32 s18, 3670016
  s_mov_b32 s19, 0x00020000
  s_mul_i32 s14, s10, 917504
  s_add_u32 s20, s6, s14
  s_addc_u32 s21, s7, 0
  s_mov_b32 s22, 917504
  s_mov_b32 s23, 0x00020000
  s_mov_b32 s32, 0xffff0000
  s_mov_b32 s24, 0
  s_mov_b32 s25, 114688
  s_mov_b32 s26, 229376
  s_mov_b32 s27, 344064
  s_mov_b32 s28, 458752
  s_mov_b32 s29, 573440
  s_mov_b32 s30, 688128
  s_mov_b32 s31, 802816
  buffer_load_dwordx4 v[32:35], v3, s[20:23], s24 offen
  buffer_load_dwordx4 v[36:39], v3, s[20:23], s25 offen
  buffer_load_dwordx4 v[40:43], v3, s[20:23], s26 offen
  buffer_load_dwordx4 v[44:47], v3, s[20:23], s27 offen
  buffer_load_dwordx4 v[48:51], v3, s[20:23], s28 offen
  buffer_load_dwordx4 v[52:55], v3, s[20:23], s29 offen
  buffer_load_dwordx4 v[56:59], v3, s[20:23], s30 offen
  buffer_load_dwordx4 v[60:63], v3, s[20:23], s31 offen
  buffer_load_dwordx4 v[64:67], v3, s[20:23], s24 offen offset:1024
  buffer_load_dwordx4 v[68:71], v3, s[20:23], s25 offen offset:1024
  buffer_load_dwordx4 v[72:75], v3, s[20:23], s26 offen offset:1024
  buffer_load_dwordx4 v[76:79], v3, s[20:23], s27 offen offset:1024
  buffer_load_dwordx4 v[80:83], v3, s[20:23], s28 offen offset:1024
  buffer_load_dwordx4 v[84:87], v3, s[20:23], s29 offen offset:1024
  buffer_load_dwordx4 v[88:91], v3, s[20:23], s30 offen offset:1024
  buffer_load_dwordx4 v[92:95], v3, s[20:23], s31 offen offset:1024
  buffer_load_dwordx4 v[96:99], v3, s[20:23], s24 offen offset:2048
  buffer_load_dwordx4 v[100:103], v3, s[20:23], s25 offen offset:2048
  buffer_load_dwordx4 v[104:107], v3, s[20:23], s26 offen offset:2048
  buffer_load_dwordx4 v[108:111], v3, s[20:23], s27 offen offset:2048
  buffer_load_dwordx4 v[112:115], v3, s[20:23], s28 offen offset:2048
  buffer_load_dwordx4 v[116:119], v3, s[20:23], s29 offen offset:2048
  buffer_load_dwordx4 v[120:123], v3, s[20:23], s30 offen offset:2048
  buffer_load_dwordx4 v[124:127], v3, s[20:23], s31 offen offset:2048
  buffer_load_dwordx4 v[128:131], v3, s[20:23], s24 offen offset:3072
  buffer_load_dwordx4 v[132:135], v3, s[20:23], s25 offen offset:3072
  buffer_load_dwordx4 v[136:139], v3, s[20:23], s26 offen offset:3072
  buffer_load_dwordx4 v[140:143], v3, s[20:23], s27 offen offset:3072
  buffer_load_dwordx4 v[144:147], v3, s[20:23], s28 offen offset:3072
  buffer_load_dwordx4 v[148:151], v3, s[20:23], s29 offen offset:3072
  buffer_load_dwordx4 v[152:155], v3, s[20:23], s30 offen offset:3072
  buffer_load_dwordx4 v[156:159], v3, s[20:23], s31 offen offset:3072
  s_waitcnt vmcnt(31)
  v_lshlrev_b32 v8, 16, v32
  v_and_b32 v9, s32, v32
  v_lshlrev_b32 v10, 16, v33
  v_and_b32 v11, s32, v33
  v_lshlrev_b32 v12, 16, v34
  v_and_b32 v13, s32, v34
  v_lshlrev_b32 v14, 16, v35
  v_and_b32 v15, s32, v35
  s_waitcnt vmcnt(30)
  v_lshlrev_b32 v16, 16, v36
  v_and_b32 v17, s32, v36
  v_lshlrev_b32 v18, 16, v37
  v_and_b32 v19, s32, v37
  v_lshlrev_b32 v20, 16, v38
  v_and_b32 v21, s32, v38
  v_lshlrev_b32 v22, 16, v39
  v_and_b32 v23, s32, v39
  v_add_f32 v8, v8, v16
  v_add_f32 v9, v9, v17
  v_add_f32 v10, v10, v18
  v_add_f32 v11, v11, v19
  v_add_f32 v12, v12, v20
  v_add_f32 v13, v13, v21
  v_add_f32 v14, v14, v22
  v_add_f32 v15, v15, v23
  s_waitcnt vmcnt(29)
  v_lshlrev_b32 v16, 16, v40
  v_and_b32 v17, s32, v40
  v_lshlrev_b32 v18, 16, v41
  v_and_b32 v19, s32, v41
  v_lshlrev_b32 v20, 16, v42
  v_and_b32 v21, s32, v42
  v_lshlrev_b32 v22, 16, v43
  v_and_b32 v23, s32, v43
  v_add_f32 v8, v8, v16
  v_add_f32 v9, v9, v17
  v_add_f32 v10, v10, v18
  v_add_f32 v11, v11, v19
  v_add_f32 v12, v12, v20
  v_add_f32 v13, v13, v21
  v_add_f32 v14, v14, v22
  v_add_f32 v15, v15, v23
  s_waitcnt vmcnt(28)
  v_lshlrev_b32 v16, 16, v44
  v_and_b32 v17, s32, v44
  v_lshlrev_b32 v18, 16, v45
  v_and_b32 v19, s32, v45
  v_lshlrev_b32 v20, 16, v46
  v_and_b32 v21, s32, v46
  v_lshlrev_b32 v22, 16, v47
  v_and_b32 v23, s32, v47
  v_add_f32 v8, v8, v16
  v_add_f32 v9, v9, v17
  v_add_f32 v10, v10, v18
  v_add_f32 v11, v11, v19
  v_add_f32 v12, v12, v20
  v_add_f32 v13, v13, v21
  v_add_f32 v14, v14, v22
  v_add_f32 v15, v15, v23
  s_waitcnt vmcnt(27)
  v_lshlrev_b32 v16, 16, v48
  v_and_b32 v17, s32, v48
  v_lshlrev_b32 v18, 16, v49
  v_and_b32 v19, s32, v49
  v_lshlrev_b32 v20, 16, v50
  v_and_b32 v21, s32, v50
  v_lshlrev_b32 v22, 16, v51
  v_and_b32 v23, s32, v51
  v_add_f32 v8, v8, v16
  v_add_f32 v9, v9, v17
  v_add_f32 v10, v10, v18
  v_add_f32 v11, v11, v19
  v_add_f32 v12, v12, v20
  v_add_f32 v13, v13, v21
  v_add_f32 v14, v14, v22
  v_add_f32 v15, v15, v23
  s_waitcnt vmcnt(26)
  v_lshlrev_b32 v16, 16, v52
  v_and_b32 v17, s32, v52
  v_lshlrev_b32 v18, 16, v53
  v_and_b32 v19, s32, v53
  v_lshlrev_b32 v20, 16, v54
  v_and_b32 v21, s32, v54
  v_lshlrev_b32 v22, 16, v55
  v_and_b32 v23, s32, v55
  v_add_f32 v8, v8, v16
  v_add_f32 v9, v9, v17
  v_add_f32 v10, v10, v18
  v_add_f32 v11, v11, v19
  v_add_f32 v12, v12, v20
  v_add_f32 v13, v13, v21
  v_add_f32 v14, v14, v22
  v_add_f32 v15, v15, v23
  s_waitcnt vmcnt(25)
  v_lshlrev_b32 v16, 16, v56
  v_and_b32 v17, s32, v56
  v_lshlrev_b32 v18, 16, v57
  v_and_b32 v19, s32, v57
  v_lshlrev_b32 v20, 16, v58
  v_and_b32 v21, s32, v58
  v_lshlrev_b32 v22, 16, v59
  v_and_b32 v23, s32, v59
  v_add_f32 v8, v8, v16
  v_add_f32 v9, v9, v17
  v_add_f32 v10, v10, v18
  v_add_f32 v11, v11, v19
  v_add_f32 v12, v12, v20
  v_add_f32 v13, v13, v21
  v_add_f32 v14, v14, v22
  v_add_f32 v15, v15, v23
  s_waitcnt vmcnt(24)
  v_lshlrev_b32 v16, 16, v60
  v_and_b32 v17, s32, v60
  v_lshlrev_b32 v18, 16, v61
  v_and_b32 v19, s32, v61
  v_lshlrev_b32 v20, 16, v62
  v_and_b32 v21, s32, v62
  v_lshlrev_b32 v22, 16, v63
  v_and_b32 v23, s32, v63
  v_add_f32 v8, v8, v16
  v_add_f32 v9, v9, v17
  v_add_f32 v10, v10, v18
  v_add_f32 v11, v11, v19
  v_add_f32 v12, v12, v20
  v_add_f32 v13, v13, v21
  v_add_f32 v14, v14, v22
  v_add_f32 v15, v15, v23
  v_cvt_pk_bf16_f32 v24, v8, v9
  v_cvt_pk_bf16_f32 v25, v10, v11
  v_cvt_pk_bf16_f32 v26, v12, v13
  v_cvt_pk_bf16_f32 v27, v14, v15
  buffer_store_dwordx4 v[24:27], v4, s[16:19], 0 offen
  s_waitcnt vmcnt(24)
  v_lshlrev_b32 v8, 16, v64
  v_and_b32 v9, s32, v64
  v_lshlrev_b32 v10, 16, v65
  v_and_b32 v11, s32, v65
  v_lshlrev_b32 v12, 16, v66
  v_and_b32 v13, s32, v66
  v_lshlrev_b32 v14, 16, v67
  v_and_b32 v15, s32, v67
  s_waitcnt vmcnt(23)
  v_lshlrev_b32 v16, 16, v68
  v_and_b32 v17, s32, v68
  v_lshlrev_b32 v18, 16, v69
  v_and_b32 v19, s32, v69
  v_lshlrev_b32 v20, 16, v70
  v_and_b32 v21, s32, v70
  v_lshlrev_b32 v22, 16, v71
  v_and_b32 v23, s32, v71
  v_add_f32 v8, v8, v16
  v_add_f32 v9, v9, v17
  v_add_f32 v10, v10, v18
  v_add_f32 v11, v11, v19
  v_add_f32 v12, v12, v20
  v_add_f32 v13, v13, v21
  v_add_f32 v14, v14, v22
  v_add_f32 v15, v15, v23
  s_waitcnt vmcnt(22)
  v_lshlrev_b32 v16, 16, v72
  v_and_b32 v17, s32, v72
  v_lshlrev_b32 v18, 16, v73
  v_and_b32 v19, s32, v73
  v_lshlrev_b32 v20, 16, v74
  v_and_b32 v21, s32, v74
  v_lshlrev_b32 v22, 16, v75
  v_and_b32 v23, s32, v75
  v_add_f32 v8, v8, v16
  v_add_f32 v9, v9, v17
  v_add_f32 v10, v10, v18
  v_add_f32 v11, v11, v19
  v_add_f32 v12, v12, v20
  v_add_f32 v13, v13, v21
  v_add_f32 v14, v14, v22
  v_add_f32 v15, v15, v23
  s_waitcnt vmcnt(21)
  v_lshlrev_b32 v16, 16, v76
  v_and_b32 v17, s32, v76
  v_lshlrev_b32 v18, 16, v77
  v_and_b32 v19, s32, v77
  v_lshlrev_b32 v20, 16, v78
  v_and_b32 v21, s32, v78
  v_lshlrev_b32 v22, 16, v79
  v_and_b32 v23, s32, v79
  v_add_f32 v8, v8, v16
  v_add_f32 v9, v9, v17
  v_add_f32 v10, v10, v18
  v_add_f32 v11, v11, v19
  v_add_f32 v12, v12, v20
  v_add_f32 v13, v13, v21
  v_add_f32 v14, v14, v22
  v_add_f32 v15, v15, v23
  s_waitcnt vmcnt(20)
  v_lshlrev_b32 v16, 16, v80
  v_and_b32 v17, s32, v80
  v_lshlrev_b32 v18, 16, v81
  v_and_b32 v19, s32, v81
  v_lshlrev_b32 v20, 16, v82
  v_and_b32 v21, s32, v82
  v_lshlrev_b32 v22, 16, v83
  v_and_b32 v23, s32, v83
  v_add_f32 v8, v8, v16
  v_add_f32 v9, v9, v17
  v_add_f32 v10, v10, v18
  v_add_f32 v11, v11, v19
  v_add_f32 v12, v12, v20
  v_add_f32 v13, v13, v21
  v_add_f32 v14, v14, v22
  v_add_f32 v15, v15, v23
  s_waitcnt vmcnt(19)
  v_lshlrev_b32 v16, 16, v84
  v_and_b32 v17, s32, v84
  v_lshlrev_b32 v18, 16, v85
  v_and_b32 v19, s32, v85
  v_lshlrev_b32 v20, 16, v86
  v_and_b32 v21, s32, v86
  v_lshlrev_b32 v22, 16, v87
  v_and_b32 v23, s32, v87
  v_add_f32 v8, v8, v16
  v_add_f32 v9, v9, v17
  v_add_f32 v10, v10, v18
  v_add_f32 v11, v11, v19
  v_add_f32 v12, v12, v20
  v_add_f32 v13, v13, v21
  v_add_f32 v14, v14, v22
  v_add_f32 v15, v15, v23
  s_waitcnt vmcnt(18)
  v_lshlrev_b32 v16, 16, v88
  v_and_b32 v17, s32, v88
  v_lshlrev_b32 v18, 16, v89
  v_and_b32 v19, s32, v89
  v_lshlrev_b32 v20, 16, v90
  v_and_b32 v21, s32, v90
  v_lshlrev_b32 v22, 16, v91
  v_and_b32 v23, s32, v91
  v_add_f32 v8, v8, v16
  v_add_f32 v9, v9, v17
  v_add_f32 v10, v10, v18
  v_add_f32 v11, v11, v19
  v_add_f32 v12, v12, v20
  v_add_f32 v13, v13, v21
  v_add_f32 v14, v14, v22
  v_add_f32 v15, v15, v23
  s_waitcnt vmcnt(17)
  v_lshlrev_b32 v16, 16, v92
  v_and_b32 v17, s32, v92
  v_lshlrev_b32 v18, 16, v93
  v_and_b32 v19, s32, v93
  v_lshlrev_b32 v20, 16, v94
  v_and_b32 v21, s32, v94
  v_lshlrev_b32 v22, 16, v95
  v_and_b32 v23, s32, v95
  v_add_f32 v8, v8, v16
  v_add_f32 v9, v9, v17
  v_add_f32 v10, v10, v18
  v_add_f32 v11, v11, v19
  v_add_f32 v12, v12, v20
  v_add_f32 v13, v13, v21
  v_add_f32 v14, v14, v22
  v_add_f32 v15, v15, v23
  v_cvt_pk_bf16_f32 v28, v8, v9
  v_cvt_pk_bf16_f32 v29, v10, v11
  v_cvt_pk_bf16_f32 v30, v12, v13
  v_cvt_pk_bf16_f32 v31, v14, v15
  buffer_store_dwordx4 v[28:31], v4, s[16:19], 0 offen offset:32
  s_waitcnt vmcnt(17)
  v_lshlrev_b32 v8, 16, v96
  v_and_b32 v9, s32, v96
  v_lshlrev_b32 v10, 16, v97
  v_and_b32 v11, s32, v97
  v_lshlrev_b32 v12, 16, v98
  v_and_b32 v13, s32, v98
  v_lshlrev_b32 v14, 16, v99
  v_and_b32 v15, s32, v99
  s_waitcnt vmcnt(16)
  v_lshlrev_b32 v16, 16, v100
  v_and_b32 v17, s32, v100
  v_lshlrev_b32 v18, 16, v101
  v_and_b32 v19, s32, v101
  v_lshlrev_b32 v20, 16, v102
  v_and_b32 v21, s32, v102
  v_lshlrev_b32 v22, 16, v103
  v_and_b32 v23, s32, v103
  v_add_f32 v8, v8, v16
  v_add_f32 v9, v9, v17
  v_add_f32 v10, v10, v18
  v_add_f32 v11, v11, v19
  v_add_f32 v12, v12, v20
  v_add_f32 v13, v13, v21
  v_add_f32 v14, v14, v22
  v_add_f32 v15, v15, v23
  s_waitcnt vmcnt(15)
  v_lshlrev_b32 v16, 16, v104
  v_and_b32 v17, s32, v104
  v_lshlrev_b32 v18, 16, v105
  v_and_b32 v19, s32, v105
  v_lshlrev_b32 v20, 16, v106
  v_and_b32 v21, s32, v106
  v_lshlrev_b32 v22, 16, v107
  v_and_b32 v23, s32, v107
  v_add_f32 v8, v8, v16
  v_add_f32 v9, v9, v17
  v_add_f32 v10, v10, v18
  v_add_f32 v11, v11, v19
  v_add_f32 v12, v12, v20
  v_add_f32 v13, v13, v21
  v_add_f32 v14, v14, v22
  v_add_f32 v15, v15, v23
  s_waitcnt vmcnt(14)
  v_lshlrev_b32 v16, 16, v108
  v_and_b32 v17, s32, v108
  v_lshlrev_b32 v18, 16, v109
  v_and_b32 v19, s32, v109
  v_lshlrev_b32 v20, 16, v110
  v_and_b32 v21, s32, v110
  v_lshlrev_b32 v22, 16, v111
  v_and_b32 v23, s32, v111
  v_add_f32 v8, v8, v16
  v_add_f32 v9, v9, v17
  v_add_f32 v10, v10, v18
  v_add_f32 v11, v11, v19
  v_add_f32 v12, v12, v20
  v_add_f32 v13, v13, v21
  v_add_f32 v14, v14, v22
  v_add_f32 v15, v15, v23
  s_waitcnt vmcnt(13)
  v_lshlrev_b32 v16, 16, v112
  v_and_b32 v17, s32, v112
  v_lshlrev_b32 v18, 16, v113
  v_and_b32 v19, s32, v113
  v_lshlrev_b32 v20, 16, v114
  v_and_b32 v21, s32, v114
  v_lshlrev_b32 v22, 16, v115
  v_and_b32 v23, s32, v115
  v_add_f32 v8, v8, v16
  v_add_f32 v9, v9, v17
  v_add_f32 v10, v10, v18
  v_add_f32 v11, v11, v19
  v_add_f32 v12, v12, v20
  v_add_f32 v13, v13, v21
  v_add_f32 v14, v14, v22
  v_add_f32 v15, v15, v23
  s_waitcnt vmcnt(12)
  v_lshlrev_b32 v16, 16, v116
  v_and_b32 v17, s32, v116
  v_lshlrev_b32 v18, 16, v117
  v_and_b32 v19, s32, v117
  v_lshlrev_b32 v20, 16, v118
  v_and_b32 v21, s32, v118
  v_lshlrev_b32 v22, 16, v119
  v_and_b32 v23, s32, v119
  v_add_f32 v8, v8, v16
  v_add_f32 v9, v9, v17
  v_add_f32 v10, v10, v18
  v_add_f32 v11, v11, v19
  v_add_f32 v12, v12, v20
  v_add_f32 v13, v13, v21
  v_add_f32 v14, v14, v22
  v_add_f32 v15, v15, v23
  s_waitcnt vmcnt(11)
  v_lshlrev_b32 v16, 16, v120
  v_and_b32 v17, s32, v120
  v_lshlrev_b32 v18, 16, v121
  v_and_b32 v19, s32, v121
  v_lshlrev_b32 v20, 16, v122
  v_and_b32 v21, s32, v122
  v_lshlrev_b32 v22, 16, v123
  v_and_b32 v23, s32, v123
  v_add_f32 v8, v8, v16
  v_add_f32 v9, v9, v17
  v_add_f32 v10, v10, v18
  v_add_f32 v11, v11, v19
  v_add_f32 v12, v12, v20
  v_add_f32 v13, v13, v21
  v_add_f32 v14, v14, v22
  v_add_f32 v15, v15, v23
  s_waitcnt vmcnt(10)
  v_lshlrev_b32 v16, 16, v124
  v_and_b32 v17, s32, v124
  v_lshlrev_b32 v18, 16, v125
  v_and_b32 v19, s32, v125
  v_lshlrev_b32 v20, 16, v126
  v_and_b32 v21, s32, v126
  v_lshlrev_b32 v22, 16, v127
  v_and_b32 v23, s32, v127
  v_add_f32 v8, v8, v16
  v_add_f32 v9, v9, v17
  v_add_f32 v10, v10, v18
  v_add_f32 v11, v11, v19
  v_add_f32 v12, v12, v20
  v_add_f32 v13, v13, v21
  v_add_f32 v14, v14, v22
  v_add_f32 v15, v15, v23
  v_cvt_pk_bf16_f32 v24, v8, v9
  v_cvt_pk_bf16_f32 v25, v10, v11
  v_cvt_pk_bf16_f32 v26, v12, v13
  v_cvt_pk_bf16_f32 v27, v14, v15
  buffer_store_dwordx4 v[24:27], v4, s[16:19], 0 offen offset:64
  s_waitcnt vmcnt(10)
  v_lshlrev_b32 v8, 16, v128
  v_and_b32 v9, s32, v128
  v_lshlrev_b32 v10, 16, v129
  v_and_b32 v11, s32, v129
  v_lshlrev_b32 v12, 16, v130
  v_and_b32 v13, s32, v130
  v_lshlrev_b32 v14, 16, v131
  v_and_b32 v15, s32, v131
  s_waitcnt vmcnt(9)
  v_lshlrev_b32 v16, 16, v132
  v_and_b32 v17, s32, v132
  v_lshlrev_b32 v18, 16, v133
  v_and_b32 v19, s32, v133
  v_lshlrev_b32 v20, 16, v134
  v_and_b32 v21, s32, v134
  v_lshlrev_b32 v22, 16, v135
  v_and_b32 v23, s32, v135
  v_add_f32 v8, v8, v16
  v_add_f32 v9, v9, v17
  v_add_f32 v10, v10, v18
  v_add_f32 v11, v11, v19
  v_add_f32 v12, v12, v20
  v_add_f32 v13, v13, v21
  v_add_f32 v14, v14, v22
  v_add_f32 v15, v15, v23
  s_waitcnt vmcnt(8)
  v_lshlrev_b32 v16, 16, v136
  v_and_b32 v17, s32, v136
  v_lshlrev_b32 v18, 16, v137
  v_and_b32 v19, s32, v137
  v_lshlrev_b32 v20, 16, v138
  v_and_b32 v21, s32, v138
  v_lshlrev_b32 v22, 16, v139
  v_and_b32 v23, s32, v139
  v_add_f32 v8, v8, v16
  v_add_f32 v9, v9, v17
  v_add_f32 v10, v10, v18
  v_add_f32 v11, v11, v19
  v_add_f32 v12, v12, v20
  v_add_f32 v13, v13, v21
  v_add_f32 v14, v14, v22
  v_add_f32 v15, v15, v23
  s_waitcnt vmcnt(7)
  v_lshlrev_b32 v16, 16, v140
  v_and_b32 v17, s32, v140
  v_lshlrev_b32 v18, 16, v141
  v_and_b32 v19, s32, v141
  v_lshlrev_b32 v20, 16, v142
  v_and_b32 v21, s32, v142
  v_lshlrev_b32 v22, 16, v143
  v_and_b32 v23, s32, v143
  v_add_f32 v8, v8, v16
  v_add_f32 v9, v9, v17
  v_add_f32 v10, v10, v18
  v_add_f32 v11, v11, v19
  v_add_f32 v12, v12, v20
  v_add_f32 v13, v13, v21
  v_add_f32 v14, v14, v22
  v_add_f32 v15, v15, v23
  s_waitcnt vmcnt(6)
  v_lshlrev_b32 v16, 16, v144
  v_and_b32 v17, s32, v144
  v_lshlrev_b32 v18, 16, v145
  v_and_b32 v19, s32, v145
  v_lshlrev_b32 v20, 16, v146
  v_and_b32 v21, s32, v146
  v_lshlrev_b32 v22, 16, v147
  v_and_b32 v23, s32, v147
  v_add_f32 v8, v8, v16
  v_add_f32 v9, v9, v17
  v_add_f32 v10, v10, v18
  v_add_f32 v11, v11, v19
  v_add_f32 v12, v12, v20
  v_add_f32 v13, v13, v21
  v_add_f32 v14, v14, v22
  v_add_f32 v15, v15, v23
  s_waitcnt vmcnt(5)
  v_lshlrev_b32 v16, 16, v148
  v_and_b32 v17, s32, v148
  v_lshlrev_b32 v18, 16, v149
  v_and_b32 v19, s32, v149
  v_lshlrev_b32 v20, 16, v150
  v_and_b32 v21, s32, v150
  v_lshlrev_b32 v22, 16, v151
  v_and_b32 v23, s32, v151
  v_add_f32 v8, v8, v16
  v_add_f32 v9, v9, v17
  v_add_f32 v10, v10, v18
  v_add_f32 v11, v11, v19
  v_add_f32 v12, v12, v20
  v_add_f32 v13, v13, v21
  v_add_f32 v14, v14, v22
  v_add_f32 v15, v15, v23
  s_waitcnt vmcnt(4)
  v_lshlrev_b32 v16, 16, v152
  v_and_b32 v17, s32, v152
  v_lshlrev_b32 v18, 16, v153
  v_and_b32 v19, s32, v153
  v_lshlrev_b32 v20, 16, v154
  v_and_b32 v21, s32, v154
  v_lshlrev_b32 v22, 16, v155
  v_and_b32 v23, s32, v155
  v_add_f32 v8, v8, v16
  v_add_f32 v9, v9, v17
  v_add_f32 v10, v10, v18
  v_add_f32 v11, v11, v19
  v_add_f32 v12, v12, v20
  v_add_f32 v13, v13, v21
  v_add_f32 v14, v14, v22
  v_add_f32 v15, v15, v23
  s_waitcnt vmcnt(3)
  v_lshlrev_b32 v16, 16, v156
  v_and_b32 v17, s32, v156
  v_lshlrev_b32 v18, 16, v157
  v_and_b32 v19, s32, v157
  v_lshlrev_b32 v20, 16, v158
  v_and_b32 v21, s32, v158
  v_lshlrev_b32 v22, 16, v159
  v_and_b32 v23, s32, v159
  v_add_f32 v8, v8, v16
  v_add_f32 v9, v9, v17
  v_add_f32 v10, v10, v18
  v_add_f32 v11, v11, v19
  v_add_f32 v12, v12, v20
  v_add_f32 v13, v13, v21
  v_add_f32 v14, v14, v22
  v_add_f32 v15, v15, v23
  v_cvt_pk_bf16_f32 v28, v8, v9
  v_cvt_pk_bf16_f32 v29, v10, v11
  v_cvt_pk_bf16_f32 v30, v12, v13
  v_cvt_pk_bf16_f32 v31, v14, v15
  buffer_store_dwordx4 v[28:31], v4, s[16:19], 0 offen offset:96
L2_end:
  s_endpgm
L_text_end:
.section .rodata,"a"
.p2align 6
.amdhsa_kernel concat_heads__gqa_block_cached__gqa_block_cached__near_ridge_kernel
  .amdhsa_next_free_vgpr 512
  .amdhsa_next_free_sgpr 102
  .amdhsa_accum_offset 256
  .amdhsa_group_segment_fixed_size 0
  .amdhsa_kernarg_size 104
  .amdhsa_user_sgpr_count 2
  .amdhsa_user_sgpr_kernarg_segment_ptr 1
  .amdhsa_system_sgpr_workgroup_id_x 1
.end_amdhsa_kernel
.p2align 6
.amdhsa_kernel reduce_out_kernel
  .amdhsa_next_free_vgpr 160
  .amdhsa_next_free_sgpr 40
  .amdhsa_accum_offset 160
  .amdhsa_group_segment_fixed_size 0
  .amdhsa_kernarg_size 104
  .amdhsa_user_sgpr_count 2
  .amdhsa_user_sgpr_kernarg_segment_ptr 1
  .amdhsa_system_sgpr_workgroup_id_x 1
.end_amdhsa_kernel
```
